```python
import torch

def _softmax(x, axis=-1):
    return torch.softmax(x, dim=axis)
def _gelu(x):
    return torch.nn.functional.gelu(x, approximate="tanh")
def _silu(x):
    return torch.nn.functional.silu(x)
def _sigmoid(x):
    return torch.sigmoid(x)
def _layernorm(x, axis=-1, eps=1e-5):
    m = x.mean(dim=axis, keepdim=True)
    v = x.var(dim=axis, keepdim=True, unbiased=False)
    return (x - m) / torch.sqrt(v + eps)
def _scatter_add(tgt, idx, src, axis=0):
    return tgt.clone().index_add_(axis, idx, src)
def _segment_sum(src, seg, n):
    out = torch.zeros((n,) + src.shape[1:], dtype=src.dtype)
    return out.index_add_(0, seg, src)
def _pad(x, pw):
    flat = tuple(v for pair in reversed(pw) for v in pair)
    return torch.nn.functional.pad(x, flat)

kernel_name = 'recurrent_scan__gqa_block_cached__glu_gated_bilinear__prompt'

def setup_inputs():

    _w = (lambda a: (lambda t: t.to(torch.bfloat16) if t.is_floating_point() else t)(torch.as_tensor(a)))
    def _A_setup():
        B, Sq, D = 1, 2048, 448
        Hq, Hkv, Sk, Dh = 16, 8, 2048, 256
        assert Hq % Hkv == 0, (Hq, Hkv)
        return {
            "x": _w((lambda *s: torch.randn(*s, dtype=torch.bfloat16) * 0.05)(B, Sq, D)),
            "k_cache": _w((lambda *s: torch.randn(*s, dtype=torch.bfloat16) * 1.6)(B, Hkv, Sk, Dh)),
            "v_cache": _w((lambda *s: torch.randn(*s, dtype=torch.bfloat16) * 1.6)(B, Hkv, Sk, Dh)),
            "wq": _w((lambda *s: torch.randn(*s, dtype=torch.bfloat16) * 1.6)(D, Hq * Dh) * (D ** -0.5)),
            "wo": _w((lambda *s: torch.randn(*s, dtype=torch.bfloat16) * 1.6)(Hq * Dh, D) * ((Hq * Dh) ** -0.5)),
        }
    _A_in = _A_setup()

    def _B_setup():
        B, S, D, F = 1, 2048, 448, 1792
        return {
            "x": _w((lambda *s: torch.randn(*s, dtype=torch.bfloat16) * 0.05)(B, S, D)),
            "w_gate": _w((lambda *s: torch.randn(*s, dtype=torch.bfloat16) * 0.2)(D, F) * (D ** -0.5)),
            "w_up": _w((lambda *s: torch.randn(*s, dtype=torch.bfloat16) * 0.2)(D, F) * (D ** -0.5)),
            "w_down": _w((lambda *s: torch.randn(*s, dtype=torch.bfloat16) * 0.2)(F, D) * (F ** -0.5)),
        }
    _B_in = _B_setup()

    return {
        "A_x": _A_in["x"],
        "A_k_cache": _A_in["k_cache"],
        "A_v_cache": _A_in["v_cache"],
        "A_wq": _A_in["wq"],
        "A_wo": _A_in["wo"],
        "B_x": _B_in["x"],
        "B_w_gate": _B_in["w_gate"],
        "B_w_up": _B_in["w_up"],
        "B_w_down": _B_in["w_down"],
    }

def reference(A_x, A_k_cache, A_v_cache, A_wq, A_wo, B_x, B_w_gate, B_w_up, B_w_down):
    def _A_ref(x, k_cache, v_cache, wq, wo):
        B, Sq, D = x.shape
        Hq, Dh = 16, 256
        Hkv = k_cache.shape[1]
        rep = Hq // Hkv
        q = (lambda x, *d: x.permute(*d))((x @ wq).reshape(B, Sq, Hq, Dh), 0, 2, 1, 3)
        k = (lambda x, n, axis: torch.repeat_interleave(x, n, dim=axis))(k_cache, rep, axis=1)
        v = (lambda x, n, axis: torch.repeat_interleave(x, n, dim=axis))(v_cache, rep, axis=1)
        scores = torch.einsum("bhqd,bhkd->bhqk", q, k) * (Dh ** -0.5)
        p = _softmax(scores, axis=-1)
        o = torch.einsum("bhqk,bhkd->bhqd", p, v)
        return (lambda x, *d: x.permute(*d))(o, 0, 2, 1, 3).reshape(B, Sq, Hq * Dh) @ wo

    def _B_ref(x, w_gate, w_up, w_down):
        g = torch.einsum("bsd,df->bsf", x, w_gate)
        u = torch.einsum("bsd,df->bsf", x, w_up)
        h = g * u
        return torch.einsum("bsf,fd->bsd", h, w_down)

    x = A_x
    xn = _layernorm(x, axis=-1)
    s = _A_ref(xn, A_k_cache, A_v_cache, A_wq, A_wo)
    g = _silu(_B_ref(xn, B_w_gate, B_w_up, B_w_down))
    return x + s * g
```

```asm
; @launch grid=(256,1,1) block=(256,1,1) lds=152064
.amdgcn_target "amdgcn-amd-amdhsa--gfx950"
.text
.globl recurrent_scan__gqa_block_cached__glu_gated_bilinear__prompt_kernel
.p2align 8
.type recurrent_scan__gqa_block_cached__glu_gated_bilinear__prompt_kernel,@function
recurrent_scan__gqa_block_cached__glu_gated_bilinear__prompt_kernel:
    s_cmp_ge_u32 s2, 256
    s_cbranch_scc1 done
    s_load_dwordx2 s[4:5], s[0:1], 0
    s_load_dwordx2 s[12:13], s[0:1], 24
    s_load_dwordx4 s[8:11], s[0:1], 48
    s_load_dwordx2 s[16:17], s[0:1], 64
    s_load_dwordx2 s[20:21], s[0:1], 8
    s_load_dwordx2 s[24:25], s[0:1], 16
    s_load_dwordx2 s[28:29], s[0:1], 32
    s_load_dwordx2 s[32:33], s[0:1], 88
    s_load_dwordx2 s[44:45], s[0:1], 72
    s_load_dwordx2 s[96:97], s[0:1], 80
    v_lshrrev_b32 v208, 6, v0
    v_and_b32 v13, 63, v0
    s_and_b32 s55, s2, 7
    s_lshr_b32 s60, s2, 4
    v_readfirstlane_b32 s36, v208
    s_nop 2
    s_lshr_b32 s42, s2, 3
    s_lshl2_add_u32 s42, s42, s36
    s_getpc_b64 s[100:101]
    s_mul_i32 s42, s42, 640
    v_lshlrev_b32 v240, 7, v13
    v_add_u32 v240, s42, v240
    v_min_u32 v240, 80000, v240
    s_mov_b64 exec, 31
    global_load_dword v15, v240, s[100:101]
    s_mov_b64 exec, -1
    v_mul_u32_u24 v212, 28672, v208
    v_lshl_add_u32 v212, v13, 4, v212
    v_add_u32 v213, 4096, v212
    v_xor_b32 v128, 0, v212
    v_cmp_le_u32 vcc, 48, v13
    v_xor_b32 v214, 0, v212
    v_xor_b32 v129, 32, v212
    v_cndmask_b32 v129, v214, v129, vcc
    v_xor_b32 v130, 32, v212
    v_cmp_le_u32 vcc, 32, v13
    v_xor_b32 v214, 32, v212
    v_xor_b32 v131, 64, v212
    v_cndmask_b32 v131, v214, v131, vcc
    v_xor_b32 v132, 64, v213
    v_cmp_le_u32 vcc, 16, v13
    v_xor_b32 v214, 64, v213
    v_xor_b32 v133, 96, v213
    v_cndmask_b32 v133, v214, v133, vcc
    v_xor_b32 v134, 96, v213
    s_mul_i32 s49, s60, 114688
    s_mov_b32 s6, 1835008
    s_mov_b32 s7, 0x20000
    s_mul_i32 s61, s36, 28672
    s_waitcnt lgkmcnt(0)
    s_add_u32 m0, s61, 33792
    s_nop 0
    buffer_load_dwordx4 v128, s[4:7], s49 offen offset:0 lds
    s_bfe_u32 s41, s2, 0x10003
    s_lshl1_add_u32 s59, s55, s41
    s_mul_i32 s37, s36, 4224
    v_and_b32 v209, 15, v13
    v_lshrrev_b32 v210, 4, v13
    v_lshrrev_b32 v212, 5, v13
    v_lshlrev_b32 v212, 5, v212
    v_bfe_u32 v214, v13, 4, 1
    v_lshl_add_u32 v212, v214, 2, v212
    buffer_load_dwordx4 v129, s[4:7], s49 offen offset:1024 lds
    v_lshl_add_u32 v212, v208, 3, v212
    v_lshlrev_b32 v212, 13, v212
    v_lshl_add_u32 v2, v209, 4, v212
    s_lshl_b32 s42, s59, 9
    s_mov_b32 s56, 7160
    s_mov_b32 s57, 14272
    s_mov_b32 s63, 21432
    s_add_u32 s12, s12, s42
    s_addc_u32 s13, s13, 0
    buffer_load_dwordx4 v130, s[4:7], s49 offen offset:2048 lds
    s_sub_u32 s14, 3670016, s42
    s_mov_b32 s15, 0x20000
    s_mov_b32 s34, 134217728
    s_mov_b32 s35, 0x20000
    s_lshl_b32 s42, s60, 7
    s_lshl2_add_u32 s42, s59, s42
    s_add_u32 s42, s42, 100663296
    v_cmp_eq_u32 vcc, 0, v0
    v_mov_b32 v212, s42
    buffer_load_dwordx4 v131, s[4:7], s49 offen offset:3072 lds
    v_mov_b32 v215, 0x80000000
    v_cndmask_b32 v212, v215, v212, vcc
    v_mov_b32 v239, 0
    v_mov_b32 v238, v212
    v_accvgpr_write_b32 a181, v212
    s_lshl_b32 s42, s60, 4
    v_mov_b32 v213, s42
    v_cndmask_b32 v236, v215, v213, vcc
    v_mov_b32 v237, 1
    s_add_u32 m0, s61, 37888
    s_nop 0
    buffer_load_dwordx4 v132, s[4:7], s49 offen offset:0 lds
    s_mov_b32 s98, 256
    s_mov_b32 s99, 0x20000
    s_mov_b32 s62, 0x8000
    s_lshr_b32 s58, s2, 3
    s_min_u32 s58, s58, 27
    s_mul_i32 s38, s55, 28
    s_add_u32 s58, s58, s38
    s_mul_i32 s38, s58, 9363
    s_lshr_b32 s38, s38, 16
    buffer_load_dwordx4 v133, s[4:7], s49 offen offset:1024 lds
    s_mul_i32 s39, s38, 7
    s_sub_u32 s39, s58, s39
    s_add_u32 s51, s39, 2
    s_lshr_b32 s42, s38, 1
    s_lshl_b32 s3, s42, 4
    s_lshl_b32 s42, s42, 7
    s_add_u32 s42, s42, 100663296
    v_lshl_add_u32 v213, v209, 2, s42
    v_accvgpr_write_b32 a180, v213
    buffer_load_dwordx4 v134, s[4:7], s49 offen offset:2048 lds
    s_lshl2_add_u32 s42, s38, s36
    s_mul_i32 s53, s42, 229376
    s_mul_i32 s100, s39, 32768
    s_add_u32 s53, s53, s100
    s_add_u32 s53, s53, 16777216
    s_mul_i32 s42, s42, 14336
    s_lshl_b32 s100, s39, 7
    s_add_u32 s42, s42, s100
    s_cmp_ge_u32 s2, 224
    s_cselect_b32 s42, 0x80000000, s42
    s_cselect_b32 s53, 0x80000000, s53
    s_add_u32 m0, s61, 40960
    s_add_u32 s49, s49, 7168
    buffer_load_dwordx4 v128, s[4:7], s49 offen offset:0 lds
    v_mul_u32_u24 v212, 896, v209
    v_lshl_add_u32 v212, v210, 3, v212
    v_add_u32 v212, s42, v212
    v_accvgpr_write_b32 a182, v212
    v_lshrrev_b32 v212, 3, v13
    v_mul_u32_u24 v212, 3584, v212
    v_and_b32 v214, 7, v13
    v_lshl_add_u32 v212, v214, 4, v212
    s_lshl_b32 s42, s39, 7
    buffer_load_dwordx4 v129, s[4:7], s49 offen offset:1024 lds
    v_accvgpr_write_b32 a184, v212
    s_add_u32 s16, s16, s42
    s_addc_u32 s17, s17, 0
    s_sub_u32 s18, 1605632, s42
    s_mov_b32 s19, 0x20000
    s_cmp_ge_u32 s36, 2
    s_cselect_b32 s8, s10, s8
    s_cselect_b32 s9, s11, s9
    s_mul_i32 s42, s59, 224
    buffer_load_dwordx4 v130, s[4:7], s49 offen offset:2048 lds
    s_add_u32 s8, s8, s42
    s_addc_u32 s9, s9, 0
    s_sub_u32 s10, 1605632, s42
    s_mov_b32 s11, 0x20000
    s_mul_i32 s42, s59, 229376
    s_add_u32 s28, s28, s42
    s_addc_u32 s29, s29, 0
    s_mov_b32 s30, 229376
    s_mov_b32 s31, 0x20000
    buffer_load_dwordx4 v131, s[4:7], s49 offen offset:3072 lds
    s_lshl_b32 s42, s55, 20
    s_add_u32 s20, s20, s42
    s_addc_u32 s21, s21, 0
    s_mov_b32 s22, 0x100000
    s_mov_b32 s23, 0x20000
    s_add_u32 s24, s24, s42
    s_addc_u32 s25, s25, 0
    s_mov_b32 s26, 0x100000
    s_mov_b32 s27, 0x20000
    s_add_u32 m0, s61, 45056
    s_nop 0
    buffer_load_dwordx4 v132, s[4:7], s49 offen offset:0 lds
    s_lshl2_add_u32 s42, s60, s36
    s_mul_i32 s42, s42, 458752
    s_mul_i32 s58, s59, 1024
    s_add_u32 s42, s42, s58
    s_add_u32 s50, s42, 16777216
    s_mul_i32 s100, s38, 229376
    s_mov_b32 s40, 0x5d800000
    s_mov_b32 s46, 0x3f803f80
    s_mov_b32 s47, 0x00003f80
    buffer_load_dwordx4 v133, s[4:7], s49 offen offset:1024 lds
    s_mov_b32 s48, 0x3f800000
    s_mul_i32 s58, s36, 14336
    s_add_u32 s38, s100, s58
    s_and_b32 s58, s53, 0x80000000
    s_or_b32 s38, s38, s58
    s_lshl2_add_u32 s42, s39, s36
    s_lshl_b32 s42, s42, 13
    s_add_u32 s42, s42, s100
    s_or_b32 s92, s42, s58
    buffer_load_dwordx4 v134, s[4:7], s49 offen offset:2048 lds
    s_lshr_b32 s42, s36, 1
    s_mul_i32 s52, s42, 16896
    s_and_b32 s42, s36, 1
    s_mul_i32 s43, s42, 7168
    s_add_u32 s52, s52, s43
    s_mul_i32 s42, s42, 114688
    v_add_u32 v212, 0, v13
    v_mul_u32_u24 v213, 4682, v212
    v_lshrrev_b32 v213, 16, v213
    s_add_u32 m0, s61, 48128
    s_add_u32 s49, s49, 7168
    buffer_load_dwordx4 v128, s[4:7], s49 offen offset:0 lds
    v_mul_u32_u24 v214, 14, v213
    v_sub_u32 v212, v212, v214
    v_lshlrev_b32 v212, 4, v212
    v_subrev_u32 v212, 0, v212
    v_and_b32 v214, 12, v213
    v_lshlrev_b32 v214, 1, v214
    v_lshrrev_b32 v216, 4, v213
    v_lshl_add_u32 v214, v216, 2, v214
    v_and_b32 v213, 3, v213
    buffer_load_dwordx4 v129, s[4:7], s49 offen offset:1024 lds
    v_add_u32 v214, v214, v213
    v_mul_u32_u24 v214, 3584, v214
    v_add3_u32 v214, v214, v212, s42
    v_accvgpr_write_b32 a68, v214
    v_add_u32 v212, 64, v13
    v_mul_u32_u24 v213, 4682, v212
    v_lshrrev_b32 v213, 16, v213
    v_mul_u32_u24 v214, 14, v213
    v_sub_u32 v212, v212, v214
    buffer_load_dwordx4 v130, s[4:7], s49 offen offset:2048 lds
    v_lshlrev_b32 v212, 4, v212
    v_subrev_u32 v212, 1024, v212
    v_and_b32 v214, 12, v213
    v_lshlrev_b32 v214, 1, v214
    v_lshrrev_b32 v216, 4, v213
    v_lshl_add_u32 v214, v216, 2, v214
    v_and_b32 v213, 3, v213
    v_add_u32 v214, v214, v213
    v_mul_u32_u24 v214, 3584, v214
    buffer_load_dwordx4 v131, s[4:7], s49 offen offset:3072 lds
    v_add3_u32 v214, v214, v212, s42
    v_accvgpr_write_b32 a69, v214
    v_add_u32 v212, 128, v13
    v_mul_u32_u24 v213, 4682, v212
    v_lshrrev_b32 v213, 16, v213
    v_mul_u32_u24 v214, 14, v213
    v_sub_u32 v212, v212, v214
    v_lshlrev_b32 v212, 4, v212
    v_subrev_u32 v212, 2048, v212
    v_and_b32 v214, 12, v213
    v_lshlrev_b32 v214, 1, v214
    v_lshrrev_b32 v216, 4, v213
    v_lshl_add_u32 v214, v216, 2, v214
    v_and_b32 v213, 3, v213
    v_add_u32 v214, v214, v213
    v_mul_u32_u24 v214, 3584, v214
    v_add3_u32 v214, v214, v212, s42
    v_accvgpr_write_b32 a70, v214
    v_add_u32 v212, 192, v13
    v_mul_u32_u24 v213, 4682, v212
    v_lshrrev_b32 v213, 16, v213
    v_mul_u32_u24 v214, 14, v213
    v_sub_u32 v212, v212, v214
    v_lshlrev_b32 v212, 4, v212
    v_subrev_u32 v212, 3072, v212
    v_and_b32 v214, 12, v213
    v_lshlrev_b32 v214, 1, v214
    v_lshrrev_b32 v216, 4, v213
    v_lshl_add_u32 v214, v216, 2, v214
    v_and_b32 v213, 3, v213
    v_add_u32 v214, v214, v213
    v_mul_u32_u24 v214, 3584, v214
    v_add3_u32 v214, v214, v212, s42
    v_accvgpr_write_b32 a71, v214
    v_add_u32 v212, 256, v13
    v_mul_u32_u24 v213, 4682, v212
    v_lshrrev_b32 v213, 16, v213
    v_mul_u32_u24 v214, 14, v213
    v_sub_u32 v212, v212, v214
    v_lshlrev_b32 v212, 4, v212
    v_subrev_u32 v212, 0, v212
    v_and_b32 v214, 12, v213
    v_lshlrev_b32 v214, 1, v214
    v_lshrrev_b32 v216, 4, v213
    v_lshl_add_u32 v214, v216, 2, v214
    v_and_b32 v213, 3, v213
    v_add_u32 v214, v214, v213
    v_mul_u32_u24 v214, 3584, v214
    v_add3_u32 v214, v214, v212, s42
    v_accvgpr_write_b32 a72, v214
    v_add_u32 v212, 320, v13
    v_mul_u32_u24 v213, 4682, v212
    v_lshrrev_b32 v213, 16, v213
    v_mul_u32_u24 v214, 14, v213
    v_sub_u32 v212, v212, v214
    v_lshlrev_b32 v212, 4, v212
    v_subrev_u32 v212, 1024, v212
    v_and_b32 v214, 12, v213
    v_lshlrev_b32 v214, 1, v214
    v_lshrrev_b32 v216, 4, v213
    v_lshl_add_u32 v214, v216, 2, v214
    v_and_b32 v213, 3, v213
    v_add_u32 v214, v214, v213
    v_mul_u32_u24 v214, 3584, v214
    v_add3_u32 v214, v214, v212, s42
    v_accvgpr_write_b32 a73, v214
    v_add_u32 v212, 384, v13
    v_mul_u32_u24 v213, 4682, v212
    v_lshrrev_b32 v213, 16, v213
    v_mul_u32_u24 v214, 14, v213
    v_sub_u32 v212, v212, v214
    v_lshlrev_b32 v212, 4, v212
    v_subrev_u32 v212, 2048, v212
    v_and_b32 v214, 12, v213
    v_lshlrev_b32 v214, 1, v214
    v_lshrrev_b32 v216, 4, v213
    v_lshl_add_u32 v214, v216, 2, v214
    v_and_b32 v213, 3, v213
    v_add_u32 v214, v214, v213
    v_mul_u32_u24 v214, 3584, v214
    v_add3_u32 v214, v214, v212, s42
    v_accvgpr_write_b32 a74, v214
    v_lshrrev_b32 v212, 2, v13
    v_and_b32 v213, 3, v13
    v_lshlrev_b32 v213, 3, v213
    v_mul_u32_u24 v214, 1056, v212
    v_add_u32 v0, v214, v213
    v_accvgpr_write_b32 a179, v0
    v_mul_u32_u24 v214, 4224, v210
    v_lshl_add_u32 v214, v213, 1, v214
    v_bfe_u32 v216, v13, 2, 1
    v_mul_u32_u24 v216, 1032, v216
    v_add_u32 v214, v214, v216
    v_bfe_u32 v216, v13, 3, 1
    v_mul_u32_u24 v216, 2112, v216
    v_add_u32 v0, v214, v216
    v_add_u32 v1, 67584, v0
    s_lshl_b32 s42, s41, 5
    s_mul_i32 s43, s41, 224
    v_mul_u32_u24 v214, 224, v212
    v_add3_u32 v214, v214, v213, s42
    v_accvgpr_write_b32 a64, v214
    v_add_u32 v216, 67584, v214
    v_accvgpr_write_b32 a65, v216
    v_subrev_u32 v214, s43, v214
    v_accvgpr_write_b32 a66, v214
    v_add_u32 v214, 67584, v214
    v_accvgpr_write_b32 a67, v214
    v_and_b32 v214, 7, v212
    v_mul_u32_u24 v214, 1056, v214
    v_add_u32 v214, v214, v213
    v_lshrrev_b32 v212, 5, v13
    v_lshl_add_u32 v214, v212, 7, v214
    v_accvgpr_write_b32 a176, v214
    v_bfe_u32 v214, v13, 2, 2
    v_mul_u32_u24 v214, 1056, v214
    v_lshl_add_u32 v214, v210, 7, v214
    v_add3_u32 v214, v214, v213, s37
    v_accvgpr_write_b32 a183, v214
    v_mul_u32_u24 v212, 1056, v209
    v_lshl_add_u32 v212, v210, 4, v212
    v_add_u32 v212, 67584, v212
    v_accvgpr_write_b32 a177, v212
    v_lshlrev_b32 v212, 4, v13
    v_lshl_add_u32 v212, v208, 12, v212
    v_accvgpr_write_b32 a178, v212
    v_lshrrev_b32 v212, 1, v208
    v_lshlrev_b32 v212, 6, v212
    v_and_b32 v214, 56, v13
    v_add_u32 v212, v212, v214
    v_and_b32 v214, 1, v208
    v_lshl_add_u32 v212, v214, 2, v212
    v_mul_u32_u24 v212, 896, v212
    v_and_b32 v214, 7, v13
    v_lshl_add_u32 v14, v214, 4, v212
    v_and_b32 v214, 6, v209
    v_xor_b32 v214, v214, v210
    v_lshlrev_b32 v214, 4, v214
    v_lshl_add_u32 v212, v208, 5, v209
    v_mul_u32_u24 v213, 896, v212
    v_add_u32 v213, 33792, v213
    v_add_u32 v136, v213, v214
    v_xor_b32 v214, 64, v214
    v_add_u32 v137, v213, v214
    v_mov_b32 v216, 0
    v_mov_b32 v217, 0
    v_mov_b32 v218, 0
    v_mov_b32 v219, 0
    v_mov_b32 v224, 0
    v_mov_b32 v225, 0
    v_mov_b32 v226, 0
    v_mov_b32 v227, 0
    s_waitcnt vmcnt(4)
    ds_read_b128 v[16:19], v136 offset:0
    ds_read_b128 v[20:23], v137 offset:0
    ds_read_b128 v[24:27], v136 offset:128
    ds_read_b128 v[28:31], v137 offset:128
    ds_read_b128 v[32:35], v136 offset:256
    ds_read_b128 v[36:39], v137 offset:256
    ds_read_b128 v[40:43], v136 offset:384
    ds_read_b128 v[44:47], v137 offset:384
    ds_read_b128 v[48:51], v136 offset:512
    ds_read_b128 v[52:55], v137 offset:512
    ds_read_b128 v[56:59], v136 offset:640
    ds_read_b128 v[60:63], v137 offset:640
    ds_read_b128 v[64:67], v136 offset:768
    ds_read_b128 v[68:71], v137 offset:768
    s_waitcnt lgkmcnt(12)
    s_add_u32 m0, s61, 52224
    s_nop 0
    buffer_load_dwordx4 v132, s[4:7], s49 offen offset:0 lds
    v_dot2c_f32_bf16 v216, s46, v16
    v_dot2c_f32_bf16 v218, s46, v17
    v_dot2c_f32_bf16 v216, s46, v18
    v_dot2c_f32_bf16 v218, s46, v19
    buffer_load_dwordx4 v133, s[4:7], s49 offen offset:1024 lds
    v_dot2c_f32_bf16 v216, s46, v20
    v_dot2c_f32_bf16 v218, s46, v21
    v_dot2c_f32_bf16 v216, s46, v22
    v_dot2c_f32_bf16 v218, s46, v23
    s_waitcnt lgkmcnt(10)
    buffer_load_dwordx4 v134, s[4:7], s49 offen offset:2048 lds
    v_dot2c_f32_bf16 v216, s46, v24
    v_dot2c_f32_bf16 v218, s46, v25
    v_dot2c_f32_bf16 v216, s46, v26
    v_dot2c_f32_bf16 v218, s46, v27
    s_add_u32 m0, s61, 55296
    s_add_u32 s49, s49, 7168
    buffer_load_dwordx4 v128, s[4:7], s49 offen offset:0 lds
    v_dot2c_f32_bf16 v216, s46, v28
    v_dot2c_f32_bf16 v218, s46, v29
    v_dot2c_f32_bf16 v216, s46, v30
    v_dot2c_f32_bf16 v218, s46, v31
    s_waitcnt lgkmcnt(8)
    buffer_load_dwordx4 v129, s[4:7], s49 offen offset:1024 lds
    v_dot2c_f32_bf16 v216, s46, v32
    v_dot2c_f32_bf16 v218, s46, v33
    v_dot2c_f32_bf16 v216, s46, v34
    v_dot2c_f32_bf16 v218, s46, v35
    buffer_load_dwordx4 v130, s[4:7], s49 offen offset:2048 lds
    v_dot2c_f32_bf16 v216, s46, v36
    v_dot2c_f32_bf16 v218, s46, v37
    v_dot2c_f32_bf16 v216, s46, v38
    v_dot2c_f32_bf16 v218, s46, v39
    s_waitcnt lgkmcnt(6)
    buffer_load_dwordx4 v131, s[4:7], s49 offen offset:3072 lds
    v_dot2c_f32_bf16 v216, s46, v40
    v_dot2c_f32_bf16 v218, s46, v41
    v_dot2c_f32_bf16 v216, s46, v42
    v_dot2c_f32_bf16 v218, s46, v43
    s_add_u32 m0, s61, 59392
    s_nop 0
    buffer_load_dwordx4 v132, s[4:7], s49 offen offset:0 lds
    v_dot2c_f32_bf16 v216, s46, v44
    v_dot2c_f32_bf16 v218, s46, v45
    v_dot2c_f32_bf16 v216, s46, v46
    v_dot2c_f32_bf16 v218, s46, v47
    s_waitcnt lgkmcnt(4)
    buffer_load_dwordx4 v133, s[4:7], s49 offen offset:1024 lds
    v_dot2c_f32_bf16 v216, s46, v48
    v_dot2c_f32_bf16 v218, s46, v49
    v_dot2c_f32_bf16 v216, s46, v50
    v_dot2c_f32_bf16 v218, s46, v51
    buffer_load_dwordx4 v134, s[4:7], s49 offen offset:2048 lds
    v_dot2c_f32_bf16 v216, s46, v52
    v_dot2c_f32_bf16 v218, s46, v53
    v_dot2c_f32_bf16 v216, s46, v54
    v_dot2c_f32_bf16 v218, s46, v55
    s_waitcnt lgkmcnt(2)
    v_dot2c_f32_bf16 v216, s46, v56
    v_dot2c_f32_bf16 v218, s46, v57
    v_dot2c_f32_bf16 v216, s46, v58
    v_dot2c_f32_bf16 v218, s46, v59
    v_dot2c_f32_bf16 v216, s46, v60
    v_dot2c_f32_bf16 v218, s46, v61
    v_dot2c_f32_bf16 v216, s46, v62
    v_dot2c_f32_bf16 v218, s46, v63
    s_waitcnt lgkmcnt(0)
    v_dot2c_f32_bf16 v216, s46, v64
    v_dot2c_f32_bf16 v218, s46, v65
    v_dot2c_f32_bf16 v216, s46, v66
    v_dot2c_f32_bf16 v218, s46, v67
    v_dot2c_f32_bf16 v216, s46, v68
    v_dot2c_f32_bf16 v218, s46, v69
    v_dot2c_f32_bf16 v216, s46, v70
    v_dot2c_f32_bf16 v218, s46, v71
    s_nop 2
    v_add_f32 v216, v216, v218
    v_mov_b32 v218, v216
    s_nop 1
    v_permlane32_swap_b32 v216, v218
    v_add_f32 v216, v216, v218
    v_mov_b32 v218, v216
    s_nop 1
    v_permlane16_swap_b32 v216, v218
    v_add_f32 v216, v216, v218
    v_mul_f32 v216, 0x3b124925, v216
    v_cvt_pk_bf16_f32 v220, v216, v216
    v_lshlrev_b32 v220, 16, v220
    v_sub_f32 v216, v216, v220
    v_xor_b32 v220, 0x80000000, v220
    s_add_u32 m0, s37, 0
    s_nop 0
    buffer_load_dwordx4 v2, s[12:15], 0 offen offset:0 lds
    v_dot2_f32_bf16 v228, v16, s47, v220
    v_dot2_f32_bf16 v229, v16, s48, v220
    v_dot2_f32_bf16 v230, v17, s47, v220
    v_dot2_f32_bf16 v231, v17, s48, v220
    v_dot2_f32_bf16 v232, v18, s47, v220
    v_dot2_f32_bf16 v233, v18, s48, v220
    v_cvt_pk_bf16_f32 v16, v228, v229
    v_dot2_f32_bf16 v234, v19, s47, v220
    v_dot2_f32_bf16 v235, v19, s48, v220
    v_cvt_pk_bf16_f32 v17, v230, v231
    v_dot2c_f32_bf16 v226, v16, v16
    v_dot2_f32_bf16 v228, v20, s47, v220
    v_dot2_f32_bf16 v229, v20, s48, v220
    v_cvt_pk_bf16_f32 v18, v232, v233
    v_dot2c_f32_bf16 v224, v17, v17
    v_dot2_f32_bf16 v230, v21, s47, v220
    buffer_load_dwordx4 v2, s[12:15], s56 offen offset:1032 lds
    v_dot2_f32_bf16 v231, v21, s48, v220
    v_cvt_pk_bf16_f32 v19, v234, v235
    v_dot2c_f32_bf16 v226, v18, v18
    v_dot2_f32_bf16 v232, v22, s47, v220
    v_dot2_f32_bf16 v233, v22, s48, v220
    v_cvt_pk_bf16_f32 v20, v228, v229
    v_dot2c_f32_bf16 v224, v19, v19
    v_dot2_f32_bf16 v234, v23, s47, v220
    v_dot2_f32_bf16 v235, v23, s48, v220
    v_cvt_pk_bf16_f32 v21, v230, v231
    v_dot2c_f32_bf16 v226, v20, v20
    v_dot2_f32_bf16 v228, v24, s47, v220
    v_dot2_f32_bf16 v229, v24, s48, v220
    v_cvt_pk_bf16_f32 v22, v232, v233
    v_dot2c_f32_bf16 v224, v21, v21
    v_dot2_f32_bf16 v230, v25, s47, v220
    buffer_load_dwordx4 v2, s[12:15], s57 offen offset:2112 lds
    v_dot2_f32_bf16 v231, v25, s48, v220
    v_cvt_pk_bf16_f32 v23, v234, v235
    v_dot2c_f32_bf16 v226, v22, v22
    v_dot2_f32_bf16 v232, v26, s47, v220
    v_dot2_f32_bf16 v233, v26, s48, v220
    v_cvt_pk_bf16_f32 v24, v228, v229
    v_dot2c_f32_bf16 v224, v23, v23
    v_dot2_f32_bf16 v234, v27, s47, v220
    v_dot2_f32_bf16 v235, v27, s48, v220
    v_cvt_pk_bf16_f32 v25, v230, v231
    v_dot2c_f32_bf16 v226, v24, v24
    v_dot2_f32_bf16 v228, v28, s47, v220
    v_dot2_f32_bf16 v229, v28, s48, v220
    v_cvt_pk_bf16_f32 v26, v232, v233
    v_dot2c_f32_bf16 v224, v25, v25
    v_dot2_f32_bf16 v230, v29, s47, v220
    buffer_load_dwordx4 v2, s[12:15], s63 offen offset:3144 lds
    v_add_u32 v2, 524288, v2
    v_dot2_f32_bf16 v231, v29, s48, v220
    v_cvt_pk_bf16_f32 v27, v234, v235
    v_dot2c_f32_bf16 v226, v26, v26
    v_dot2_f32_bf16 v232, v30, s47, v220
    v_dot2_f32_bf16 v233, v30, s48, v220
    v_cvt_pk_bf16_f32 v28, v228, v229
    v_dot2c_f32_bf16 v224, v27, v27
    v_dot2_f32_bf16 v234, v31, s47, v220
    v_dot2_f32_bf16 v235, v31, s48, v220
    v_cvt_pk_bf16_f32 v29, v230, v231
    v_dot2c_f32_bf16 v226, v28, v28
    v_dot2_f32_bf16 v228, v32, s47, v220
    v_dot2_f32_bf16 v229, v32, s48, v220
    v_cvt_pk_bf16_f32 v30, v232, v233
    v_dot2c_f32_bf16 v224, v29, v29
    v_dot2_f32_bf16 v230, v33, s47, v220
    s_add_u32 m0, s37, 16896
    s_nop 0
    buffer_load_dwordx4 v2, s[12:15], 0 offen offset:0 lds
    v_dot2_f32_bf16 v231, v33, s48, v220
    v_cvt_pk_bf16_f32 v31, v234, v235
    v_dot2c_f32_bf16 v226, v30, v30
    v_dot2_f32_bf16 v232, v34, s47, v220
    v_dot2_f32_bf16 v233, v34, s48, v220
    v_cvt_pk_bf16_f32 v32, v228, v229
    v_dot2c_f32_bf16 v224, v31, v31
    v_dot2_f32_bf16 v234, v35, s47, v220
    v_dot2_f32_bf16 v235, v35, s48, v220
    v_cvt_pk_bf16_f32 v33, v230, v231
    v_dot2c_f32_bf16 v226, v32, v32
    v_dot2_f32_bf16 v228, v36, s47, v220
    v_dot2_f32_bf16 v229, v36, s48, v220
    v_cvt_pk_bf16_f32 v34, v232, v233
    v_dot2c_f32_bf16 v224, v33, v33
    v_dot2_f32_bf16 v230, v37, s47, v220
    buffer_load_dwordx4 v2, s[12:15], s56 offen offset:1032 lds
    v_dot2_f32_bf16 v231, v37, s48, v220
    v_cvt_pk_bf16_f32 v35, v234, v235
    v_dot2c_f32_bf16 v226, v34, v34
    v_dot2_f32_bf16 v232, v38, s47, v220
    v_dot2_f32_bf16 v233, v38, s48, v220
    v_cvt_pk_bf16_f32 v36, v228, v229
    v_dot2c_f32_bf16 v224, v35, v35
    v_dot2_f32_bf16 v234, v39, s47, v220
    v_dot2_f32_bf16 v235, v39, s48, v220
    v_cvt_pk_bf16_f32 v37, v230, v231
    v_dot2c_f32_bf16 v226, v36, v36
    v_dot2_f32_bf16 v228, v40, s47, v220
    v_dot2_f32_bf16 v229, v40, s48, v220
    v_cvt_pk_bf16_f32 v38, v232, v233
    v_dot2c_f32_bf16 v224, v37, v37
    v_dot2_f32_bf16 v230, v41, s47, v220
    buffer_load_dwordx4 v2, s[12:15], s57 offen offset:2112 lds
    v_dot2_f32_bf16 v231, v41, s48, v220
    v_cvt_pk_bf16_f32 v39, v234, v235
    v_dot2c_f32_bf16 v226, v38, v38
    v_dot2_f32_bf16 v232, v42, s47, v220
    v_dot2_f32_bf16 v233, v42, s48, v220
    v_cvt_pk_bf16_f32 v40, v228, v229
    v_dot2c_f32_bf16 v224, v39, v39
    v_dot2_f32_bf16 v234, v43, s47, v220
    v_dot2_f32_bf16 v235, v43, s48, v220
    v_cvt_pk_bf16_f32 v41, v230, v231
    v_dot2c_f32_bf16 v226, v40, v40
    v_dot2_f32_bf16 v228, v44, s47, v220
    v_dot2_f32_bf16 v229, v44, s48, v220
    v_cvt_pk_bf16_f32 v42, v232, v233
    v_dot2c_f32_bf16 v224, v41, v41
    v_dot2_f32_bf16 v230, v45, s47, v220
    buffer_load_dwordx4 v2, s[12:15], s63 offen offset:3144 lds
    v_add_u32 v2, 524288, v2
    v_dot2_f32_bf16 v231, v45, s48, v220
    v_cvt_pk_bf16_f32 v43, v234, v235
    v_dot2c_f32_bf16 v226, v42, v42
    v_dot2_f32_bf16 v232, v46, s47, v220
    v_dot2_f32_bf16 v233, v46, s48, v220
    v_cvt_pk_bf16_f32 v44, v228, v229
    v_dot2c_f32_bf16 v224, v43, v43
    v_dot2_f32_bf16 v234, v47, s47, v220
    v_dot2_f32_bf16 v235, v47, s48, v220
    v_cvt_pk_bf16_f32 v45, v230, v231
    v_dot2c_f32_bf16 v226, v44, v44
    v_dot2_f32_bf16 v228, v48, s47, v220
    v_dot2_f32_bf16 v229, v48, s48, v220
    v_cvt_pk_bf16_f32 v46, v232, v233
    v_dot2c_f32_bf16 v224, v45, v45
    v_dot2_f32_bf16 v230, v49, s47, v220
    buffer_store_dword v239, v238, s[32:35], 0 offen sc1
    v_dot2_f32_bf16 v231, v49, s48, v220
    v_cvt_pk_bf16_f32 v47, v234, v235
    v_dot2c_f32_bf16 v226, v46, v46
    v_dot2_f32_bf16 v232, v50, s47, v220
    v_dot2_f32_bf16 v233, v50, s48, v220
    v_cvt_pk_bf16_f32 v48, v228, v229
    v_dot2c_f32_bf16 v224, v47, v47
    v_dot2_f32_bf16 v234, v51, s47, v220
    v_dot2_f32_bf16 v235, v51, s48, v220
    v_cvt_pk_bf16_f32 v49, v230, v231
    v_dot2c_f32_bf16 v226, v48, v48
    v_dot2_f32_bf16 v228, v52, s47, v220
    v_dot2_f32_bf16 v229, v52, s48, v220
    v_cvt_pk_bf16_f32 v50, v232, v233
    v_dot2c_f32_bf16 v224, v49, v49
    v_dot2_f32_bf16 v230, v53, s47, v220
    s_lshl2_add_u32 s42, s60, s36
    s_mul_i32 s42, s42, 57344
    v_lshrrev_b32 v240, 2, v13
    v_lshlrev_b32 v240, 13, v240
    v_and_b32 v241, 3, v13
    v_lshl_add_u32 v240, v241, 7, v240
    s_mov_b64 exec, 0xfffffff
    buffer_load_dword v15, v240, s[12:15], s42 offen
    s_mov_b64 exec, -1
    v_dot2_f32_bf16 v231, v53, s48, v220
    v_cvt_pk_bf16_f32 v51, v234, v235
    v_dot2c_f32_bf16 v226, v50, v50
    v_dot2_f32_bf16 v232, v54, s47, v220
    v_dot2_f32_bf16 v233, v54, s48, v220
    v_cvt_pk_bf16_f32 v52, v228, v229
    v_dot2c_f32_bf16 v224, v51, v51
    v_dot2_f32_bf16 v234, v55, s47, v220
    v_dot2_f32_bf16 v235, v55, s48, v220
    v_cvt_pk_bf16_f32 v53, v230, v231
    v_dot2c_f32_bf16 v226, v52, v52
    v_dot2_f32_bf16 v228, v56, s47, v220
    v_dot2_f32_bf16 v229, v56, s48, v220
    v_cvt_pk_bf16_f32 v54, v232, v233
    v_dot2c_f32_bf16 v224, v53, v53
    v_dot2_f32_bf16 v230, v57, s47, v220
    v_dot2_f32_bf16 v231, v57, s48, v220
    v_cvt_pk_bf16_f32 v55, v234, v235
    v_dot2c_f32_bf16 v226, v54, v54
    v_dot2_f32_bf16 v232, v58, s47, v220
    v_dot2_f32_bf16 v233, v58, s48, v220
    v_cvt_pk_bf16_f32 v56, v228, v229
    v_dot2c_f32_bf16 v224, v55, v55
    v_dot2_f32_bf16 v234, v59, s47, v220
    v_dot2_f32_bf16 v235, v59, s48, v220
    v_cvt_pk_bf16_f32 v57, v230, v231
    v_dot2c_f32_bf16 v226, v56, v56
    v_dot2_f32_bf16 v228, v60, s47, v220
    v_dot2_f32_bf16 v229, v60, s48, v220
    v_cvt_pk_bf16_f32 v58, v232, v233
    v_dot2c_f32_bf16 v224, v57, v57
    v_dot2_f32_bf16 v230, v61, s47, v220
    v_dot2_f32_bf16 v231, v61, s48, v220
    v_cvt_pk_bf16_f32 v59, v234, v235
    v_dot2c_f32_bf16 v226, v58, v58
    v_dot2_f32_bf16 v232, v62, s47, v220
    v_dot2_f32_bf16 v233, v62, s48, v220
    v_cvt_pk_bf16_f32 v60, v228, v229
    v_dot2c_f32_bf16 v224, v59, v59
    v_dot2_f32_bf16 v234, v63, s47, v220
    v_dot2_f32_bf16 v235, v63, s48, v220
    v_cvt_pk_bf16_f32 v61, v230, v231
    v_dot2c_f32_bf16 v226, v60, v60
    v_dot2_f32_bf16 v228, v64, s47, v220
    v_dot2_f32_bf16 v229, v64, s48, v220
    v_cvt_pk_bf16_f32 v62, v232, v233
    v_dot2c_f32_bf16 v224, v61, v61
    v_dot2_f32_bf16 v230, v65, s47, v220
    v_dot2_f32_bf16 v231, v65, s48, v220
    v_cvt_pk_bf16_f32 v63, v234, v235
    v_dot2c_f32_bf16 v226, v62, v62
    v_dot2_f32_bf16 v232, v66, s47, v220
    v_dot2_f32_bf16 v233, v66, s48, v220
    v_cvt_pk_bf16_f32 v64, v228, v229
    v_dot2c_f32_bf16 v224, v63, v63
    v_dot2_f32_bf16 v234, v67, s47, v220
    v_dot2_f32_bf16 v235, v67, s48, v220
    v_cvt_pk_bf16_f32 v65, v230, v231
    v_dot2c_f32_bf16 v226, v64, v64
    v_dot2_f32_bf16 v228, v68, s47, v220
    v_dot2_f32_bf16 v229, v68, s48, v220
    v_cvt_pk_bf16_f32 v66, v232, v233
    v_dot2c_f32_bf16 v224, v65, v65
    v_dot2_f32_bf16 v230, v69, s47, v220
    v_dot2_f32_bf16 v231, v69, s48, v220
    v_cvt_pk_bf16_f32 v67, v234, v235
    v_dot2c_f32_bf16 v226, v66, v66
    v_dot2_f32_bf16 v232, v70, s47, v220
    v_dot2_f32_bf16 v233, v70, s48, v220
    v_cvt_pk_bf16_f32 v68, v228, v229
    v_dot2c_f32_bf16 v224, v67, v67
    v_dot2_f32_bf16 v234, v71, s47, v220
    v_dot2_f32_bf16 v235, v71, s48, v220
    v_cvt_pk_bf16_f32 v69, v230, v231
    v_dot2c_f32_bf16 v226, v68, v68
    v_cvt_pk_bf16_f32 v70, v232, v233
    v_dot2c_f32_bf16 v224, v69, v69
    v_cvt_pk_bf16_f32 v71, v234, v235
    v_dot2c_f32_bf16 v226, v70, v70
    v_dot2c_f32_bf16 v224, v71, v71
    s_waitcnt vmcnt(10)
    ds_read_b128 v[72:75], v136 offset:14336
    ds_read_b128 v[76:79], v137 offset:14336
    ds_read_b128 v[80:83], v136 offset:14464
    ds_read_b128 v[84:87], v137 offset:14464
    ds_read_b128 v[88:91], v136 offset:14592
    ds_read_b128 v[92:95], v137 offset:14592
    ds_read_b128 v[96:99], v136 offset:14720
    ds_read_b128 v[100:103], v137 offset:14720
    ds_read_b128 v[104:107], v136 offset:14848
    ds_read_b128 v[108:111], v137 offset:14848
    ds_read_b128 v[112:115], v136 offset:14976
    ds_read_b128 v[116:119], v137 offset:14976
    ds_read_b128 v[120:123], v136 offset:15104
    ds_read_b128 v[124:127], v137 offset:15104
    s_waitcnt lgkmcnt(12)
    v_dot2c_f32_bf16 v217, s46, v72
    v_dot2c_f32_bf16 v219, s46, v73
    v_dot2c_f32_bf16 v217, s46, v74
    v_dot2c_f32_bf16 v219, s46, v75
    v_dot2c_f32_bf16 v217, s46, v76
    v_dot2c_f32_bf16 v219, s46, v77
    v_dot2c_f32_bf16 v217, s46, v78
    v_dot2c_f32_bf16 v219, s46, v79
    s_waitcnt lgkmcnt(10)
    v_dot2c_f32_bf16 v217, s46, v80
    v_dot2c_f32_bf16 v219, s46, v81
    v_dot2c_f32_bf16 v217, s46, v82
    v_dot2c_f32_bf16 v219, s46, v83
    v_dot2c_f32_bf16 v217, s46, v84
    v_dot2c_f32_bf16 v219, s46, v85
    v_dot2c_f32_bf16 v217, s46, v86
    v_dot2c_f32_bf16 v219, s46, v87
    s_waitcnt lgkmcnt(8)
    v_dot2c_f32_bf16 v217, s46, v88
    v_dot2c_f32_bf16 v219, s46, v89
    v_dot2c_f32_bf16 v217, s46, v90
    v_dot2c_f32_bf16 v219, s46, v91
    v_dot2c_f32_bf16 v217, s46, v92
    v_dot2c_f32_bf16 v219, s46, v93
    v_dot2c_f32_bf16 v217, s46, v94
    v_dot2c_f32_bf16 v219, s46, v95
    s_waitcnt lgkmcnt(6)
    v_dot2c_f32_bf16 v217, s46, v96
    v_dot2c_f32_bf16 v219, s46, v97
    v_dot2c_f32_bf16 v217, s46, v98
    v_dot2c_f32_bf16 v219, s46, v99
    v_dot2c_f32_bf16 v217, s46, v100
    v_dot2c_f32_bf16 v219, s46, v101
    v_dot2c_f32_bf16 v217, s46, v102
    v_dot2c_f32_bf16 v219, s46, v103
    s_waitcnt lgkmcnt(4)
    v_dot2c_f32_bf16 v217, s46, v104
    v_dot2c_f32_bf16 v219, s46, v105
    v_dot2c_f32_bf16 v217, s46, v106
    v_dot2c_f32_bf16 v219, s46, v107
    v_dot2c_f32_bf16 v217, s46, v108
    v_dot2c_f32_bf16 v219, s46, v109
    v_dot2c_f32_bf16 v217, s46, v110
    v_dot2c_f32_bf16 v219, s46, v111
    s_waitcnt lgkmcnt(2)
    v_dot2c_f32_bf16 v217, s46, v112
    v_dot2c_f32_bf16 v219, s46, v113
    v_dot2c_f32_bf16 v217, s46, v114
    v_dot2c_f32_bf16 v219, s46, v115
    v_dot2c_f32_bf16 v217, s46, v116
    v_dot2c_f32_bf16 v219, s46, v117
    v_dot2c_f32_bf16 v217, s46, v118
    v_dot2c_f32_bf16 v219, s46, v119
    s_waitcnt lgkmcnt(0)
    v_dot2c_f32_bf16 v217, s46, v120
    v_dot2c_f32_bf16 v219, s46, v121
    v_dot2c_f32_bf16 v217, s46, v122
    v_dot2c_f32_bf16 v219, s46, v123
    v_dot2c_f32_bf16 v217, s46, v124
    v_dot2c_f32_bf16 v219, s46, v125
    v_dot2c_f32_bf16 v217, s46, v126
    v_dot2c_f32_bf16 v219, s46, v127
    s_barrier
    s_nop 1
    v_add_f32 v217, v217, v219
    v_mov_b32 v219, v217
    s_nop 1
    v_permlane32_swap_b32 v217, v219
    v_add_f32 v217, v217, v219
    v_mov_b32 v219, v217
    s_nop 1
    v_permlane16_swap_b32 v217, v219
    v_add_f32 v217, v217, v219
    v_mul_f32 v217, 0x3b124925, v217
    v_cvt_pk_bf16_f32 v220, v217, v217
    v_lshlrev_b32 v220, 16, v220
    v_sub_f32 v217, v217, v220
    v_xor_b32 v220, 0x80000000, v220
    s_add_u32 m0, s37, 33792
    s_nop 0
    buffer_load_dwordx4 v2, s[12:15], 0 offen offset:0 lds
    v_dot2_f32_bf16 v228, v72, s47, v220
    v_dot2_f32_bf16 v229, v72, s48, v220
    v_dot2_f32_bf16 v230, v73, s47, v220
    v_dot2_f32_bf16 v231, v73, s48, v220
    v_dot2_f32_bf16 v232, v74, s47, v220
    v_dot2_f32_bf16 v233, v74, s48, v220
    v_cvt_pk_bf16_f32 v72, v228, v229
    v_dot2_f32_bf16 v234, v75, s47, v220
    v_dot2_f32_bf16 v235, v75, s48, v220
    v_cvt_pk_bf16_f32 v73, v230, v231
    v_dot2c_f32_bf16 v227, v72, v72
    v_dot2_f32_bf16 v228, v76, s47, v220
    v_dot2_f32_bf16 v229, v76, s48, v220
    v_cvt_pk_bf16_f32 v74, v232, v233
    v_dot2c_f32_bf16 v225, v73, v73
    v_dot2_f32_bf16 v230, v77, s47, v220
    v_dot2_f32_bf16 v231, v77, s48, v220
    v_cvt_pk_bf16_f32 v75, v234, v235
    v_dot2c_f32_bf16 v227, v74, v74
    v_dot2_f32_bf16 v232, v78, s47, v220
    buffer_load_dwordx4 v2, s[12:15], s56 offen offset:1032 lds
    v_dot2_f32_bf16 v233, v78, s48, v220
    v_cvt_pk_bf16_f32 v76, v228, v229
    v_dot2c_f32_bf16 v225, v75, v75
    v_dot2_f32_bf16 v234, v79, s47, v220
    v_dot2_f32_bf16 v235, v79, s48, v220
    v_cvt_pk_bf16_f32 v77, v230, v231
    v_dot2c_f32_bf16 v227, v76, v76
    v_dot2_f32_bf16 v228, v80, s47, v220
    v_dot2_f32_bf16 v229, v80, s48, v220
    v_cvt_pk_bf16_f32 v78, v232, v233
    v_dot2c_f32_bf16 v225, v77, v77
    v_dot2_f32_bf16 v230, v81, s47, v220
    v_dot2_f32_bf16 v231, v81, s48, v220
    v_cvt_pk_bf16_f32 v79, v234, v235
    v_dot2c_f32_bf16 v227, v78, v78
    v_dot2_f32_bf16 v232, v82, s47, v220
    v_dot2_f32_bf16 v233, v82, s48, v220
    v_cvt_pk_bf16_f32 v80, v228, v229
    v_dot2c_f32_bf16 v225, v79, v79
    v_dot2_f32_bf16 v234, v83, s47, v220
    buffer_load_dwordx4 v2, s[12:15], s57 offen offset:2112 lds
    v_dot2_f32_bf16 v235, v83, s48, v220
    v_cvt_pk_bf16_f32 v81, v230, v231
    v_dot2c_f32_bf16 v227, v80, v80
    v_dot2_f32_bf16 v228, v84, s47, v220
    v_dot2_f32_bf16 v229, v84, s48, v220
    v_cvt_pk_bf16_f32 v82, v232, v233
    v_dot2c_f32_bf16 v225, v81, v81
    v_dot2_f32_bf16 v230, v85, s47, v220
    v_dot2_f32_bf16 v231, v85, s48, v220
    v_cvt_pk_bf16_f32 v83, v234, v235
    v_dot2c_f32_bf16 v227, v82, v82
    v_dot2_f32_bf16 v232, v86, s47, v220
    v_dot2_f32_bf16 v233, v86, s48, v220
    v_cvt_pk_bf16_f32 v84, v228, v229
    v_dot2c_f32_bf16 v225, v83, v83
    v_dot2_f32_bf16 v234, v87, s47, v220
    v_dot2_f32_bf16 v235, v87, s48, v220
    v_cvt_pk_bf16_f32 v85, v230, v231
    v_dot2c_f32_bf16 v227, v84, v84
    v_dot2_f32_bf16 v228, v88, s47, v220
    buffer_load_dwordx4 v2, s[12:15], s63 offen offset:3144 lds
    v_add_u32 v2, 524288, v2
    v_dot2_f32_bf16 v229, v88, s48, v220
    v_cvt_pk_bf16_f32 v86, v232, v233
    v_dot2c_f32_bf16 v225, v85, v85
    v_dot2_f32_bf16 v230, v89, s47, v220
    v_dot2_f32_bf16 v231, v89, s48, v220
    v_cvt_pk_bf16_f32 v87, v234, v235
    v_dot2c_f32_bf16 v227, v86, v86
    v_dot2_f32_bf16 v232, v90, s47, v220
    v_dot2_f32_bf16 v233, v90, s48, v220
    v_cvt_pk_bf16_f32 v88, v228, v229
    v_dot2c_f32_bf16 v225, v87, v87
    v_dot2_f32_bf16 v234, v91, s47, v220
    v_dot2_f32_bf16 v235, v91, s48, v220
    v_cvt_pk_bf16_f32 v89, v230, v231
    v_dot2c_f32_bf16 v227, v88, v88
    v_dot2_f32_bf16 v228, v92, s47, v220
    v_dot2_f32_bf16 v229, v92, s48, v220
    v_cvt_pk_bf16_f32 v90, v232, v233
    v_dot2c_f32_bf16 v225, v89, v89
    v_dot2_f32_bf16 v230, v93, s47, v220
    v_mul_u32_u24 v240, 21846, v13
    v_lshrrev_b32 v240, 16, v240
    v_mul_u32_u24 v241, 3, v240
    v_sub_u32 v241, v13, v241
    v_lshlrev_b32 v241, 7, v241
    v_min_u32 v241, 220, v241
    s_and_b32 s42, s36, 1
    s_lshl1_add_u32 s42, s60, s42
    s_mul_i32 s42, s42, 50176
    v_mul_u32_u24 v240, 3584, v240
    v_add_u32 v240, v240, v241
    s_mov_b32 exec_hi, 0x3ff
    buffer_load_dword v15, v240, s[8:11], s42 offen
    s_mov_b64 exec, -1
    v_dot2_f32_bf16 v231, v93, s48, v220
    v_cvt_pk_bf16_f32 v91, v234, v235
    v_dot2c_f32_bf16 v227, v90, v90
    v_dot2_f32_bf16 v232, v94, s47, v220
    v_dot2_f32_bf16 v233, v94, s48, v220
    v_cvt_pk_bf16_f32 v92, v228, v229
    v_dot2c_f32_bf16 v225, v91, v91
    v_dot2_f32_bf16 v234, v95, s47, v220
    v_dot2_f32_bf16 v235, v95, s48, v220
    v_cvt_pk_bf16_f32 v93, v230, v231
    v_dot2c_f32_bf16 v227, v92, v92
    v_dot2_f32_bf16 v228, v96, s47, v220
    v_dot2_f32_bf16 v229, v96, s48, v220
    v_cvt_pk_bf16_f32 v94, v232, v233
    v_dot2c_f32_bf16 v225, v93, v93
    v_dot2_f32_bf16 v230, v97, s47, v220
    v_dot2_f32_bf16 v231, v97, s48, v220
    v_cvt_pk_bf16_f32 v95, v234, v235
    v_dot2c_f32_bf16 v227, v94, v94
    v_dot2_f32_bf16 v232, v98, s47, v220
    v_dot2_f32_bf16 v233, v98, s48, v220
    v_cvt_pk_bf16_f32 v96, v228, v229
    v_dot2c_f32_bf16 v225, v95, v95
    v_dot2_f32_bf16 v234, v99, s47, v220
    v_dot2_f32_bf16 v235, v99, s48, v220
    v_cvt_pk_bf16_f32 v97, v230, v231
    v_dot2c_f32_bf16 v227, v96, v96
    v_dot2_f32_bf16 v228, v100, s47, v220
    v_dot2_f32_bf16 v229, v100, s48, v220
    v_cvt_pk_bf16_f32 v98, v232, v233
    v_dot2c_f32_bf16 v225, v97, v97
    v_dot2_f32_bf16 v230, v101, s47, v220
    v_dot2_f32_bf16 v231, v101, s48, v220
    v_cvt_pk_bf16_f32 v99, v234, v235
    v_dot2c_f32_bf16 v227, v98, v98
    v_dot2_f32_bf16 v232, v102, s47, v220
    v_dot2_f32_bf16 v233, v102, s48, v220
    v_cvt_pk_bf16_f32 v100, v228, v229
    v_dot2c_f32_bf16 v225, v99, v99
    v_dot2_f32_bf16 v234, v103, s47, v220
    v_dot2_f32_bf16 v235, v103, s48, v220
    v_cvt_pk_bf16_f32 v101, v230, v231
    v_dot2c_f32_bf16 v227, v100, v100
    v_dot2_f32_bf16 v228, v104, s47, v220
    v_dot2_f32_bf16 v229, v104, s48, v220
    v_cvt_pk_bf16_f32 v102, v232, v233
    v_dot2c_f32_bf16 v225, v101, v101
    v_dot2_f32_bf16 v230, v105, s47, v220
    v_dot2_f32_bf16 v231, v105, s48, v220
    v_cvt_pk_bf16_f32 v103, v234, v235
    v_dot2c_f32_bf16 v227, v102, v102
    v_dot2_f32_bf16 v232, v106, s47, v220
    v_dot2_f32_bf16 v233, v106, s48, v220
    v_cvt_pk_bf16_f32 v104, v228, v229
    v_dot2c_f32_bf16 v225, v103, v103
    v_dot2_f32_bf16 v234, v107, s47, v220
    v_dot2_f32_bf16 v235, v107, s48, v220
    v_cvt_pk_bf16_f32 v105, v230, v231
    v_dot2c_f32_bf16 v227, v104, v104
    v_dot2_f32_bf16 v228, v108, s47, v220
    v_dot2_f32_bf16 v229, v108, s48, v220
    v_cvt_pk_bf16_f32 v106, v232, v233
    v_dot2c_f32_bf16 v225, v105, v105
    v_dot2_f32_bf16 v230, v109, s47, v220
    v_dot2_f32_bf16 v231, v109, s48, v220
    v_cvt_pk_bf16_f32 v107, v234, v235
    v_dot2c_f32_bf16 v227, v106, v106
    v_dot2_f32_bf16 v232, v110, s47, v220
    v_dot2_f32_bf16 v233, v110, s48, v220
    v_cvt_pk_bf16_f32 v108, v228, v229
    v_dot2c_f32_bf16 v225, v107, v107
    v_dot2_f32_bf16 v234, v111, s47, v220
    v_dot2_f32_bf16 v235, v111, s48, v220
    v_cvt_pk_bf16_f32 v109, v230, v231
    v_dot2c_f32_bf16 v227, v108, v108
    v_dot2_f32_bf16 v228, v112, s47, v220
    v_dot2_f32_bf16 v229, v112, s48, v220
    v_cvt_pk_bf16_f32 v110, v232, v233
    v_dot2c_f32_bf16 v225, v109, v109
    v_dot2_f32_bf16 v230, v113, s47, v220
    v_dot2_f32_bf16 v231, v113, s48, v220
    v_cvt_pk_bf16_f32 v111, v234, v235
    v_dot2c_f32_bf16 v227, v110, v110
    v_dot2_f32_bf16 v232, v114, s47, v220
    v_dot2_f32_bf16 v233, v114, s48, v220
    v_cvt_pk_bf16_f32 v112, v228, v229
    v_dot2c_f32_bf16 v225, v111, v111
    v_dot2_f32_bf16 v234, v115, s47, v220
    v_dot2_f32_bf16 v235, v115, s48, v220
    v_cvt_pk_bf16_f32 v113, v230, v231
    v_dot2c_f32_bf16 v227, v112, v112
    v_dot2_f32_bf16 v228, v116, s47, v220
    v_dot2_f32_bf16 v229, v116, s48, v220
    v_cvt_pk_bf16_f32 v114, v232, v233
    v_dot2c_f32_bf16 v225, v113, v113
    v_dot2_f32_bf16 v230, v117, s47, v220
    v_dot2_f32_bf16 v231, v117, s48, v220
    v_cvt_pk_bf16_f32 v115, v234, v235
    v_dot2c_f32_bf16 v227, v114, v114
    v_dot2_f32_bf16 v232, v118, s47, v220
    v_dot2_f32_bf16 v233, v118, s48, v220
    v_cvt_pk_bf16_f32 v116, v228, v229
    v_dot2c_f32_bf16 v225, v115, v115
    v_dot2_f32_bf16 v234, v119, s47, v220
    v_dot2_f32_bf16 v235, v119, s48, v220
    v_cvt_pk_bf16_f32 v117, v230, v231
    v_dot2c_f32_bf16 v227, v116, v116
    v_dot2_f32_bf16 v228, v120, s47, v220
    v_dot2_f32_bf16 v229, v120, s48, v220
    v_cvt_pk_bf16_f32 v118, v232, v233
    v_dot2c_f32_bf16 v225, v117, v117
    v_dot2_f32_bf16 v230, v121, s47, v220
    v_dot2_f32_bf16 v231, v121, s48, v220
    v_cvt_pk_bf16_f32 v119, v234, v235
    v_dot2c_f32_bf16 v227, v118, v118
    v_dot2_f32_bf16 v232, v122, s47, v220
    v_dot2_f32_bf16 v233, v122, s48, v220
    v_cvt_pk_bf16_f32 v120, v228, v229
    v_dot2c_f32_bf16 v225, v119, v119
    v_dot2_f32_bf16 v234, v123, s47, v220
    v_dot2_f32_bf16 v235, v123, s48, v220
    v_cvt_pk_bf16_f32 v121, v230, v231
    v_dot2c_f32_bf16 v227, v120, v120
    v_dot2_f32_bf16 v228, v124, s47, v220
    v_dot2_f32_bf16 v229, v124, s48, v220
    v_cvt_pk_bf16_f32 v122, v232, v233
    v_dot2c_f32_bf16 v225, v121, v121
    v_dot2_f32_bf16 v230, v125, s47, v220
    v_dot2_f32_bf16 v231, v125, s48, v220
    v_cvt_pk_bf16_f32 v123, v234, v235
    v_dot2c_f32_bf16 v227, v122, v122
    v_dot2_f32_bf16 v232, v126, s47, v220
    v_dot2_f32_bf16 v233, v126, s48, v220
    v_cvt_pk_bf16_f32 v124, v228, v229
    v_dot2c_f32_bf16 v225, v123, v123
    v_dot2_f32_bf16 v234, v127, s47, v220
    v_dot2_f32_bf16 v235, v127, s48, v220
    v_cvt_pk_bf16_f32 v125, v230, v231
    v_dot2c_f32_bf16 v227, v124, v124
    v_cvt_pk_bf16_f32 v126, v232, v233
    v_dot2c_f32_bf16 v225, v125, v125
    v_cvt_pk_bf16_f32 v127, v234, v235
    v_dot2c_f32_bf16 v227, v126, v126
    v_dot2c_f32_bf16 v225, v127, v127
    s_add_u32 m0, s37, 50688
    s_waitcnt vmcnt(6)
    buffer_atomic_add v237, v236, s[96:99], 0 offen sc1
    s_barrier
    ds_read_b64_tr_b16 a[192:193], v0 offset:0
    ds_read_b64_tr_b16 a[194:195], v0 offset:256
    ds_read_b64_tr_b16 a[196:197], v0 offset:512
    ds_read_b64_tr_b16 a[198:199], v0 offset:768
    ds_read_b64_tr_b16 a[200:201], v0 offset:8
    ds_read_b64_tr_b16 a[202:203], v0 offset:264
    ds_read_b64_tr_b16 a[204:205], v0 offset:520
    ds_read_b64_tr_b16 a[206:207], v0 offset:776
    ds_read_b64_tr_b16 a[208:209], v0 offset:64
    ds_read_b64_tr_b16 a[210:211], v0 offset:320
    ds_read_b64_tr_b16 a[212:213], v0 offset:576
    ds_read_b64_tr_b16 a[214:215], v0 offset:832
    ds_read_b64_tr_b16 a[216:217], v0 offset:72
    ds_read_b64_tr_b16 a[218:219], v0 offset:328
    ds_read_b64_tr_b16 a[220:221], v0 offset:584
    ds_read_b64_tr_b16 a[222:223], v0 offset:840
    s_waitcnt lgkmcnt(14)
    v_mfma_f32_16x16x32_bf16 v[128:131], a[192:195], v[16:19], 0
    ds_read_b64_tr_b16 a[224:225], v0 offset:128
    s_waitcnt lgkmcnt(13)
    v_mfma_f32_16x16x32_bf16 v[128:131], a[196:199], v[20:23], v[128:131]
    ds_read_b64_tr_b16 a[226:227], v0 offset:384
    v_mfma_f32_16x16x32_bf16 v[132:135], a[196:199], v[76:79], 0
    ds_read_b64_tr_b16 a[228:229], v0 offset:640
    v_add_f32 v224, v224, v226
    v_mfma_f32_16x16x32_bf16 v[132:135], a[192:195], v[72:75], v[132:135]
    ds_read_b64_tr_b16 a[230:231], v0 offset:896
    v_add_f32 v225, v225, v227
    v_mov_b32 v226, v224
    s_waitcnt lgkmcnt(14)
    v_mfma_f32_16x16x32_bf16 v[140:143], a[200:203], v[72:75], 0
    ds_read_b64_tr_b16 a[232:233], v0 offset:136
    ds_read_b64_tr_b16 a[234:235], v0 offset:392
    s_waitcnt lgkmcnt(14)
    v_mfma_f32_16x16x32_bf16 v[140:143], a[204:207], v[76:79], v[140:143]
    buffer_load_dwordx4 v2, s[12:15], 0 offen offset:0 lds
    v_mov_b32 v227, v225
    v_mfma_f32_16x16x32_bf16 v[136:139], a[204:207], v[20:23], 0
    ds_read_b64_tr_b16 a[236:237], v0 offset:648
    v_mfma_f32_16x16x32_bf16 v[136:139], a[200:203], v[16:19], v[136:139]
    s_waitcnt lgkmcnt(7)
    ds_read_b64_tr_b16 a[238:239], v0 offset:904
    v_permlane32_swap_b32 v224, v226
    v_mfma_f32_16x16x32_bf16 v[144:147], a[208:211], v[16:19], 0
    ds_read_b64_tr_b16 a[240:241], v0 offset:192
    ds_read_b64_tr_b16 a[242:243], v0 offset:448
    v_mfma_f32_16x16x32_bf16 v[144:147], a[212:215], v[20:23], v[144:147]
    buffer_load_dwordx4 v2, s[12:15], s56 offen offset:1032 lds
    v_permlane32_swap_b32 v225, v227
    v_mfma_f32_16x16x32_bf16 v[148:151], a[212:215], v[76:79], 0
    ds_read_b64_tr_b16 a[244:245], v0 offset:704
    v_add_f32 v224, v224, v226
    v_mfma_f32_16x16x32_bf16 v[148:151], a[208:211], v[72:75], v[148:151]
    ds_read_b64_tr_b16 a[246:247], v0 offset:960
    v_add_f32 v225, v225, v227
    v_mov_b32 v226, v224
    v_mfma_f32_16x16x32_bf16 v[156:159], a[216:219], v[72:75], 0
    ds_read_b64_tr_b16 a[248:249], v0 offset:200
    ds_read_b64_tr_b16 a[250:251], v0 offset:456
    v_mfma_f32_16x16x32_bf16 v[156:159], a[220:223], v[76:79], v[156:159]
    buffer_load_dwordx4 v2, s[12:15], s57 offen offset:2112 lds
    v_mov_b32 v227, v225
    v_mfma_f32_16x16x32_bf16 v[152:155], a[220:223], v[20:23], 0
    ds_read_b64_tr_b16 a[252:253], v0 offset:712
    ds_read_b64_tr_b16 a[254:255], v0 offset:968
    v_mfma_f32_16x16x32_bf16 v[152:155], a[216:219], v[16:19], v[152:155]
    s_waitcnt vmcnt(63) lgkmcnt(8)
    s_barrier
    v_permlane16_swap_b32 v224, v226
    v_mfma_f32_16x16x32_bf16 v[160:163], a[224:227], v[16:19], 0
    ds_read_b64_tr_b16 a[192:193], v0 offset:16896
    ds_read_b64_tr_b16 a[194:195], v0 offset:17152
    v_mfma_f32_16x16x32_bf16 v[160:163], a[228:231], v[20:23], v[160:163]
    buffer_load_dwordx4 v2, s[12:15], s63 offen offset:3144 lds
    s_add_u32 m0, s37, 67584
    v_mfma_f32_16x16x32_bf16 v[164:167], a[228:231], v[76:79], 0
    ds_read_b64_tr_b16 a[196:197], v0 offset:17408
    v_add_u32 v2, 524288, v2
    v_mfma_f32_16x16x32_bf16 v[164:167], a[224:227], v[72:75], v[164:167]
    ds_read_b64_tr_b16 a[198:199], v0 offset:17664
    v_permlane16_swap_b32 v225, v227
    v_mfma_f32_16x16x32_bf16 v[172:175], a[232:235], v[72:75], 0
    ds_read_b64_tr_b16 a[200:201], v0 offset:16904
    ds_read_b64_tr_b16 a[202:203], v0 offset:17160
    v_mfma_f32_16x16x32_bf16 v[172:175], a[236:239], v[76:79], v[172:175]
    buffer_load_dwordx4 v2, s[12:15], 0 offen offset:0 lds
    v_add_f32 v224, v224, v226
    v_mfma_f32_16x16x32_bf16 v[168:171], a[236:239], v[20:23], 0
    ds_read_b64_tr_b16 a[204:205], v0 offset:17416
    v_add_f32 v225, v225, v227
    v_mfma_f32_16x16x32_bf16 v[168:171], a[232:235], v[16:19], v[168:171]
    s_waitcnt lgkmcnt(7)
    ds_read_b64_tr_b16 a[206:207], v0 offset:17672
    v_mul_f32 v224, 0x3b124925, v224
    v_mfma_f32_16x16x32_bf16 v[176:179], a[240:243], v[16:19], 0
    ds_read_b64_tr_b16 a[208:209], v0 offset:16960
    ds_read_b64_tr_b16 a[210:211], v0 offset:17216
    v_mfma_f32_16x16x32_bf16 v[176:179], a[244:247], v[20:23], v[176:179]
    buffer_load_dwordx4 v2, s[12:15], s56 offen offset:1032 lds
    v_fma_f32 v224, -v216, v216, v224
    v_mfma_f32_16x16x32_bf16 v[180:183], a[244:247], v[76:79], 0
    ds_read_b64_tr_b16 a[212:213], v0 offset:17472
    v_max_f32 v224, 0, v224
    v_mfma_f32_16x16x32_bf16 v[180:183], a[240:243], v[72:75], v[180:183]
    ds_read_b64_tr_b16 a[214:215], v0 offset:17728
    v_cvt_pk_bf16_f32 v224, v224, v224
    v_lshlrev_b32 v224, 16, v224
    v_mfma_f32_16x16x32_bf16 v[188:191], a[248:251], v[72:75], 0
    ds_read_b64_tr_b16 a[216:217], v0 offset:16968
    ds_read_b64_tr_b16 a[218:219], v0 offset:17224
    v_mfma_f32_16x16x32_bf16 v[188:191], a[252:255], v[76:79], v[188:191]
    buffer_load_dwordx4 v2, s[12:15], s57 offen offset:2112 lds
    v_add_f32 v224, 0x3727c5ac, v224
    v_mfma_f32_16x16x32_bf16 v[184:187], a[252:255], v[20:23], 0
    ds_read_b64_tr_b16 a[220:221], v0 offset:17480
    v_cvt_pk_bf16_f32 v224, v224, v224
    v_mfma_f32_16x16x32_bf16 v[184:187], a[248:251], v[16:19], v[184:187]
    s_waitcnt lgkmcnt(7)
    ds_read_b64_tr_b16 a[222:223], v0 offset:17736
    v_lshlrev_b32 v224, 16, v224
    v_mfma_f32_16x16x32_bf16 v[128:131], a[192:195], v[24:27], v[128:131]
    ds_read_b64_tr_b16 a[224:225], v0 offset:17024
    ds_read_b64_tr_b16 a[226:227], v0 offset:17280
    v_mfma_f32_16x16x32_bf16 v[128:131], a[196:199], v[28:31], v[128:131]
    buffer_load_dwordx4 v2, s[12:15], s63 offen offset:3144 lds
    s_add_u32 m0, s37, 84480
    v_mfma_f32_16x16x32_bf16 v[132:135], a[196:199], v[84:87], v[132:135]
    ds_read_b64_tr_b16 a[228:229], v0 offset:17536
    v_add_u32 v2, 524288, v2
    v_mfma_f32_16x16x32_bf16 v[132:135], a[192:195], v[80:83], v[132:135]
    ds_read_b64_tr_b16 a[230:231], v0 offset:17792
    v_sqrt_f32 v224, v224
    v_mfma_f32_16x16x32_bf16 v[140:143], a[200:203], v[80:83], v[140:143]
    ds_read_b64_tr_b16 a[232:233], v0 offset:17032
    ds_read_b64_tr_b16 a[234:235], v0 offset:17288
    v_mfma_f32_16x16x32_bf16 v[140:143], a[204:207], v[84:87], v[140:143]
    buffer_load_dwordx4 v2, s[12:15], 0 offen offset:0 lds
    v_cvt_pk_bf16_f32 v224, v224, v224
    v_mfma_f32_16x16x32_bf16 v[136:139], a[204:207], v[28:31], v[136:139]
    ds_read_b64_tr_b16 a[236:237], v0 offset:17544
    v_lshlrev_b32 v224, 16, v224
    v_mfma_f32_16x16x32_bf16 v[136:139], a[200:203], v[24:27], v[136:139]
    s_waitcnt lgkmcnt(7)
    ds_read_b64_tr_b16 a[238:239], v0 offset:17800
    v_rcp_f32 v224, v224
    v_mfma_f32_16x16x32_bf16 v[144:147], a[208:211], v[24:27], v[144:147]
    ds_read_b64_tr_b16 a[240:241], v0 offset:17088
    ds_read_b64_tr_b16 a[242:243], v0 offset:17344
    v_mfma_f32_16x16x32_bf16 v[144:147], a[212:215], v[28:31], v[144:147]
    buffer_load_dwordx4 v2, s[12:15], s56 offen offset:1032 lds
    v_mul_f32 v3, v224, v224
    v_mfma_f32_16x16x32_bf16 v[148:151], a[212:215], v[84:87], v[148:151]
    ds_read_b64_tr_b16 a[244:245], v0 offset:17600
    v_mul_f32 v5, 0x3db8aa3b, v224
    v_mfma_f32_16x16x32_bf16 v[148:151], a[208:211], v[80:83], v[148:151]
    ds_read_b64_tr_b16 a[246:247], v0 offset:17856
    v_mul_f32 v225, 0x3b124925, v225
    v_fma_f32 v225, -v217, v217, v225
    v_mfma_f32_16x16x32_bf16 v[156:159], a[216:219], v[80:83], v[156:159]
    ds_read_b64_tr_b16 a[248:249], v0 offset:17096
    ds_read_b64_tr_b16 a[250:251], v0 offset:17352
    v_mfma_f32_16x16x32_bf16 v[156:159], a[220:223], v[84:87], v[156:159]
    buffer_load_dwordx4 v2, s[12:15], s57 offen offset:2112 lds
    v_max_f32 v225, 0, v225
    v_mfma_f32_16x16x32_bf16 v[152:155], a[220:223], v[28:31], v[152:155]
    ds_read_b64_tr_b16 a[252:253], v0 offset:17608
    ds_read_b64_tr_b16 a[254:255], v0 offset:17864
    v_mfma_f32_16x16x32_bf16 v[152:155], a[216:219], v[24:27], v[152:155]
    s_waitcnt vmcnt(13) lgkmcnt(8)
    s_barrier
    v_cvt_pk_bf16_f32 v225, v225, v225
    v_lshlrev_b32 v225, 16, v225
    v_mfma_f32_16x16x32_bf16 v[160:163], a[224:227], v[24:27], v[160:163]
    ds_read_b64_tr_b16 a[192:193], v0 offset:33792
    ds_read_b64_tr_b16 a[194:195], v0 offset:34048
    v_mfma_f32_16x16x32_bf16 v[160:163], a[228:231], v[28:31], v[160:163]
    buffer_load_dwordx4 v2, s[12:15], s63 offen offset:3144 lds
    s_add_u32 m0, s37, 101376
    v_add_f32 v225, 0x3727c5ac, v225
    v_mfma_f32_16x16x32_bf16 v[164:167], a[228:231], v[84:87], v[164:167]
    ds_read_b64_tr_b16 a[196:197], v0 offset:34304
    v_add_u32 v2, 524288, v2
    v_mfma_f32_16x16x32_bf16 v[164:167], a[224:227], v[80:83], v[164:167]
    ds_read_b64_tr_b16 a[198:199], v0 offset:34560
    v_cvt_pk_bf16_f32 v225, v225, v225
    v_lshlrev_b32 v225, 16, v225
    v_mfma_f32_16x16x32_bf16 v[172:175], a[232:235], v[80:83], v[172:175]
    ds_read_b64_tr_b16 a[200:201], v0 offset:33800
    ds_read_b64_tr_b16 a[202:203], v0 offset:34056
    v_mfma_f32_16x16x32_bf16 v[172:175], a[236:239], v[84:87], v[172:175]
    buffer_load_dwordx4 v2, s[12:15], 0 offen offset:0 lds
    v_sqrt_f32 v225, v225
    v_mfma_f32_16x16x32_bf16 v[168:171], a[236:239], v[28:31], v[168:171]
    ds_read_b64_tr_b16 a[204:205], v0 offset:34312
    v_cvt_pk_bf16_f32 v225, v225, v225
    v_mfma_f32_16x16x32_bf16 v[168:171], a[232:235], v[24:27], v[168:171]
    s_waitcnt lgkmcnt(7)
    ds_read_b64_tr_b16 a[206:207], v0 offset:34568
    v_lshlrev_b32 v225, 16, v225
    v_mfma_f32_16x16x32_bf16 v[176:179], a[240:243], v[24:27], v[176:179]
    ds_read_b64_tr_b16 a[208:209], v0 offset:33856
    ds_read_b64_tr_b16 a[210:211], v0 offset:34112
    v_mfma_f32_16x16x32_bf16 v[176:179], a[244:247], v[28:31], v[176:179]
    buffer_load_dwordx4 v2, s[12:15], s56 offen offset:1032 lds
    v_rcp_f32 v225, v225
    v_mfma_f32_16x16x32_bf16 v[180:183], a[244:247], v[84:87], v[180:183]
    ds_read_b64_tr_b16 a[212:213], v0 offset:34368
    v_mul_f32 v4, v225, v225
    v_mfma_f32_16x16x32_bf16 v[180:183], a[240:243], v[80:83], v[180:183]
    ds_read_b64_tr_b16 a[214:215], v0 offset:34624
    v_mul_f32 v6, 0x3db8aa3b, v225
    v_mfma_f32_16x16x32_bf16 v[188:191], a[248:251], v[80:83], v[188:191]
    ds_read_b64_tr_b16 a[216:217], v0 offset:33864
    ds_read_b64_tr_b16 a[218:219], v0 offset:34120
    v_mfma_f32_16x16x32_bf16 v[188:191], a[252:255], v[84:87], v[188:191]
    buffer_load_dwordx4 v2, s[12:15], s57 offen offset:2112 lds
    v_mfma_f32_16x16x32_bf16 v[184:187], a[252:255], v[28:31], v[184:187]
    ds_read_b64_tr_b16 a[220:221], v0 offset:34376
    v_mfma_f32_16x16x32_bf16 v[184:187], a[248:251], v[24:27], v[184:187]
    s_waitcnt lgkmcnt(7)
    ds_read_b64_tr_b16 a[222:223], v0 offset:34632
    v_mfma_f32_16x16x32_bf16 v[128:131], a[192:195], v[32:35], v[128:131]
    ds_read_b64_tr_b16 a[224:225], v0 offset:33920
    ds_read_b64_tr_b16 a[226:227], v0 offset:34176
    v_mfma_f32_16x16x32_bf16 v[128:131], a[196:199], v[36:39], v[128:131]
    buffer_load_dwordx4 v2, s[12:15], s63 offen offset:3144 lds
    s_add_u32 m0, s37, 118272
    v_mfma_f32_16x16x32_bf16 v[132:135], a[196:199], v[92:95], v[132:135]
    ds_read_b64_tr_b16 a[228:229], v0 offset:34432
    v_add_u32 v2, 4291821824, v2
    v_mfma_f32_16x16x32_bf16 v[132:135], a[192:195], v[88:91], v[132:135]
    ds_read_b64_tr_b16 a[230:231], v0 offset:34688
    v_mfma_f32_16x16x32_bf16 v[140:143], a[200:203], v[88:91], v[140:143]
    ds_read_b64_tr_b16 a[232:233], v0 offset:33928
    ds_read_b64_tr_b16 a[234:235], v0 offset:34184
    v_mfma_f32_16x16x32_bf16 v[140:143], a[204:207], v[92:95], v[140:143]
    buffer_load_dwordx4 v2, s[12:15], 0 offen offset:0 lds
    v_mfma_f32_16x16x32_bf16 v[136:139], a[204:207], v[36:39], v[136:139]
    ds_read_b64_tr_b16 a[236:237], v0 offset:34440
    v_mfma_f32_16x16x32_bf16 v[136:139], a[200:203], v[32:35], v[136:139]
    s_waitcnt lgkmcnt(7)
    ds_read_b64_tr_b16 a[238:239], v0 offset:34696
    v_mfma_f32_16x16x32_bf16 v[144:147], a[208:211], v[32:35], v[144:147]
    ds_read_b64_tr_b16 a[240:241], v0 offset:33984
    ds_read_b64_tr_b16 a[242:243], v0 offset:34240
    v_mfma_f32_16x16x32_bf16 v[144:147], a[212:215], v[36:39], v[144:147]
    buffer_load_dwordx4 v2, s[12:15], s56 offen offset:1032 lds
    v_mfma_f32_16x16x32_bf16 v[148:151], a[212:215], v[92:95], v[148:151]
    ds_read_b64_tr_b16 a[244:245], v0 offset:34496
    v_mfma_f32_16x16x32_bf16 v[148:151], a[208:211], v[88:91], v[148:151]
    ds_read_b64_tr_b16 a[246:247], v0 offset:34752
    v_mfma_f32_16x16x32_bf16 v[156:159], a[216:219], v[88:91], v[156:159]
    ds_read_b64_tr_b16 a[248:249], v0 offset:33992
    ds_read_b64_tr_b16 a[250:251], v0 offset:34248
    v_mfma_f32_16x16x32_bf16 v[156:159], a[220:223], v[92:95], v[156:159]
    buffer_load_dwordx4 v2, s[12:15], s57 offen offset:2112 lds
    v_mfma_f32_16x16x32_bf16 v[152:155], a[220:223], v[36:39], v[152:155]
    ds_read_b64_tr_b16 a[252:253], v0 offset:34504
    ds_read_b64_tr_b16 a[254:255], v0 offset:34760
    v_mfma_f32_16x16x32_bf16 v[152:155], a[216:219], v[32:35], v[152:155]
    s_waitcnt vmcnt(15) lgkmcnt(8)
    s_barrier
    v_mfma_f32_16x16x32_bf16 v[160:163], a[224:227], v[32:35], v[160:163]
    ds_read_b64_tr_b16 a[192:193], v0 offset:50688
    ds_read_b64_tr_b16 a[194:195], v0 offset:50944
    v_mfma_f32_16x16x32_bf16 v[160:163], a[228:231], v[36:39], v[160:163]
    buffer_load_dwordx4 v2, s[12:15], s63 offen offset:3144 lds
    s_add_u32 m0, s37, 0
    v_mfma_f32_16x16x32_bf16 v[164:167], a[228:231], v[92:95], v[164:167]
    ds_read_b64_tr_b16 a[196:197], v0 offset:51200
    v_add_u32 v2, 524288, v2
    v_mfma_f32_16x16x32_bf16 v[164:167], a[224:227], v[88:91], v[164:167]
    ds_read_b64_tr_b16 a[198:199], v0 offset:51456
    v_mfma_f32_16x16x32_bf16 v[172:175], a[232:235], v[88:91], v[172:175]
    ds_read_b64_tr_b16 a[200:201], v0 offset:50696
    ds_read_b64_tr_b16 a[202:203], v0 offset:50952
    v_mfma_f32_16x16x32_bf16 v[172:175], a[236:239], v[92:95], v[172:175]
    buffer_load_dwordx4 v2, s[12:15], 0 offen offset:0 lds
    v_mfma_f32_16x16x32_bf16 v[168:171], a[236:239], v[36:39], v[168:171]
    ds_read_b64_tr_b16 a[204:205], v0 offset:51208
    v_mfma_f32_16x16x32_bf16 v[168:171], a[232:235], v[32:35], v[168:171]
    s_waitcnt lgkmcnt(7)
    ds_read_b64_tr_b16 a[206:207], v0 offset:51464
    v_mfma_f32_16x16x32_bf16 v[176:179], a[240:243], v[32:35], v[176:179]
    ds_read_b64_tr_b16 a[208:209], v0 offset:50752
    ds_read_b64_tr_b16 a[210:211], v0 offset:51008
    v_mfma_f32_16x16x32_bf16 v[176:179], a[244:247], v[36:39], v[176:179]
    buffer_load_dwordx4 v2, s[12:15], s56 offen offset:1032 lds
    v_mfma_f32_16x16x32_bf16 v[180:183], a[244:247], v[92:95], v[180:183]
    ds_read_b64_tr_b16 a[212:213], v0 offset:51264
    v_mfma_f32_16x16x32_bf16 v[180:183], a[240:243], v[88:91], v[180:183]
    ds_read_b64_tr_b16 a[214:215], v0 offset:51520
    v_mfma_f32_16x16x32_bf16 v[188:191], a[248:251], v[88:91], v[188:191]
    ds_read_b64_tr_b16 a[216:217], v0 offset:50760
    ds_read_b64_tr_b16 a[218:219], v0 offset:51016
    v_mfma_f32_16x16x32_bf16 v[188:191], a[252:255], v[92:95], v[188:191]
    buffer_load_dwordx4 v2, s[12:15], s57 offen offset:2112 lds
    v_mfma_f32_16x16x32_bf16 v[184:187], a[252:255], v[36:39], v[184:187]
    ds_read_b64_tr_b16 a[220:221], v0 offset:51272
    v_mfma_f32_16x16x32_bf16 v[184:187], a[248:251], v[32:35], v[184:187]
    s_waitcnt lgkmcnt(7)
    ds_read_b64_tr_b16 a[222:223], v0 offset:51528
    v_mfma_f32_16x16x32_bf16 v[128:131], a[192:195], v[40:43], v[128:131]
    ds_read_b64_tr_b16 a[224:225], v0 offset:50816
    ds_read_b64_tr_b16 a[226:227], v0 offset:51072
    v_mfma_f32_16x16x32_bf16 v[128:131], a[196:199], v[44:47], v[128:131]
    buffer_load_dwordx4 v2, s[12:15], s63 offen offset:3144 lds
    s_add_u32 m0, s37, 16896
    v_mfma_f32_16x16x32_bf16 v[132:135], a[196:199], v[100:103], v[132:135]
    ds_read_b64_tr_b16 a[228:229], v0 offset:51328
    v_add_u32 v2, 524288, v2
    v_mfma_f32_16x16x32_bf16 v[132:135], a[192:195], v[96:99], v[132:135]
    ds_read_b64_tr_b16 a[230:231], v0 offset:51584
    v_mfma_f32_16x16x32_bf16 v[140:143], a[200:203], v[96:99], v[140:143]
    ds_read_b64_tr_b16 a[232:233], v0 offset:50824
    ds_read_b64_tr_b16 a[234:235], v0 offset:51080
    v_mfma_f32_16x16x32_bf16 v[140:143], a[204:207], v[100:103], v[140:143]
    buffer_load_dwordx4 v2, s[12:15], 0 offen offset:0 lds
    v_mfma_f32_16x16x32_bf16 v[136:139], a[204:207], v[44:47], v[136:139]
    ds_read_b64_tr_b16 a[236:237], v0 offset:51336
    v_mfma_f32_16x16x32_bf16 v[136:139], a[200:203], v[40:43], v[136:139]
    s_waitcnt lgkmcnt(7)
    ds_read_b64_tr_b16 a[238:239], v0 offset:51592
    v_mfma_f32_16x16x32_bf16 v[144:147], a[208:211], v[40:43], v[144:147]
    ds_read_b64_tr_b16 a[240:241], v0 offset:50880
    ds_read_b64_tr_b16 a[242:243], v0 offset:51136
    v_mfma_f32_16x16x32_bf16 v[144:147], a[212:215], v[44:47], v[144:147]
    buffer_load_dwordx4 v2, s[12:15], s56 offen offset:1032 lds
    v_mfma_f32_16x16x32_bf16 v[148:151], a[212:215], v[100:103], v[148:151]
    ds_read_b64_tr_b16 a[244:245], v0 offset:51392
    v_mfma_f32_16x16x32_bf16 v[148:151], a[208:211], v[96:99], v[148:151]
    ds_read_b64_tr_b16 a[246:247], v0 offset:51648
    v_mfma_f32_16x16x32_bf16 v[156:159], a[216:219], v[96:99], v[156:159]
    ds_read_b64_tr_b16 a[248:249], v0 offset:50888
    ds_read_b64_tr_b16 a[250:251], v0 offset:51144
    v_mfma_f32_16x16x32_bf16 v[156:159], a[220:223], v[100:103], v[156:159]
    buffer_load_dwordx4 v2, s[12:15], s57 offen offset:2112 lds
    v_mfma_f32_16x16x32_bf16 v[152:155], a[220:223], v[44:47], v[152:155]
    ds_read_b64_tr_b16 a[252:253], v0 offset:51400
    ds_read_b64_tr_b16 a[254:255], v0 offset:51656
    v_mfma_f32_16x16x32_bf16 v[152:155], a[216:219], v[40:43], v[152:155]
    s_waitcnt vmcnt(19) lgkmcnt(8)
    s_barrier
    v_mfma_f32_16x16x32_bf16 v[160:163], a[224:227], v[40:43], v[160:163]
    ds_read_b64_tr_b16 a[192:193], v1 offset:0
    ds_read_b64_tr_b16 a[194:195], v1 offset:256
    v_mfma_f32_16x16x32_bf16 v[160:163], a[228:231], v[44:47], v[160:163]
    buffer_load_dwordx4 v2, s[12:15], s63 offen offset:3144 lds
    s_add_u32 m0, s37, 33792
    v_mfma_f32_16x16x32_bf16 v[164:167], a[228:231], v[100:103], v[164:167]
    ds_read_b64_tr_b16 a[196:197], v1 offset:512
    v_add_u32 v2, 524288, v2
    v_mfma_f32_16x16x32_bf16 v[164:167], a[224:227], v[96:99], v[164:167]
    ds_read_b64_tr_b16 a[198:199], v1 offset:768
    v_mfma_f32_16x16x32_bf16 v[172:175], a[232:235], v[96:99], v[172:175]
    ds_read_b64_tr_b16 a[200:201], v1 offset:8
    ds_read_b64_tr_b16 a[202:203], v1 offset:264
    v_mfma_f32_16x16x32_bf16 v[172:175], a[236:239], v[100:103], v[172:175]
    buffer_load_dwordx4 v2, s[12:15], 0 offen offset:0 lds
    v_mfma_f32_16x16x32_bf16 v[168:171], a[236:239], v[44:47], v[168:171]
    ds_read_b64_tr_b16 a[204:205], v1 offset:520
    v_mfma_f32_16x16x32_bf16 v[168:171], a[232:235], v[40:43], v[168:171]
    s_waitcnt lgkmcnt(7)
    ds_read_b64_tr_b16 a[206:207], v1 offset:776
    v_mfma_f32_16x16x32_bf16 v[176:179], a[240:243], v[40:43], v[176:179]
    ds_read_b64_tr_b16 a[208:209], v1 offset:64
    ds_read_b64_tr_b16 a[210:211], v1 offset:320
    v_mfma_f32_16x16x32_bf16 v[176:179], a[244:247], v[44:47], v[176:179]
    buffer_load_dwordx4 v2, s[12:15], s56 offen offset:1032 lds
    v_mfma_f32_16x16x32_bf16 v[180:183], a[244:247], v[100:103], v[180:183]
    ds_read_b64_tr_b16 a[212:213], v1 offset:576
    v_mfma_f32_16x16x32_bf16 v[180:183], a[240:243], v[96:99], v[180:183]
    ds_read_b64_tr_b16 a[214:215], v1 offset:832
    v_mfma_f32_16x16x32_bf16 v[188:191], a[248:251], v[96:99], v[188:191]
    ds_read_b64_tr_b16 a[216:217], v1 offset:72
    ds_read_b64_tr_b16 a[218:219], v1 offset:328
    v_mfma_f32_16x16x32_bf16 v[188:191], a[252:255], v[100:103], v[188:191]
    buffer_load_dwordx4 v2, s[12:15], s57 offen offset:2112 lds
    v_mfma_f32_16x16x32_bf16 v[184:187], a[252:255], v[44:47], v[184:187]
    ds_read_b64_tr_b16 a[220:221], v1 offset:584
    v_mfma_f32_16x16x32_bf16 v[184:187], a[248:251], v[40:43], v[184:187]
    s_waitcnt lgkmcnt(7)
    ds_read_b64_tr_b16 a[222:223], v1 offset:840
    v_mfma_f32_16x16x32_bf16 v[128:131], a[192:195], v[48:51], v[128:131]
    ds_read_b64_tr_b16 a[224:225], v1 offset:128
    ds_read_b64_tr_b16 a[226:227], v1 offset:384
    v_mfma_f32_16x16x32_bf16 v[128:131], a[196:199], v[52:55], v[128:131]
    buffer_load_dwordx4 v2, s[12:15], s63 offen offset:3144 lds
    s_add_u32 m0, s37, 50688
    v_mfma_f32_16x16x32_bf16 v[132:135], a[196:199], v[108:111], v[132:135]
    ds_read_b64_tr_b16 a[228:229], v1 offset:640
    v_add_u32 v2, 524288, v2
    v_mfma_f32_16x16x32_bf16 v[132:135], a[192:195], v[104:107], v[132:135]
    ds_read_b64_tr_b16 a[230:231], v1 offset:896
    v_mfma_f32_16x16x32_bf16 v[140:143], a[200:203], v[104:107], v[140:143]
    ds_read_b64_tr_b16 a[232:233], v1 offset:136
    v_mfma_f32_16x16x32_bf16 v[140:143], a[204:207], v[108:111], v[140:143]
    ds_read_b64_tr_b16 a[234:235], v1 offset:392
    v_mfma_f32_16x16x32_bf16 v[136:139], a[204:207], v[52:55], v[136:139]
    ds_read_b64_tr_b16 a[236:237], v1 offset:648
    v_mfma_f32_16x16x32_bf16 v[136:139], a[200:203], v[48:51], v[136:139]
    s_waitcnt lgkmcnt(7)
    ds_read_b64_tr_b16 a[238:239], v1 offset:904
    v_mfma_f32_16x16x32_bf16 v[144:147], a[208:211], v[48:51], v[144:147]
    ds_read_b64_tr_b16 a[240:241], v1 offset:192
    v_mfma_f32_16x16x32_bf16 v[144:147], a[212:215], v[52:55], v[144:147]
    ds_read_b64_tr_b16 a[242:243], v1 offset:448
    v_mfma_f32_16x16x32_bf16 v[148:151], a[212:215], v[108:111], v[148:151]
    ds_read_b64_tr_b16 a[244:245], v1 offset:704
    v_mfma_f32_16x16x32_bf16 v[148:151], a[208:211], v[104:107], v[148:151]
    ds_read_b64_tr_b16 a[246:247], v1 offset:960
    v_mfma_f32_16x16x32_bf16 v[156:159], a[216:219], v[104:107], v[156:159]
    ds_read_b64_tr_b16 a[248:249], v1 offset:200
    v_mfma_f32_16x16x32_bf16 v[156:159], a[220:223], v[108:111], v[156:159]
    ds_read_b64_tr_b16 a[250:251], v1 offset:456
    v_mfma_f32_16x16x32_bf16 v[152:155], a[220:223], v[52:55], v[152:155]
    ds_read_b64_tr_b16 a[252:253], v1 offset:712
    ds_read_b64_tr_b16 a[254:255], v1 offset:968
    v_mfma_f32_16x16x32_bf16 v[152:155], a[216:219], v[48:51], v[152:155]
    s_waitcnt vmcnt(20) lgkmcnt(8)
    s_barrier
    v_mfma_f32_16x16x32_bf16 v[160:163], a[224:227], v[48:51], v[160:163]
    ds_read_b64_tr_b16 a[192:193], v1 offset:16896
    ds_read_b64_tr_b16 a[194:195], v1 offset:17152
    v_mfma_f32_16x16x32_bf16 v[160:163], a[228:231], v[52:55], v[160:163]
    buffer_load_dwordx4 v2, s[12:15], 0 offen offset:0 lds
    v_mfma_f32_16x16x32_bf16 v[164:167], a[228:231], v[108:111], v[164:167]
    ds_read_b64_tr_b16 a[196:197], v1 offset:17408
    v_mfma_f32_16x16x32_bf16 v[164:167], a[224:227], v[104:107], v[164:167]
    ds_read_b64_tr_b16 a[198:199], v1 offset:17664
    v_mfma_f32_16x16x32_bf16 v[172:175], a[232:235], v[104:107], v[172:175]
    ds_read_b64_tr_b16 a[200:201], v1 offset:16904
    ds_read_b64_tr_b16 a[202:203], v1 offset:17160
    v_mfma_f32_16x16x32_bf16 v[172:175], a[236:239], v[108:111], v[172:175]
    buffer_load_dwordx4 v2, s[12:15], s56 offen offset:1032 lds
    v_mfma_f32_16x16x32_bf16 v[168:171], a[236:239], v[52:55], v[168:171]
    ds_read_b64_tr_b16 a[204:205], v1 offset:17416
    v_mfma_f32_16x16x32_bf16 v[168:171], a[232:235], v[48:51], v[168:171]
    s_waitcnt lgkmcnt(7)
    ds_read_b64_tr_b16 a[206:207], v1 offset:17672
    v_mfma_f32_16x16x32_bf16 v[176:179], a[240:243], v[48:51], v[176:179]
    ds_read_b64_tr_b16 a[208:209], v1 offset:16960
    ds_read_b64_tr_b16 a[210:211], v1 offset:17216
    v_mfma_f32_16x16x32_bf16 v[176:179], a[244:247], v[52:55], v[176:179]
    buffer_load_dwordx4 v2, s[12:15], s57 offen offset:2112 lds
    v_mfma_f32_16x16x32_bf16 v[180:183], a[244:247], v[108:111], v[180:183]
    ds_read_b64_tr_b16 a[212:213], v1 offset:17472
    v_mfma_f32_16x16x32_bf16 v[180:183], a[240:243], v[104:107], v[180:183]
    ds_read_b64_tr_b16 a[214:215], v1 offset:17728
    v_mfma_f32_16x16x32_bf16 v[188:191], a[248:251], v[104:107], v[188:191]
    ds_read_b64_tr_b16 a[216:217], v1 offset:16968
    ds_read_b64_tr_b16 a[218:219], v1 offset:17224
    v_mfma_f32_16x16x32_bf16 v[188:191], a[252:255], v[108:111], v[188:191]
    buffer_load_dwordx4 v2, s[12:15], s63 offen offset:3144 lds
    s_add_u32 m0, s37, 67584
    v_mfma_f32_16x16x32_bf16 v[184:187], a[252:255], v[52:55], v[184:187]
    ds_read_b64_tr_b16 a[220:221], v1 offset:17480
    v_add_u32 v2, 524288, v2
    v_mfma_f32_16x16x32_bf16 v[184:187], a[248:251], v[48:51], v[184:187]
    s_waitcnt lgkmcnt(7)
    ds_read_b64_tr_b16 a[222:223], v1 offset:17736
    v_mfma_f32_16x16x32_bf16 v[128:131], a[192:195], v[56:59], v[128:131]
    ds_read_b64_tr_b16 a[224:225], v1 offset:17024
    v_mfma_f32_16x16x32_bf16 v[128:131], a[196:199], v[60:63], v[128:131]
    ds_read_b64_tr_b16 a[226:227], v1 offset:17280
    v_mfma_f32_16x16x32_bf16 v[132:135], a[196:199], v[116:119], v[132:135]
    ds_read_b64_tr_b16 a[228:229], v1 offset:17536
    v_mfma_f32_16x16x32_bf16 v[132:135], a[192:195], v[112:115], v[132:135]
    ds_read_b64_tr_b16 a[230:231], v1 offset:17792
    v_mfma_f32_16x16x32_bf16 v[140:143], a[200:203], v[112:115], v[140:143]
    ds_read_b64_tr_b16 a[232:233], v1 offset:17032
    v_mfma_f32_16x16x32_bf16 v[140:143], a[204:207], v[116:119], v[140:143]
    ds_read_b64_tr_b16 a[234:235], v1 offset:17288
    v_mfma_f32_16x16x32_bf16 v[136:139], a[204:207], v[60:63], v[136:139]
    ds_read_b64_tr_b16 a[236:237], v1 offset:17544
    v_mfma_f32_16x16x32_bf16 v[136:139], a[200:203], v[56:59], v[136:139]
    s_waitcnt lgkmcnt(7)
    ds_read_b64_tr_b16 a[238:239], v1 offset:17800
    v_mfma_f32_16x16x32_bf16 v[144:147], a[208:211], v[56:59], v[144:147]
    ds_read_b64_tr_b16 a[240:241], v1 offset:17088
    v_mfma_f32_16x16x32_bf16 v[144:147], a[212:215], v[60:63], v[144:147]
    ds_read_b64_tr_b16 a[242:243], v1 offset:17344
    v_mfma_f32_16x16x32_bf16 v[148:151], a[212:215], v[116:119], v[148:151]
    ds_read_b64_tr_b16 a[244:245], v1 offset:17600
    v_mfma_f32_16x16x32_bf16 v[148:151], a[208:211], v[112:115], v[148:151]
    ds_read_b64_tr_b16 a[246:247], v1 offset:17856
    v_mfma_f32_16x16x32_bf16 v[156:159], a[216:219], v[112:115], v[156:159]
    ds_read_b64_tr_b16 a[248:249], v1 offset:17096
    v_mfma_f32_16x16x32_bf16 v[156:159], a[220:223], v[116:119], v[156:159]
    ds_read_b64_tr_b16 a[250:251], v1 offset:17352
    v_mfma_f32_16x16x32_bf16 v[152:155], a[220:223], v[60:63], v[152:155]
    ds_read_b64_tr_b16 a[252:253], v1 offset:17608
    ds_read_b64_tr_b16 a[254:255], v1 offset:17864
    v_mfma_f32_16x16x32_bf16 v[152:155], a[216:219], v[56:59], v[152:155]
    s_waitcnt vmcnt(20) lgkmcnt(8)
    s_barrier
    v_mfma_f32_16x16x32_bf16 v[160:163], a[224:227], v[56:59], v[160:163]
    ds_read_b64_tr_b16 a[192:193], v1 offset:33792
    ds_read_b64_tr_b16 a[194:195], v1 offset:34048
    v_mfma_f32_16x16x32_bf16 v[160:163], a[228:231], v[60:63], v[160:163]
    buffer_load_dwordx4 v2, s[12:15], 0 offen offset:0 lds
    v_mfma_f32_16x16x32_bf16 v[164:167], a[228:231], v[116:119], v[164:167]
    ds_read_b64_tr_b16 a[196:197], v1 offset:34304
    v_mfma_f32_16x16x32_bf16 v[164:167], a[224:227], v[112:115], v[164:167]
    ds_read_b64_tr_b16 a[198:199], v1 offset:34560
    v_mfma_f32_16x16x32_bf16 v[172:175], a[232:235], v[112:115], v[172:175]
    ds_read_b64_tr_b16 a[200:201], v1 offset:33800
    ds_read_b64_tr_b16 a[202:203], v1 offset:34056
    v_mfma_f32_16x16x32_bf16 v[172:175], a[236:239], v[116:119], v[172:175]
    buffer_load_dwordx4 v2, s[12:15], s56 offen offset:1032 lds
    v_mfma_f32_16x16x32_bf16 v[168:171], a[236:239], v[60:63], v[168:171]
    ds_read_b64_tr_b16 a[204:205], v1 offset:34312
    v_mfma_f32_16x16x32_bf16 v[168:171], a[232:235], v[56:59], v[168:171]
    s_waitcnt lgkmcnt(7)
    ds_read_b64_tr_b16 a[206:207], v1 offset:34568
    v_mfma_f32_16x16x32_bf16 v[176:179], a[240:243], v[56:59], v[176:179]
    ds_read_b64_tr_b16 a[208:209], v1 offset:33856
    ds_read_b64_tr_b16 a[210:211], v1 offset:34112
    v_mfma_f32_16x16x32_bf16 v[176:179], a[244:247], v[60:63], v[176:179]
    buffer_load_dwordx4 v2, s[12:15], s57 offen offset:2112 lds
    v_mfma_f32_16x16x32_bf16 v[180:183], a[244:247], v[116:119], v[180:183]
    ds_read_b64_tr_b16 a[212:213], v1 offset:34368
    v_mfma_f32_16x16x32_bf16 v[180:183], a[240:243], v[112:115], v[180:183]
    ds_read_b64_tr_b16 a[214:215], v1 offset:34624
    v_mfma_f32_16x16x32_bf16 v[188:191], a[248:251], v[112:115], v[188:191]
    ds_read_b64_tr_b16 a[216:217], v1 offset:33864
    ds_read_b64_tr_b16 a[218:219], v1 offset:34120
    v_mfma_f32_16x16x32_bf16 v[188:191], a[252:255], v[116:119], v[188:191]
    buffer_load_dwordx4 v2, s[12:15], s63 offen offset:3144 lds
    s_add_u32 m0, s37, 84480
    v_mfma_f32_16x16x32_bf16 v[184:187], a[252:255], v[60:63], v[184:187]
    ds_read_b64_tr_b16 a[220:221], v1 offset:34376
    v_add_u32 v2, 524288, v2
    v_mfma_f32_16x16x32_bf16 v[184:187], a[248:251], v[56:59], v[184:187]
    s_waitcnt lgkmcnt(7)
    ds_read_b64_tr_b16 a[222:223], v1 offset:34632
    v_mfma_f32_16x16x32_bf16 v[128:131], a[192:195], v[64:67], v[128:131]
    ds_read_b64_tr_b16 a[224:225], v1 offset:33920
    v_mfma_f32_16x16x32_bf16 v[128:131], a[196:199], v[68:71], v[128:131]
    ds_read_b64_tr_b16 a[226:227], v1 offset:34176
    v_mfma_f32_16x16x32_bf16 v[132:135], a[196:199], v[124:127], v[132:135]
    ds_read_b64_tr_b16 a[228:229], v1 offset:34432
    v_mfma_f32_16x16x32_bf16 v[132:135], a[192:195], v[120:123], v[132:135]
    ds_read_b64_tr_b16 a[230:231], v1 offset:34688
    v_mfma_f32_16x16x32_bf16 v[140:143], a[200:203], v[120:123], v[140:143]
    ds_read_b64_tr_b16 a[232:233], v1 offset:33928
    v_mfma_f32_16x16x32_bf16 v[140:143], a[204:207], v[124:127], v[140:143]
    ds_read_b64_tr_b16 a[234:235], v1 offset:34184
    v_mfma_f32_16x16x32_bf16 v[136:139], a[204:207], v[68:71], v[136:139]
    ds_read_b64_tr_b16 a[236:237], v1 offset:34440
    v_mfma_f32_16x16x32_bf16 v[136:139], a[200:203], v[64:67], v[136:139]
    s_waitcnt lgkmcnt(7)
    ds_read_b64_tr_b16 a[238:239], v1 offset:34696
    v_mfma_f32_16x16x32_bf16 v[144:147], a[208:211], v[64:67], v[144:147]
    ds_read_b64_tr_b16 a[240:241], v1 offset:33984
    v_mfma_f32_16x16x32_bf16 v[144:147], a[212:215], v[68:71], v[144:147]
    ds_read_b64_tr_b16 a[242:243], v1 offset:34240
    v_mfma_f32_16x16x32_bf16 v[148:151], a[212:215], v[124:127], v[148:151]
    ds_read_b64_tr_b16 a[244:245], v1 offset:34496
    v_mfma_f32_16x16x32_bf16 v[148:151], a[208:211], v[120:123], v[148:151]
    ds_read_b64_tr_b16 a[246:247], v1 offset:34752
    v_mfma_f32_16x16x32_bf16 v[156:159], a[216:219], v[120:123], v[156:159]
    ds_read_b64_tr_b16 a[248:249], v1 offset:33992
    v_mfma_f32_16x16x32_bf16 v[156:159], a[220:223], v[124:127], v[156:159]
    ds_read_b64_tr_b16 a[250:251], v1 offset:34248
    v_mfma_f32_16x16x32_bf16 v[152:155], a[220:223], v[68:71], v[152:155]
    ds_read_b64_tr_b16 a[252:253], v1 offset:34504
    ds_read_b64_tr_b16 a[254:255], v1 offset:34760
    v_mfma_f32_16x16x32_bf16 v[152:155], a[216:219], v[64:67], v[152:155]
    s_waitcnt vmcnt(20) lgkmcnt(8)
    s_barrier
    v_mfma_f32_16x16x32_bf16 v[160:163], a[224:227], v[64:67], v[160:163]
    ds_read_b64_tr_b16 a[192:193], v1 offset:50688
    ds_read_b64_tr_b16 a[194:195], v1 offset:50944
    v_mfma_f32_16x16x32_bf16 v[160:163], a[228:231], v[68:71], v[160:163]
    buffer_load_dwordx4 v2, s[12:15], 0 offen offset:0 lds
    v_mfma_f32_16x16x32_bf16 v[164:167], a[228:231], v[124:127], v[164:167]
    ds_read_b64_tr_b16 a[196:197], v1 offset:51200
    v_mfma_f32_16x16x32_bf16 v[164:167], a[224:227], v[120:123], v[164:167]
    ds_read_b64_tr_b16 a[198:199], v1 offset:51456
    v_mfma_f32_16x16x32_bf16 v[172:175], a[232:235], v[120:123], v[172:175]
    ds_read_b64_tr_b16 a[200:201], v1 offset:50696
    ds_read_b64_tr_b16 a[202:203], v1 offset:50952
    v_mfma_f32_16x16x32_bf16 v[172:175], a[236:239], v[124:127], v[172:175]
    buffer_load_dwordx4 v2, s[12:15], s56 offen offset:1032 lds
    v_mfma_f32_16x16x32_bf16 v[168:171], a[236:239], v[68:71], v[168:171]
    ds_read_b64_tr_b16 a[204:205], v1 offset:51208
    v_mfma_f32_16x16x32_bf16 v[168:171], a[232:235], v[64:67], v[168:171]
    s_waitcnt lgkmcnt(7)
    ds_read_b64_tr_b16 a[206:207], v1 offset:51464
    v_mfma_f32_16x16x32_bf16 v[176:179], a[240:243], v[64:67], v[176:179]
    ds_read_b64_tr_b16 a[208:209], v1 offset:50752
    ds_read_b64_tr_b16 a[210:211], v1 offset:51008
    v_mfma_f32_16x16x32_bf16 v[176:179], a[244:247], v[68:71], v[176:179]
    buffer_load_dwordx4 v2, s[12:15], s57 offen offset:2112 lds
    v_mfma_f32_16x16x32_bf16 v[180:183], a[244:247], v[124:127], v[180:183]
    ds_read_b64_tr_b16 a[212:213], v1 offset:51264
    v_mfma_f32_16x16x32_bf16 v[180:183], a[240:243], v[120:123], v[180:183]
    ds_read_b64_tr_b16 a[214:215], v1 offset:51520
    v_mfma_f32_16x16x32_bf16 v[188:191], a[248:251], v[120:123], v[188:191]
    ds_read_b64_tr_b16 a[216:217], v1 offset:50760
    ds_read_b64_tr_b16 a[218:219], v1 offset:51016
    v_mfma_f32_16x16x32_bf16 v[188:191], a[252:255], v[124:127], v[188:191]
    buffer_load_dwordx4 v2, s[12:15], s63 offen offset:3144 lds
    s_add_u32 m0, s52, 101376
    v_mfma_f32_16x16x32_bf16 v[184:187], a[252:255], v[68:71], v[184:187]
    s_mov_b32 s58, 0
    ds_read_b64_tr_b16 a[220:221], v1 offset:51272
    v_mfma_f32_16x16x32_bf16 v[184:187], a[248:251], v[64:67], v[184:187]
    s_waitcnt lgkmcnt(7)
    ds_read_b64_tr_b16 a[222:223], v1 offset:51528
    v_mfma_f32_16x16x32_bf16 v[192:195], a[192:195], v[16:19], 0
    ds_read_b64_tr_b16 a[224:225], v1 offset:50816
    v_mfma_f32_16x16x32_bf16 v[192:195], a[196:199], v[20:23], v[192:195]
    ds_read_b64_tr_b16 a[226:227], v1 offset:51072
    v_mfma_f32_16x16x32_bf16 v[196:199], a[196:199], v[76:79], 0
    ds_read_b64_tr_b16 a[228:229], v1 offset:51328
    v_mfma_f32_16x16x32_bf16 v[196:199], a[192:195], v[72:75], v[196:199]
    ds_read_b64_tr_b16 a[230:231], v1 offset:51584
    v_mfma_f32_16x16x32_bf16 v[204:207], a[200:203], v[72:75], 0
    ds_read_b64_tr_b16 a[232:233], v1 offset:50824
    v_mfma_f32_16x16x32_bf16 v[204:207], a[204:207], v[76:79], v[204:207]
    ds_read_b64_tr_b16 a[234:235], v1 offset:51080
    v_mul_f32 v128, v128, v5
    v_mul_f32 v136, v136, v5
    v_mfma_f32_16x16x32_bf16 v[200:203], a[204:207], v[20:23], 0
    ds_read_b64_tr_b16 a[236:237], v1 offset:51336
    v_mul_f32 v129, v129, v5
    v_mfma_f32_16x16x32_bf16 v[200:203], a[200:203], v[16:19], v[200:203]
    s_waitcnt lgkmcnt(7)
    ds_read_b64_tr_b16 a[238:239], v1 offset:51592
    v_mul_f32 v137, v137, v5
    v_mfma_f32_16x16x32_bf16 v[208:211], a[208:211], v[16:19], 0
    ds_read_b64_tr_b16 a[240:241], v1 offset:50880
    v_mul_f32 v130, v130, v5
    v_mfma_f32_16x16x32_bf16 v[208:211], a[212:215], v[20:23], v[208:211]
    ds_read_b64_tr_b16 a[242:243], v1 offset:51136
    v_mul_f32 v138, v138, v5
    v_mul_f32 v131, v131, v5
    v_mfma_f32_16x16x32_bf16 v[212:215], a[212:215], v[76:79], 0
    ds_read_b64_tr_b16 a[244:245], v1 offset:51392
    v_mul_f32 v139, v139, v5
    v_mfma_f32_16x16x32_bf16 v[212:215], a[208:211], v[72:75], v[212:215]
    ds_read_b64_tr_b16 a[246:247], v1 offset:51648
    v_cvt_pk_bf16_f32 v128, v128, v129
    v_cvt_pk_bf16_f32 v136, v136, v137
    v_mfma_f32_16x16x32_bf16 v[220:223], a[216:219], v[72:75], 0
    ds_read_b64_tr_b16 a[248:249], v1 offset:50888
    v_cvt_pk_bf16_f32 v129, v130, v131
    v_mfma_f32_16x16x32_bf16 v[220:223], a[220:223], v[76:79], v[220:223]
    ds_read_b64_tr_b16 a[250:251], v1 offset:51144
    v_cvt_pk_bf16_f32 v137, v138, v139
    v_accvgpr_write_b32 a0, v128
    v_mfma_f32_16x16x32_bf16 v[216:219], a[220:223], v[20:23], 0
    ds_read_b64_tr_b16 a[252:253], v1 offset:51400
    ds_read_b64_tr_b16 a[254:255], v1 offset:51656
    v_mfma_f32_16x16x32_bf16 v[216:219], a[216:219], v[16:19], v[216:219]
    s_waitcnt vmcnt(20) lgkmcnt(8)
    s_barrier
    v_accvgpr_write_b32 a1, v129
    v_accvgpr_write_b32 a2, v136
    s_lshr_b32 s42, s2, 3
    s_lshl2_add_u32 s42, s42, s36
    s_mul_i32 s42, s42, 1024
    v_lshlrev_b32 v7, 7, v13
    s_mov_b64 exec, 0xff
    buffer_load_dword v15, v7, s[20:23], s42 offen
    s_mov_b64 exec, -1
    s_lshr_b32 s42, s2, 3
    s_lshl2_add_u32 s42, s42, s36
    s_mul_i32 s42, s42, 1024
    v_lshlrev_b32 v7, 7, v13
    s_mov_b64 exec, 0xff
    buffer_load_dword v15, v7, s[24:27], s42 offen
    s_mov_b64 exec, -1
    v_mfma_f32_16x16x32_bf16 v[224:227], a[224:227], v[16:19], 0
    ds_read_b64_tr_b16 a[192:193], v0 offset:0
    v_accvgpr_write_b32 a3, v137
    v_mfma_f32_16x16x32_bf16 v[224:227], a[228:231], v[20:23], v[224:227]
    ds_read_b64_tr_b16 a[194:195], v0 offset:256
    v_mul_f32 v132, v132, v6
    v_mul_f32 v140, v140, v6
    v_mfma_f32_16x16x32_bf16 v[228:231], a[228:231], v[76:79], 0
    ds_read_b64_tr_b16 a[196:197], v0 offset:512
    v_mul_f32 v133, v133, v6
    v_mfma_f32_16x16x32_bf16 v[228:231], a[224:227], v[72:75], v[228:231]
    ds_read_b64_tr_b16 a[198:199], v0 offset:768
    v_mul_f32 v141, v141, v6
    v_mul_f32 v134, v134, v6
    v_mfma_f32_16x16x32_bf16 v[236:239], a[232:235], v[72:75], 0
    ds_read_b64_tr_b16 a[200:201], v0 offset:8
    v_mul_f32 v142, v142, v6
    v_mfma_f32_16x16x32_bf16 v[236:239], a[236:239], v[76:79], v[236:239]
    ds_read_b64_tr_b16 a[202:203], v0 offset:264
    v_mul_f32 v135, v135, v6
    v_mul_f32 v143, v143, v6
    v_mfma_f32_16x16x32_bf16 v[232:235], a[236:239], v[20:23], 0
    ds_read_b64_tr_b16 a[204:205], v0 offset:520
    v_cvt_pk_bf16_f32 v132, v132, v133
    v_mfma_f32_16x16x32_bf16 v[232:235], a[232:235], v[16:19], v[232:235]
    s_waitcnt lgkmcnt(7)
    ds_read_b64_tr_b16 a[206:207], v0 offset:776
    v_cvt_pk_bf16_f32 v140, v140, v141
    v_mfma_f32_16x16x32_bf16 v[240:243], a[240:243], v[16:19], 0
    ds_read_b64_tr_b16 a[208:209], v0 offset:64
    v_cvt_pk_bf16_f32 v133, v134, v135
    v_mfma_f32_16x16x32_bf16 v[240:243], a[244:247], v[20:23], v[240:243]
    ds_read_b64_tr_b16 a[210:211], v0 offset:320
    v_cvt_pk_bf16_f32 v141, v142, v143
    v_accvgpr_write_b32 a32, v132
    v_mfma_f32_16x16x32_bf16 v[244:247], a[244:247], v[76:79], 0
    ds_read_b64_tr_b16 a[212:213], v0 offset:576
    v_accvgpr_write_b32 a33, v133
    v_mfma_f32_16x16x32_bf16 v[244:247], a[240:243], v[72:75], v[244:247]
    ds_read_b64_tr_b16 a[214:215], v0 offset:832
    v_accvgpr_write_b32 a34, v140
    v_accvgpr_write_b32 a35, v141
    v_mfma_f32_16x16x32_bf16 v[252:255], a[248:251], v[72:75], 0
    ds_read_b64_tr_b16 a[216:217], v0 offset:72
    v_accvgpr_read_b32 v128, a64
    v_mfma_f32_16x16x32_bf16 v[252:255], a[252:255], v[76:79], v[252:255]
    ds_read_b64_tr_b16 a[218:219], v0 offset:328
    v_accvgpr_read_b32 v129, a65
    v_accvgpr_read_b32 v130, a66
    v_mfma_f32_16x16x32_bf16 v[248:251], a[252:255], v[20:23], 0
    ds_read_b64_tr_b16 a[220:221], v0 offset:584
    v_accvgpr_read_b32 v131, a67
    v_mfma_f32_16x16x32_bf16 v[248:251], a[248:251], v[16:19], v[248:251]
    s_waitcnt lgkmcnt(7)
    ds_read_b64_tr_b16 a[222:223], v0 offset:840
    v_accvgpr_read_b32 v132, a68
    v_mfma_f32_16x16x32_bf16 v[192:195], a[192:195], v[24:27], v[192:195]
    ds_read_b64_tr_b16 a[224:225], v0 offset:128
    v_accvgpr_read_b32 v133, a69
    v_mfma_f32_16x16x32_bf16 v[192:195], a[196:199], v[28:31], v[192:195]
    ds_read_b64_tr_b16 a[226:227], v0 offset:384
    v_accvgpr_read_b32 v134, a70
    v_accvgpr_read_b32 v135, a71
    v_mfma_f32_16x16x32_bf16 v[196:199], a[196:199], v[84:87], v[196:199]
    ds_read_b64_tr_b16 a[228:229], v0 offset:640
    v_accvgpr_read_b32 v136, a72
    v_mfma_f32_16x16x32_bf16 v[196:199], a[192:195], v[80:83], v[196:199]
    ds_read_b64_tr_b16 a[230:231], v0 offset:896
    v_accvgpr_read_b32 v137, a73
    v_accvgpr_read_b32 v138, a74
    v_mfma_f32_16x16x32_bf16 v[204:207], a[200:203], v[80:83], v[204:207]
    ds_read_b64_tr_b16 a[232:233], v0 offset:136
    v_mul_f32 v144, v144, v5
    v_mfma_f32_16x16x32_bf16 v[204:207], a[204:207], v[84:87], v[204:207]
    ds_read_b64_tr_b16 a[234:235], v0 offset:392
    v_mul_f32 v152, v152, v5
    v_mul_f32 v145, v145, v5
    v_mfma_f32_16x16x32_bf16 v[200:203], a[204:207], v[28:31], v[200:203]
    ds_read_b64_tr_b16 a[236:237], v0 offset:648
    v_mul_f32 v153, v153, v5
    v_mfma_f32_16x16x32_bf16 v[200:203], a[200:203], v[24:27], v[200:203]
    s_waitcnt lgkmcnt(7)
    ds_read_b64_tr_b16 a[238:239], v0 offset:904
    v_mul_f32 v146, v146, v5
    v_mfma_f32_16x16x32_bf16 v[208:211], a[208:211], v[24:27], v[208:211]
    ds_read_b64_tr_b16 a[240:241], v0 offset:192
    v_mul_f32 v154, v154, v5
    v_mfma_f32_16x16x32_bf16 v[208:211], a[212:215], v[28:31], v[208:211]
    ds_read_b64_tr_b16 a[242:243], v0 offset:448
    v_mul_f32 v147, v147, v5
    v_mul_f32 v155, v155, v5
    v_mfma_f32_16x16x32_bf16 v[212:215], a[212:215], v[84:87], v[212:215]
    ds_read_b64_tr_b16 a[244:245], v0 offset:704
    v_cvt_pk_bf16_f32 v144, v144, v145
    v_mfma_f32_16x16x32_bf16 v[212:215], a[208:211], v[80:83], v[212:215]
    ds_read_b64_tr_b16 a[246:247], v0 offset:960
    v_cvt_pk_bf16_f32 v152, v152, v153
    v_cvt_pk_bf16_f32 v145, v146, v147
    v_mfma_f32_16x16x32_bf16 v[220:223], a[216:219], v[80:83], v[220:223]
    ds_read_b64_tr_b16 a[248:249], v0 offset:200
    v_cvt_pk_bf16_f32 v153, v154, v155
    v_mfma_f32_16x16x32_bf16 v[220:223], a[220:223], v[84:87], v[220:223]
    ds_read_b64_tr_b16 a[250:251], v0 offset:456
    v_accvgpr_write_b32 a4, v144
    v_accvgpr_write_b32 a5, v145
    v_mfma_f32_16x16x32_bf16 v[216:219], a[220:223], v[28:31], v[216:219]
    ds_read_b64_tr_b16 a[252:253], v0 offset:712
    ds_read_b64_tr_b16 a[254:255], v0 offset:968
    v_mfma_f32_16x16x32_bf16 v[216:219], a[216:219], v[24:27], v[216:219]
    s_waitcnt vmcnt(18) lgkmcnt(8)
    s_barrier
    v_accvgpr_write_b32 a6, v152
    v_accvgpr_write_b32 a7, v153
    v_mfma_f32_16x16x32_bf16 v[224:227], a[224:227], v[24:27], v[224:227]
    ds_read_b64_tr_b16 a[192:193], v0 offset:16896
    ds_read_b64_tr_b16 a[194:195], v0 offset:17152
    v_mfma_f32_16x16x32_bf16 v[224:227], a[228:231], v[28:31], v[224:227]
    buffer_load_dwordx4 v132, s[8:11], s58 offen offset:0 lds
    v_mul_f32 v148, v148, v6
    v_mfma_f32_16x16x32_bf16 v[228:231], a[228:231], v[84:87], v[228:231]
    ds_read_b64_tr_b16 a[196:197], v0 offset:17408
    v_mul_f32 v156, v156, v6
    v_mfma_f32_16x16x32_bf16 v[228:231], a[224:227], v[80:83], v[228:231]
    ds_read_b64_tr_b16 a[198:199], v0 offset:17664
    v_mul_f32 v149, v149, v6
    v_mul_f32 v157, v157, v6
    v_mfma_f32_16x16x32_bf16 v[236:239], a[232:235], v[80:83], v[236:239]
    ds_read_b64_tr_b16 a[200:201], v0 offset:16904
    ds_read_b64_tr_b16 a[202:203], v0 offset:17160
    v_mfma_f32_16x16x32_bf16 v[236:239], a[236:239], v[84:87], v[236:239]
    buffer_load_dwordx4 v133, s[8:11], s58 offen offset:1024 lds
    v_mul_f32 v150, v150, v6
    v_mfma_f32_16x16x32_bf16 v[232:235], a[236:239], v[28:31], v[232:235]
    ds_read_b64_tr_b16 a[204:205], v0 offset:17416
    v_mul_f32 v158, v158, v6
    v_mfma_f32_16x16x32_bf16 v[232:235], a[232:235], v[24:27], v[232:235]
    s_waitcnt lgkmcnt(7)
    ds_read_b64_tr_b16 a[206:207], v0 offset:17672
    v_mul_f32 v151, v151, v6
    v_mfma_f32_16x16x32_bf16 v[240:243], a[240:243], v[24:27], v[240:243]
    ds_read_b64_tr_b16 a[208:209], v0 offset:16960
    ds_read_b64_tr_b16 a[210:211], v0 offset:17216
    v_mfma_f32_16x16x32_bf16 v[240:243], a[244:247], v[28:31], v[240:243]
    buffer_load_dwordx4 v134, s[8:11], s58 offen offset:2048 lds
    v_mul_f32 v159, v159, v6
    v_mfma_f32_16x16x32_bf16 v[244:247], a[244:247], v[84:87], v[244:247]
    ds_read_b64_tr_b16 a[212:213], v0 offset:17472
    v_cvt_pk_bf16_f32 v148, v148, v149
    v_mfma_f32_16x16x32_bf16 v[244:247], a[240:243], v[80:83], v[244:247]
    ds_read_b64_tr_b16 a[214:215], v0 offset:17728
    v_cvt_pk_bf16_f32 v156, v156, v157
    v_cvt_pk_bf16_f32 v149, v150, v151
    v_mfma_f32_16x16x32_bf16 v[252:255], a[248:251], v[80:83], v[252:255]
    ds_read_b64_tr_b16 a[216:217], v0 offset:16968
    ds_read_b64_tr_b16 a[218:219], v0 offset:17224
    v_mfma_f32_16x16x32_bf16 v[252:255], a[252:255], v[84:87], v[252:255]
    buffer_load_dwordx4 v135, s[8:11], s58 offen offset:3072 lds
    s_add_u32 m0, s52, 105472
    v_cvt_pk_bf16_f32 v157, v158, v159
    v_mfma_f32_16x16x32_bf16 v[248:251], a[252:255], v[28:31], v[248:251]
    ds_read_b64_tr_b16 a[220:221], v0 offset:17480
    v_accvgpr_write_b32 a36, v148
    v_mfma_f32_16x16x32_bf16 v[248:251], a[248:251], v[24:27], v[248:251]
    s_waitcnt lgkmcnt(7)
    ds_read_b64_tr_b16 a[222:223], v0 offset:17736
    v_accvgpr_write_b32 a37, v149
    v_mfma_f32_16x16x32_bf16 v[192:195], a[192:195], v[32:35], v[192:195]
    ds_read_b64_tr_b16 a[224:225], v0 offset:17024
    ds_read_b64_tr_b16 a[226:227], v0 offset:17280
    v_mfma_f32_16x16x32_bf16 v[192:195], a[196:199], v[36:39], v[192:195]
    buffer_load_dwordx4 v136, s[8:11], s58 offen offset:0 lds
    v_accvgpr_write_b32 a38, v156
    v_mfma_f32_16x16x32_bf16 v[196:199], a[196:199], v[92:95], v[196:199]
    ds_read_b64_tr_b16 a[228:229], v0 offset:17536
    v_accvgpr_write_b32 a39, v157
    v_mfma_f32_16x16x32_bf16 v[196:199], a[192:195], v[88:91], v[196:199]
    ds_read_b64_tr_b16 a[230:231], v0 offset:17792
    v_mul_f32 v160, v160, v5
    v_mul_f32 v168, v168, v5
    v_mfma_f32_16x16x32_bf16 v[204:207], a[200:203], v[88:91], v[204:207]
    ds_read_b64_tr_b16 a[232:233], v0 offset:17032
    ds_read_b64_tr_b16 a[234:235], v0 offset:17288
    v_mfma_f32_16x16x32_bf16 v[204:207], a[204:207], v[92:95], v[204:207]
    buffer_load_dwordx4 v137, s[8:11], s58 offen offset:1024 lds
    v_mul_f32 v161, v161, v5
    v_mfma_f32_16x16x32_bf16 v[200:203], a[204:207], v[36:39], v[200:203]
    ds_read_b64_tr_b16 a[236:237], v0 offset:17544
    v_mul_f32 v169, v169, v5
    v_mfma_f32_16x16x32_bf16 v[200:203], a[200:203], v[32:35], v[200:203]
    s_waitcnt lgkmcnt(7)
    ds_read_b64_tr_b16 a[238:239], v0 offset:17800
    v_mul_f32 v162, v162, v5
    v_mfma_f32_16x16x32_bf16 v[208:211], a[208:211], v[32:35], v[208:211]
    ds_read_b64_tr_b16 a[240:241], v0 offset:17088
    ds_read_b64_tr_b16 a[242:243], v0 offset:17344
    v_mfma_f32_16x16x32_bf16 v[208:211], a[212:215], v[36:39], v[208:211]
    buffer_load_dwordx4 v138, s[8:11], s58 offen offset:2048 lds
    s_add_u32 m0, s52, 0
    v_mul_f32 v170, v170, v5
    v_mfma_f32_16x16x32_bf16 v[212:215], a[212:215], v[92:95], v[212:215]
    s_mov_b32 s58, 229376
    ds_read_b64_tr_b16 a[244:245], v0 offset:17600
    v_mfma_f32_16x16x32_bf16 v[212:215], a[208:211], v[88:91], v[212:215]
    ds_read_b64_tr_b16 a[246:247], v0 offset:17856
    v_mul_f32 v163, v163, v5
    v_mul_f32 v171, v171, v5
    v_mfma_f32_16x16x32_bf16 v[220:223], a[216:219], v[88:91], v[220:223]
    ds_read_b64_tr_b16 a[248:249], v0 offset:17096
    v_cvt_pk_bf16_f32 v160, v160, v161
    v_mfma_f32_16x16x32_bf16 v[220:223], a[220:223], v[92:95], v[220:223]
    ds_read_b64_tr_b16 a[250:251], v0 offset:17352
    v_cvt_pk_bf16_f32 v168, v168, v169
    v_cvt_pk_bf16_f32 v161, v162, v163
    v_mfma_f32_16x16x32_bf16 v[216:219], a[220:223], v[36:39], v[216:219]
    ds_read_b64_tr_b16 a[252:253], v0 offset:17608
    ds_read_b64_tr_b16 a[254:255], v0 offset:17864
    v_mfma_f32_16x16x32_bf16 v[216:219], a[216:219], v[32:35], v[216:219]
    s_waitcnt vmcnt(21) lgkmcnt(8)
    s_barrier
    v_cvt_pk_bf16_f32 v169, v170, v171
    v_accvgpr_write_b32 a8, v160
    v_mfma_f32_16x16x32_bf16 v[224:227], a[224:227], v[32:35], v[224:227]
    ds_read_b64_tr_b16 a[192:193], v0 offset:33792
    v_accvgpr_write_b32 a9, v161
    v_mfma_f32_16x16x32_bf16 v[224:227], a[228:231], v[36:39], v[224:227]
    ds_read_b64_tr_b16 a[194:195], v0 offset:34048
    v_accvgpr_write_b32 a10, v168
    v_accvgpr_write_b32 a11, v169
    v_mfma_f32_16x16x32_bf16 v[228:231], a[228:231], v[92:95], v[228:231]
    ds_read_b64_tr_b16 a[196:197], v0 offset:34304
    v_mul_f32 v164, v164, v6
    v_mfma_f32_16x16x32_bf16 v[228:231], a[224:227], v[88:91], v[228:231]
    ds_read_b64_tr_b16 a[198:199], v0 offset:34560
    v_mul_f32 v172, v172, v6
    v_mul_f32 v165, v165, v6
    v_mfma_f32_16x16x32_bf16 v[236:239], a[232:235], v[88:91], v[236:239]
    ds_read_b64_tr_b16 a[200:201], v0 offset:33800
    v_mul_f32 v173, v173, v6
    v_mfma_f32_16x16x32_bf16 v[236:239], a[236:239], v[92:95], v[236:239]
    ds_read_b64_tr_b16 a[202:203], v0 offset:34056
    v_mul_f32 v166, v166, v6
    v_mul_f32 v174, v174, v6
    v_mfma_f32_16x16x32_bf16 v[232:235], a[236:239], v[36:39], v[232:235]
    ds_read_b64_tr_b16 a[204:205], v0 offset:34312
    v_mul_f32 v167, v167, v6
    v_mfma_f32_16x16x32_bf16 v[232:235], a[232:235], v[32:35], v[232:235]
    s_waitcnt lgkmcnt(7)
    ds_read_b64_tr_b16 a[206:207], v0 offset:34568
    v_mul_f32 v175, v175, v6
    v_mfma_f32_16x16x32_bf16 v[240:243], a[240:243], v[32:35], v[240:243]
    ds_read_b64_tr_b16 a[208:209], v0 offset:33856
    v_cvt_pk_bf16_f32 v164, v164, v165
    v_mfma_f32_16x16x32_bf16 v[240:243], a[244:247], v[36:39], v[240:243]
    ds_read_b64_tr_b16 a[210:211], v0 offset:34112
    v_cvt_pk_bf16_f32 v172, v172, v173
    v_cvt_pk_bf16_f32 v165, v166, v167
    v_mfma_f32_16x16x32_bf16 v[244:247], a[244:247], v[92:95], v[244:247]
    ds_read_b64_tr_b16 a[212:213], v0 offset:34368
    v_cvt_pk_bf16_f32 v173, v174, v175
    v_mfma_f32_16x16x32_bf16 v[244:247], a[240:243], v[88:91], v[244:247]
    ds_read_b64_tr_b16 a[214:215], v0 offset:34624
    v_accvgpr_write_b32 a40, v164
    v_accvgpr_write_b32 a41, v165
    v_mfma_f32_16x16x32_bf16 v[252:255], a[248:251], v[88:91], v[252:255]
    ds_read_b64_tr_b16 a[216:217], v0 offset:33864
    v_accvgpr_write_b32 a42, v172
    v_mfma_f32_16x16x32_bf16 v[252:255], a[252:255], v[92:95], v[252:255]
    ds_read_b64_tr_b16 a[218:219], v0 offset:34120
    v_accvgpr_write_b32 a43, v173
    v_mul_f32 v176, v176, v5
    v_mfma_f32_16x16x32_bf16 v[248:251], a[252:255], v[36:39], v[248:251]
    ds_read_b64_tr_b16 a[220:221], v0 offset:34376
    v_mul_f32 v184, v184, v5
    v_mfma_f32_16x16x32_bf16 v[248:251], a[248:251], v[32:35], v[248:251]
    s_waitcnt lgkmcnt(7)
    ds_read_b64_tr_b16 a[222:223], v0 offset:34632
    v_mul_f32 v177, v177, v5
    v_mfma_f32_16x16x32_bf16 v[192:195], a[192:195], v[40:43], v[192:195]
    ds_read_b64_tr_b16 a[224:225], v0 offset:33920
    v_mul_f32 v185, v185, v5
    v_mfma_f32_16x16x32_bf16 v[192:195], a[196:199], v[44:47], v[192:195]
    ds_read_b64_tr_b16 a[226:227], v0 offset:34176
    v_mul_f32 v178, v178, v5
    v_mul_f32 v186, v186, v5
    v_mfma_f32_16x16x32_bf16 v[196:199], a[196:199], v[100:103], v[196:199]
    ds_read_b64_tr_b16 a[228:229], v0 offset:34432
    v_mul_f32 v179, v179, v5
    v_mfma_f32_16x16x32_bf16 v[196:199], a[192:195], v[96:99], v[196:199]
    ds_read_b64_tr_b16 a[230:231], v0 offset:34688
    v_mul_f32 v187, v187, v5
    v_cvt_pk_bf16_f32 v176, v176, v177
    v_mfma_f32_16x16x32_bf16 v[204:207], a[200:203], v[96:99], v[204:207]
    ds_read_b64_tr_b16 a[232:233], v0 offset:33928
    v_cvt_pk_bf16_f32 v184, v184, v185
    v_mfma_f32_16x16x32_bf16 v[204:207], a[204:207], v[100:103], v[204:207]
    ds_read_b64_tr_b16 a[234:235], v0 offset:34184
    v_cvt_pk_bf16_f32 v177, v178, v179
    v_cvt_pk_bf16_f32 v185, v186, v187
    v_mfma_f32_16x16x32_bf16 v[200:203], a[204:207], v[44:47], v[200:203]
    ds_read_b64_tr_b16 a[236:237], v0 offset:34440
    v_accvgpr_write_b32 a12, v176
    v_mfma_f32_16x16x32_bf16 v[200:203], a[200:203], v[40:43], v[200:203]
    s_waitcnt lgkmcnt(7)
    ds_read_b64_tr_b16 a[238:239], v0 offset:34696
    v_accvgpr_write_b32 a13, v177
    v_mfma_f32_16x16x32_bf16 v[208:211], a[208:211], v[40:43], v[208:211]
    ds_read_b64_tr_b16 a[240:241], v0 offset:33984
    v_accvgpr_write_b32 a14, v184
    v_mfma_f32_16x16x32_bf16 v[208:211], a[212:215], v[44:47], v[208:211]
    ds_read_b64_tr_b16 a[242:243], v0 offset:34240
    v_accvgpr_write_b32 a15, v185
    v_mul_f32 v180, v180, v6
    v_mfma_f32_16x16x32_bf16 v[212:215], a[212:215], v[100:103], v[212:215]
    ds_read_b64_tr_b16 a[244:245], v0 offset:34496
    v_mul_f32 v188, v188, v6
    v_mfma_f32_16x16x32_bf16 v[212:215], a[208:211], v[96:99], v[212:215]
    ds_read_b64_tr_b16 a[246:247], v0 offset:34752
    v_mul_f32 v181, v181, v6
    v_mul_f32 v189, v189, v6
    v_mfma_f32_16x16x32_bf16 v[220:223], a[216:219], v[96:99], v[220:223]
    ds_read_b64_tr_b16 a[248:249], v0 offset:33992
    v_mul_f32 v182, v182, v6
    v_mfma_f32_16x16x32_bf16 v[220:223], a[220:223], v[100:103], v[220:223]
    ds_read_b64_tr_b16 a[250:251], v0 offset:34248
    v_mul_f32 v190, v190, v6
    v_mul_f32 v183, v183, v6
    v_mfma_f32_16x16x32_bf16 v[216:219], a[220:223], v[44:47], v[216:219]
    ds_read_b64_tr_b16 a[252:253], v0 offset:34504
    ds_read_b64_tr_b16 a[254:255], v0 offset:34760
    v_mfma_f32_16x16x32_bf16 v[216:219], a[216:219], v[40:43], v[216:219]
    s_waitcnt vmcnt(17) lgkmcnt(8)
    s_barrier
    v_mul_f32 v191, v191, v6
    v_cvt_pk_bf16_f32 v180, v180, v181
    v_mfma_f32_16x16x32_bf16 v[224:227], a[224:227], v[40:43], v[224:227]
    ds_read_b64_tr_b16 a[192:193], v0 offset:50688
    ds_read_b64_tr_b16 a[194:195], v0 offset:50944
    v_mfma_f32_16x16x32_bf16 v[224:227], a[228:231], v[44:47], v[224:227]
    buffer_load_dwordx4 v132, s[8:11], s58 offen offset:0 lds
    v_cvt_pk_bf16_f32 v188, v188, v189
    v_mfma_f32_16x16x32_bf16 v[228:231], a[228:231], v[100:103], v[228:231]
    ds_read_b64_tr_b16 a[196:197], v0 offset:51200
    v_cvt_pk_bf16_f32 v181, v182, v183
    v_mfma_f32_16x16x32_bf16 v[228:231], a[224:227], v[96:99], v[228:231]
    ds_read_b64_tr_b16 a[198:199], v0 offset:51456
    v_cvt_pk_bf16_f32 v189, v190, v191
    v_accvgpr_write_b32 a44, v180
    v_mfma_f32_16x16x32_bf16 v[236:239], a[232:235], v[96:99], v[236:239]
    ds_read_b64_tr_b16 a[200:201], v0 offset:50696
    ds_read_b64_tr_b16 a[202:203], v0 offset:50952
    v_mfma_f32_16x16x32_bf16 v[236:239], a[236:239], v[100:103], v[236:239]
    buffer_load_dwordx4 v133, s[8:11], s58 offen offset:1024 lds
    v_accvgpr_write_b32 a45, v181
    v_mfma_f32_16x16x32_bf16 v[232:235], a[236:239], v[44:47], v[232:235]
    ds_read_b64_tr_b16 a[204:205], v0 offset:51208
    v_accvgpr_write_b32 a46, v188
    v_mfma_f32_16x16x32_bf16 v[232:235], a[232:235], v[40:43], v[232:235]
    s_waitcnt lgkmcnt(7)
    ds_read_b64_tr_b16 a[206:207], v0 offset:51464
    v_accvgpr_write_b32 a47, v189
    v_mfma_f32_16x16x32_bf16 v[240:243], a[240:243], v[40:43], v[240:243]
    ds_read_b64_tr_b16 a[208:209], v0 offset:50752
    ds_read_b64_tr_b16 a[210:211], v0 offset:51008
    v_mfma_f32_16x16x32_bf16 v[240:243], a[244:247], v[44:47], v[240:243]
    buffer_load_dwordx4 v134, s[8:11], s58 offen offset:2048 lds
    v_mfma_f32_16x16x32_bf16 v[244:247], a[244:247], v[100:103], v[244:247]
    ds_read_b64_tr_b16 a[212:213], v0 offset:51264
    v_mfma_f32_16x16x32_bf16 v[244:247], a[240:243], v[96:99], v[244:247]
    ds_read_b64_tr_b16 a[214:215], v0 offset:51520
    v_mfma_f32_16x16x32_bf16 v[252:255], a[248:251], v[96:99], v[252:255]
    ds_read_b64_tr_b16 a[216:217], v0 offset:50760
    ds_read_b64_tr_b16 a[218:219], v0 offset:51016
    v_mfma_f32_16x16x32_bf16 v[252:255], a[252:255], v[100:103], v[252:255]
    buffer_load_dwordx4 v135, s[8:11], s58 offen offset:3072 lds
    s_add_u32 m0, s52, 4096
    v_mfma_f32_16x16x32_bf16 v[248:251], a[252:255], v[44:47], v[248:251]
    ds_read_b64_tr_b16 a[220:221], v0 offset:51272
    v_mfma_f32_16x16x32_bf16 v[248:251], a[248:251], v[40:43], v[248:251]
    s_waitcnt lgkmcnt(7)
    ds_read_b64_tr_b16 a[222:223], v0 offset:51528
    v_mfma_f32_16x16x32_bf16 v[192:195], a[192:195], v[48:51], v[192:195]
    ds_read_b64_tr_b16 a[224:225], v0 offset:50816
    ds_read_b64_tr_b16 a[226:227], v0 offset:51072
    v_mfma_f32_16x16x32_bf16 v[192:195], a[196:199], v[52:55], v[192:195]
    buffer_load_dwordx4 v136, s[8:11], s58 offen offset:0 lds
    v_mfma_f32_16x16x32_bf16 v[196:199], a[196:199], v[108:111], v[196:199]
    ds_read_b64_tr_b16 a[228:229], v0 offset:51328
    v_mfma_f32_16x16x32_bf16 v[196:199], a[192:195], v[104:107], v[196:199]
    ds_read_b64_tr_b16 a[230:231], v0 offset:51584
    v_mfma_f32_16x16x32_bf16 v[204:207], a[200:203], v[104:107], v[204:207]
    ds_read_b64_tr_b16 a[232:233], v0 offset:50824
    ds_read_b64_tr_b16 a[234:235], v0 offset:51080
    v_mfma_f32_16x16x32_bf16 v[204:207], a[204:207], v[108:111], v[204:207]
    buffer_load_dwordx4 v137, s[8:11], s58 offen offset:1024 lds
    v_mfma_f32_16x16x32_bf16 v[200:203], a[204:207], v[52:55], v[200:203]
    ds_read_b64_tr_b16 a[236:237], v0 offset:51336
    v_mfma_f32_16x16x32_bf16 v[200:203], a[200:203], v[48:51], v[200:203]
    s_waitcnt lgkmcnt(7)
    ds_read_b64_tr_b16 a[238:239], v0 offset:51592
    v_mfma_f32_16x16x32_bf16 v[208:211], a[208:211], v[48:51], v[208:211]
    ds_read_b64_tr_b16 a[240:241], v0 offset:50880
    ds_read_b64_tr_b16 a[242:243], v0 offset:51136
    v_mfma_f32_16x16x32_bf16 v[208:211], a[212:215], v[52:55], v[208:211]
    buffer_load_dwordx4 v138, s[8:11], s58 offen offset:2048 lds
    s_add_u32 m0, s52, 33792
    v_mfma_f32_16x16x32_bf16 v[212:215], a[212:215], v[108:111], v[212:215]
    s_mov_b32 s58, 458752
    ds_read_b64_tr_b16 a[244:245], v0 offset:51392
    v_mfma_f32_16x16x32_bf16 v[212:215], a[208:211], v[104:107], v[212:215]
    ds_read_b64_tr_b16 a[246:247], v0 offset:51648
    v_mfma_f32_16x16x32_bf16 v[220:223], a[216:219], v[104:107], v[220:223]
    ds_read_b64_tr_b16 a[248:249], v0 offset:50888
    v_mfma_f32_16x16x32_bf16 v[220:223], a[220:223], v[108:111], v[220:223]
    ds_read_b64_tr_b16 a[250:251], v0 offset:51144
    v_mfma_f32_16x16x32_bf16 v[216:219], a[220:223], v[52:55], v[216:219]
    ds_read_b64_tr_b16 a[252:253], v0 offset:51400
    ds_read_b64_tr_b16 a[254:255], v0 offset:51656
    v_mfma_f32_16x16x32_bf16 v[216:219], a[216:219], v[48:51], v[216:219]
    s_waitcnt vmcnt(20) lgkmcnt(8)
    s_barrier
    v_mfma_f32_16x16x32_bf16 v[224:227], a[224:227], v[48:51], v[224:227]
    ds_read_b64_tr_b16 a[192:193], v1 offset:0
    v_mfma_f32_16x16x32_bf16 v[224:227], a[228:231], v[52:55], v[224:227]
    ds_read_b64_tr_b16 a[194:195], v1 offset:256
    v_mfma_f32_16x16x32_bf16 v[228:231], a[228:231], v[108:111], v[228:231]
    ds_read_b64_tr_b16 a[196:197], v1 offset:512
    v_mfma_f32_16x16x32_bf16 v[228:231], a[224:227], v[104:107], v[228:231]
    ds_read_b64_tr_b16 a[198:199], v1 offset:768
    v_mfma_f32_16x16x32_bf16 v[236:239], a[232:235], v[104:107], v[236:239]
    ds_read_b64_tr_b16 a[200:201], v1 offset:8
    v_mfma_f32_16x16x32_bf16 v[236:239], a[236:239], v[108:111], v[236:239]
    ds_read_b64_tr_b16 a[202:203], v1 offset:264
    v_mfma_f32_16x16x32_bf16 v[232:235], a[236:239], v[52:55], v[232:235]
    ds_read_b64_tr_b16 a[204:205], v1 offset:520
    v_mfma_f32_16x16x32_bf16 v[232:235], a[232:235], v[48:51], v[232:235]
    s_waitcnt lgkmcnt(7)
    ds_read_b64_tr_b16 a[206:207], v1 offset:776
    v_mfma_f32_16x16x32_bf16 v[240:243], a[240:243], v[48:51], v[240:243]
    ds_read_b64_tr_b16 a[208:209], v1 offset:64
    v_mfma_f32_16x16x32_bf16 v[240:243], a[244:247], v[52:55], v[240:243]
    ds_read_b64_tr_b16 a[210:211], v1 offset:320
    v_mfma_f32_16x16x32_bf16 v[244:247], a[244:247], v[108:111], v[244:247]
    ds_read_b64_tr_b16 a[212:213], v1 offset:576
    v_mfma_f32_16x16x32_bf16 v[244:247], a[240:243], v[104:107], v[244:247]
    ds_read_b64_tr_b16 a[214:215], v1 offset:832
    v_mfma_f32_16x16x32_bf16 v[252:255], a[248:251], v[104:107], v[252:255]
    ds_read_b64_tr_b16 a[216:217], v1 offset:72
    v_mfma_f32_16x16x32_bf16 v[252:255], a[252:255], v[108:111], v[252:255]
    ds_read_b64_tr_b16 a[218:219], v1 offset:328
    v_mfma_f32_16x16x32_bf16 v[248:251], a[252:255], v[52:55], v[248:251]
    ds_read_b64_tr_b16 a[220:221], v1 offset:584
    v_mfma_f32_16x16x32_bf16 v[248:251], a[248:251], v[48:51], v[248:251]
    s_waitcnt lgkmcnt(7)
    ds_read_b64_tr_b16 a[222:223], v1 offset:840
    v_mfma_f32_16x16x32_bf16 v[192:195], a[192:195], v[56:59], v[192:195]
    ds_read_b64_tr_b16 a[224:225], v1 offset:128
    v_mfma_f32_16x16x32_bf16 v[192:195], a[196:199], v[60:63], v[192:195]
    ds_read_b64_tr_b16 a[226:227], v1 offset:384
    v_mfma_f32_16x16x32_bf16 v[196:199], a[196:199], v[116:119], v[196:199]
    ds_read_b64_tr_b16 a[228:229], v1 offset:640
    v_mfma_f32_16x16x32_bf16 v[196:199], a[192:195], v[112:115], v[196:199]
    ds_read_b64_tr_b16 a[230:231], v1 offset:896
    v_mfma_f32_16x16x32_bf16 v[204:207], a[200:203], v[112:115], v[204:207]
    ds_read_b64_tr_b16 a[232:233], v1 offset:136
    v_mfma_f32_16x16x32_bf16 v[204:207], a[204:207], v[116:119], v[204:207]
    ds_read_b64_tr_b16 a[234:235], v1 offset:392
    v_mfma_f32_16x16x32_bf16 v[200:203], a[204:207], v[60:63], v[200:203]
    ds_read_b64_tr_b16 a[236:237], v1 offset:648
    v_mfma_f32_16x16x32_bf16 v[200:203], a[200:203], v[56:59], v[200:203]
    s_waitcnt lgkmcnt(7)
    ds_read_b64_tr_b16 a[238:239], v1 offset:904
    v_mfma_f32_16x16x32_bf16 v[208:211], a[208:211], v[56:59], v[208:211]
    ds_read_b64_tr_b16 a[240:241], v1 offset:192
    v_mfma_f32_16x16x32_bf16 v[208:211], a[212:215], v[60:63], v[208:211]
    ds_read_b64_tr_b16 a[242:243], v1 offset:448
    v_mfma_f32_16x16x32_bf16 v[212:215], a[212:215], v[116:119], v[212:215]
    ds_read_b64_tr_b16 a[244:245], v1 offset:704
    v_mfma_f32_16x16x32_bf16 v[212:215], a[208:211], v[112:115], v[212:215]
    ds_read_b64_tr_b16 a[246:247], v1 offset:960
    v_mfma_f32_16x16x32_bf16 v[220:223], a[216:219], v[112:115], v[220:223]
    ds_read_b64_tr_b16 a[248:249], v1 offset:200
    v_mfma_f32_16x16x32_bf16 v[220:223], a[220:223], v[116:119], v[220:223]
    ds_read_b64_tr_b16 a[250:251], v1 offset:456
    v_mfma_f32_16x16x32_bf16 v[216:219], a[220:223], v[60:63], v[216:219]
    ds_read_b64_tr_b16 a[252:253], v1 offset:712
    ds_read_b64_tr_b16 a[254:255], v1 offset:968
    v_mfma_f32_16x16x32_bf16 v[216:219], a[216:219], v[56:59], v[216:219]
    s_waitcnt vmcnt(16) lgkmcnt(8)
    s_barrier
    v_mfma_f32_16x16x32_bf16 v[224:227], a[224:227], v[56:59], v[224:227]
    ds_read_b64_tr_b16 a[192:193], v1 offset:16896
    ds_read_b64_tr_b16 a[194:195], v1 offset:17152
    v_mfma_f32_16x16x32_bf16 v[224:227], a[228:231], v[60:63], v[224:227]
    buffer_load_dwordx4 v132, s[8:11], s58 offen offset:0 lds
    v_mfma_f32_16x16x32_bf16 v[228:231], a[228:231], v[116:119], v[228:231]
    ds_read_b64_tr_b16 a[196:197], v1 offset:17408
    v_mfma_f32_16x16x32_bf16 v[228:231], a[224:227], v[112:115], v[228:231]
    ds_read_b64_tr_b16 a[198:199], v1 offset:17664
    v_mfma_f32_16x16x32_bf16 v[236:239], a[232:235], v[112:115], v[236:239]
    ds_read_b64_tr_b16 a[200:201], v1 offset:16904
    ds_read_b64_tr_b16 a[202:203], v1 offset:17160
    v_mfma_f32_16x16x32_bf16 v[236:239], a[236:239], v[116:119], v[236:239]
    buffer_load_dwordx4 v133, s[8:11], s58 offen offset:1024 lds
    v_mfma_f32_16x16x32_bf16 v[232:235], a[236:239], v[60:63], v[232:235]
    ds_read_b64_tr_b16 a[204:205], v1 offset:17416
    v_mfma_f32_16x16x32_bf16 v[232:235], a[232:235], v[56:59], v[232:235]
    s_waitcnt lgkmcnt(7)
    ds_read_b64_tr_b16 a[206:207], v1 offset:17672
    v_mfma_f32_16x16x32_bf16 v[240:243], a[240:243], v[56:59], v[240:243]
    ds_read_b64_tr_b16 a[208:209], v1 offset:16960
    ds_read_b64_tr_b16 a[210:211], v1 offset:17216
    v_mfma_f32_16x16x32_bf16 v[240:243], a[244:247], v[60:63], v[240:243]
    buffer_load_dwordx4 v134, s[8:11], s58 offen offset:2048 lds
    v_mfma_f32_16x16x32_bf16 v[244:247], a[244:247], v[116:119], v[244:247]
    ds_read_b64_tr_b16 a[212:213], v1 offset:17472
    v_mfma_f32_16x16x32_bf16 v[244:247], a[240:243], v[112:115], v[244:247]
    ds_read_b64_tr_b16 a[214:215], v1 offset:17728
    v_mfma_f32_16x16x32_bf16 v[252:255], a[248:251], v[112:115], v[252:255]
    ds_read_b64_tr_b16 a[216:217], v1 offset:16968
    ds_read_b64_tr_b16 a[218:219], v1 offset:17224
    v_mfma_f32_16x16x32_bf16 v[252:255], a[252:255], v[116:119], v[252:255]
    buffer_load_dwordx4 v135, s[8:11], s58 offen offset:3072 lds
    s_add_u32 m0, s52, 37888
    v_mfma_f32_16x16x32_bf16 v[248:251], a[252:255], v[60:63], v[248:251]
    ds_read_b64_tr_b16 a[220:221], v1 offset:17480
    v_mfma_f32_16x16x32_bf16 v[248:251], a[248:251], v[56:59], v[248:251]
    s_waitcnt lgkmcnt(7)
    ds_read_b64_tr_b16 a[222:223], v1 offset:17736
    v_mfma_f32_16x16x32_bf16 v[192:195], a[192:195], v[64:67], v[192:195]
    ds_read_b64_tr_b16 a[224:225], v1 offset:17024
    ds_read_b64_tr_b16 a[226:227], v1 offset:17280
    v_mfma_f32_16x16x32_bf16 v[192:195], a[196:199], v[68:71], v[192:195]
    buffer_load_dwordx4 v136, s[8:11], s58 offen offset:0 lds
    v_mfma_f32_16x16x32_bf16 v[196:199], a[196:199], v[124:127], v[196:199]
    ds_read_b64_tr_b16 a[228:229], v1 offset:17536
    v_mfma_f32_16x16x32_bf16 v[196:199], a[192:195], v[120:123], v[196:199]
    ds_read_b64_tr_b16 a[230:231], v1 offset:17792
    v_mfma_f32_16x16x32_bf16 v[204:207], a[200:203], v[120:123], v[204:207]
    ds_read_b64_tr_b16 a[232:233], v1 offset:17032
    ds_read_b64_tr_b16 a[234:235], v1 offset:17288
    v_mfma_f32_16x16x32_bf16 v[204:207], a[204:207], v[124:127], v[204:207]
    buffer_load_dwordx4 v137, s[8:11], s58 offen offset:1024 lds
    v_mfma_f32_16x16x32_bf16 v[200:203], a[204:207], v[68:71], v[200:203]
    ds_read_b64_tr_b16 a[236:237], v1 offset:17544
    v_mfma_f32_16x16x32_bf16 v[200:203], a[200:203], v[64:67], v[200:203]
    s_waitcnt lgkmcnt(7)
    ds_read_b64_tr_b16 a[238:239], v1 offset:17800
    v_mfma_f32_16x16x32_bf16 v[208:211], a[208:211], v[64:67], v[208:211]
    ds_read_b64_tr_b16 a[240:241], v1 offset:17088
    ds_read_b64_tr_b16 a[242:243], v1 offset:17344
    v_mfma_f32_16x16x32_bf16 v[208:211], a[212:215], v[68:71], v[208:211]
    buffer_load_dwordx4 v138, s[8:11], s58 offen offset:2048 lds
    s_add_u32 m0, s52, 67584
    v_mfma_f32_16x16x32_bf16 v[212:215], a[212:215], v[124:127], v[212:215]
    s_mov_b32 s58, 688128
    ds_read_b64_tr_b16 a[244:245], v1 offset:17600
    v_mfma_f32_16x16x32_bf16 v[212:215], a[208:211], v[120:123], v[212:215]
    ds_read_b64_tr_b16 a[246:247], v1 offset:17856
    v_mfma_f32_16x16x32_bf16 v[220:223], a[216:219], v[120:123], v[220:223]
    ds_read_b64_tr_b16 a[248:249], v1 offset:17096
    v_mfma_f32_16x16x32_bf16 v[220:223], a[220:223], v[124:127], v[220:223]
    ds_read_b64_tr_b16 a[250:251], v1 offset:17352
    v_mfma_f32_16x16x32_bf16 v[216:219], a[220:223], v[68:71], v[216:219]
    ds_read_b64_tr_b16 a[252:253], v1 offset:17608
    ds_read_b64_tr_b16 a[254:255], v1 offset:17864
    v_mfma_f32_16x16x32_bf16 v[216:219], a[216:219], v[64:67], v[216:219]
    s_waitcnt vmcnt(14) lgkmcnt(8)
    s_barrier
    v_mfma_f32_16x16x32_bf16 v[224:227], a[224:227], v[64:67], v[224:227]
    ds_read_b64_tr_b16 a[192:193], v129 offset:33792
    v_mfma_f32_16x16x32_bf16 v[224:227], a[228:231], v[68:71], v[224:227]
    ds_read_b64_tr_b16 a[194:195], v129 offset:37376
    v_mfma_f32_16x16x32_bf16 v[228:231], a[228:231], v[124:127], v[228:231]
    ds_read_b64_tr_b16 a[196:197], v129 offset:40960
    v_mfma_f32_16x16x32_bf16 v[228:231], a[224:227], v[120:123], v[228:231]
    ds_read_b64_tr_b16 a[198:199], v129 offset:44544
    v_mfma_f32_16x16x32_bf16 v[236:239], a[232:235], v[120:123], v[236:239]
    ds_read_b64_tr_b16 a[200:201], v129 offset:50688
    v_mfma_f32_16x16x32_bf16 v[236:239], a[236:239], v[124:127], v[236:239]
    ds_read_b64_tr_b16 a[202:203], v129 offset:54272
    v_mfma_f32_16x16x32_bf16 v[232:235], a[236:239], v[68:71], v[232:235]
    ds_read_b64_tr_b16 a[204:205], v129 offset:57856
    v_mfma_f32_16x16x32_bf16 v[232:235], a[232:235], v[64:67], v[232:235]
    s_waitcnt lgkmcnt(7)
    ds_read_b64_tr_b16 a[206:207], v129 offset:61440
    v_mfma_f32_16x16x32_bf16 v[240:243], a[240:243], v[64:67], v[240:243]
    ds_read_b64_tr_b16 a[208:209], v129 offset:33824
    v_mfma_f32_16x16x32_bf16 v[240:243], a[244:247], v[68:71], v[240:243]
    ds_read_b64_tr_b16 a[210:211], v129 offset:37408
    v_mfma_f32_16x16x32_bf16 v[244:247], a[244:247], v[124:127], v[244:247]
    ds_read_b64_tr_b16 a[212:213], v129 offset:40992
    v_mfma_f32_16x16x32_bf16 v[244:247], a[240:243], v[120:123], v[244:247]
    ds_read_b64_tr_b16 a[214:215], v129 offset:44576
    v_mfma_f32_16x16x32_bf16 v[252:255], a[248:251], v[120:123], v[252:255]
    ds_read_b64_tr_b16 a[216:217], v129 offset:50720
    v_mfma_f32_16x16x32_bf16 v[252:255], a[252:255], v[124:127], v[252:255]
    ds_read_b64_tr_b16 a[218:219], v129 offset:54304
    v_mfma_f32_16x16x32_bf16 v[248:251], a[252:255], v[68:71], v[248:251]
    ds_read_b64_tr_b16 a[220:221], v129 offset:57888
    v_mfma_f32_16x16x32_bf16 v[248:251], a[248:251], v[64:67], v[248:251]
    s_waitcnt lgkmcnt(7)
    ds_read_b64_tr_b16 a[222:223], v129 offset:61472
    v_mfma_f32_16x16x32_bf16 a[64:67], a[192:195], v[16:19], 0
    ds_read_b64_tr_b16 a[224:225], v129 offset:33856
    v_mfma_f32_16x16x32_bf16 a[64:67], a[196:199], v[20:23], a[64:67]
    ds_read_b64_tr_b16 a[226:227], v129 offset:37440
    v_mfma_f32_16x16x32_bf16 a[68:71], a[196:199], v[76:79], 0
    ds_read_b64_tr_b16 a[228:229], v129 offset:41024
    v_mfma_f32_16x16x32_bf16 a[68:71], a[192:195], v[72:75], a[68:71]
    ds_read_b64_tr_b16 a[230:231], v129 offset:44608
    v_mfma_f32_16x16x32_bf16 a[124:127], a[200:203], v[72:75], 0
    ds_read_b64_tr_b16 a[232:233], v129 offset:50752
    v_mfma_f32_16x16x32_bf16 a[124:127], a[204:207], v[76:79], a[124:127]
    ds_read_b64_tr_b16 a[234:235], v129 offset:54336
    v_mul_f32 v192, v192, v5
    v_mul_f32 v200, v200, v5
    v_mfma_f32_16x16x32_bf16 a[120:123], a[204:207], v[20:23], 0
    ds_read_b64_tr_b16 a[236:237], v129 offset:57920
    v_mul_f32 v193, v193, v5
    v_mfma_f32_16x16x32_bf16 a[120:123], a[200:203], v[16:19], a[120:123]
    s_waitcnt lgkmcnt(7)
    ds_read_b64_tr_b16 a[238:239], v129 offset:61504
    v_mul_f32 v201, v201, v5
    v_mfma_f32_16x16x32_bf16 a[72:75], a[208:211], v[16:19], 0
    ds_read_b64_tr_b16 a[240:241], v129 offset:33888
    v_mul_f32 v194, v194, v5
    v_mfma_f32_16x16x32_bf16 a[72:75], a[212:215], v[20:23], a[72:75]
    ds_read_b64_tr_b16 a[242:243], v129 offset:37472
    v_mul_f32 v202, v202, v5
    v_mul_f32 v195, v195, v5
    v_mfma_f32_16x16x32_bf16 a[76:79], a[212:215], v[76:79], 0
    ds_read_b64_tr_b16 a[244:245], v129 offset:41056
    v_mul_f32 v203, v203, v5
    v_mfma_f32_16x16x32_bf16 a[76:79], a[208:211], v[72:75], a[76:79]
    ds_read_b64_tr_b16 a[246:247], v129 offset:44640
    v_cvt_pk_bf16_f32 v192, v192, v193
    v_cvt_pk_bf16_f32 v200, v200, v201
    v_mfma_f32_16x16x32_bf16 a[132:135], a[216:219], v[72:75], 0
    ds_read_b64_tr_b16 a[248:249], v129 offset:50784
    v_cvt_pk_bf16_f32 v193, v194, v195
    v_mfma_f32_16x16x32_bf16 a[132:135], a[220:223], v[76:79], a[132:135]
    ds_read_b64_tr_b16 a[250:251], v129 offset:54368
    v_cvt_pk_bf16_f32 v201, v202, v203
    v_accvgpr_write_b32 a16, v192
    v_mfma_f32_16x16x32_bf16 a[128:131], a[220:223], v[20:23], 0
    ds_read_b64_tr_b16 a[252:253], v129 offset:57952
    v_accvgpr_write_b32 a17, v193
    v_mfma_f32_16x16x32_bf16 a[128:131], a[216:219], v[16:19], a[128:131]
    s_waitcnt lgkmcnt(7)
    s_and_b32 s41, s59, 1
    ds_read_b64_tr_b16 a[254:255], v129 offset:61536
    v_accvgpr_write_b32 a18, v200
    v_mfma_f32_16x16x32_bf16 a[80:83], a[224:227], v[16:19], 0
    ds_read_b64_tr_b16 a[192:193], v129 offset:33920
    v_accvgpr_write_b32 a19, v201
    v_mfma_f32_16x16x32_bf16 a[80:83], a[228:231], v[20:23], a[80:83]
    ds_read_b64_tr_b16 a[194:195], v129 offset:37504
    v_mul_f32 v196, v196, v6
    v_mul_f32 v204, v204, v6
    v_mfma_f32_16x16x32_bf16 a[84:87], a[228:231], v[76:79], 0
    ds_read_b64_tr_b16 a[196:197], v129 offset:41088
    v_mul_f32 v197, v197, v6
    v_mfma_f32_16x16x32_bf16 a[84:87], a[224:227], v[72:75], a[84:87]
    ds_read_b64_tr_b16 a[198:199], v129 offset:44672
    v_mul_f32 v205, v205, v6
    v_mul_f32 v198, v198, v6
    v_mfma_f32_16x16x32_bf16 a[140:143], a[232:235], v[72:75], 0
    ds_read_b64_tr_b16 a[200:201], v129 offset:50816
    v_mul_f32 v206, v206, v6
    v_mfma_f32_16x16x32_bf16 a[140:143], a[236:239], v[76:79], a[140:143]
    ds_read_b64_tr_b16 a[202:203], v129 offset:54400
    v_mul_f32 v199, v199, v6
    v_mul_f32 v207, v207, v6
    v_mfma_f32_16x16x32_bf16 a[136:139], a[236:239], v[20:23], 0
    ds_read_b64_tr_b16 a[204:205], v129 offset:57984
    v_cvt_pk_bf16_f32 v196, v196, v197
    v_mfma_f32_16x16x32_bf16 a[136:139], a[232:235], v[16:19], a[136:139]
    s_waitcnt lgkmcnt(7)
    s_lshl2_add_u32 s43, s60, s36
    ds_read_b64_tr_b16 a[206:207], v129 offset:61568
    v_cvt_pk_bf16_f32 v204, v204, v205
    v_mfma_f32_16x16x32_bf16 a[88:91], a[240:243], v[16:19], 0
    ds_read_b64_tr_b16 a[208:209], v129 offset:33952
    v_cvt_pk_bf16_f32 v197, v198, v199
    v_mfma_f32_16x16x32_bf16 a[88:91], a[244:247], v[20:23], a[88:91]
    ds_read_b64_tr_b16 a[210:211], v129 offset:37536
    v_cvt_pk_bf16_f32 v205, v206, v207
    v_accvgpr_write_b32 a48, v196
    v_mfma_f32_16x16x32_bf16 a[92:95], a[244:247], v[76:79], 0
    ds_read_b64_tr_b16 a[212:213], v129 offset:41120
    v_accvgpr_write_b32 a49, v197
    v_mfma_f32_16x16x32_bf16 a[92:95], a[240:243], v[72:75], a[92:95]
    ds_read_b64_tr_b16 a[214:215], v129 offset:44704
    v_accvgpr_write_b32 a50, v204
    v_accvgpr_write_b32 a51, v205
    v_mfma_f32_16x16x32_bf16 a[148:151], a[248:251], v[72:75], 0
    ds_read_b64_tr_b16 a[216:217], v129 offset:50848
    v_mul_f32 v208, v208, v5
    v_mfma_f32_16x16x32_bf16 a[148:151], a[252:255], v[76:79], a[148:151]
    ds_read_b64_tr_b16 a[218:219], v129 offset:54432
    v_mul_f32 v216, v216, v5
    v_mul_f32 v209, v209, v5
    v_mfma_f32_16x16x32_bf16 a[144:147], a[252:255], v[20:23], 0
    ds_read_b64_tr_b16 a[220:221], v129 offset:58016
    v_mul_f32 v217, v217, v5
    v_mfma_f32_16x16x32_bf16 a[144:147], a[248:251], v[16:19], a[144:147]
    s_waitcnt lgkmcnt(7)
    s_mul_i32 s43, s43, 114688
    ds_read_b64_tr_b16 a[222:223], v129 offset:61600
    v_mul_f32 v210, v210, v5
    v_mfma_f32_16x16x32_bf16 a[96:99], a[192:195], v[16:19], 0
    ds_read_b64_tr_b16 a[224:225], v131 offset:33984
    v_mul_f32 v218, v218, v5
    v_mfma_f32_16x16x32_bf16 a[96:99], a[196:199], v[20:23], a[96:99]
    ds_read_b64_tr_b16 a[226:227], v131 offset:37568
    v_mul_f32 v211, v211, v5
    v_mul_f32 v219, v219, v5
    v_mfma_f32_16x16x32_bf16 a[100:103], a[196:199], v[76:79], 0
    ds_read_b64_tr_b16 a[228:229], v131 offset:41152
    v_cvt_pk_bf16_f32 v208, v208, v209
    v_mfma_f32_16x16x32_bf16 a[100:103], a[192:195], v[72:75], a[100:103]
    ds_read_b64_tr_b16 a[230:231], v131 offset:44736
    v_cvt_pk_bf16_f32 v216, v216, v217
    v_cvt_pk_bf16_f32 v209, v210, v211
    v_mfma_f32_16x16x32_bf16 a[156:159], a[200:203], v[72:75], 0
    ds_read_b64_tr_b16 a[232:233], v131 offset:50880
    v_cvt_pk_bf16_f32 v217, v218, v219
    v_mfma_f32_16x16x32_bf16 a[156:159], a[204:207], v[76:79], a[156:159]
    ds_read_b64_tr_b16 a[234:235], v131 offset:54464
    v_accvgpr_write_b32 a20, v208
    v_accvgpr_write_b32 a21, v209
    v_mfma_f32_16x16x32_bf16 a[152:155], a[204:207], v[20:23], 0
    ds_read_b64_tr_b16 a[236:237], v131 offset:58048
    ds_read_b64_tr_b16 a[238:239], v131 offset:61632
    v_mfma_f32_16x16x32_bf16 a[152:155], a[200:203], v[16:19], a[152:155]
    s_waitcnt vmcnt(7) lgkmcnt(8)
    s_barrier
    v_accvgpr_write_b32 a22, v216
    v_accvgpr_write_b32 a23, v217
    v_mfma_f32_16x16x32_bf16 a[104:107], a[208:211], v[16:19], 0
    ds_read_b64_tr_b16 a[240:241], v128 offset:0
    ds_read_b64_tr_b16 a[242:243], v128 offset:3584
    v_mfma_f32_16x16x32_bf16 a[104:107], a[212:215], v[20:23], a[104:107]
    s_mul_i32 s12, s55, 7168
    buffer_load_dwordx4 v132, s[8:11], s58 offen offset:0 lds
    v_mul_f32 v212, v212, v6
    v_mfma_f32_16x16x32_bf16 a[108:111], a[212:215], v[76:79], 0
    ds_read_b64_tr_b16 a[244:245], v128 offset:7168
    v_mul_f32 v220, v220, v6
    v_mfma_f32_16x16x32_bf16 a[108:111], a[208:211], v[72:75], a[108:111]
    ds_read_b64_tr_b16 a[246:247], v128 offset:10752
    v_mul_f32 v213, v213, v6
    v_mul_f32 v221, v221, v6
    v_mfma_f32_16x16x32_bf16 a[164:167], a[216:219], v[72:75], 0
    ds_read_b64_tr_b16 a[248:249], v128 offset:16896
    ds_read_b64_tr_b16 a[250:251], v128 offset:20480
    v_mfma_f32_16x16x32_bf16 a[164:167], a[220:223], v[76:79], a[164:167]
    s_add_u32 s12, s12, s43
    buffer_load_dwordx4 v133, s[8:11], s58 offen offset:1024 lds
    v_mul_f32 v214, v214, v6
    v_mfma_f32_16x16x32_bf16 a[160:163], a[220:223], v[20:23], 0
    ds_read_b64_tr_b16 a[252:253], v128 offset:24064
    v_mul_f32 v222, v222, v6
    v_mfma_f32_16x16x32_bf16 a[160:163], a[216:219], v[16:19], a[160:163]
    s_waitcnt lgkmcnt(7)
    s_lshl3_add_u32 s14, s41, s12
    ds_read_b64_tr_b16 a[254:255], v128 offset:27648
    v_mul_f32 v215, v215, v6
    v_mfma_f32_16x16x32_bf16 a[112:115], a[224:227], v[16:19], 0
    ds_read_b64_tr_b16 a[192:193], v128 offset:32
    ds_read_b64_tr_b16 a[194:195], v128 offset:3616
    v_mfma_f32_16x16x32_bf16 a[112:115], a[228:231], v[20:23], a[112:115]
    s_add_u32 s15, s14, 57344
    buffer_load_dwordx4 v134, s[8:11], s58 offen offset:2048 lds
    v_mul_f32 v223, v223, v6
    v_mfma_f32_16x16x32_bf16 a[116:119], a[228:231], v[76:79], 0
    ds_read_b64_tr_b16 a[196:197], v128 offset:7200
    v_cvt_pk_bf16_f32 v212, v212, v213
    v_mfma_f32_16x16x32_bf16 a[116:119], a[224:227], v[72:75], a[116:119]
    ds_read_b64_tr_b16 a[198:199], v128 offset:10784
    v_cvt_pk_bf16_f32 v220, v220, v221
    v_cvt_pk_bf16_f32 v213, v214, v215
    v_mfma_f32_16x16x32_bf16 a[172:175], a[232:235], v[72:75], 0
    ds_read_b64_tr_b16 a[200:201], v128 offset:16928
    ds_read_b64_tr_b16 a[202:203], v128 offset:20512
    v_mfma_f32_16x16x32_bf16 a[172:175], a[236:239], v[76:79], a[172:175]
    buffer_load_dwordx4 v135, s[8:11], s58 offen offset:3072 lds
    s_add_u32 m0, s52, 71680
    v_cvt_pk_bf16_f32 v221, v222, v223
    v_mfma_f32_16x16x32_bf16 a[168:171], a[236:239], v[20:23], 0
    ds_read_b64_tr_b16 a[204:205], v128 offset:24096
    v_accvgpr_write_b32 a52, v212
    v_mfma_f32_16x16x32_bf16 a[168:171], a[232:235], v[16:19], a[168:171]
    s_waitcnt lgkmcnt(7)
    s_lshl_b32 s41, s41, 12
    ds_read_b64_tr_b16 a[206:207], v128 offset:27680
    v_accvgpr_write_b32 a53, v213
    v_mfma_f32_16x16x32_bf16 a[64:67], a[240:243], v[24:27], a[64:67]
    ds_read_b64_tr_b16 a[208:209], v128 offset:64
    ds_read_b64_tr_b16 a[210:211], v128 offset:3648
    v_mfma_f32_16x16x32_bf16 a[64:67], a[244:247], v[28:31], a[64:67]
    s_add_u32 s12, s12, s41
    buffer_load_dwordx4 v136, s[8:11], s58 offen offset:0 lds
    v_accvgpr_write_b32 a54, v220
    v_mfma_f32_16x16x32_bf16 a[68:71], a[244:247], v[84:87], a[68:71]
    ds_read_b64_tr_b16 a[212:213], v128 offset:7232
    v_accvgpr_write_b32 a55, v221
    v_mfma_f32_16x16x32_bf16 a[68:71], a[240:243], v[80:83], a[68:71]
    ds_read_b64_tr_b16 a[214:215], v128 offset:10816
    v_mul_f32 v224, v224, v5
    v_mul_f32 v232, v232, v5
    v_mfma_f32_16x16x32_bf16 a[124:127], a[248:251], v[80:83], a[124:127]
    ds_read_b64_tr_b16 a[216:217], v128 offset:16960
    ds_read_b64_tr_b16 a[218:219], v128 offset:20544
    v_mfma_f32_16x16x32_bf16 a[124:127], a[252:255], v[84:87], a[124:127]
    s_add_u32 s13, s12, 57344
    buffer_load_dwordx4 v137, s[8:11], s58 offen offset:1024 lds
    v_mul_f32 v225, v225, v5
    v_mfma_f32_16x16x32_bf16 a[120:123], a[252:255], v[28:31], a[120:123]
    ds_read_b64_tr_b16 a[220:221], v128 offset:24128
    v_mul_f32 v233, v233, v5
    v_mfma_f32_16x16x32_bf16 a[120:123], a[248:251], v[24:27], a[120:123]
    s_waitcnt lgkmcnt(7)
    ds_read_b64_tr_b16 a[222:223], v128 offset:27712
    v_mul_f32 v226, v226, v5
    v_mfma_f32_16x16x32_bf16 a[72:75], a[192:195], v[24:27], a[72:75]
    ds_read_b64_tr_b16 a[224:225], v128 offset:96
    ds_read_b64_tr_b16 a[226:227], v128 offset:3680
    v_mfma_f32_16x16x32_bf16 a[72:75], a[196:199], v[28:31], a[72:75]
    buffer_load_dwordx4 v138, s[8:11], s58 offen offset:2048 lds
    s_add_u32 m0, s52, 101376
    v_mul_f32 v234, v234, v5
    v_mfma_f32_16x16x32_bf16 a[76:79], a[196:199], v[84:87], a[76:79]
    s_mov_b32 s58, 917504
    ds_read_b64_tr_b16 a[228:229], v128 offset:7264
    v_mfma_f32_16x16x32_bf16 a[76:79], a[192:195], v[80:83], a[76:79]
    ds_read_b64_tr_b16 a[230:231], v128 offset:10848
    v_mul_f32 v227, v227, v5
    v_mul_f32 v235, v235, v5
    v_mfma_f32_16x16x32_bf16 a[132:135], a[200:203], v[80:83], a[132:135]
    ds_read_b64_tr_b16 a[232:233], v128 offset:16992
    v_cvt_pk_bf16_f32 v224, v224, v225
    v_mfma_f32_16x16x32_bf16 a[132:135], a[204:207], v[84:87], a[132:135]
    ds_read_b64_tr_b16 a[234:235], v128 offset:20576
    v_cvt_pk_bf16_f32 v232, v232, v233
    v_cvt_pk_bf16_f32 v225, v226, v227
    v_mfma_f32_16x16x32_bf16 a[128:131], a[204:207], v[28:31], a[128:131]
    ds_read_b64_tr_b16 a[236:237], v128 offset:24160
    v_cvt_pk_bf16_f32 v233, v234, v235
    v_mfma_f32_16x16x32_bf16 a[128:131], a[200:203], v[24:27], a[128:131]
    s_waitcnt lgkmcnt(7)
    ds_read_b64_tr_b16 a[238:239], v128 offset:27744
    v_accvgpr_write_b32 a24, v224
    v_mfma_f32_16x16x32_bf16 a[80:83], a[208:211], v[24:27], a[80:83]
    ds_read_b64_tr_b16 a[240:241], v128 offset:128
    v_accvgpr_write_b32 a25, v225
    v_mfma_f32_16x16x32_bf16 a[80:83], a[212:215], v[28:31], a[80:83]
    ds_read_b64_tr_b16 a[242:243], v128 offset:3712
    v_accvgpr_write_b32 a26, v232
    v_accvgpr_write_b32 a27, v233
    v_mfma_f32_16x16x32_bf16 a[84:87], a[212:215], v[84:87], a[84:87]
    ds_read_b64_tr_b16 a[244:245], v128 offset:7296
    v_mul_f32 v228, v228, v6
    v_mfma_f32_16x16x32_bf16 a[84:87], a[208:211], v[80:83], a[84:87]
    ds_read_b64_tr_b16 a[246:247], v128 offset:10880
    v_mul_f32 v236, v236, v6
    v_mul_f32 v229, v229, v6
    v_mfma_f32_16x16x32_bf16 a[140:143], a[216:219], v[80:83], a[140:143]
    ds_read_b64_tr_b16 a[248:249], v128 offset:17024
    v_mul_f32 v237, v237, v6
    v_mfma_f32_16x16x32_bf16 a[140:143], a[220:223], v[84:87], a[140:143]
    ds_read_b64_tr_b16 a[250:251], v128 offset:20608
    v_mul_f32 v230, v230, v6
    v_mul_f32 v238, v238, v6
    v_mfma_f32_16x16x32_bf16 a[136:139], a[220:223], v[28:31], a[136:139]
    ds_read_b64_tr_b16 a[252:253], v128 offset:24192
    v_mul_f32 v231, v231, v6
    v_mfma_f32_16x16x32_bf16 a[136:139], a[216:219], v[24:27], a[136:139]
    s_waitcnt lgkmcnt(7)
    ds_read_b64_tr_b16 a[254:255], v128 offset:27776
    v_mul_f32 v239, v239, v6
    v_mfma_f32_16x16x32_bf16 a[88:91], a[224:227], v[24:27], a[88:91]
    ds_read_b64_tr_b16 a[192:193], v128 offset:160
    v_cvt_pk_bf16_f32 v228, v228, v229
    v_mfma_f32_16x16x32_bf16 a[88:91], a[228:231], v[28:31], a[88:91]
    ds_read_b64_tr_b16 a[194:195], v128 offset:3744
    v_cvt_pk_bf16_f32 v236, v236, v237
    v_cvt_pk_bf16_f32 v229, v230, v231
    v_mfma_f32_16x16x32_bf16 a[92:95], a[228:231], v[84:87], a[92:95]
    ds_read_b64_tr_b16 a[196:197], v128 offset:7328
    v_cvt_pk_bf16_f32 v237, v238, v239
    v_mfma_f32_16x16x32_bf16 a[92:95], a[224:227], v[80:83], a[92:95]
    ds_read_b64_tr_b16 a[198:199], v128 offset:10912
    v_accvgpr_write_b32 a56, v228
    v_accvgpr_write_b32 a57, v229
    v_mfma_f32_16x16x32_bf16 a[148:151], a[232:235], v[80:83], a[148:151]
    ds_read_b64_tr_b16 a[200:201], v128 offset:17056
    v_accvgpr_write_b32 a58, v236
    v_mfma_f32_16x16x32_bf16 a[148:151], a[236:239], v[84:87], a[148:151]
    ds_read_b64_tr_b16 a[202:203], v128 offset:20640
    v_accvgpr_write_b32 a59, v237
    v_mul_f32 v240, v240, v5
    v_mfma_f32_16x16x32_bf16 a[144:147], a[236:239], v[28:31], a[144:147]
    ds_read_b64_tr_b16 a[204:205], v128 offset:24224
    v_mul_f32 v248, v248, v5
    v_mfma_f32_16x16x32_bf16 a[144:147], a[232:235], v[24:27], a[144:147]
    s_waitcnt lgkmcnt(7)
    ds_read_b64_tr_b16 a[206:207], v128 offset:27808
    v_mul_f32 v241, v241, v5
    v_mfma_f32_16x16x32_bf16 a[96:99], a[240:243], v[24:27], a[96:99]
    ds_read_b64_tr_b16 a[208:209], v130 offset:192
    v_mul_f32 v249, v249, v5
    v_mfma_f32_16x16x32_bf16 a[96:99], a[244:247], v[28:31], a[96:99]
    ds_read_b64_tr_b16 a[210:211], v130 offset:3776
    v_mul_f32 v242, v242, v5
    v_mul_f32 v250, v250, v5
    v_mfma_f32_16x16x32_bf16 a[100:103], a[244:247], v[84:87], a[100:103]
    ds_read_b64_tr_b16 a[212:213], v130 offset:7360
    v_mul_f32 v243, v243, v5
    v_mfma_f32_16x16x32_bf16 a[100:103], a[240:243], v[80:83], a[100:103]
    ds_read_b64_tr_b16 a[214:215], v130 offset:10944
    v_mul_f32 v251, v251, v5
    v_cvt_pk_bf16_f32 v240, v240, v241
    v_mfma_f32_16x16x32_bf16 a[156:159], a[248:251], v[80:83], a[156:159]
    ds_read_b64_tr_b16 a[216:217], v130 offset:17088
    v_cvt_pk_bf16_f32 v248, v248, v249
    v_mfma_f32_16x16x32_bf16 a[156:159], a[252:255], v[84:87], a[156:159]
    ds_read_b64_tr_b16 a[218:219], v130 offset:20672
    v_cvt_pk_bf16_f32 v241, v242, v243
    v_cvt_pk_bf16_f32 v249, v250, v251
    v_mfma_f32_16x16x32_bf16 a[152:155], a[252:255], v[28:31], a[152:155]
    ds_read_b64_tr_b16 a[220:221], v130 offset:24256
    ds_read_b64_tr_b16 a[222:223], v130 offset:27840
    v_mfma_f32_16x16x32_bf16 a[152:155], a[248:251], v[24:27], a[152:155]
    s_waitcnt vmcnt(7) lgkmcnt(8)
    s_barrier
    v_accvgpr_write_b32 a28, v240
    v_accvgpr_write_b32 a29, v241
    v_mfma_f32_16x16x32_bf16 a[104:107], a[192:195], v[24:27], a[104:107]
    ds_read_b64_tr_b16 a[224:225], v128 offset:33792
    ds_read_b64_tr_b16 a[226:227], v128 offset:37376
    v_mfma_f32_16x16x32_bf16 a[104:107], a[196:199], v[28:31], a[104:107]
    buffer_load_dwordx4 v132, s[8:11], s58 offen offset:0 lds
    v_accvgpr_write_b32 a30, v248
    v_mfma_f32_16x16x32_bf16 a[108:111], a[196:199], v[84:87], a[108:111]
    ds_read_b64_tr_b16 a[228:229], v128 offset:40960
    v_accvgpr_write_b32 a31, v249
    v_mfma_f32_16x16x32_bf16 a[108:111], a[192:195], v[80:83], a[108:111]
    ds_read_b64_tr_b16 a[230:231], v128 offset:44544
    v_mul_f32 v244, v244, v6
    v_mul_f32 v252, v252, v6
    v_mfma_f32_16x16x32_bf16 a[164:167], a[200:203], v[80:83], a[164:167]
    ds_read_b64_tr_b16 a[232:233], v128 offset:50688
    ds_read_b64_tr_b16 a[234:235], v128 offset:54272
    v_mfma_f32_16x16x32_bf16 a[164:167], a[204:207], v[84:87], a[164:167]
    buffer_load_dwordx4 v133, s[8:11], s58 offen offset:1024 lds
    v_mul_f32 v245, v245, v6
    v_mfma_f32_16x16x32_bf16 a[160:163], a[204:207], v[28:31], a[160:163]
    ds_read_b64_tr_b16 a[236:237], v128 offset:57856
    v_mul_f32 v253, v253, v6
    v_mfma_f32_16x16x32_bf16 a[160:163], a[200:203], v[24:27], a[160:163]
    s_waitcnt lgkmcnt(7)
    ds_read_b64_tr_b16 a[238:239], v128 offset:61440
    v_mul_f32 v246, v246, v6
    v_mfma_f32_16x16x32_bf16 a[112:115], a[208:211], v[24:27], a[112:115]
    ds_read_b64_tr_b16 a[240:241], v128 offset:33824
    ds_read_b64_tr_b16 a[242:243], v128 offset:37408
    v_mfma_f32_16x16x32_bf16 a[112:115], a[212:215], v[28:31], a[112:115]
    buffer_load_dwordx4 v134, s[8:11], s58 offen offset:2048 lds
    v_mul_f32 v254, v254, v6
    v_mfma_f32_16x16x32_bf16 a[116:119], a[212:215], v[84:87], a[116:119]
    ds_read_b64_tr_b16 a[244:245], v128 offset:40992
    v_mul_f32 v247, v247, v6
    v_mfma_f32_16x16x32_bf16 a[116:119], a[208:211], v[80:83], a[116:119]
    ds_read_b64_tr_b16 a[246:247], v128 offset:44576
    v_mul_f32 v255, v255, v6
    v_cvt_pk_bf16_f32 v244, v244, v245
    v_mfma_f32_16x16x32_bf16 a[172:175], a[216:219], v[80:83], a[172:175]
    ds_read_b64_tr_b16 a[248:249], v128 offset:50720
    ds_read_b64_tr_b16 a[250:251], v128 offset:54304
    v_mfma_f32_16x16x32_bf16 a[172:175], a[220:223], v[84:87], a[172:175]
    buffer_load_dwordx4 v135, s[8:11], s58 offen offset:3072 lds
    s_add_u32 m0, s52, 105472
    v_cvt_pk_bf16_f32 v252, v252, v253
    v_mfma_f32_16x16x32_bf16 a[168:171], a[220:223], v[28:31], a[168:171]
    ds_read_b64_tr_b16 a[252:253], v128 offset:57888
    v_cvt_pk_bf16_f32 v245, v246, v247
    v_mfma_f32_16x16x32_bf16 a[168:171], a[216:219], v[24:27], a[168:171]
    s_waitcnt lgkmcnt(7)
    ds_read_b64_tr_b16 a[254:255], v128 offset:61472
    v_cvt_pk_bf16_f32 v253, v254, v255
    v_mfma_f32_16x16x32_bf16 a[64:67], a[224:227], v[32:35], a[64:67]
    ds_read_b64_tr_b16 a[192:193], v128 offset:33856
    ds_read_b64_tr_b16 a[194:195], v128 offset:37440
    v_mfma_f32_16x16x32_bf16 a[64:67], a[228:231], v[36:39], a[64:67]
    buffer_load_dwordx4 v136, s[8:11], s58 offen offset:0 lds
    v_accvgpr_write_b32 a60, v244
    v_mfma_f32_16x16x32_bf16 a[68:71], a[228:231], v[92:95], a[68:71]
    ds_read_b64_tr_b16 a[196:197], v128 offset:41024
    v_accvgpr_write_b32 a61, v245
    v_mfma_f32_16x16x32_bf16 a[68:71], a[224:227], v[88:91], a[68:71]
    ds_read_b64_tr_b16 a[198:199], v128 offset:44608
    v_accvgpr_write_b32 a62, v252
    v_accvgpr_write_b32 a63, v253
    v_mfma_f32_16x16x32_bf16 a[124:127], a[232:235], v[88:91], a[124:127]
    ds_read_b64_tr_b16 a[200:201], v128 offset:50752
    ds_read_b64_tr_b16 a[202:203], v128 offset:54336
    v_mfma_f32_16x16x32_bf16 a[124:127], a[236:239], v[92:95], a[124:127]
    buffer_load_dwordx4 v137, s[8:11], s58 offen offset:1024 lds
    v_lshlrev_b32 v6, 4, v13
    v_mfma_f32_16x16x32_bf16 a[120:123], a[236:239], v[36:39], a[120:123]
    ds_read_b64_tr_b16 a[204:205], v128 offset:57920
    v_accvgpr_read_b32 v1, a177
    v_mfma_f32_16x16x32_bf16 a[120:123], a[232:235], v[32:35], a[120:123]
    s_waitcnt lgkmcnt(7)
    ds_read_b64_tr_b16 a[206:207], v128 offset:61504
    v_accvgpr_read_b32 v2, a178
    v_mfma_f32_16x16x32_bf16 a[72:75], a[240:243], v[32:35], a[72:75]
    ds_read_b64_tr_b16 a[208:209], v128 offset:33888
    ds_read_b64_tr_b16 a[210:211], v128 offset:37472
    v_mfma_f32_16x16x32_bf16 a[72:75], a[244:247], v[36:39], a[72:75]
    buffer_load_dwordx4 v138, s[8:11], s58 offen offset:2048 lds
    s_add_u32 m0, s52, 0
    v_accvgpr_read_b32 v0, a179
    v_mfma_f32_16x16x32_bf16 a[76:79], a[244:247], v[92:95], a[76:79]
    s_mov_b32 s58, 1146880
    ds_read_b64_tr_b16 a[212:213], v128 offset:41056
    v_mfma_f32_16x16x32_bf16 a[76:79], a[240:243], v[88:91], a[76:79]
    ds_read_b64_tr_b16 a[214:215], v128 offset:44640
    v_mfma_f32_16x16x32_bf16 a[132:135], a[248:251], v[88:91], a[132:135]
    ds_read_b64_tr_b16 a[216:217], v128 offset:50784
    v_mfma_f32_16x16x32_bf16 a[132:135], a[252:255], v[92:95], a[132:135]
    ds_read_b64_tr_b16 a[218:219], v128 offset:54368
    v_mfma_f32_16x16x32_bf16 a[128:131], a[252:255], v[36:39], a[128:131]
    ds_read_b64_tr_b16 a[220:221], v128 offset:57952
    v_mfma_f32_16x16x32_bf16 a[128:131], a[248:251], v[32:35], a[128:131]
    s_waitcnt lgkmcnt(7)
    ds_read_b64_tr_b16 a[222:223], v128 offset:61536
    v_mfma_f32_16x16x32_bf16 a[80:83], a[192:195], v[32:35], a[80:83]
    ds_read_b64_tr_b16 a[224:225], v128 offset:33920
    v_mfma_f32_16x16x32_bf16 a[80:83], a[196:199], v[36:39], a[80:83]
    ds_read_b64_tr_b16 a[226:227], v128 offset:37504
    v_mfma_f32_16x16x32_bf16 a[84:87], a[196:199], v[92:95], a[84:87]
    ds_read_b64_tr_b16 a[228:229], v128 offset:41088
    v_mfma_f32_16x16x32_bf16 a[84:87], a[192:195], v[88:91], a[84:87]
    ds_read_b64_tr_b16 a[230:231], v128 offset:44672
    v_mfma_f32_16x16x32_bf16 a[140:143], a[200:203], v[88:91], a[140:143]
    ds_read_b64_tr_b16 a[232:233], v128 offset:50816
    v_mfma_f32_16x16x32_bf16 a[140:143], a[204:207], v[92:95], a[140:143]
    ds_read_b64_tr_b16 a[234:235], v128 offset:54400
    v_mfma_f32_16x16x32_bf16 a[136:139], a[204:207], v[36:39], a[136:139]
    ds_read_b64_tr_b16 a[236:237], v128 offset:57984
    v_mfma_f32_16x16x32_bf16 a[136:139], a[200:203], v[32:35], a[136:139]
    s_waitcnt lgkmcnt(7)
    ds_read_b64_tr_b16 a[238:239], v128 offset:61568
    v_mfma_f32_16x16x32_bf16 a[88:91], a[208:211], v[32:35], a[88:91]
    ds_read_b64_tr_b16 a[240:241], v128 offset:33952
    v_mfma_f32_16x16x32_bf16 a[88:91], a[212:215], v[36:39], a[88:91]
    ds_read_b64_tr_b16 a[242:243], v128 offset:37536
    v_mfma_f32_16x16x32_bf16 a[92:95], a[212:215], v[92:95], a[92:95]
    ds_read_b64_tr_b16 a[244:245], v128 offset:41120
    v_mfma_f32_16x16x32_bf16 a[92:95], a[208:211], v[88:91], a[92:95]
    ds_read_b64_tr_b16 a[246:247], v128 offset:44704
    v_mfma_f32_16x16x32_bf16 a[148:151], a[216:219], v[88:91], a[148:151]
    ds_read_b64_tr_b16 a[248:249], v128 offset:50848
    v_mfma_f32_16x16x32_bf16 a[148:151], a[220:223], v[92:95], a[148:151]
    ds_read_b64_tr_b16 a[250:251], v128 offset:54432
    v_mfma_f32_16x16x32_bf16 a[144:147], a[220:223], v[36:39], a[144:147]
    ds_read_b64_tr_b16 a[252:253], v128 offset:58016
    v_mfma_f32_16x16x32_bf16 a[144:147], a[216:219], v[32:35], a[144:147]
    s_waitcnt lgkmcnt(7)
    ds_read_b64_tr_b16 a[254:255], v128 offset:61600
    v_mfma_f32_16x16x32_bf16 a[96:99], a[224:227], v[32:35], a[96:99]
    ds_read_b64_tr_b16 a[192:193], v130 offset:33984
    v_mfma_f32_16x16x32_bf16 a[96:99], a[228:231], v[36:39], a[96:99]
    ds_read_b64_tr_b16 a[194:195], v130 offset:37568
    v_mfma_f32_16x16x32_bf16 a[100:103], a[228:231], v[92:95], a[100:103]
    ds_read_b64_tr_b16 a[196:197], v130 offset:41152
    v_mfma_f32_16x16x32_bf16 a[100:103], a[224:227], v[88:91], a[100:103]
    ds_read_b64_tr_b16 a[198:199], v130 offset:44736
    v_mfma_f32_16x16x32_bf16 a[156:159], a[232:235], v[88:91], a[156:159]
    ds_read_b64_tr_b16 a[200:201], v130 offset:50880
    v_mfma_f32_16x16x32_bf16 a[156:159], a[236:239], v[92:95], a[156:159]
    ds_read_b64_tr_b16 a[202:203], v130 offset:54464
    v_mfma_f32_16x16x32_bf16 a[152:155], a[236:239], v[36:39], a[152:155]
    ds_read_b64_tr_b16 a[204:205], v130 offset:58048
    ds_read_b64_tr_b16 a[206:207], v130 offset:61632
    v_mfma_f32_16x16x32_bf16 a[152:155], a[232:235], v[32:35], a[152:155]
    s_waitcnt vmcnt(7) lgkmcnt(8)
    s_barrier
    v_mfma_f32_16x16x32_bf16 a[104:107], a[240:243], v[32:35], a[104:107]
    ds_read_b64_tr_b16 a[208:209], v129 offset:0
    ds_read_b64_tr_b16 a[210:211], v129 offset:3584
    v_mfma_f32_16x16x32_bf16 a[104:107], a[244:247], v[36:39], a[104:107]
    buffer_load_dwordx4 v132, s[8:11], s58 offen offset:0 lds
    v_mfma_f32_16x16x32_bf16 a[108:111], a[244:247], v[92:95], a[108:111]
    ds_read_b64_tr_b16 a[212:213], v129 offset:7168
    v_mfma_f32_16x16x32_bf16 a[108:111], a[240:243], v[88:91], a[108:111]
    ds_read_b64_tr_b16 a[214:215], v129 offset:10752
    v_mfma_f32_16x16x32_bf16 a[164:167], a[248:251], v[88:91], a[164:167]
    ds_read_b64_tr_b16 a[216:217], v129 offset:16896
    ds_read_b64_tr_b16 a[218:219], v129 offset:20480
    v_mfma_f32_16x16x32_bf16 a[164:167], a[252:255], v[92:95], a[164:167]
    buffer_load_dwordx4 v133, s[8:11], s58 offen offset:1024 lds
    v_mfma_f32_16x16x32_bf16 a[160:163], a[252:255], v[36:39], a[160:163]
    ds_read_b64_tr_b16 a[220:221], v129 offset:24064
    v_mfma_f32_16x16x32_bf16 a[160:163], a[248:251], v[32:35], a[160:163]
    s_waitcnt lgkmcnt(7)
    ds_read_b64_tr_b16 a[222:223], v129 offset:27648
    v_mfma_f32_16x16x32_bf16 a[112:115], a[192:195], v[32:35], a[112:115]
    ds_read_b64_tr_b16 a[224:225], v129 offset:32
    ds_read_b64_tr_b16 a[226:227], v129 offset:3616
    v_mfma_f32_16x16x32_bf16 a[112:115], a[196:199], v[36:39], a[112:115]
    buffer_load_dwordx4 v134, s[8:11], s58 offen offset:2048 lds
    v_mfma_f32_16x16x32_bf16 a[116:119], a[196:199], v[92:95], a[116:119]
    ds_read_b64_tr_b16 a[228:229], v129 offset:7200
    v_mfma_f32_16x16x32_bf16 a[116:119], a[192:195], v[88:91], a[116:119]
    ds_read_b64_tr_b16 a[230:231], v129 offset:10784
    v_mfma_f32_16x16x32_bf16 a[172:175], a[200:203], v[88:91], a[172:175]
    ds_read_b64_tr_b16 a[232:233], v129 offset:16928
    ds_read_b64_tr_b16 a[234:235], v129 offset:20512
    v_mfma_f32_16x16x32_bf16 a[172:175], a[204:207], v[92:95], a[172:175]
    buffer_load_dwordx4 v135, s[8:11], s58 offen offset:3072 lds
    s_add_u32 m0, s52, 4096
    v_mfma_f32_16x16x32_bf16 a[168:171], a[204:207], v[36:39], a[168:171]
    ds_read_b64_tr_b16 a[236:237], v129 offset:24096
    v_mfma_f32_16x16x32_bf16 a[168:171], a[200:203], v[32:35], a[168:171]
    s_waitcnt lgkmcnt(7)
    ds_read_b64_tr_b16 a[238:239], v129 offset:27680
    v_mfma_f32_16x16x32_bf16 a[64:67], a[208:211], v[40:43], a[64:67]
    ds_read_b64_tr_b16 a[240:241], v129 offset:64
    ds_read_b64_tr_b16 a[242:243], v129 offset:3648
    v_mfma_f32_16x16x32_bf16 a[64:67], a[212:215], v[44:47], a[64:67]
    buffer_load_dwordx4 v136, s[8:11], s58 offen offset:0 lds
    v_mfma_f32_16x16x32_bf16 a[68:71], a[212:215], v[100:103], a[68:71]
    ds_read_b64_tr_b16 a[244:245], v129 offset:7232
    v_mfma_f32_16x16x32_bf16 a[68:71], a[208:211], v[96:99], a[68:71]
    ds_read_b64_tr_b16 a[246:247], v129 offset:10816
    v_mfma_f32_16x16x32_bf16 a[124:127], a[216:219], v[96:99], a[124:127]
    ds_read_b64_tr_b16 a[248:249], v129 offset:16960
    ds_read_b64_tr_b16 a[250:251], v129 offset:20544
    v_mfma_f32_16x16x32_bf16 a[124:127], a[220:223], v[100:103], a[124:127]
    buffer_load_dwordx4 v137, s[8:11], s58 offen offset:1024 lds
    v_mfma_f32_16x16x32_bf16 a[120:123], a[220:223], v[44:47], a[120:123]
    ds_read_b64_tr_b16 a[252:253], v129 offset:24128
    v_mfma_f32_16x16x32_bf16 a[120:123], a[216:219], v[40:43], a[120:123]
    s_waitcnt lgkmcnt(7)
    ds_read_b64_tr_b16 a[254:255], v129 offset:27712
    v_mfma_f32_16x16x32_bf16 a[72:75], a[224:227], v[40:43], a[72:75]
    ds_read_b64_tr_b16 a[192:193], v129 offset:96
    ds_read_b64_tr_b16 a[194:195], v129 offset:3680
    v_mfma_f32_16x16x32_bf16 a[72:75], a[228:231], v[44:47], a[72:75]
    buffer_load_dwordx4 v138, s[8:11], s58 offen offset:2048 lds
    s_add_u32 m0, s52, 33792
    v_mfma_f32_16x16x32_bf16 a[76:79], a[228:231], v[100:103], a[76:79]
    s_mov_b32 s58, 1376256
    ds_read_b64_tr_b16 a[196:197], v129 offset:7264
    v_mfma_f32_16x16x32_bf16 a[76:79], a[224:227], v[96:99], a[76:79]
    ds_read_b64_tr_b16 a[198:199], v129 offset:10848
    v_mfma_f32_16x16x32_bf16 a[132:135], a[232:235], v[96:99], a[132:135]
    ds_read_b64_tr_b16 a[200:201], v129 offset:16992
    v_mfma_f32_16x16x32_bf16 a[132:135], a[236:239], v[100:103], a[132:135]
    ds_read_b64_tr_b16 a[202:203], v129 offset:20576
    v_mfma_f32_16x16x32_bf16 a[128:131], a[236:239], v[44:47], a[128:131]
    ds_read_b64_tr_b16 a[204:205], v129 offset:24160
    v_mfma_f32_16x16x32_bf16 a[128:131], a[232:235], v[40:43], a[128:131]
    s_waitcnt lgkmcnt(7)
    ds_read_b64_tr_b16 a[206:207], v129 offset:27744
    v_mfma_f32_16x16x32_bf16 a[80:83], a[240:243], v[40:43], a[80:83]
    ds_read_b64_tr_b16 a[208:209], v129 offset:128
    v_mfma_f32_16x16x32_bf16 a[80:83], a[244:247], v[44:47], a[80:83]
    ds_read_b64_tr_b16 a[210:211], v129 offset:3712
    v_mfma_f32_16x16x32_bf16 a[84:87], a[244:247], v[100:103], a[84:87]
    ds_read_b64_tr_b16 a[212:213], v129 offset:7296
    v_mfma_f32_16x16x32_bf16 a[84:87], a[240:243], v[96:99], a[84:87]
    ds_read_b64_tr_b16 a[214:215], v129 offset:10880
    v_mfma_f32_16x16x32_bf16 a[140:143], a[248:251], v[96:99], a[140:143]
    ds_read_b64_tr_b16 a[216:217], v129 offset:17024
    v_mfma_f32_16x16x32_bf16 a[140:143], a[252:255], v[100:103], a[140:143]
    ds_read_b64_tr_b16 a[218:219], v129 offset:20608
    v_mfma_f32_16x16x32_bf16 a[136:139], a[252:255], v[44:47], a[136:139]
    ds_read_b64_tr_b16 a[220:221], v129 offset:24192
    v_mfma_f32_16x16x32_bf16 a[136:139], a[248:251], v[40:43], a[136:139]
    s_waitcnt lgkmcnt(7)
    ds_read_b64_tr_b16 a[222:223], v129 offset:27776
    v_mfma_f32_16x16x32_bf16 a[88:91], a[192:195], v[40:43], a[88:91]
    ds_read_b64_tr_b16 a[224:225], v129 offset:160
    v_mfma_f32_16x16x32_bf16 a[88:91], a[196:199], v[44:47], a[88:91]
    ds_read_b64_tr_b16 a[226:227], v129 offset:3744
    v_mfma_f32_16x16x32_bf16 a[92:95], a[196:199], v[100:103], a[92:95]
    ds_read_b64_tr_b16 a[228:229], v129 offset:7328
    v_mfma_f32_16x16x32_bf16 a[92:95], a[192:195], v[96:99], a[92:95]
    ds_read_b64_tr_b16 a[230:231], v129 offset:10912
    v_mfma_f32_16x16x32_bf16 a[148:151], a[200:203], v[96:99], a[148:151]
    ds_read_b64_tr_b16 a[232:233], v129 offset:17056
    v_mfma_f32_16x16x32_bf16 a[148:151], a[204:207], v[100:103], a[148:151]
    ds_read_b64_tr_b16 a[234:235], v129 offset:20640
    v_mfma_f32_16x16x32_bf16 a[144:147], a[204:207], v[44:47], a[144:147]
    ds_read_b64_tr_b16 a[236:237], v129 offset:24224
    v_mfma_f32_16x16x32_bf16 a[144:147], a[200:203], v[40:43], a[144:147]
    s_waitcnt lgkmcnt(7)
    ds_read_b64_tr_b16 a[238:239], v129 offset:27808
    v_mfma_f32_16x16x32_bf16 a[96:99], a[208:211], v[40:43], a[96:99]
    ds_read_b64_tr_b16 a[240:241], v131 offset:192
    v_mfma_f32_16x16x32_bf16 a[96:99], a[212:215], v[44:47], a[96:99]
    ds_read_b64_tr_b16 a[242:243], v131 offset:3776
    v_mfma_f32_16x16x32_bf16 a[100:103], a[212:215], v[100:103], a[100:103]
    ds_read_b64_tr_b16 a[244:245], v131 offset:7360
    v_mfma_f32_16x16x32_bf16 a[100:103], a[208:211], v[96:99], a[100:103]
    ds_read_b64_tr_b16 a[246:247], v131 offset:10944
    v_mfma_f32_16x16x32_bf16 a[156:159], a[216:219], v[96:99], a[156:159]
    ds_read_b64_tr_b16 a[248:249], v131 offset:17088
    v_mfma_f32_16x16x32_bf16 a[156:159], a[220:223], v[100:103], a[156:159]
    ds_read_b64_tr_b16 a[250:251], v131 offset:20672
    v_mfma_f32_16x16x32_bf16 a[152:155], a[220:223], v[44:47], a[152:155]
    ds_read_b64_tr_b16 a[252:253], v131 offset:24256
    ds_read_b64_tr_b16 a[254:255], v131 offset:27840
    v_mfma_f32_16x16x32_bf16 a[152:155], a[216:219], v[40:43], a[152:155]
    s_waitcnt vmcnt(7) lgkmcnt(8)
    s_barrier
    v_mfma_f32_16x16x32_bf16 a[104:107], a[224:227], v[40:43], a[104:107]
    ds_read_b64_tr_b16 a[192:193], v129 offset:33792
    ds_read_b64_tr_b16 a[194:195], v129 offset:37376
    v_mfma_f32_16x16x32_bf16 a[104:107], a[228:231], v[44:47], a[104:107]
    buffer_load_dwordx4 v132, s[8:11], s58 offen offset:0 lds
    v_mfma_f32_16x16x32_bf16 a[108:111], a[228:231], v[100:103], a[108:111]
    ds_read_b64_tr_b16 a[196:197], v129 offset:40960
    v_mfma_f32_16x16x32_bf16 a[108:111], a[224:227], v[96:99], a[108:111]
    ds_read_b64_tr_b16 a[198:199], v129 offset:44544
    v_mfma_f32_16x16x32_bf16 a[164:167], a[232:235], v[96:99], a[164:167]
    ds_read_b64_tr_b16 a[200:201], v129 offset:50688
    ds_read_b64_tr_b16 a[202:203], v129 offset:54272
    v_mfma_f32_16x16x32_bf16 a[164:167], a[236:239], v[100:103], a[164:167]
    buffer_load_dwordx4 v133, s[8:11], s58 offen offset:1024 lds
    v_mfma_f32_16x16x32_bf16 a[160:163], a[236:239], v[44:47], a[160:163]
    ds_read_b64_tr_b16 a[204:205], v129 offset:57856
    v_mfma_f32_16x16x32_bf16 a[160:163], a[232:235], v[40:43], a[160:163]
    s_waitcnt lgkmcnt(7)
    ds_read_b64_tr_b16 a[206:207], v129 offset:61440
    v_mfma_f32_16x16x32_bf16 a[112:115], a[240:243], v[40:43], a[112:115]
    ds_read_b64_tr_b16 a[208:209], v129 offset:33824
    ds_read_b64_tr_b16 a[210:211], v129 offset:37408
    v_mfma_f32_16x16x32_bf16 a[112:115], a[244:247], v[44:47], a[112:115]
    buffer_load_dwordx4 v134, s[8:11], s58 offen offset:2048 lds
    v_mfma_f32_16x16x32_bf16 a[116:119], a[244:247], v[100:103], a[116:119]
    ds_read_b64_tr_b16 a[212:213], v129 offset:40992
    v_mfma_f32_16x16x32_bf16 a[116:119], a[240:243], v[96:99], a[116:119]
    ds_read_b64_tr_b16 a[214:215], v129 offset:44576
    v_mfma_f32_16x16x32_bf16 a[172:175], a[248:251], v[96:99], a[172:175]
    ds_read_b64_tr_b16 a[216:217], v129 offset:50720
    ds_read_b64_tr_b16 a[218:219], v129 offset:54304
    v_mfma_f32_16x16x32_bf16 a[172:175], a[252:255], v[100:103], a[172:175]
    buffer_load_dwordx4 v135, s[8:11], s58 offen offset:3072 lds
    s_add_u32 m0, s52, 37888
    v_mfma_f32_16x16x32_bf16 a[168:171], a[252:255], v[44:47], a[168:171]
    ds_read_b64_tr_b16 a[220:221], v129 offset:57888
    v_mfma_f32_16x16x32_bf16 a[168:171], a[248:251], v[40:43], a[168:171]
    s_waitcnt lgkmcnt(7)
    ds_read_b64_tr_b16 a[222:223], v129 offset:61472
    v_mfma_f32_16x16x32_bf16 a[64:67], a[192:195], v[48:51], a[64:67]
    ds_read_b64_tr_b16 a[224:225], v129 offset:33856
    ds_read_b64_tr_b16 a[226:227], v129 offset:37440
    v_mfma_f32_16x16x32_bf16 a[64:67], a[196:199], v[52:55], a[64:67]
    buffer_load_dwordx4 v136, s[8:11], s58 offen offset:0 lds
    v_mfma_f32_16x16x32_bf16 a[68:71], a[196:199], v[108:111], a[68:71]
    ds_read_b64_tr_b16 a[228:229], v129 offset:41024
    v_mfma_f32_16x16x32_bf16 a[68:71], a[192:195], v[104:107], a[68:71]
    ds_read_b64_tr_b16 a[230:231], v129 offset:44608
    v_mfma_f32_16x16x32_bf16 a[124:127], a[200:203], v[104:107], a[124:127]
    ds_read_b64_tr_b16 a[232:233], v129 offset:50752
    ds_read_b64_tr_b16 a[234:235], v129 offset:54336
    v_mfma_f32_16x16x32_bf16 a[124:127], a[204:207], v[108:111], a[124:127]
    buffer_load_dwordx4 v137, s[8:11], s58 offen offset:1024 lds
    v_mfma_f32_16x16x32_bf16 a[120:123], a[204:207], v[52:55], a[120:123]
    ds_read_b64_tr_b16 a[236:237], v129 offset:57920
    v_mfma_f32_16x16x32_bf16 a[120:123], a[200:203], v[48:51], a[120:123]
    s_waitcnt lgkmcnt(7)
    ds_read_b64_tr_b16 a[238:239], v129 offset:61504
    v_mfma_f32_16x16x32_bf16 a[72:75], a[208:211], v[48:51], a[72:75]
    ds_read_b64_tr_b16 a[240:241], v129 offset:33888
    ds_read_b64_tr_b16 a[242:243], v129 offset:37472
    v_mfma_f32_16x16x32_bf16 a[72:75], a[212:215], v[52:55], a[72:75]
    buffer_load_dwordx4 v138, s[8:11], s58 offen offset:2048 lds
    s_add_u32 m0, s37, 67584
    v_mfma_f32_16x16x32_bf16 a[76:79], a[212:215], v[108:111], a[76:79]
    s_mov_b32 s58, 0
    ds_read_b64_tr_b16 a[244:245], v129 offset:41056
    v_mfma_f32_16x16x32_bf16 a[76:79], a[208:211], v[104:107], a[76:79]
    ds_read_b64_tr_b16 a[246:247], v129 offset:44640
    v_mfma_f32_16x16x32_bf16 a[132:135], a[216:219], v[104:107], a[132:135]
    ds_read_b64_tr_b16 a[248:249], v129 offset:50784
    v_mfma_f32_16x16x32_bf16 a[132:135], a[220:223], v[108:111], a[132:135]
    ds_read_b64_tr_b16 a[250:251], v129 offset:54368
    v_mfma_f32_16x16x32_bf16 a[128:131], a[220:223], v[52:55], a[128:131]
    ds_read_b64_tr_b16 a[252:253], v129 offset:57952
    v_mfma_f32_16x16x32_bf16 a[128:131], a[216:219], v[48:51], a[128:131]
    s_waitcnt lgkmcnt(7)
    ds_read_b64_tr_b16 a[254:255], v129 offset:61536
    v_mfma_f32_16x16x32_bf16 a[80:83], a[224:227], v[48:51], a[80:83]
    ds_read_b64_tr_b16 a[192:193], v129 offset:33920
    v_mfma_f32_16x16x32_bf16 a[80:83], a[228:231], v[52:55], a[80:83]
    ds_read_b64_tr_b16 a[194:195], v129 offset:37504
    v_mfma_f32_16x16x32_bf16 a[84:87], a[228:231], v[108:111], a[84:87]
    ds_read_b64_tr_b16 a[196:197], v129 offset:41088
    v_mfma_f32_16x16x32_bf16 a[84:87], a[224:227], v[104:107], a[84:87]
    ds_read_b64_tr_b16 a[198:199], v129 offset:44672
    v_mfma_f32_16x16x32_bf16 a[140:143], a[232:235], v[104:107], a[140:143]
    ds_read_b64_tr_b16 a[200:201], v129 offset:50816
    v_mfma_f32_16x16x32_bf16 a[140:143], a[236:239], v[108:111], a[140:143]
    ds_read_b64_tr_b16 a[202:203], v129 offset:54400
    v_mfma_f32_16x16x32_bf16 a[136:139], a[236:239], v[52:55], a[136:139]
    ds_read_b64_tr_b16 a[204:205], v129 offset:57984
    v_mfma_f32_16x16x32_bf16 a[136:139], a[232:235], v[48:51], a[136:139]
    s_waitcnt lgkmcnt(7)
    ds_read_b64_tr_b16 a[206:207], v129 offset:61568
    v_mfma_f32_16x16x32_bf16 a[88:91], a[240:243], v[48:51], a[88:91]
    ds_read_b64_tr_b16 a[208:209], v129 offset:33952
    v_mfma_f32_16x16x32_bf16 a[88:91], a[244:247], v[52:55], a[88:91]
    ds_read_b64_tr_b16 a[210:211], v129 offset:37536
    v_mfma_f32_16x16x32_bf16 a[92:95], a[244:247], v[108:111], a[92:95]
    ds_read_b64_tr_b16 a[212:213], v129 offset:41120
    v_mfma_f32_16x16x32_bf16 a[92:95], a[240:243], v[104:107], a[92:95]
    ds_read_b64_tr_b16 a[214:215], v129 offset:44704
    v_mfma_f32_16x16x32_bf16 a[148:151], a[248:251], v[104:107], a[148:151]
    ds_read_b64_tr_b16 a[216:217], v129 offset:50848
    v_mfma_f32_16x16x32_bf16 a[148:151], a[252:255], v[108:111], a[148:151]
    ds_read_b64_tr_b16 a[218:219], v129 offset:54432
    v_mfma_f32_16x16x32_bf16 a[144:147], a[252:255], v[52:55], a[144:147]
    ds_read_b64_tr_b16 a[220:221], v129 offset:58016
    v_mfma_f32_16x16x32_bf16 a[144:147], a[248:251], v[48:51], a[144:147]
    s_waitcnt lgkmcnt(7)
    ds_read_b64_tr_b16 a[222:223], v129 offset:61600
    v_mfma_f32_16x16x32_bf16 a[96:99], a[192:195], v[48:51], a[96:99]
    ds_read_b64_tr_b16 a[224:225], v131 offset:33984
    v_mfma_f32_16x16x32_bf16 a[96:99], a[196:199], v[52:55], a[96:99]
    ds_read_b64_tr_b16 a[226:227], v131 offset:37568
    v_mfma_f32_16x16x32_bf16 a[100:103], a[196:199], v[108:111], a[100:103]
    ds_read_b64_tr_b16 a[228:229], v131 offset:41152
    v_mfma_f32_16x16x32_bf16 a[100:103], a[192:195], v[104:107], a[100:103]
    ds_read_b64_tr_b16 a[230:231], v131 offset:44736
    v_mfma_f32_16x16x32_bf16 a[156:159], a[200:203], v[104:107], a[156:159]
    ds_read_b64_tr_b16 a[232:233], v131 offset:50880
    v_mfma_f32_16x16x32_bf16 a[156:159], a[204:207], v[108:111], a[156:159]
    ds_read_b64_tr_b16 a[234:235], v131 offset:54464
    v_mfma_f32_16x16x32_bf16 a[152:155], a[204:207], v[52:55], a[152:155]
    ds_read_b64_tr_b16 a[236:237], v131 offset:58048
    ds_read_b64_tr_b16 a[238:239], v131 offset:61632
    v_mfma_f32_16x16x32_bf16 a[152:155], a[200:203], v[48:51], a[152:155]
    s_waitcnt vmcnt(7) lgkmcnt(8)
    s_barrier
    v_mfma_f32_16x16x32_bf16 a[104:107], a[208:211], v[48:51], a[104:107]
    ds_read_b64_tr_b16 a[240:241], v128 offset:0
    ds_read_b64_tr_b16 a[242:243], v128 offset:3584
    v_mfma_f32_16x16x32_bf16 a[104:107], a[212:215], v[52:55], a[104:107]
    buffer_load_dwordx4 v2, s[20:23], s58 offen offset:0 lds
    s_add_u32 m0, s37, 67616
    v_mfma_f32_16x16x32_bf16 a[108:111], a[212:215], v[108:111], a[108:111]
    ds_read_b64_tr_b16 a[244:245], v128 offset:7168
    v_mfma_f32_16x16x32_bf16 a[108:111], a[208:211], v[104:107], a[108:111]
    ds_read_b64_tr_b16 a[246:247], v128 offset:10752
    v_mfma_f32_16x16x32_bf16 a[164:167], a[216:219], v[104:107], a[164:167]
    ds_read_b64_tr_b16 a[248:249], v128 offset:16896
    ds_read_b64_tr_b16 a[250:251], v128 offset:20480
    v_mfma_f32_16x16x32_bf16 a[164:167], a[220:223], v[108:111], a[164:167]
    buffer_load_dwordx4 v2, s[20:23], s58 offen offset:1024 lds
    s_add_u32 m0, s37, 67648
    v_mfma_f32_16x16x32_bf16 a[160:163], a[220:223], v[52:55], a[160:163]
    ds_read_b64_tr_b16 a[252:253], v128 offset:24064
    v_mfma_f32_16x16x32_bf16 a[160:163], a[216:219], v[48:51], a[160:163]
    s_waitcnt lgkmcnt(7)
    ds_read_b64_tr_b16 a[254:255], v128 offset:27648
    v_mfma_f32_16x16x32_bf16 a[112:115], a[224:227], v[48:51], a[112:115]
    ds_read_b64_tr_b16 a[192:193], v128 offset:32
    ds_read_b64_tr_b16 a[194:195], v128 offset:3616
    v_mfma_f32_16x16x32_bf16 a[112:115], a[228:231], v[52:55], a[112:115]
    buffer_load_dwordx4 v2, s[20:23], s58 offen offset:2048 lds
    s_add_u32 m0, s37, 67680
    v_mfma_f32_16x16x32_bf16 a[116:119], a[228:231], v[108:111], a[116:119]
    ds_read_b64_tr_b16 a[196:197], v128 offset:7200
    v_mfma_f32_16x16x32_bf16 a[116:119], a[224:227], v[104:107], a[116:119]
    ds_read_b64_tr_b16 a[198:199], v128 offset:10784
    v_mfma_f32_16x16x32_bf16 a[172:175], a[232:235], v[104:107], a[172:175]
    ds_read_b64_tr_b16 a[200:201], v128 offset:16928
    ds_read_b64_tr_b16 a[202:203], v128 offset:20512
    v_mfma_f32_16x16x32_bf16 a[172:175], a[236:239], v[108:111], a[172:175]
    buffer_load_dwordx4 v2, s[20:23], s58 offen offset:3072 lds
    s_add_u32 m0, s37, 84480
    v_mfma_f32_16x16x32_bf16 a[168:171], a[236:239], v[52:55], a[168:171]
    s_mov_b32 s58, 16384
    ds_read_b64_tr_b16 a[204:205], v128 offset:24096
    v_mfma_f32_16x16x32_bf16 a[168:171], a[232:235], v[48:51], a[168:171]
    s_waitcnt lgkmcnt(7)
    ds_read_b64_tr_b16 a[206:207], v128 offset:27680
    v_mfma_f32_16x16x32_bf16 a[64:67], a[240:243], v[56:59], a[64:67]
    ds_read_b64_tr_b16 a[208:209], v128 offset:64
    ds_read_b64_tr_b16 a[210:211], v128 offset:3648
    v_mfma_f32_16x16x32_bf16 a[64:67], a[244:247], v[60:63], a[64:67]
    buffer_load_dwordx4 v2, s[20:23], s58 offen offset:0 lds
    s_add_u32 m0, s37, 84512
    v_mfma_f32_16x16x32_bf16 a[68:71], a[244:247], v[116:119], a[68:71]
    ds_read_b64_tr_b16 a[212:213], v128 offset:7232
    v_mfma_f32_16x16x32_bf16 a[68:71], a[240:243], v[112:115], a[68:71]
    ds_read_b64_tr_b16 a[214:215], v128 offset:10816
    v_mfma_f32_16x16x32_bf16 a[124:127], a[248:251], v[112:115], a[124:127]
    ds_read_b64_tr_b16 a[216:217], v128 offset:16960
    ds_read_b64_tr_b16 a[218:219], v128 offset:20544
    v_mfma_f32_16x16x32_bf16 a[124:127], a[252:255], v[116:119], a[124:127]
    buffer_load_dwordx4 v2, s[20:23], s58 offen offset:1024 lds
    s_add_u32 m0, s37, 84544
    v_mfma_f32_16x16x32_bf16 a[120:123], a[252:255], v[60:63], a[120:123]
    ds_read_b64_tr_b16 a[220:221], v128 offset:24128
    v_mfma_f32_16x16x32_bf16 a[120:123], a[248:251], v[56:59], a[120:123]
    s_waitcnt lgkmcnt(7)
    ds_read_b64_tr_b16 a[222:223], v128 offset:27712
    v_mfma_f32_16x16x32_bf16 a[72:75], a[192:195], v[56:59], a[72:75]
    ds_read_b64_tr_b16 a[224:225], v128 offset:96
    ds_read_b64_tr_b16 a[226:227], v128 offset:3680
    v_mfma_f32_16x16x32_bf16 a[72:75], a[196:199], v[60:63], a[72:75]
    buffer_load_dwordx4 v2, s[20:23], s58 offen offset:2048 lds
    s_add_u32 m0, s37, 84576
    v_mfma_f32_16x16x32_bf16 a[76:79], a[196:199], v[116:119], a[76:79]
    ds_read_b64_tr_b16 a[228:229], v128 offset:7264
    v_mfma_f32_16x16x32_bf16 a[76:79], a[192:195], v[112:115], a[76:79]
    ds_read_b64_tr_b16 a[230:231], v128 offset:10848
    v_mfma_f32_16x16x32_bf16 a[132:135], a[200:203], v[112:115], a[132:135]
    ds_read_b64_tr_b16 a[232:233], v128 offset:16992
    ds_read_b64_tr_b16 a[234:235], v128 offset:20576
    v_mfma_f32_16x16x32_bf16 a[132:135], a[204:207], v[116:119], a[132:135]
    buffer_load_dwordx4 v2, s[20:23], s58 offen offset:3072 lds
    s_add_u32 m0, s37, 101376
    v_mfma_f32_16x16x32_bf16 a[128:131], a[204:207], v[60:63], a[128:131]
    s_mov_b32 s58, 32768
    ds_read_b64_tr_b16 a[236:237], v128 offset:24160
    v_mfma_f32_16x16x32_bf16 a[128:131], a[200:203], v[56:59], a[128:131]
    s_waitcnt lgkmcnt(7)
    ds_read_b64_tr_b16 a[238:239], v128 offset:27744
    v_mfma_f32_16x16x32_bf16 a[80:83], a[208:211], v[56:59], a[80:83]
    ds_read_b64_tr_b16 a[240:241], v128 offset:128
    v_mfma_f32_16x16x32_bf16 a[80:83], a[212:215], v[60:63], a[80:83]
    ds_read_b64_tr_b16 a[242:243], v128 offset:3712
    v_mfma_f32_16x16x32_bf16 a[84:87], a[212:215], v[116:119], a[84:87]
    ds_read_b64_tr_b16 a[244:245], v128 offset:7296
    v_mfma_f32_16x16x32_bf16 a[84:87], a[208:211], v[112:115], a[84:87]
    ds_read_b64_tr_b16 a[246:247], v128 offset:10880
    v_mfma_f32_16x16x32_bf16 a[140:143], a[216:219], v[112:115], a[140:143]
    ds_read_b64_tr_b16 a[248:249], v128 offset:17024
    v_mfma_f32_16x16x32_bf16 a[140:143], a[220:223], v[116:119], a[140:143]
    ds_read_b64_tr_b16 a[250:251], v128 offset:20608
    v_mfma_f32_16x16x32_bf16 a[136:139], a[220:223], v[60:63], a[136:139]
    ds_read_b64_tr_b16 a[252:253], v128 offset:24192
    v_mfma_f32_16x16x32_bf16 a[136:139], a[216:219], v[56:59], a[136:139]
    s_waitcnt lgkmcnt(7)
    ds_read_b64_tr_b16 a[254:255], v128 offset:27776
    v_mfma_f32_16x16x32_bf16 a[88:91], a[224:227], v[56:59], a[88:91]
    ds_read_b64_tr_b16 a[192:193], v128 offset:160
    v_mfma_f32_16x16x32_bf16 a[88:91], a[228:231], v[60:63], a[88:91]
    ds_read_b64_tr_b16 a[194:195], v128 offset:3744
    v_mfma_f32_16x16x32_bf16 a[92:95], a[228:231], v[116:119], a[92:95]
    ds_read_b64_tr_b16 a[196:197], v128 offset:7328
    v_mfma_f32_16x16x32_bf16 a[92:95], a[224:227], v[112:115], a[92:95]
    ds_read_b64_tr_b16 a[198:199], v128 offset:10912
    v_mfma_f32_16x16x32_bf16 a[148:151], a[232:235], v[112:115], a[148:151]
    ds_read_b64_tr_b16 a[200:201], v128 offset:17056
    v_mfma_f32_16x16x32_bf16 a[148:151], a[236:239], v[116:119], a[148:151]
    ds_read_b64_tr_b16 a[202:203], v128 offset:20640
    v_mfma_f32_16x16x32_bf16 a[144:147], a[236:239], v[60:63], a[144:147]
    ds_read_b64_tr_b16 a[204:205], v128 offset:24224
    v_mfma_f32_16x16x32_bf16 a[144:147], a[232:235], v[56:59], a[144:147]
    s_waitcnt lgkmcnt(7)
    ds_read_b64_tr_b16 a[206:207], v128 offset:27808
    v_mfma_f32_16x16x32_bf16 a[96:99], a[240:243], v[56:59], a[96:99]
    ds_read_b64_tr_b16 a[208:209], v130 offset:192
    v_mfma_f32_16x16x32_bf16 a[96:99], a[244:247], v[60:63], a[96:99]
    ds_read_b64_tr_b16 a[210:211], v130 offset:3776
    v_mfma_f32_16x16x32_bf16 a[100:103], a[244:247], v[116:119], a[100:103]
    ds_read_b64_tr_b16 a[212:213], v130 offset:7360
    v_mfma_f32_16x16x32_bf16 a[100:103], a[240:243], v[112:115], a[100:103]
    ds_read_b64_tr_b16 a[214:215], v130 offset:10944
    v_mfma_f32_16x16x32_bf16 a[156:159], a[248:251], v[112:115], a[156:159]
    ds_read_b64_tr_b16 a[216:217], v130 offset:17088
    v_mfma_f32_16x16x32_bf16 a[156:159], a[252:255], v[116:119], a[156:159]
    ds_read_b64_tr_b16 a[218:219], v130 offset:20672
    v_mfma_f32_16x16x32_bf16 a[152:155], a[252:255], v[60:63], a[152:155]
    ds_read_b64_tr_b16 a[220:221], v130 offset:24256
    ds_read_b64_tr_b16 a[222:223], v130 offset:27840
    v_mfma_f32_16x16x32_bf16 a[152:155], a[248:251], v[56:59], a[152:155]
    s_waitcnt vmcnt(8) lgkmcnt(8)
    s_barrier
    v_mfma_f32_16x16x32_bf16 a[104:107], a[192:195], v[56:59], a[104:107]
    ds_read_b64_tr_b16 a[224:225], v128 offset:33792
    ds_read_b64_tr_b16 a[226:227], v128 offset:37376
    v_mfma_f32_16x16x32_bf16 a[104:107], a[196:199], v[60:63], a[104:107]
    buffer_load_dwordx4 v2, s[20:23], s58 offen offset:0 lds
    s_add_u32 m0, s37, 101408
    v_mfma_f32_16x16x32_bf16 a[108:111], a[196:199], v[116:119], a[108:111]
    ds_read_b64_tr_b16 a[228:229], v128 offset:40960
    v_mfma_f32_16x16x32_bf16 a[108:111], a[192:195], v[112:115], a[108:111]
    ds_read_b64_tr_b16 a[230:231], v128 offset:44544
    v_mfma_f32_16x16x32_bf16 a[164:167], a[200:203], v[112:115], a[164:167]
    ds_read_b64_tr_b16 a[232:233], v128 offset:50688
    ds_read_b64_tr_b16 a[234:235], v128 offset:54272
    v_mfma_f32_16x16x32_bf16 a[164:167], a[204:207], v[116:119], a[164:167]
    buffer_load_dwordx4 v2, s[20:23], s58 offen offset:1024 lds
    s_add_u32 m0, s37, 101440
    v_mfma_f32_16x16x32_bf16 a[160:163], a[204:207], v[60:63], a[160:163]
    ds_read_b64_tr_b16 a[236:237], v128 offset:57856
    v_mfma_f32_16x16x32_bf16 a[160:163], a[200:203], v[56:59], a[160:163]
    s_waitcnt lgkmcnt(7)
    ds_read_b64_tr_b16 a[238:239], v128 offset:61440
    v_mfma_f32_16x16x32_bf16 a[112:115], a[208:211], v[56:59], a[112:115]
    ds_read_b64_tr_b16 a[240:241], v128 offset:33824
    ds_read_b64_tr_b16 a[242:243], v128 offset:37408
    v_mfma_f32_16x16x32_bf16 a[112:115], a[212:215], v[60:63], a[112:115]
    buffer_load_dwordx4 v2, s[20:23], s58 offen offset:2048 lds
    s_add_u32 m0, s37, 101472
    v_mfma_f32_16x16x32_bf16 a[116:119], a[212:215], v[116:119], a[116:119]
    ds_read_b64_tr_b16 a[244:245], v128 offset:40992
    v_mfma_f32_16x16x32_bf16 a[116:119], a[208:211], v[112:115], a[116:119]
    ds_read_b64_tr_b16 a[246:247], v128 offset:44576
    v_mfma_f32_16x16x32_bf16 a[172:175], a[216:219], v[112:115], a[172:175]
    ds_read_b64_tr_b16 a[248:249], v128 offset:50720
    ds_read_b64_tr_b16 a[250:251], v128 offset:54304
    v_mfma_f32_16x16x32_bf16 a[172:175], a[220:223], v[116:119], a[172:175]
    buffer_load_dwordx4 v2, s[20:23], s58 offen offset:3072 lds
    s_add_u32 m0, s37, 118272
    v_mfma_f32_16x16x32_bf16 a[168:171], a[220:223], v[60:63], a[168:171]
    s_mov_b32 s58, 49152
    ds_read_b64_tr_b16 a[252:253], v128 offset:57888
    v_mfma_f32_16x16x32_bf16 a[168:171], a[216:219], v[56:59], a[168:171]
    s_waitcnt lgkmcnt(7)
    ds_read_b64_tr_b16 a[254:255], v128 offset:61472
    v_mfma_f32_16x16x32_bf16 a[64:67], a[224:227], v[64:67], a[64:67]
    ds_read_b64_tr_b16 a[192:193], v128 offset:33856
    ds_read_b64_tr_b16 a[194:195], v128 offset:37440
    v_mfma_f32_16x16x32_bf16 a[64:67], a[228:231], v[68:71], a[64:67]
    buffer_load_dwordx4 v2, s[20:23], s58 offen offset:0 lds
    s_add_u32 m0, s37, 118304
    v_mfma_f32_16x16x32_bf16 a[68:71], a[228:231], v[124:127], a[68:71]
    ds_read_b64_tr_b16 a[196:197], v128 offset:41024
    v_mfma_f32_16x16x32_bf16 a[68:71], a[224:227], v[120:123], a[68:71]
    ds_read_b64_tr_b16 a[198:199], v128 offset:44608
    v_mfma_f32_16x16x32_bf16 a[124:127], a[232:235], v[120:123], a[124:127]
    ds_read_b64_tr_b16 a[200:201], v128 offset:50752
    ds_read_b64_tr_b16 a[202:203], v128 offset:54336
    v_mfma_f32_16x16x32_bf16 a[124:127], a[236:239], v[124:127], a[124:127]
    buffer_load_dwordx4 v2, s[20:23], s58 offen offset:1024 lds
    s_add_u32 m0, s37, 118336
    v_mfma_f32_16x16x32_bf16 a[120:123], a[236:239], v[68:71], a[120:123]
    ds_read_b64_tr_b16 a[204:205], v128 offset:57920
    v_mfma_f32_16x16x32_bf16 a[120:123], a[232:235], v[64:67], a[120:123]
    s_waitcnt lgkmcnt(7)
    ds_read_b64_tr_b16 a[206:207], v128 offset:61504
    v_mfma_f32_16x16x32_bf16 a[72:75], a[240:243], v[64:67], a[72:75]
    ds_read_b64_tr_b16 a[208:209], v128 offset:33888
    ds_read_b64_tr_b16 a[210:211], v128 offset:37472
    v_mfma_f32_16x16x32_bf16 a[72:75], a[244:247], v[68:71], a[72:75]
    buffer_load_dwordx4 v2, s[20:23], s58 offen offset:2048 lds
    s_add_u32 m0, s37, 118368
    v_mfma_f32_16x16x32_bf16 a[76:79], a[244:247], v[124:127], a[76:79]
    ds_read_b64_tr_b16 a[212:213], v128 offset:41056
    v_mfma_f32_16x16x32_bf16 a[76:79], a[240:243], v[120:123], a[76:79]
    ds_read_b64_tr_b16 a[214:215], v128 offset:44640
    v_mfma_f32_16x16x32_bf16 a[132:135], a[248:251], v[120:123], a[132:135]
    ds_read_b64_tr_b16 a[216:217], v128 offset:50784
    ds_read_b64_tr_b16 a[218:219], v128 offset:54368
    v_mfma_f32_16x16x32_bf16 a[132:135], a[252:255], v[124:127], a[132:135]
    buffer_load_dwordx4 v2, s[20:23], s58 offen offset:3072 lds
    s_add_u32 m0, s37, 0
    v_mfma_f32_16x16x32_bf16 a[128:131], a[252:255], v[68:71], a[128:131]
    s_mov_b32 s58, 0
    ds_read_b64_tr_b16 a[220:221], v128 offset:57952
    v_mfma_f32_16x16x32_bf16 a[128:131], a[248:251], v[64:67], a[128:131]
    s_waitcnt lgkmcnt(7)
    ds_read_b64_tr_b16 a[222:223], v128 offset:61536
    v_mfma_f32_16x16x32_bf16 a[80:83], a[192:195], v[64:67], a[80:83]
    ds_read_b64_tr_b16 a[224:225], v128 offset:33920
    v_mfma_f32_16x16x32_bf16 a[80:83], a[196:199], v[68:71], a[80:83]
    ds_read_b64_tr_b16 a[226:227], v128 offset:37504
    v_mfma_f32_16x16x32_bf16 a[84:87], a[196:199], v[124:127], a[84:87]
    ds_read_b64_tr_b16 a[228:229], v128 offset:41088
    v_mfma_f32_16x16x32_bf16 a[84:87], a[192:195], v[120:123], a[84:87]
    ds_read_b64_tr_b16 a[230:231], v128 offset:44672
    v_mfma_f32_16x16x32_bf16 a[140:143], a[200:203], v[120:123], a[140:143]
    ds_read_b64_tr_b16 a[232:233], v128 offset:50816
    v_mfma_f32_16x16x32_bf16 a[140:143], a[204:207], v[124:127], a[140:143]
    ds_read_b64_tr_b16 a[234:235], v128 offset:54400
    v_mfma_f32_16x16x32_bf16 a[136:139], a[204:207], v[68:71], a[136:139]
    ds_read_b64_tr_b16 a[236:237], v128 offset:57984
    v_mfma_f32_16x16x32_bf16 a[136:139], a[200:203], v[64:67], a[136:139]
    s_waitcnt lgkmcnt(7)
    ds_read_b64_tr_b16 a[238:239], v128 offset:61568
    v_mfma_f32_16x16x32_bf16 a[88:91], a[208:211], v[64:67], a[88:91]
    ds_read_b64_tr_b16 a[240:241], v128 offset:33952
    v_mfma_f32_16x16x32_bf16 a[88:91], a[212:215], v[68:71], a[88:91]
    ds_read_b64_tr_b16 a[242:243], v128 offset:37536
    v_mfma_f32_16x16x32_bf16 a[92:95], a[212:215], v[124:127], a[92:95]
    ds_read_b64_tr_b16 a[244:245], v128 offset:41120
    v_mfma_f32_16x16x32_bf16 a[92:95], a[208:211], v[120:123], a[92:95]
    ds_read_b64_tr_b16 a[246:247], v128 offset:44704
    v_mfma_f32_16x16x32_bf16 a[148:151], a[216:219], v[120:123], a[148:151]
    ds_read_b64_tr_b16 a[248:249], v128 offset:50848
    v_mfma_f32_16x16x32_bf16 a[148:151], a[220:223], v[124:127], a[148:151]
    ds_read_b64_tr_b16 a[250:251], v128 offset:54432
    v_mfma_f32_16x16x32_bf16 a[144:147], a[220:223], v[68:71], a[144:147]
    ds_read_b64_tr_b16 a[252:253], v128 offset:58016
    v_mfma_f32_16x16x32_bf16 a[144:147], a[216:219], v[64:67], a[144:147]
    s_waitcnt lgkmcnt(7)
    ds_read_b64_tr_b16 a[254:255], v128 offset:61600
    v_mfma_f32_16x16x32_bf16 a[96:99], a[224:227], v[64:67], a[96:99]
    ds_read_b64_tr_b16 a[192:193], v130 offset:33984
    v_mfma_f32_16x16x32_bf16 a[96:99], a[228:231], v[68:71], a[96:99]
    ds_read_b64_tr_b16 a[194:195], v130 offset:37568
    v_mfma_f32_16x16x32_bf16 a[100:103], a[228:231], v[124:127], a[100:103]
    ds_read_b64_tr_b16 a[196:197], v130 offset:41152
    v_mfma_f32_16x16x32_bf16 a[100:103], a[224:227], v[120:123], a[100:103]
    ds_read_b64_tr_b16 a[198:199], v130 offset:44736
    v_mfma_f32_16x16x32_bf16 a[156:159], a[232:235], v[120:123], a[156:159]
    ds_read_b64_tr_b16 a[200:201], v130 offset:50880
    v_mfma_f32_16x16x32_bf16 a[156:159], a[236:239], v[124:127], a[156:159]
    ds_read_b64_tr_b16 a[202:203], v130 offset:54464
    v_mfma_f32_16x16x32_bf16 a[152:155], a[236:239], v[68:71], a[152:155]
    ds_read_b64_tr_b16 a[204:205], v130 offset:58048
    ds_read_b64_tr_b16 a[206:207], v130 offset:61632
    v_mfma_f32_16x16x32_bf16 a[152:155], a[232:235], v[64:67], a[152:155]
    s_waitcnt vmcnt(12) lgkmcnt(8)
    s_barrier
    v_mfma_f32_16x16x32_bf16 a[104:107], a[240:243], v[64:67], a[104:107]
    ds_read_b128 a[208:211], v1 offset:0
    v_mfma_f32_16x16x32_bf16 a[104:107], a[244:247], v[68:71], a[104:107]
    buffer_load_dwordx4 v2, s[24:27], s58 offen offset:0 lds
    s_add_u32 m0, s37, 32
    v_mfma_f32_16x16x32_bf16 a[108:111], a[244:247], v[124:127], a[108:111]
    ds_read_b128 a[212:215], v1 offset:64
    v_mfma_f32_16x16x32_bf16 a[108:111], a[240:243], v[120:123], a[108:111]
    v_mfma_f32_16x16x32_bf16 a[164:167], a[248:251], v[120:123], a[164:167]
    ds_read_b128 a[216:219], v1 offset:128
    v_mfma_f32_16x16x32_bf16 a[164:167], a[252:255], v[124:127], a[164:167]
    buffer_load_dwordx4 v2, s[24:27], s58 offen offset:1024 lds
    s_add_u32 m0, s37, 64
    v_mfma_f32_16x16x32_bf16 a[160:163], a[252:255], v[68:71], a[160:163]
    ds_read_b128 a[220:223], v1 offset:192
    v_mfma_f32_16x16x32_bf16 a[160:163], a[248:251], v[64:67], a[160:163]
    s_waitcnt lgkmcnt(4)
    v_mfma_f32_16x16x32_bf16 a[112:115], a[192:195], v[64:67], a[112:115]
    ds_read_b128 a[224:227], v1 offset:256
    v_mfma_f32_16x16x32_bf16 a[112:115], a[196:199], v[68:71], a[112:115]
    buffer_load_dwordx4 v2, s[24:27], s58 offen offset:2048 lds
    s_add_u32 m0, s37, 96
    v_mfma_f32_16x16x32_bf16 a[116:119], a[196:199], v[124:127], a[116:119]
    ds_read_b128 a[228:231], v1 offset:320
    v_mfma_f32_16x16x32_bf16 a[116:119], a[192:195], v[120:123], a[116:119]
    v_mfma_f32_16x16x32_bf16 a[172:175], a[200:203], v[120:123], a[172:175]
    ds_read_b128 a[232:235], v1 offset:384
    v_mfma_f32_16x16x32_bf16 a[172:175], a[204:207], v[124:127], a[172:175]
    buffer_load_dwordx4 v2, s[24:27], s58 offen offset:3072 lds
    s_add_u32 m0, s37, 16896
    v_mfma_f32_16x16x32_bf16 a[168:171], a[204:207], v[68:71], a[168:171]
    s_mov_b32 s58, 16384
    ds_read_b128 a[236:239], v1 offset:448
    v_mfma_f32_16x16x32_bf16 a[168:171], a[200:203], v[64:67], a[168:171]
    s_waitcnt lgkmcnt(4)
    v_mfma_f32_16x16x32_bf16 v[80:83], a[208:211], a[0:3], 0
    ds_read_b128 a[240:243], v1 offset:512
    v_add_u32 v114, 16384, v2
    v_mfma_f32_16x16x32_bf16 v[80:83], a[212:215], a[4:7], v[80:83]
    buffer_load_dwordx4 v2, s[24:27], s58 offen offset:0 lds
    s_add_u32 m0, s37, 16928
    v_add_u32 v112, 16352, v2
    v_mfma_f32_16x16x32_bf16 v[84:87], a[212:215], a[36:39], 0
    ds_read_b128 a[244:247], v1 offset:576
    v_add_u32 v121, 16320, v2
    v_mfma_f32_16x16x32_bf16 v[84:87], a[208:211], a[32:35], v[84:87]
    s_add_u32 s8, s38, 0
    s_add_u32 s9, s38, 57344
    v_add_u32 v122, 16288, v2
    v_mfma_f32_16x16x32_bf16 v[84:87], a[216:219], a[40:43], v[84:87]
    s_add_u32 s11, s38, 114688
    ds_read_b128 a[248:251], v1 offset:640
    v_mfma_f32_16x16x32_bf16 v[84:87], a[220:223], a[44:47], v[84:87]
    buffer_load_dwordx4 v2, s[24:27], s58 offen offset:1024 lds
    s_add_u32 m0, s37, 16960
    v_accvgpr_read_b32 v7, a64
    v_mfma_f32_16x16x32_bf16 v[80:83], a[220:223], a[12:15], v[80:83]
    ds_read_b128 a[252:255], v1 offset:704
    v_accvgpr_read_b32 v9, a120
    v_mfma_f32_16x16x32_bf16 v[80:83], a[216:219], a[8:11], v[80:83]
    s_waitcnt lgkmcnt(4)
    s_add_u32 s54, s38, 172032
    v_mul_f32 v7, v7, v3
    v_mfma_f32_16x16x32_bf16 v[80:83], a[224:227], a[16:19], v[80:83]
    ds_read_b128 a[192:195], v1 offset:768
    v_accvgpr_read_b32 v8, a65
    v_mfma_f32_16x16x32_bf16 v[80:83], a[228:231], a[20:23], v[80:83]
    buffer_load_dwordx4 v2, s[24:27], s58 offen offset:2048 lds
    s_add_u32 m0, s37, 16992
    v_mul_f32 v7, v7, v9
    v_mfma_f32_16x16x32_bf16 v[84:87], a[228:231], a[52:55], v[84:87]
    ds_read_b128 a[196:199], v1 offset:832
    v_accvgpr_read_b32 v9, a121
    v_mfma_f32_16x16x32_bf16 v[84:87], a[224:227], a[48:51], v[84:87]
    v_mul_f32 v8, v8, v3
    v_mfma_f32_16x16x32_bf16 v[84:87], a[232:235], a[56:59], v[84:87]
    ds_read_b128 a[200:203], v1 offset:896
    v_mul_f32 v8, v8, v9
    v_mfma_f32_16x16x32_bf16 v[84:87], a[236:239], a[60:63], v[84:87]
    buffer_load_dwordx4 v2, s[24:27], s58 offen offset:3072 lds
    s_add_u32 m0, s37, 67584
    v_cvt_pk_bf16_f32 v40, v7, v8
    v_mfma_f32_16x16x32_bf16 v[80:83], a[236:239], a[28:31], v[80:83]
    ds_read_b128 a[204:207], v1 offset:960
    v_accvgpr_read_b32 v10, a66
    v_mfma_f32_16x16x32_bf16 v[80:83], a[232:235], a[24:27], v[80:83]
    s_waitcnt vmcnt(16) lgkmcnt(4)
    s_barrier
    v_accvgpr_read_b32 v12, a122
    v_mul_f32 v10, v10, v3
    v_accvgpr_read_b32 v11, a67
    v_mfma_f32_16x16x32_bf16 v[88:91], a[240:243], a[0:3], 0
    ds_read_b128 a[208:211], v1 offset:16896
    v_mul_f32 v10, v10, v12
    v_mfma_f32_16x16x32_bf16 v[88:91], a[244:247], a[4:7], v[88:91]
    v_accvgpr_read_b32 v12, a123
    v_mul_f32 v11, v11, v3
    v_mul_f32 v11, v11, v12
    v_cvt_pk_bf16_f32 v41, v10, v11
    v_mfma_f32_16x16x32_bf16 v[92:95], a[244:247], a[36:39], 0
    ds_read_b128 a[212:215], v1 offset:16960
    v_accvgpr_read_b32 v7, a72
    v_mfma_f32_16x16x32_bf16 v[92:95], a[240:243], a[32:35], v[92:95]
    v_accvgpr_read_b32 v9, a128
    v_mfma_f32_16x16x32_bf16 v[92:95], a[248:251], a[40:43], v[92:95]
    ds_read_b128 a[216:219], v1 offset:17024
    v_mul_f32 v7, v7, v3
    v_mfma_f32_16x16x32_bf16 v[92:95], a[252:255], a[44:47], v[92:95]
    v_accvgpr_read_b32 v8, a73
    v_mul_f32 v7, v7, v9
    v_accvgpr_read_b32 v9, a129
    v_mul_f32 v8, v8, v3
    v_mfma_f32_16x16x32_bf16 v[88:91], a[252:255], a[12:15], v[88:91]
    ds_read_b128 a[220:223], v1 offset:17088
    v_mul_f32 v8, v8, v9
    v_mfma_f32_16x16x32_bf16 v[88:91], a[248:251], a[8:11], v[88:91]
    s_waitcnt lgkmcnt(4)
    v_cvt_pk_bf16_f32 v42, v7, v8
    v_mfma_f32_16x16x32_bf16 v[88:91], a[192:195], a[16:19], v[88:91]
    ds_read_b128 a[224:227], v1 offset:17152
    v_accvgpr_read_b32 v10, a74
    v_mfma_f32_16x16x32_bf16 v[88:91], a[196:199], a[20:23], v[88:91]
    v_accvgpr_read_b32 v12, a130
    v_mul_f32 v10, v10, v3
    v_accvgpr_read_b32 v11, a75
    v_mul_f32 v10, v10, v12
    v_mfma_f32_16x16x32_bf16 v[92:95], a[196:199], a[52:55], v[92:95]
    ds_read_b128 a[228:231], v1 offset:17216
    v_accvgpr_read_b32 v12, a131
    v_mfma_f32_16x16x32_bf16 v[92:95], a[192:195], a[48:51], v[92:95]
    v_mul_f32 v11, v11, v3
    v_mfma_f32_16x16x32_bf16 v[92:95], a[200:203], a[56:59], v[92:95]
    ds_read_b128 a[232:235], v1 offset:17280
    v_mul_f32 v11, v11, v12
    v_mfma_f32_16x16x32_bf16 v[92:95], a[204:207], a[60:63], v[92:95]
    v_cvt_pk_bf16_f32 v43, v10, v11
    v_mfma_f32_16x16x32_bf16 v[88:91], a[204:207], a[28:31], v[88:91]
    ds_read_b128 a[236:239], v1 offset:17344
    buffer_store_dwordx4 v[40:43], v6, s[32:35], s12 offen offset:0 sc1
    v_mfma_f32_16x16x32_bf16 v[88:91], a[200:203], a[24:27], v[88:91]
    s_waitcnt lgkmcnt(4)
    s_nop 4
    s_mov_b32 s38, 16384
    s_mov_b32 s49, 49152
    s_mov_b32 s57, 32768
    s_mov_b32 s56, 65536
    v_max_f32 v104, v80, v81
    v_max_f32 v105, v84, v85
    v_max3_f32 v104, v104, v82, v83
    v_max3_f32 v105, v105, v86, v87
    v_max3_f32 v104, v104, v88, v89
    v_max3_f32 v105, v105, v92, v93
    v_max3_f32 v104, v104, v90, v91
    v_max3_f32 v105, v105, v94, v95
    v_mov_b32 v106, v104
    v_mov_b32 v107, v105
    s_nop 0
    v_permlane32_swap_b32 v104, v106
    v_permlane32_swap_b32 v105, v107
    v_max_f32 v104, v104, v106
    v_max_f32 v105, v105, v107
    v_mov_b32 v106, v104
    v_mov_b32 v107, v105
    s_nop 0
    v_permlane16_swap_b32 v104, v106
    v_permlane16_swap_b32 v105, v107
    v_max_f32 v104, v104, v106
    v_max_f32 v105, v105, v107
    v_sub_f32 v96, 0, v104
    v_sub_f32 v80, v80, v104
    v_sub_f32 v97, 0, v104
    v_sub_f32 v81, v81, v104
    v_sub_f32 v98, 0, v104
    v_sub_f32 v82, v82, v104
    v_sub_f32 v99, 0, v104
    v_sub_f32 v83, v83, v104
    v_sub_f32 v100, 0, v105
    v_sub_f32 v84, v84, v105
    v_sub_f32 v101, 0, v105
    v_sub_f32 v85, v85, v105
    v_sub_f32 v102, 0, v105
    v_sub_f32 v86, v86, v105
    v_sub_f32 v103, 0, v105
    v_sub_f32 v87, v87, v105
    v_sub_f32 v88, v88, v104
    v_sub_f32 v89, v89, v104
    v_sub_f32 v90, v90, v104
    v_sub_f32 v91, v91, v104
    v_sub_f32 v92, v92, v105
    v_sub_f32 v93, v93, v105
    v_sub_f32 v94, v94, v105
    v_sub_f32 v95, v95, v105
    v_exp_f32 v64, v80
    v_exp_f32 v65, v81
    v_exp_f32 v66, v82
    v_exp_f32 v67, v83
    v_exp_f32 v68, v84
    v_exp_f32 v69, v85
    v_exp_f32 v70, v86
    v_exp_f32 v71, v87
    v_mfma_f32_16x16x32_bf16 v[48:51], a[208:211], a[0:3], v[96:99]
    ds_read_b128 a[240:243], v1 offset:17408
    v_add_f32 v118, v64, v65
    v_mfma_f32_16x16x32_bf16 v[48:51], a[212:215], a[4:7], v[48:51]
    v_cvt_pk_bf16_f32 v16, v64, v65
    v_add_f32 v118, v118, v66
    v_add_f32 v118, v118, v67
    v_cvt_pk_bf16_f32 v17, v66, v67
    v_add_f32 v119, v68, v69
    v_mfma_f32_16x16x32_bf16 v[52:55], a[212:215], a[36:39], v[100:103]
    ds_read_b128 a[244:247], v1 offset:17472
    v_cvt_pk_bf16_f32 v20, v68, v69
    v_mfma_f32_16x16x32_bf16 v[52:55], a[208:211], a[32:35], v[52:55]
    v_add_f32 v119, v119, v70
    v_mfma_f32_16x16x32_bf16 v[52:55], a[216:219], a[40:43], v[52:55]
    ds_read_b128 a[248:251], v1 offset:17536
    v_accvgpr_read_b32 v7, a68
    v_mfma_f32_16x16x32_bf16 v[52:55], a[220:223], a[44:47], v[52:55]
    v_exp_f32 v72, v88
    v_accvgpr_read_b32 v9, a124
    v_mul_f32 v7, v7, v4
    v_mfma_f32_16x16x32_bf16 v[48:51], a[220:223], a[12:15], v[48:51]
    ds_read_b128 a[252:255], v1 offset:17600
    v_add_f32 v119, v119, v71
    v_mfma_f32_16x16x32_bf16 v[48:51], a[216:219], a[8:11], v[48:51]
    s_waitcnt lgkmcnt(4)
    v_cvt_pk_bf16_f32 v21, v70, v71
    v_mfma_f32_16x16x32_bf16 v[48:51], a[224:227], a[16:19], v[48:51]
    ds_read_b128 a[192:195], v1 offset:17664
    v_accvgpr_read_b32 v8, a69
    v_mfma_f32_16x16x32_bf16 v[48:51], a[228:231], a[20:23], v[48:51]
    v_exp_f32 v73, v89
    v_mul_f32 v7, v7, v9
    v_accvgpr_read_b32 v9, a125
    v_mfma_f32_16x16x32_bf16 v[52:55], a[228:231], a[52:55], v[52:55]
    ds_read_b128 a[196:199], v1 offset:17728
    v_add_f32 v118, v118, v72
    v_mfma_f32_16x16x32_bf16 v[52:55], a[224:227], a[48:51], v[52:55]
    v_exp_f32 v74, v90
    v_mfma_f32_16x16x32_bf16 v[52:55], a[232:235], a[56:59], v[52:55]
    ds_read_b128 a[200:203], v1 offset:17792
    v_add_f32 v118, v118, v73
    v_mfma_f32_16x16x32_bf16 v[52:55], a[236:239], a[60:63], v[52:55]
    v_cvt_pk_bf16_f32 v18, v72, v73
    v_exp_f32 v75, v91
    v_mul_f32 v8, v8, v4
    v_mfma_f32_16x16x32_bf16 v[48:51], a[236:239], a[28:31], v[48:51]
    ds_read_b128 a[204:207], v1 offset:17856
    v_add_f32 v118, v118, v74
    v_mfma_f32_16x16x32_bf16 v[48:51], a[232:235], a[24:27], v[48:51]
    s_waitcnt vmcnt(13) lgkmcnt(4)
    s_barrier
    v_exp_f32 v76, v92
    v_mul_f32 v8, v8, v9
    v_mfma_f32_16x16x32_bf16 v[56:59], a[240:243], a[0:3], v[96:99]
    ds_read_b128 a[208:211], v1 offset:33792
    v_add_f32 v118, v118, v75
    v_mfma_f32_16x16x32_bf16 v[56:59], a[244:247], a[4:7], v[56:59]
    v_cvt_pk_bf16_f32 v19, v74, v75
    v_exp_f32 v77, v93
    v_cvt_pk_bf16_f32 v44, v7, v8
    v_mfma_f32_16x16x32_bf16 v[60:63], a[244:247], a[36:39], v[100:103]
    ds_read_b128 a[212:215], v1 offset:33856
    v_add_f32 v119, v119, v76
    v_mfma_f32_16x16x32_bf16 v[60:63], a[240:243], a[32:35], v[60:63]
    v_exp_f32 v78, v94
    v_mfma_f32_16x16x32_bf16 v[60:63], a[248:251], a[40:43], v[60:63]
    ds_read_b128 a[216:219], v1 offset:33920
    v_add_f32 v119, v119, v77
    v_mfma_f32_16x16x32_bf16 v[60:63], a[252:255], a[44:47], v[60:63]
    v_cvt_pk_bf16_f32 v22, v76, v77
    v_exp_f32 v79, v95
    v_accvgpr_read_b32 v10, a70
    v_mfma_f32_16x16x32_bf16 v[56:59], a[252:255], a[12:15], v[56:59]
    ds_read_b128 a[220:223], v1 offset:33984
    v_add_f32 v119, v119, v78
    v_mfma_f32_16x16x32_bf16 v[56:59], a[248:251], a[8:11], v[56:59]
    s_waitcnt lgkmcnt(4)
    v_add_f32 v119, v119, v79
    v_mfma_f32_16x16x32_bf16 v[56:59], a[192:195], a[16:19], v[56:59]
    ds_read_b128 a[224:227], v1 offset:34048
    v_cvt_pk_bf16_f32 v23, v78, v79
    v_mfma_f32_16x16x32_bf16 v[56:59], a[196:199], a[20:23], v[56:59]
    v_mov_b32 v116, v118
    v_mov_b32 v117, v119
    v_exp_f32 v64, v48
    v_mfma_f32_16x16x32_bf16 v[60:63], a[196:199], a[52:55], v[60:63]
    ds_read_b128 a[228:231], v1 offset:34112
    v_accvgpr_read_b32 v12, a126
    v_mfma_f32_16x16x32_bf16 v[60:63], a[192:195], a[48:51], v[60:63]
    v_exp_f32 v65, v49
    v_mfma_f32_16x16x32_bf16 v[60:63], a[200:203], a[56:59], v[60:63]
    ds_read_b128 a[232:235], v1 offset:34176
    v_mul_f32 v10, v10, v4
    v_mfma_f32_16x16x32_bf16 v[60:63], a[204:207], a[60:63], v[60:63]
    v_exp_f32 v66, v50
    v_accvgpr_read_b32 v11, a71
    v_mul_f32 v10, v10, v12
    v_mfma_f32_16x16x32_bf16 v[56:59], a[204:207], a[28:31], v[56:59]
    ds_read_b128 a[236:239], v1 offset:34240
    v_add_f32 v118, v64, v65
    v_mfma_f32_16x16x32_bf16 v[56:59], a[200:203], a[24:27], v[56:59]
    s_waitcnt vmcnt(9) lgkmcnt(4)
    s_barrier
    v_cvt_pk_bf16_f32 v24, v64, v65
    v_exp_f32 v67, v51
    v_mfma_f32_16x16x32_bf16 v[80:83], a[208:211], a[0:3], v[96:99]
    ds_read_b128 a[240:243], v1 offset:34304
    v_add_f32 v118, v118, v66
    v_mfma_f32_16x16x32_bf16 v[80:83], a[212:215], a[4:7], v[80:83]
    buffer_load_dwordx4 v114, s[20:23], s49 offen offset:0 lds
    v_exp_f32 v68, v52
    v_mfma_f32_16x16x32_bf16 v[84:87], a[212:215], a[36:39], v[100:103]
    ds_read_b128 a[244:247], v1 offset:34368
    v_add_f32 v118, v118, v67
    v_mfma_f32_16x16x32_bf16 v[84:87], a[208:211], a[32:35], v[84:87]
    buffer_load_dwordx4 v112, s[20:23], s49 offen offset:1056 lds
    v_mfma_f32_16x16x32_bf16 v[84:87], a[216:219], a[40:43], v[84:87]
    ds_read_b128 a[248:251], v1 offset:34432
    v_cvt_pk_bf16_f32 v25, v66, v67
    v_mfma_f32_16x16x32_bf16 v[84:87], a[220:223], a[44:47], v[84:87]
    buffer_load_dwordx4 v121, s[20:23], s49 offen offset:2112 lds
    v_exp_f32 v69, v53
    v_mfma_f32_16x16x32_bf16 v[80:83], a[220:223], a[12:15], v[80:83]
    ds_read_b128 a[252:255], v1 offset:34496
    v_accvgpr_read_b32 v12, a127
    v_mfma_f32_16x16x32_bf16 v[80:83], a[216:219], a[8:11], v[80:83]
    s_waitcnt lgkmcnt(4)
    buffer_load_dwordx4 v122, s[20:23], s49 offen offset:3168 lds
    s_add_u32 m0, s37, 84480
    v_mfma_f32_16x16x32_bf16 v[80:83], a[224:227], a[16:19], v[80:83]
    s_add_u32 s49, s49, 16384
    ds_read_b128 a[192:195], v1 offset:34560
    v_mfma_f32_16x16x32_bf16 v[80:83], a[228:231], a[20:23], v[80:83]
    buffer_load_dwordx4 v114, s[20:23], s49 offen offset:0 lds
    v_exp_f32 v70, v54
    v_mfma_f32_16x16x32_bf16 v[84:87], a[228:231], a[52:55], v[84:87]
    ds_read_b128 a[196:199], v1 offset:34624
    v_add_f32 v119, v68, v69
    v_mfma_f32_16x16x32_bf16 v[84:87], a[224:227], a[48:51], v[84:87]
    buffer_load_dwordx4 v112, s[20:23], s49 offen offset:1056 lds
    v_mfma_f32_16x16x32_bf16 v[84:87], a[232:235], a[56:59], v[84:87]
    ds_read_b128 a[200:203], v1 offset:34688
    v_cvt_pk_bf16_f32 v28, v68, v69
    v_mfma_f32_16x16x32_bf16 v[84:87], a[236:239], a[60:63], v[84:87]
    buffer_load_dwordx4 v121, s[20:23], s49 offen offset:2112 lds
    v_exp_f32 v71, v55
    v_mfma_f32_16x16x32_bf16 v[80:83], a[236:239], a[28:31], v[80:83]
    ds_read_b128 a[204:207], v1 offset:34752
    v_add_f32 v119, v119, v70
    v_mfma_f32_16x16x32_bf16 v[80:83], a[232:235], a[24:27], v[80:83]
    s_waitcnt lgkmcnt(4)
    buffer_load_dwordx4 v122, s[20:23], s49 offen offset:3168 lds
    s_add_u32 m0, s37, 33792
    v_exp_f32 v72, v56
    v_mfma_f32_16x16x32_bf16 v[88:91], a[240:243], a[0:3], v[96:99]
    s_add_u32 s49, s49, 16384
    ds_read_b128 a[208:211], v1 offset:50688
    v_add_f32 v119, v119, v71
    v_cvt_pk_bf16_f32 v29, v70, v71
    v_exp_f32 v73, v57
    v_add_f32 v118, v118, v72
    v_exp_f32 v74, v58
    v_add_f32 v118, v118, v73
    v_cvt_pk_bf16_f32 v26, v72, v73
    v_exp_f32 v75, v59
    v_add_f32 v118, v118, v74
    v_exp_f32 v76, v60
    v_add_f32 v118, v118, v75
    v_cvt_pk_bf16_f32 v27, v74, v75
    v_exp_f32 v77, v61
    v_add_f32 v119, v119, v76
    v_exp_f32 v78, v62
    v_add_f32 v119, v119, v77
    v_cvt_pk_bf16_f32 v30, v76, v77
    v_exp_f32 v79, v63
    v_add_f32 v119, v119, v78
    v_add_f32 v119, v119, v79
    v_cvt_pk_bf16_f32 v31, v78, v79
    v_add_f32 v120, v118, v119
    v_cmp_nge_f32 vcc, s40, v120
    s_nop 0
    s_cbranch_vccnz slow_t1
back_t1:
    v_add_f32 v116, v116, v118
    v_add_f32 v117, v117, v119
    v_mfma_f32_16x16x32_bf16 v[88:91], a[244:247], a[4:7], v[88:91]
    v_mul_f32 v11, v11, v4
    v_mul_f32 v11, v11, v12
    v_cvt_pk_bf16_f32 v45, v10, v11
    v_accvgpr_read_b32 v7, a76
    v_mfma_f32_16x16x32_bf16 v[92:95], a[244:247], a[36:39], v[100:103]
    ds_read_b128 a[212:215], v1 offset:50752
    v_accvgpr_read_b32 v9, a132
    v_mfma_f32_16x16x32_bf16 v[92:95], a[240:243], a[32:35], v[92:95]
    v_exp_f32 v68, v84
    v_mfma_f32_16x16x32_bf16 v[92:95], a[248:251], a[40:43], v[92:95]
    ds_read_b128 a[216:219], v1 offset:50816
    v_mul_f32 v7, v7, v4
    v_mfma_f32_16x16x32_bf16 v[92:95], a[252:255], a[44:47], v[92:95]
    v_exp_f32 v69, v85
    v_accvgpr_read_b32 v8, a77
    v_mul_f32 v7, v7, v9
    v_mfma_f32_16x16x32_bf16 v[88:91], a[252:255], a[12:15], v[88:91]
    ds_read_b128 a[220:223], v1 offset:50880
    v_add_f32 v119, v68, v69
    v_mfma_f32_16x16x32_bf16 v[88:91], a[248:251], a[8:11], v[88:91]
    s_waitcnt lgkmcnt(4)
    v_exp_f32 v70, v86
    v_mfma_f32_16x16x32_bf16 v[88:91], a[192:195], a[16:19], v[88:91]
    ds_read_b128 a[224:227], v1 offset:50944
    v_cvt_pk_bf16_f32 v36, v68, v69
    v_mfma_f32_16x16x32_bf16 v[88:91], a[196:199], a[20:23], v[88:91]
    v_exp_f32 v71, v87
    v_accvgpr_read_b32 v9, a133
    v_mul_f32 v8, v8, v4
    v_mfma_f32_16x16x32_bf16 v[92:95], a[196:199], a[52:55], v[92:95]
    ds_read_b128 a[228:231], v1 offset:51008
    v_add_f32 v119, v119, v70
    v_mfma_f32_16x16x32_bf16 v[92:95], a[192:195], a[48:51], v[92:95]
    v_exp_f32 v64, v80
    v_mfma_f32_16x16x32_bf16 v[92:95], a[200:203], a[56:59], v[92:95]
    ds_read_b128 a[232:235], v1 offset:51072
    v_cvt_pk_bf16_f32 v37, v70, v71
    v_mfma_f32_16x16x32_bf16 v[92:95], a[204:207], a[60:63], v[92:95]
    v_exp_f32 v65, v81
    v_mul_f32 v8, v8, v9
    v_cvt_pk_bf16_f32 v46, v7, v8
    v_mfma_f32_16x16x32_bf16 v[88:91], a[204:207], a[28:31], v[88:91]
    ds_read_b128 a[236:239], v1 offset:51136
    v_add_f32 v119, v119, v71
    v_mfma_f32_16x16x32_bf16 v[88:91], a[200:203], a[24:27], v[88:91]
    s_waitcnt lgkmcnt(4)
    v_exp_f32 v66, v82
    v_accvgpr_read_b32 v10, a78
    v_accvgpr_read_b32 v12, a134
    v_mfma_f32_16x16x32_bf16 v[48:51], a[208:211], a[0:3], v[96:99]
    ds_read_b128 a[240:243], v1 offset:51200
    v_add_f32 v118, v64, v65
    v_mfma_f32_16x16x32_bf16 v[48:51], a[212:215], a[4:7], v[48:51]
    v_exp_f32 v67, v83
    v_mul_f32 v10, v10, v4
    v_accvgpr_read_b32 v11, a79
    v_mfma_f32_16x16x32_bf16 v[52:55], a[212:215], a[36:39], v[100:103]
    ds_read_b128 a[244:247], v1 offset:51264
    v_cvt_pk_bf16_f32 v32, v64, v65
    v_mfma_f32_16x16x32_bf16 v[52:55], a[208:211], a[32:35], v[52:55]
    v_exp_f32 v76, v92
    v_mfma_f32_16x16x32_bf16 v[52:55], a[216:219], a[40:43], v[52:55]
    ds_read_b128 a[248:251], v1 offset:51328
    v_add_f32 v118, v118, v66
    v_mfma_f32_16x16x32_bf16 v[52:55], a[220:223], a[44:47], v[52:55]
    v_exp_f32 v77, v93
    v_mul_f32 v10, v10, v12
    v_accvgpr_read_b32 v12, a135
    v_mfma_f32_16x16x32_bf16 v[48:51], a[220:223], a[12:15], v[48:51]
    ds_read_b128 a[252:255], v1 offset:51392
    v_cvt_pk_bf16_f32 v33, v66, v67
    v_mfma_f32_16x16x32_bf16 v[48:51], a[216:219], a[8:11], v[48:51]
    s_waitcnt lgkmcnt(4)
    v_exp_f32 v78, v94
    v_mfma_f32_16x16x32_bf16 v[48:51], a[224:227], a[16:19], v[48:51]
    ds_read_b128 a[192:195], v1 offset:51456
    v_add_f32 v118, v118, v67
    v_mfma_f32_16x16x32_bf16 v[48:51], a[228:231], a[20:23], v[48:51]
    v_exp_f32 v79, v95
    v_mul_f32 v11, v11, v4
    v_mul_f32 v11, v11, v12
    v_mfma_f32_16x16x32_bf16 v[52:55], a[228:231], a[52:55], v[52:55]
    ds_read_b128 a[196:199], v1 offset:51520
    v_add_f32 v119, v119, v76
    v_mfma_f32_16x16x32_bf16 v[52:55], a[224:227], a[48:51], v[52:55]
    v_exp_f32 v72, v88
    v_mfma_f32_16x16x32_bf16 v[52:55], a[232:235], a[56:59], v[52:55]
    ds_read_b128 a[200:203], v1 offset:51584
    v_cvt_pk_bf16_f32 v38, v76, v77
    v_mfma_f32_16x16x32_bf16 v[52:55], a[236:239], a[60:63], v[52:55]
    v_exp_f32 v73, v89
    v_cvt_pk_bf16_f32 v47, v10, v11
    v_mfma_f32_16x16x32_bf16 v[48:51], a[236:239], a[28:31], v[48:51]
    ds_read_b128 a[204:207], v1 offset:51648
    v_add_f32 v119, v119, v77
    v_mfma_f32_16x16x32_bf16 v[48:51], a[232:235], a[24:27], v[48:51]
    s_waitcnt vmcnt(9) lgkmcnt(4)
    s_barrier
    buffer_store_dwordx4 v[44:47], v6, s[32:35], s13 offen offset:0 sc1
    v_add_f32 v119, v119, v78
    v_mfma_f32_16x16x32_bf16 v[56:59], a[240:243], a[0:3], v[96:99]
    ds_read_b64_tr_b16 a[208:209], v0 offset:0
    ds_read_b64_tr_b16 a[210:211], v0 offset:512
    v_mfma_f32_16x16x32_bf16 v[56:59], a[244:247], a[4:7], v[56:59]
    v_exp_f32 v74, v90
    v_accvgpr_read_b32 v7, a80
    v_accvgpr_read_b32 v9, a136
    v_mfma_f32_16x16x32_bf16 v[60:63], a[244:247], a[36:39], v[100:103]
    ds_read_b64_tr_b16 a[212:213], v0 offset:16896
    ds_read_b64_tr_b16 a[214:215], v0 offset:17408
    v_mfma_f32_16x16x32_bf16 v[60:63], a[240:243], a[32:35], v[60:63]
    v_exp_f32 v75, v91
    v_mfma_f32_16x16x32_bf16 v[60:63], a[248:251], a[40:43], v[60:63]
    ds_read_b64_tr_b16 a[216:217], v0 offset:32
    ds_read_b64_tr_b16 a[218:219], v0 offset:544
    v_mfma_f32_16x16x32_bf16 v[60:63], a[252:255], a[44:47], v[60:63]
    buffer_load_dwordx4 v114, s[24:27], s38 offen offset:0 lds
    v_mul_f32 v7, v7, v3
    v_accvgpr_read_b32 v8, a81
    v_mfma_f32_16x16x32_bf16 v[56:59], a[252:255], a[12:15], v[56:59]
    ds_read_b64_tr_b16 a[220:221], v0 offset:16928
    ds_read_b64_tr_b16 a[222:223], v0 offset:17440
    v_mfma_f32_16x16x32_bf16 v[56:59], a[248:251], a[8:11], v[56:59]
    s_waitcnt lgkmcnt(8)
    v_exp_f32 v68, v52
    v_mfma_f32_16x16x32_bf16 v[56:59], a[192:195], a[16:19], v[56:59]
    ds_read_b64_tr_b16 a[224:225], v0 offset:64
    ds_read_b64_tr_b16 a[226:227], v0 offset:576
    v_mfma_f32_16x16x32_bf16 v[56:59], a[196:199], a[20:23], v[56:59]
    buffer_load_dwordx4 v112, s[24:27], s38 offen offset:1056 lds
    v_mul_f32 v7, v7, v9
    v_accvgpr_read_b32 v9, a137
    v_mfma_f32_16x16x32_bf16 v[60:63], a[196:199], a[52:55], v[60:63]
    ds_read_b64_tr_b16 a[228:229], v0 offset:16960
    ds_read_b64_tr_b16 a[230:231], v0 offset:17472
    v_mfma_f32_16x16x32_bf16 v[60:63], a[192:195], a[48:51], v[60:63]
    v_exp_f32 v69, v53
    v_mfma_f32_16x16x32_bf16 v[60:63], a[200:203], a[56:59], v[60:63]
    ds_read_b64_tr_b16 a[232:233], v0 offset:96
    ds_read_b64_tr_b16 a[234:235], v0 offset:608
    v_mfma_f32_16x16x32_bf16 v[60:63], a[204:207], a[60:63], v[60:63]
    buffer_load_dwordx4 v121, s[24:27], s38 offen offset:2112 lds
    v_mul_f32 v8, v8, v3
    v_mul_f32 v8, v8, v9
    v_mfma_f32_16x16x32_bf16 v[56:59], a[204:207], a[28:31], v[56:59]
    ds_read_b64_tr_b16 a[236:237], v0 offset:16992
    ds_read_b64_tr_b16 a[238:239], v0 offset:17504
    v_mfma_f32_16x16x32_bf16 v[56:59], a[200:203], a[24:27], v[56:59]
    s_waitcnt lgkmcnt(8)
    v_exp_f32 v70, v54
    v_cvt_pk_bf16_f32 v108, v7, v8
    v_accvgpr_read_b32 v10, a82
    v_mfma_f32_16x16x32_bf16 v[128:131], a[208:211], v[16:19], 0
    ds_read_b64_tr_b16 a[240:241], v0 offset:128
    ds_read_b64_tr_b16 a[242:243], v0 offset:640
    v_mfma_f32_16x16x32_bf16 v[128:131], a[212:215], v[24:27], v[128:131]
    buffer_load_dwordx4 v122, s[24:27], s38 offen offset:3168 lds
    s_add_u32 m0, s37, 50688
    v_accvgpr_read_b32 v12, a138
    v_mfma_f32_16x16x32_bf16 v[132:135], a[212:215], v[28:31], 0
    ds_read_b64_tr_b16 a[244:245], v0 offset:17024
    ds_read_b64_tr_b16 a[246:247], v0 offset:17536
    v_mfma_f32_16x16x32_bf16 v[132:135], a[208:211], v[20:23], v[132:135]
    s_add_u32 s38, s38, 16384
    v_exp_f32 v71, v55
    v_mul_f32 v10, v10, v3
    v_accvgpr_read_b32 v11, a83
    v_mov_b32 v5, s3
    v_mfma_f32_16x16x32_bf16 v[140:143], a[216:219], v[20:23], 0
    ds_read_b64_tr_b16 a[248:249], v0 offset:160
    ds_read_b64_tr_b16 a[250:251], v0 offset:672
    v_mfma_f32_16x16x32_bf16 v[140:143], a[220:223], v[28:31], v[140:143]
    buffer_load_dwordx4 v114, s[24:27], s38 offen offset:0 lds
    v_mul_f32 v10, v10, v12
    v_accvgpr_read_b32 v12, a139
    v_mfma_f32_16x16x32_bf16 v[136:139], a[220:223], v[24:27], 0
    ds_read_b64_tr_b16 a[252:253], v0 offset:17056
    ds_read_b64_tr_b16 a[254:255], v0 offset:17568
    v_mfma_f32_16x16x32_bf16 v[136:139], a[216:219], v[16:19], v[136:139]
    s_waitcnt lgkmcnt(8)
    v_exp_f32 v64, v48
    v_mul_f32 v11, v11, v3
    v_mul_f32 v11, v11, v12
    v_mfma_f32_16x16x32_bf16 v[144:147], a[224:227], v[16:19], 0
    ds_read_b64_tr_b16 a[192:193], v0 offset:192
    ds_read_b64_tr_b16 a[194:195], v0 offset:704
    v_mfma_f32_16x16x32_bf16 v[144:147], a[228:231], v[24:27], v[144:147]
    buffer_load_dwordx4 v112, s[24:27], s38 offen offset:1056 lds
    v_cvt_pk_bf16_f32 v109, v10, v11
    v_accvgpr_read_b32 v7, a88
    v_mfma_f32_16x16x32_bf16 v[148:151], a[228:231], v[28:31], 0
    ds_read_b64_tr_b16 a[196:197], v0 offset:17088
    ds_read_b64_tr_b16 a[198:199], v0 offset:17600
    v_mfma_f32_16x16x32_bf16 v[148:151], a[224:227], v[20:23], v[148:151]
    v_exp_f32 v65, v49
    v_accvgpr_read_b32 v9, a144
    v_mul_f32 v7, v7, v3
    v_mfma_f32_16x16x32_bf16 v[156:159], a[232:235], v[20:23], 0
    ds_read_b64_tr_b16 a[200:201], v0 offset:224
    ds_read_b64_tr_b16 a[202:203], v0 offset:736
    v_mfma_f32_16x16x32_bf16 v[156:159], a[236:239], v[28:31], v[156:159]
    buffer_load_dwordx4 v121, s[24:27], s38 offen offset:2112 lds
    v_accvgpr_read_b32 v8, a89
    v_mul_f32 v7, v7, v9
    v_mfma_f32_16x16x32_bf16 v[152:155], a[236:239], v[24:27], 0
    ds_read_b64_tr_b16 a[204:205], v0 offset:17120
    ds_read_b64_tr_b16 a[206:207], v0 offset:17632
    v_mfma_f32_16x16x32_bf16 v[152:155], a[232:235], v[16:19], v[152:155]
    s_waitcnt lgkmcnt(8)
    v_exp_f32 v66, v50
    v_accvgpr_read_b32 v9, a145
    v_mul_f32 v8, v8, v3
    v_mfma_f32_16x16x32_bf16 v[160:163], a[240:243], v[16:19], 0
    ds_read_b64_tr_b16 a[208:209], v0 offset:256
    ds_read_b64_tr_b16 a[210:211], v0 offset:768
    v_mfma_f32_16x16x32_bf16 v[160:163], a[244:247], v[24:27], v[160:163]
    buffer_load_dwordx4 v122, s[24:27], s38 offen offset:3168 lds
    s_add_u32 m0, s37, 101376
    v_mul_f32 v8, v8, v9
    v_mfma_f32_16x16x32_bf16 v[164:167], a[244:247], v[28:31], 0
    ds_read_b64_tr_b16 a[212:213], v0 offset:17152
    ds_read_b64_tr_b16 a[214:215], v0 offset:17664
    v_mfma_f32_16x16x32_bf16 v[164:167], a[240:243], v[20:23], v[164:167]
    s_add_u32 s38, s38, 16384
    v_exp_f32 v67, v51
    v_cvt_pk_bf16_f32 v110, v7, v8
    v_accvgpr_read_b32 v10, a90
    v_mfma_f32_16x16x32_bf16 v[172:175], a[248:251], v[20:23], 0
    ds_read_b64_tr_b16 a[216:217], v0 offset:288
    v_cvt_pk_bf16_f32 v39, v78, v79
    v_mfma_f32_16x16x32_bf16 v[172:175], a[252:255], v[28:31], v[172:175]
    ds_read_b64_tr_b16 a[218:219], v0 offset:800
    v_add_f32 v119, v119, v79
    v_accvgpr_read_b32 v12, a146
    v_mul_f32 v10, v10, v3
    v_mfma_f32_16x16x32_bf16 v[168:171], a[252:255], v[24:27], 0
    ds_read_b64_tr_b16 a[220:221], v0 offset:17184
    ds_read_b64_tr_b16 a[222:223], v0 offset:17696
    buffer_load_dword v15, v5, s[96:99], 0 offen sc1
    v_mfma_f32_16x16x32_bf16 v[168:171], a[248:251], v[16:19], v[168:171]
    s_waitcnt lgkmcnt(8)
    v_exp_f32 v76, v60
    v_accvgpr_read_b32 v11, a91
    v_mul_f32 v10, v10, v12
    v_mfma_f32_16x16x32_bf16 v[176:179], a[192:195], v[16:19], 0
    ds_read_b64_tr_b16 a[224:225], v0 offset:320
    v_add_f32 v118, v118, v72
    v_mfma_f32_16x16x32_bf16 v[176:179], a[196:199], v[24:27], v[176:179]
    ds_read_b64_tr_b16 a[226:227], v0 offset:832
    v_cvt_pk_bf16_f32 v34, v72, v73
    v_accvgpr_read_b32 v12, a147
    v_mul_f32 v11, v11, v3
    v_mfma_f32_16x16x32_bf16 v[180:183], a[196:199], v[28:31], 0
    ds_read_b64_tr_b16 a[228:229], v0 offset:17216
    ds_read_b64_tr_b16 a[230:231], v0 offset:17728
    v_mfma_f32_16x16x32_bf16 v[180:183], a[192:195], v[20:23], v[180:183]
    v_exp_f32 v77, v61
    v_mul_f32 v11, v11, v12
    v_cvt_pk_bf16_f32 v111, v10, v11
    v_mfma_f32_16x16x32_bf16 v[188:191], a[200:203], v[20:23], 0
    ds_read_b64_tr_b16 a[232:233], v0 offset:352
    v_add_f32 v118, v118, v73
    v_mfma_f32_16x16x32_bf16 v[188:191], a[204:207], v[28:31], v[188:191]
    ds_read_b64_tr_b16 a[234:235], v0 offset:864
    buffer_store_dwordx4 v[108:111], v6, s[32:35], s12 offen offset:1024 sc1
    v_add_f32 v118, v118, v74
    v_mfma_f32_16x16x32_bf16 v[184:187], a[204:207], v[24:27], 0
    ds_read_b64_tr_b16 a[236:237], v0 offset:17248
    ds_read_b64_tr_b16 a[238:239], v0 offset:17760
    v_mfma_f32_16x16x32_bf16 v[184:187], a[200:203], v[16:19], v[184:187]
    s_waitcnt lgkmcnt(8)
    v_exp_f32 v78, v62
    v_accvgpr_read_b32 v7, a84
    v_accvgpr_read_b32 v9, a140
    v_mfma_f32_16x16x32_bf16 v[192:195], a[208:211], v[16:19], 0
    ds_read_b64_tr_b16 a[240:241], v0 offset:384
    v_cvt_pk_bf16_f32 v35, v74, v75
    v_mfma_f32_16x16x32_bf16 v[192:195], a[212:215], v[24:27], v[192:195]
    ds_read_b64_tr_b16 a[242:243], v0 offset:896
    v_add_f32 v118, v118, v75
    v_mul_f32 v7, v7, v4
    v_accvgpr_read_b32 v8, a85
    v_mfma_f32_16x16x32_bf16 v[196:199], a[212:215], v[28:31], 0
    ds_read_b64_tr_b16 a[244:245], v0 offset:17280
    ds_read_b64_tr_b16 a[246:247], v0 offset:17792
    v_mfma_f32_16x16x32_bf16 v[196:199], a[208:211], v[20:23], v[196:199]
    v_exp_f32 v79, v63
    v_mul_f32 v7, v7, v9
    v_accvgpr_read_b32 v9, a141
    v_mfma_f32_16x16x32_bf16 v[204:207], a[216:219], v[20:23], 0
    ds_read_b64_tr_b16 a[248:249], v0 offset:416
    v_add_f32 v119, v119, v68
    v_mfma_f32_16x16x32_bf16 v[204:207], a[220:223], v[28:31], v[204:207]
    ds_read_b64_tr_b16 a[250:251], v0 offset:928
    v_add_f32 v119, v119, v69
    v_mul_f32 v8, v8, v4
    v_mul_f32 v8, v8, v9
    v_mfma_f32_16x16x32_bf16 v[200:203], a[220:223], v[24:27], 0
    ds_read_b64_tr_b16 a[252:253], v0 offset:17312
    ds_read_b64_tr_b16 a[254:255], v0 offset:17824
    v_mfma_f32_16x16x32_bf16 v[200:203], a[216:219], v[16:19], v[200:203]
    s_waitcnt lgkmcnt(8)
    v_exp_f32 v72, v56
    v_cvt_pk_bf16_f32 v124, v7, v8
    v_accvgpr_read_b32 v10, a86
    v_mfma_f32_16x16x32_bf16 v[208:211], a[224:227], v[16:19], 0
    ds_read_b64_tr_b16 a[192:193], v0 offset:448
    v_add_f32 v119, v119, v70
    v_mfma_f32_16x16x32_bf16 v[208:211], a[228:231], v[24:27], v[208:211]
    ds_read_b64_tr_b16 a[194:195], v0 offset:960
    v_add_f32 v119, v119, v71
    v_accvgpr_read_b32 v12, a142
    v_mul_f32 v10, v10, v4
    v_mfma_f32_16x16x32_bf16 v[212:215], a[228:231], v[28:31], 0
    ds_read_b64_tr_b16 a[196:197], v0 offset:17344
    ds_read_b64_tr_b16 a[198:199], v0 offset:17856
    v_mfma_f32_16x16x32_bf16 v[212:215], a[224:227], v[20:23], v[212:215]
    v_exp_f32 v73, v57
    v_accvgpr_read_b32 v11, a87
    v_mul_f32 v10, v10, v12
    v_mfma_f32_16x16x32_bf16 v[220:223], a[232:235], v[20:23], 0
    ds_read_b64_tr_b16 a[200:201], v0 offset:480
    v_add_f32 v118, v118, v64
    v_mfma_f32_16x16x32_bf16 v[220:223], a[236:239], v[28:31], v[220:223]
    ds_read_b64_tr_b16 a[202:203], v0 offset:992
    v_add_f32 v118, v118, v65
    v_accvgpr_read_b32 v12, a143
    v_mul_f32 v11, v11, v4
    v_mfma_f32_16x16x32_bf16 v[216:219], a[236:239], v[24:27], 0
    ds_read_b64_tr_b16 a[204:205], v0 offset:17376
    ds_read_b64_tr_b16 a[206:207], v0 offset:17888
    v_mfma_f32_16x16x32_bf16 v[216:219], a[232:235], v[16:19], v[216:219]
    s_waitcnt vmcnt(11) lgkmcnt(8)
    s_barrier
    v_add_f32 v118, v118, v66
    v_mul_f32 v11, v11, v12
    v_cvt_pk_bf16_f32 v125, v10, v11
    v_mfma_f32_16x16x32_bf16 v[224:227], a[240:243], v[16:19], 0
    ds_read_b128 a[208:211], v1 offset:0
    v_add_f32 v118, v118, v67
    v_mfma_f32_16x16x32_bf16 v[224:227], a[244:247], v[24:27], v[224:227]
    buffer_load_dwordx4 v114, s[20:23], s49 offen offset:0 lds
    v_accvgpr_read_b32 v7, a92
    v_accvgpr_read_b32 v9, a148
    v_mfma_f32_16x16x32_bf16 v[228:231], a[244:247], v[28:31], 0
    ds_read_b128 a[212:215], v1 offset:64
    v_add_f32 v119, v119, v76
    v_mfma_f32_16x16x32_bf16 v[228:231], a[240:243], v[20:23], v[228:231]
    v_exp_f32 v74, v58
    v_mul_f32 v7, v7, v4
    v_accvgpr_read_b32 v8, a93
    v_mfma_f32_16x16x32_bf16 v[236:239], a[248:251], v[20:23], 0
    ds_read_b128 a[216:219], v1 offset:128
    v_add_f32 v119, v119, v77
    v_mfma_f32_16x16x32_bf16 v[236:239], a[252:255], v[28:31], v[236:239]
    buffer_load_dwordx4 v112, s[20:23], s49 offen offset:1056 lds
    v_mul_f32 v7, v7, v9
    v_accvgpr_read_b32 v9, a149
    v_mfma_f32_16x16x32_bf16 v[232:235], a[252:255], v[24:27], 0
    ds_read_b128 a[220:223], v1 offset:192
    v_add_f32 v119, v119, v78
    v_mfma_f32_16x16x32_bf16 v[232:235], a[248:251], v[16:19], v[232:235]
    s_waitcnt lgkmcnt(4)
    v_exp_f32 v75, v59
    v_mul_f32 v8, v8, v4
    v_mul_f32 v8, v8, v9
    v_mfma_f32_16x16x32_bf16 v[240:243], a[192:195], v[16:19], 0
    ds_read_b128 a[224:227], v1 offset:256
    v_add_f32 v119, v119, v79
    v_mfma_f32_16x16x32_bf16 v[240:243], a[196:199], v[24:27], v[240:243]
    buffer_load_dwordx4 v121, s[20:23], s49 offen offset:2112 lds
    v_cvt_pk_bf16_f32 v126, v7, v8
    v_accvgpr_read_b32 v10, a94
    v_mfma_f32_16x16x32_bf16 v[244:247], a[196:199], v[28:31], 0
    ds_read_b128 a[228:231], v1 offset:320
    v_add_f32 v118, v118, v72
    v_mfma_f32_16x16x32_bf16 v[244:247], a[192:195], v[20:23], v[244:247]
    v_add_f32 v118, v118, v73
    v_add_f32 v118, v118, v75
    v_accvgpr_read_b32 v12, a150
    v_mul_f32 v10, v10, v4
    v_mfma_f32_16x16x32_bf16 v[252:255], a[200:203], v[20:23], 0
    ds_read_b128 a[232:235], v1 offset:384
    v_add_f32 v118, v118, v74
    v_mfma_f32_16x16x32_bf16 v[252:255], a[204:207], v[28:31], v[252:255]
    buffer_load_dwordx4 v122, s[20:23], s49 offen offset:3168 lds
    s_add_u32 m0, s37, 118272
    v_add_f32 v120, v118, v119
    v_mfma_f32_16x16x32_bf16 v[248:251], a[204:207], v[24:27], 0
    s_add_u32 s49, s49, 16384
    ds_read_b128 a[236:239], v1 offset:448
    v_cmp_nge_f32 vcc, s40, v120
    v_mfma_f32_16x16x32_bf16 v[248:251], a[200:203], v[16:19], v[248:251]
    s_waitcnt lgkmcnt(4)
    s_cbranch_vccnz slow_t3
back_t3:
    v_add_f32 v116, v116, v118
    v_accvgpr_read_b32 v11, a95
    v_mul_f32 v10, v10, v12
    v_mfma_f32_16x16x32_bf16 v[80:83], a[208:211], a[0:3], v[96:99]
    ds_read_b128 a[240:243], v1 offset:512
    v_add_f32 v117, v117, v119
    v_mfma_f32_16x16x32_bf16 v[80:83], a[212:215], a[4:7], v[80:83]
    buffer_load_dwordx4 v114, s[20:23], s49 offen offset:0 lds
    v_accvgpr_read_b32 v12, a151
    v_mul_f32 v11, v11, v4
    v_mfma_f32_16x16x32_bf16 v[84:87], a[212:215], a[36:39], v[100:103]
    ds_read_b128 a[244:247], v1 offset:576
    v_cvt_pk_bf16_f32 v24, v64, v65
    v_mfma_f32_16x16x32_bf16 v[84:87], a[208:211], a[32:35], v[84:87]
    v_cvt_pk_bf16_f32 v25, v66, v67
    v_mfma_f32_16x16x32_bf16 v[84:87], a[216:219], a[40:43], v[84:87]
    ds_read_b128 a[248:251], v1 offset:640
    v_cvt_pk_bf16_f32 v28, v68, v69
    v_mfma_f32_16x16x32_bf16 v[84:87], a[220:223], a[44:47], v[84:87]
    buffer_load_dwordx4 v112, s[20:23], s49 offen offset:1056 lds
    v_mul_f32 v11, v11, v12
    v_cvt_pk_bf16_f32 v127, v10, v11
    v_mfma_f32_16x16x32_bf16 v[80:83], a[220:223], a[12:15], v[80:83]
    ds_read_b128 a[252:255], v1 offset:704
    v_cvt_pk_bf16_f32 v29, v70, v71
    v_mfma_f32_16x16x32_bf16 v[80:83], a[216:219], a[8:11], v[80:83]
    s_waitcnt lgkmcnt(4)
    v_cvt_pk_bf16_f32 v26, v72, v73
    v_mfma_f32_16x16x32_bf16 v[80:83], a[224:227], a[16:19], v[80:83]
    ds_read_b128 a[192:195], v1 offset:768
    v_cvt_pk_bf16_f32 v27, v74, v75
    v_mfma_f32_16x16x32_bf16 v[80:83], a[228:231], a[20:23], v[80:83]
    buffer_load_dwordx4 v121, s[20:23], s49 offen offset:2112 lds
    buffer_store_dwordx4 v[124:127], v6, s[32:35], s13 offen offset:1024 sc1
    v_accvgpr_read_b32 v7, a96
    v_mfma_f32_16x16x32_bf16 v[84:87], a[228:231], a[52:55], v[84:87]
    ds_read_b128 a[196:199], v1 offset:832
    v_cvt_pk_bf16_f32 v30, v76, v77
    v_mfma_f32_16x16x32_bf16 v[84:87], a[224:227], a[48:51], v[84:87]
    v_cvt_pk_bf16_f32 v31, v78, v79
    v_mfma_f32_16x16x32_bf16 v[84:87], a[232:235], a[56:59], v[84:87]
    ds_read_b128 a[200:203], v1 offset:896
    v_accvgpr_read_b32 v9, a152
    v_mfma_f32_16x16x32_bf16 v[84:87], a[236:239], a[60:63], v[84:87]
    buffer_load_dwordx4 v122, s[20:23], s49 offen offset:3168 lds
    s_add_u32 m0, s37, 0
    v_mul_f32 v7, v7, v3
    v_mfma_f32_16x16x32_bf16 v[80:83], a[236:239], a[28:31], v[80:83]
    s_add_u32 s49, s49, 16384
    ds_read_b128 a[204:207], v1 offset:960
    v_mfma_f32_16x16x32_bf16 v[80:83], a[232:235], a[24:27], v[80:83]
    s_waitcnt lgkmcnt(4)
    v_accvgpr_read_b32 v8, a97
    v_mul_f32 v7, v7, v9
    v_accvgpr_read_b32 v9, a153
    v_mul_f32 v8, v8, v3
    v_mfma_f32_16x16x32_bf16 v[88:91], a[240:243], a[0:3], v[96:99]
    ds_read_b128 a[208:211], v1 offset:16896
    v_mul_f32 v8, v8, v9
    v_mfma_f32_16x16x32_bf16 v[88:91], a[244:247], a[4:7], v[88:91]
    v_cvt_pk_bf16_f32 v40, v7, v8
    v_accvgpr_read_b32 v10, a98
    v_accvgpr_read_b32 v12, a154
    v_mul_f32 v10, v10, v3
    v_mfma_f32_16x16x32_bf16 v[92:95], a[244:247], a[36:39], v[100:103]
    ds_read_b128 a[212:215], v1 offset:16960
    v_accvgpr_read_b32 v11, a99
    v_mfma_f32_16x16x32_bf16 v[92:95], a[240:243], a[32:35], v[92:95]
    v_exp_f32 v68, v84
    v_mfma_f32_16x16x32_bf16 v[92:95], a[248:251], a[40:43], v[92:95]
    ds_read_b128 a[216:219], v1 offset:17024
    v_mul_f32 v10, v10, v12
    v_mfma_f32_16x16x32_bf16 v[92:95], a[252:255], a[44:47], v[92:95]
    v_exp_f32 v69, v85
    v_accvgpr_read_b32 v12, a155
    v_mul_f32 v11, v11, v3
    v_mfma_f32_16x16x32_bf16 v[88:91], a[252:255], a[12:15], v[88:91]
    ds_read_b128 a[220:223], v1 offset:17088
    v_add_f32 v119, v68, v69
    v_mfma_f32_16x16x32_bf16 v[88:91], a[248:251], a[8:11], v[88:91]
    s_waitcnt lgkmcnt(4)
    v_exp_f32 v70, v86
    v_mfma_f32_16x16x32_bf16 v[88:91], a[192:195], a[16:19], v[88:91]
    ds_read_b128 a[224:227], v1 offset:17152
    v_cvt_pk_bf16_f32 v20, v68, v69
    v_mfma_f32_16x16x32_bf16 v[88:91], a[196:199], a[20:23], v[88:91]
    v_exp_f32 v71, v87
    v_mul_f32 v11, v11, v12
    v_cvt_pk_bf16_f32 v41, v10, v11
    v_mfma_f32_16x16x32_bf16 v[92:95], a[196:199], a[52:55], v[92:95]
    ds_read_b128 a[228:231], v1 offset:17216
    v_add_f32 v119, v119, v70
    v_mfma_f32_16x16x32_bf16 v[92:95], a[192:195], a[48:51], v[92:95]
    v_exp_f32 v64, v80
    v_mfma_f32_16x16x32_bf16 v[92:95], a[200:203], a[56:59], v[92:95]
    ds_read_b128 a[232:235], v1 offset:17280
    v_cvt_pk_bf16_f32 v21, v70, v71
    v_mfma_f32_16x16x32_bf16 v[92:95], a[204:207], a[60:63], v[92:95]
    v_exp_f32 v65, v81
    v_accvgpr_read_b32 v7, a104
    v_accvgpr_read_b32 v9, a160
    v_mfma_f32_16x16x32_bf16 v[88:91], a[204:207], a[28:31], v[88:91]
    ds_read_b128 a[236:239], v1 offset:17344
    v_add_f32 v119, v119, v71
    v_mfma_f32_16x16x32_bf16 v[88:91], a[200:203], a[24:27], v[88:91]
    s_waitcnt lgkmcnt(4)
    v_exp_f32 v66, v82
    v_mul_f32 v7, v7, v3
    v_accvgpr_read_b32 v8, a105
    v_mfma_f32_16x16x32_bf16 v[48:51], a[208:211], a[0:3], v[96:99]
    ds_read_b128 a[240:243], v1 offset:17408
    v_add_f32 v118, v64, v65
    v_mfma_f32_16x16x32_bf16 v[48:51], a[212:215], a[4:7], v[48:51]
    v_exp_f32 v67, v83
    v_mul_f32 v7, v7, v9
    v_accvgpr_read_b32 v9, a161
    v_mfma_f32_16x16x32_bf16 v[52:55], a[212:215], a[36:39], v[100:103]
    ds_read_b128 a[244:247], v1 offset:17472
    v_cvt_pk_bf16_f32 v16, v64, v65
    v_mfma_f32_16x16x32_bf16 v[52:55], a[208:211], a[32:35], v[52:55]
    v_exp_f32 v76, v92
    v_mfma_f32_16x16x32_bf16 v[52:55], a[216:219], a[40:43], v[52:55]
    ds_read_b128 a[248:251], v1 offset:17536
    v_add_f32 v118, v118, v66
    v_mfma_f32_16x16x32_bf16 v[52:55], a[220:223], a[44:47], v[52:55]
    v_exp_f32 v77, v93
    v_mul_f32 v8, v8, v3
    v_mul_f32 v8, v8, v9
    v_mfma_f32_16x16x32_bf16 v[48:51], a[220:223], a[12:15], v[48:51]
    ds_read_b128 a[252:255], v1 offset:17600
    v_cvt_pk_bf16_f32 v17, v66, v67
    v_mfma_f32_16x16x32_bf16 v[48:51], a[216:219], a[8:11], v[48:51]
    s_waitcnt lgkmcnt(4)
    v_exp_f32 v78, v94
    v_mfma_f32_16x16x32_bf16 v[48:51], a[224:227], a[16:19], v[48:51]
    ds_read_b128 a[192:195], v1 offset:17664
    v_add_f32 v118, v118, v67
    v_mfma_f32_16x16x32_bf16 v[48:51], a[228:231], a[20:23], v[48:51]
    v_exp_f32 v79, v95
    v_cvt_pk_bf16_f32 v42, v7, v8
    v_accvgpr_read_b32 v10, a106
    v_mfma_f32_16x16x32_bf16 v[52:55], a[228:231], a[52:55], v[52:55]
    ds_read_b128 a[196:199], v1 offset:17728
    v_add_f32 v119, v119, v76
    v_mfma_f32_16x16x32_bf16 v[52:55], a[224:227], a[48:51], v[52:55]
    v_exp_f32 v72, v88
    v_mfma_f32_16x16x32_bf16 v[52:55], a[232:235], a[56:59], v[52:55]
    ds_read_b128 a[200:203], v1 offset:17792
    v_cvt_pk_bf16_f32 v22, v76, v77
    v_mfma_f32_16x16x32_bf16 v[52:55], a[236:239], a[60:63], v[52:55]
    v_exp_f32 v73, v89
    v_accvgpr_read_b32 v12, a162
    v_mul_f32 v10, v10, v3
    v_mfma_f32_16x16x32_bf16 v[48:51], a[236:239], a[28:31], v[48:51]
    ds_read_b128 a[204:207], v1 offset:17856
    v_add_f32 v119, v119, v77
    v_mfma_f32_16x16x32_bf16 v[48:51], a[232:235], a[24:27], v[48:51]
    s_waitcnt vmcnt(11) lgkmcnt(4)
    s_barrier
    v_add_f32 v119, v119, v78
    v_accvgpr_read_b32 v11, a107
    v_mul_f32 v10, v10, v12
    v_mfma_f32_16x16x32_bf16 v[56:59], a[240:243], a[0:3], v[96:99]
    ds_read_b64_tr_b16 a[208:209], v0 offset:33792
    ds_read_b64_tr_b16 a[210:211], v0 offset:34304
    v_mfma_f32_16x16x32_bf16 v[56:59], a[244:247], a[4:7], v[56:59]
    v_exp_f32 v74, v90
    v_accvgpr_read_b32 v12, a163
    v_mul_f32 v11, v11, v3
    v_mfma_f32_16x16x32_bf16 v[60:63], a[244:247], a[36:39], v[100:103]
    ds_read_b64_tr_b16 a[212:213], v0 offset:50688
    ds_read_b64_tr_b16 a[214:215], v0 offset:51200
    v_mfma_f32_16x16x32_bf16 v[60:63], a[240:243], a[32:35], v[60:63]
    v_exp_f32 v75, v91
    v_mfma_f32_16x16x32_bf16 v[60:63], a[248:251], a[40:43], v[60:63]
    ds_read_b64_tr_b16 a[216:217], v0 offset:33824
    ds_read_b64_tr_b16 a[218:219], v0 offset:34336
    v_mfma_f32_16x16x32_bf16 v[60:63], a[252:255], a[44:47], v[60:63]
    buffer_load_dwordx4 v114, s[24:27], s38 offen offset:0 lds
    v_mul_f32 v11, v11, v12
    v_cvt_pk_bf16_f32 v43, v10, v11
    v_mfma_f32_16x16x32_bf16 v[56:59], a[252:255], a[12:15], v[56:59]
    ds_read_b64_tr_b16 a[220:221], v0 offset:50720
    ds_read_b64_tr_b16 a[222:223], v0 offset:51232
    v_mfma_f32_16x16x32_bf16 v[56:59], a[248:251], a[8:11], v[56:59]
    s_waitcnt lgkmcnt(8)
    v_exp_f32 v68, v52
    v_mfma_f32_16x16x32_bf16 v[56:59], a[192:195], a[16:19], v[56:59]
    ds_read_b64_tr_b16 a[224:225], v0 offset:33856
    ds_read_b64_tr_b16 a[226:227], v0 offset:34368
    v_mfma_f32_16x16x32_bf16 v[56:59], a[196:199], a[20:23], v[56:59]
    buffer_load_dwordx4 v112, s[24:27], s38 offen offset:1056 lds
    buffer_store_dwordx4 v[40:43], v6, s[32:35], s12 offen offset:2048 sc1
    v_accvgpr_read_b32 v7, a100
    v_mfma_f32_16x16x32_bf16 v[60:63], a[196:199], a[52:55], v[60:63]
    ds_read_b64_tr_b16 a[228:229], v0 offset:50752
    ds_read_b64_tr_b16 a[230:231], v0 offset:51264
    v_mfma_f32_16x16x32_bf16 v[60:63], a[192:195], a[48:51], v[60:63]
    v_exp_f32 v69, v53
    v_mfma_f32_16x16x32_bf16 v[60:63], a[200:203], a[56:59], v[60:63]
    ds_read_b64_tr_b16 a[232:233], v0 offset:33888
    ds_read_b64_tr_b16 a[234:235], v0 offset:34400
    v_mfma_f32_16x16x32_bf16 v[60:63], a[204:207], a[60:63], v[60:63]
    buffer_load_dwordx4 v121, s[24:27], s38 offen offset:2112 lds
    v_accvgpr_read_b32 v9, a156
    v_mul_f32 v7, v7, v4
    v_mfma_f32_16x16x32_bf16 v[56:59], a[204:207], a[28:31], v[56:59]
    ds_read_b64_tr_b16 a[236:237], v0 offset:50784
    ds_read_b64_tr_b16 a[238:239], v0 offset:51296
    v_mfma_f32_16x16x32_bf16 v[56:59], a[200:203], a[24:27], v[56:59]
    s_waitcnt lgkmcnt(8)
    v_exp_f32 v70, v54
    v_accvgpr_read_b32 v8, a101
    v_mul_f32 v7, v7, v9
    v_mfma_f32_16x16x32_bf16 v[128:131], a[208:211], v[32:35], v[128:131]
    ds_read_b64_tr_b16 a[240:241], v0 offset:33920
    ds_read_b64_tr_b16 a[242:243], v0 offset:34432
    v_mfma_f32_16x16x32_bf16 v[128:131], a[212:215], v[24:27], v[128:131]
    buffer_load_dwordx4 v122, s[24:27], s38 offen offset:3168 lds
    s_add_u32 m0, s37, 16896
    v_accvgpr_read_b32 v9, a157
    v_mfma_f32_16x16x32_bf16 v[132:135], a[212:215], v[28:31], v[132:135]
    ds_read_b64_tr_b16 a[244:245], v0 offset:50816
    ds_read_b64_tr_b16 a[246:247], v0 offset:51328
    v_mfma_f32_16x16x32_bf16 v[132:135], a[208:211], v[36:39], v[132:135]
    s_add_u32 s38, s38, 16384
    v_exp_f32 v71, v55
    v_mul_f32 v8, v8, v4
    v_mul_f32 v8, v8, v9
    v_mfma_f32_16x16x32_bf16 v[140:143], a[216:219], v[36:39], v[140:143]
    ds_read_b64_tr_b16 a[248:249], v0 offset:33952
    ds_read_b64_tr_b16 a[250:251], v0 offset:34464
    v_mfma_f32_16x16x32_bf16 v[140:143], a[220:223], v[28:31], v[140:143]
    buffer_load_dwordx4 v114, s[24:27], s38 offen offset:0 lds
    v_cvt_pk_bf16_f32 v44, v7, v8
    v_accvgpr_read_b32 v10, a102
    v_mfma_f32_16x16x32_bf16 v[136:139], a[220:223], v[24:27], v[136:139]
    ds_read_b64_tr_b16 a[252:253], v0 offset:50848
    ds_read_b64_tr_b16 a[254:255], v0 offset:51360
    v_mfma_f32_16x16x32_bf16 v[136:139], a[216:219], v[32:35], v[136:139]
    s_waitcnt lgkmcnt(8)
    v_exp_f32 v64, v48
    v_accvgpr_read_b32 v12, a158
    v_mul_f32 v10, v10, v4
    v_mfma_f32_16x16x32_bf16 v[144:147], a[224:227], v[32:35], v[144:147]
    ds_read_b64_tr_b16 a[192:193], v0 offset:33984
    ds_read_b64_tr_b16 a[194:195], v0 offset:34496
    v_mfma_f32_16x16x32_bf16 v[144:147], a[228:231], v[24:27], v[144:147]
    buffer_load_dwordx4 v112, s[24:27], s38 offen offset:1056 lds
    v_accvgpr_read_b32 v11, a103
    v_mul_f32 v10, v10, v12
    v_mfma_f32_16x16x32_bf16 v[148:151], a[228:231], v[28:31], v[148:151]
    ds_read_b64_tr_b16 a[196:197], v0 offset:50880
    ds_read_b64_tr_b16 a[198:199], v0 offset:51392
    v_mfma_f32_16x16x32_bf16 v[148:151], a[224:227], v[36:39], v[148:151]
    v_exp_f32 v65, v49
    v_accvgpr_read_b32 v12, a159
    v_mul_f32 v11, v11, v4
    v_mfma_f32_16x16x32_bf16 v[156:159], a[232:235], v[36:39], v[156:159]
    ds_read_b64_tr_b16 a[200:201], v0 offset:34016
    ds_read_b64_tr_b16 a[202:203], v0 offset:34528
    v_mfma_f32_16x16x32_bf16 v[156:159], a[236:239], v[28:31], v[156:159]
    buffer_load_dwordx4 v121, s[24:27], s38 offen offset:2112 lds
    v_mul_f32 v11, v11, v12
    v_cvt_pk_bf16_f32 v45, v10, v11
    v_mfma_f32_16x16x32_bf16 v[152:155], a[236:239], v[24:27], v[152:155]
    ds_read_b64_tr_b16 a[204:205], v0 offset:50912
    ds_read_b64_tr_b16 a[206:207], v0 offset:51424
    v_mfma_f32_16x16x32_bf16 v[152:155], a[232:235], v[32:35], v[152:155]
    s_waitcnt lgkmcnt(8)
    v_exp_f32 v66, v50
    v_accvgpr_read_b32 v7, a108
    v_accvgpr_read_b32 v9, a164
    v_mfma_f32_16x16x32_bf16 v[160:163], a[240:243], v[32:35], v[160:163]
    ds_read_b64_tr_b16 a[208:209], v0 offset:34048
    ds_read_b64_tr_b16 a[210:211], v0 offset:34560
    v_mfma_f32_16x16x32_bf16 v[160:163], a[244:247], v[24:27], v[160:163]
    buffer_load_dwordx4 v122, s[24:27], s38 offen offset:3168 lds
    s_add_u32 m0, s37, 67584
    v_mul_f32 v7, v7, v4
    v_mfma_f32_16x16x32_bf16 v[164:167], a[244:247], v[28:31], v[164:167]
    ds_read_b64_tr_b16 a[212:213], v0 offset:50944
    ds_read_b64_tr_b16 a[214:215], v0 offset:51456
    v_mfma_f32_16x16x32_bf16 v[164:167], a[240:243], v[36:39], v[164:167]
    s_add_u32 s38, s38, 16384
    v_exp_f32 v67, v51
    v_accvgpr_read_b32 v8, a109
    v_mul_f32 v7, v7, v9
    v_mfma_f32_16x16x32_bf16 v[172:175], a[248:251], v[36:39], v[172:175]
    ds_read_b64_tr_b16 a[216:217], v0 offset:34080
    v_cvt_pk_bf16_f32 v23, v78, v79
    v_mfma_f32_16x16x32_bf16 v[172:175], a[252:255], v[28:31], v[172:175]
    ds_read_b64_tr_b16 a[218:219], v0 offset:34592
    v_add_f32 v119, v119, v79
    v_accvgpr_read_b32 v9, a165
    v_mul_f32 v8, v8, v4
    v_mfma_f32_16x16x32_bf16 v[168:171], a[252:255], v[24:27], v[168:171]
    ds_read_b64_tr_b16 a[220:221], v0 offset:50976
    ds_read_b64_tr_b16 a[222:223], v0 offset:51488
    v_mfma_f32_16x16x32_bf16 v[168:171], a[248:251], v[32:35], v[168:171]
    s_waitcnt lgkmcnt(8)
    v_exp_f32 v76, v60
    v_mul_f32 v8, v8, v9
    v_cvt_pk_bf16_f32 v46, v7, v8
    v_mfma_f32_16x16x32_bf16 v[176:179], a[192:195], v[32:35], v[176:179]
    ds_read_b64_tr_b16 a[224:225], v0 offset:34112
    v_add_f32 v118, v118, v72
    v_mfma_f32_16x16x32_bf16 v[176:179], a[196:199], v[24:27], v[176:179]
    ds_read_b64_tr_b16 a[226:227], v0 offset:34624
    v_cvt_pk_bf16_f32 v18, v72, v73
    v_accvgpr_read_b32 v10, a110
    v_accvgpr_read_b32 v12, a166
    v_mfma_f32_16x16x32_bf16 v[180:183], a[196:199], v[28:31], v[180:183]
    ds_read_b64_tr_b16 a[228:229], v0 offset:51008
    ds_read_b64_tr_b16 a[230:231], v0 offset:51520
    v_mfma_f32_16x16x32_bf16 v[180:183], a[192:195], v[36:39], v[180:183]
    v_exp_f32 v77, v61
    v_mul_f32 v10, v10, v4
    v_accvgpr_read_b32 v11, a111
    v_mfma_f32_16x16x32_bf16 v[188:191], a[200:203], v[36:39], v[188:191]
    ds_read_b64_tr_b16 a[232:233], v0 offset:34144
    v_add_f32 v118, v118, v73
    v_mfma_f32_16x16x32_bf16 v[188:191], a[204:207], v[28:31], v[188:191]
    ds_read_b64_tr_b16 a[234:235], v0 offset:34656
    v_add_f32 v118, v118, v74
    v_mul_f32 v10, v10, v12
    v_accvgpr_read_b32 v12, a167
    v_mfma_f32_16x16x32_bf16 v[184:187], a[204:207], v[24:27], v[184:187]
    ds_read_b64_tr_b16 a[236:237], v0 offset:51040
    ds_read_b64_tr_b16 a[238:239], v0 offset:51552
    v_mfma_f32_16x16x32_bf16 v[184:187], a[200:203], v[32:35], v[184:187]
    s_waitcnt lgkmcnt(8)
    v_exp_f32 v78, v62
    v_mul_f32 v11, v11, v4
    v_mul_f32 v11, v11, v12
    v_mfma_f32_16x16x32_bf16 v[192:195], a[208:211], v[32:35], v[192:195]
    ds_read_b64_tr_b16 a[240:241], v0 offset:34176
    v_cvt_pk_bf16_f32 v19, v74, v75
    v_mfma_f32_16x16x32_bf16 v[192:195], a[212:215], v[24:27], v[192:195]
    ds_read_b64_tr_b16 a[242:243], v0 offset:34688
    v_add_f32 v118, v118, v75
    v_cvt_pk_bf16_f32 v47, v10, v11
    v_mfma_f32_16x16x32_bf16 v[196:199], a[212:215], v[28:31], v[196:199]
    ds_read_b64_tr_b16 a[244:245], v0 offset:51072
    ds_read_b64_tr_b16 a[246:247], v0 offset:51584
    v_mfma_f32_16x16x32_bf16 v[196:199], a[208:211], v[36:39], v[196:199]
    buffer_store_dwordx4 v[44:47], v6, s[32:35], s13 offen offset:2048 sc1
    v_exp_f32 v79, v63
    v_mfma_f32_16x16x32_bf16 v[204:207], a[216:219], v[36:39], v[204:207]
    ds_read_b64_tr_b16 a[248:249], v0 offset:34208
    v_add_f32 v119, v119, v68
    v_mfma_f32_16x16x32_bf16 v[204:207], a[220:223], v[28:31], v[204:207]
    ds_read_b64_tr_b16 a[250:251], v0 offset:34720
    v_add_f32 v119, v119, v69
    v_accvgpr_read_b32 v7, a112
    v_accvgpr_read_b32 v9, a168
    v_mfma_f32_16x16x32_bf16 v[200:203], a[220:223], v[24:27], v[200:203]
    ds_read_b64_tr_b16 a[252:253], v0 offset:51104
    ds_read_b64_tr_b16 a[254:255], v0 offset:51616
    v_mfma_f32_16x16x32_bf16 v[200:203], a[216:219], v[32:35], v[200:203]
    s_waitcnt lgkmcnt(8)
    v_exp_f32 v72, v56
    v_mul_f32 v7, v7, v3
    v_accvgpr_read_b32 v8, a113
    v_mfma_f32_16x16x32_bf16 v[208:211], a[224:227], v[32:35], v[208:211]
    ds_read_b64_tr_b16 a[192:193], v0 offset:34240
    v_add_f32 v119, v119, v70
    v_mfma_f32_16x16x32_bf16 v[208:211], a[228:231], v[24:27], v[208:211]
    ds_read_b64_tr_b16 a[194:195], v0 offset:34752
    v_add_f32 v119, v119, v71
    v_mul_f32 v7, v7, v9
    v_accvgpr_read_b32 v9, a169
    v_mfma_f32_16x16x32_bf16 v[212:215], a[228:231], v[28:31], v[212:215]
    ds_read_b64_tr_b16 a[196:197], v0 offset:51136
    ds_read_b64_tr_b16 a[198:199], v0 offset:51648
    v_mfma_f32_16x16x32_bf16 v[212:215], a[224:227], v[36:39], v[212:215]
    v_exp_f32 v73, v57
    v_mul_f32 v8, v8, v3
    v_mul_f32 v8, v8, v9
    v_mfma_f32_16x16x32_bf16 v[220:223], a[232:235], v[36:39], v[220:223]
    ds_read_b64_tr_b16 a[200:201], v0 offset:34272
    v_add_f32 v118, v118, v64
    v_mfma_f32_16x16x32_bf16 v[220:223], a[236:239], v[28:31], v[220:223]
    ds_read_b64_tr_b16 a[202:203], v0 offset:34784
    v_add_f32 v118, v118, v65
    v_cvt_pk_bf16_f32 v108, v7, v8
    v_accvgpr_read_b32 v10, a114
    v_mfma_f32_16x16x32_bf16 v[216:219], a[236:239], v[24:27], v[216:219]
    ds_read_b64_tr_b16 a[204:205], v0 offset:51168
    ds_read_b64_tr_b16 a[206:207], v0 offset:51680
    v_mfma_f32_16x16x32_bf16 v[216:219], a[232:235], v[32:35], v[216:219]
    s_waitcnt vmcnt(10) lgkmcnt(8)
    s_barrier
    v_add_f32 v118, v118, v66
    v_accvgpr_read_b32 v12, a170
    v_mul_f32 v10, v10, v3
    v_mfma_f32_16x16x32_bf16 v[224:227], a[240:243], v[32:35], v[224:227]
    ds_read_b128 a[208:211], v1 offset:33792
    v_add_f32 v118, v118, v67
    v_mfma_f32_16x16x32_bf16 v[224:227], a[244:247], v[24:27], v[224:227]
    buffer_load_dwordx4 v114, s[20:23], s49 offen offset:0 lds
    v_accvgpr_read_b32 v11, a115
    v_mul_f32 v10, v10, v12
    v_mfma_f32_16x16x32_bf16 v[228:231], a[244:247], v[28:31], v[228:231]
    ds_read_b128 a[212:215], v1 offset:33856
    v_add_f32 v119, v119, v76
    v_mfma_f32_16x16x32_bf16 v[228:231], a[240:243], v[36:39], v[228:231]
    v_exp_f32 v74, v58
    v_accvgpr_read_b32 v12, a171
    v_mul_f32 v11, v11, v3
    v_mfma_f32_16x16x32_bf16 v[236:239], a[248:251], v[36:39], v[236:239]
    ds_read_b128 a[216:219], v1 offset:33920
    v_add_f32 v119, v119, v77
    v_mfma_f32_16x16x32_bf16 v[236:239], a[252:255], v[28:31], v[236:239]
    buffer_load_dwordx4 v112, s[20:23], s49 offen offset:1056 lds
    v_mul_f32 v11, v11, v12
    v_cvt_pk_bf16_f32 v109, v10, v11
    v_mfma_f32_16x16x32_bf16 v[232:235], a[252:255], v[24:27], v[232:235]
    ds_read_b128 a[220:223], v1 offset:33984
    v_add_f32 v119, v119, v78
    v_mfma_f32_16x16x32_bf16 v[232:235], a[248:251], v[32:35], v[232:235]
    s_waitcnt lgkmcnt(4)
    buffer_store_dwordx2 v[108:109], v6, s[32:35], s14 offen offset:3072 sc1
    v_exp_f32 v75, v59
    v_mfma_f32_16x16x32_bf16 v[240:243], a[192:195], v[32:35], v[240:243]
    ds_read_b128 a[224:227], v1 offset:34048
    v_add_f32 v119, v119, v79
    v_mfma_f32_16x16x32_bf16 v[240:243], a[196:199], v[24:27], v[240:243]
    buffer_load_dwordx4 v121, s[20:23], s49 offen offset:2112 lds
    v_accvgpr_read_b32 v7, a116
    v_accvgpr_read_b32 v9, a172
    v_mfma_f32_16x16x32_bf16 v[244:247], a[196:199], v[28:31], v[244:247]
    ds_read_b128 a[228:231], v1 offset:34112
    v_add_f32 v118, v118, v72
    v_mfma_f32_16x16x32_bf16 v[244:247], a[192:195], v[36:39], v[244:247]
    v_add_f32 v118, v118, v73
    v_add_f32 v118, v118, v75
    v_mul_f32 v7, v7, v4
    v_accvgpr_read_b32 v8, a117
    v_mfma_f32_16x16x32_bf16 v[252:255], a[200:203], v[36:39], v[252:255]
    ds_read_b128 a[232:235], v1 offset:34176
    v_add_f32 v118, v118, v74
    v_mfma_f32_16x16x32_bf16 v[252:255], a[204:207], v[28:31], v[252:255]
    buffer_load_dwordx4 v122, s[20:23], s49 offen offset:3168 lds
    s_add_u32 m0, s37, 84480
    v_add_f32 v120, v118, v119
    v_mfma_f32_16x16x32_bf16 v[248:251], a[204:207], v[24:27], v[248:251]
    s_add_u32 s49, s49, 16384
    ds_read_b128 a[236:239], v1 offset:34240
    v_cmp_nge_f32 vcc, s40, v120
    v_mfma_f32_16x16x32_bf16 v[248:251], a[200:203], v[32:35], v[248:251]
    s_waitcnt lgkmcnt(4)
    s_cbranch_vccnz slow_t5
back_t5:
    v_add_f32 v116, v116, v118
    v_mul_f32 v7, v7, v9
    v_accvgpr_read_b32 v9, a173
    v_mfma_f32_16x16x32_bf16 v[80:83], a[208:211], a[0:3], v[96:99]
    ds_read_b128 a[240:243], v1 offset:34304
    v_add_f32 v117, v117, v119
    v_mfma_f32_16x16x32_bf16 v[80:83], a[212:215], a[4:7], v[80:83]
    buffer_load_dwordx4 v114, s[20:23], s49 offen offset:0 lds
    v_mul_f32 v8, v8, v4
    v_mul_f32 v8, v8, v9
    v_mfma_f32_16x16x32_bf16 v[84:87], a[212:215], a[36:39], v[100:103]
    ds_read_b128 a[244:247], v1 offset:34368
    v_cvt_pk_bf16_f32 v24, v64, v65
    v_mfma_f32_16x16x32_bf16 v[84:87], a[208:211], a[32:35], v[84:87]
    v_cvt_pk_bf16_f32 v25, v66, v67
    v_mfma_f32_16x16x32_bf16 v[84:87], a[216:219], a[40:43], v[84:87]
    ds_read_b128 a[248:251], v1 offset:34432
    v_cvt_pk_bf16_f32 v28, v68, v69
    v_mfma_f32_16x16x32_bf16 v[84:87], a[220:223], a[44:47], v[84:87]
    buffer_load_dwordx4 v112, s[20:23], s49 offen offset:1056 lds
    v_cvt_pk_bf16_f32 v124, v7, v8
    v_accvgpr_read_b32 v10, a118
    v_mfma_f32_16x16x32_bf16 v[80:83], a[220:223], a[12:15], v[80:83]
    ds_read_b128 a[252:255], v1 offset:34496
    v_cvt_pk_bf16_f32 v29, v70, v71
    v_mfma_f32_16x16x32_bf16 v[80:83], a[216:219], a[8:11], v[80:83]
    s_waitcnt lgkmcnt(4)
    v_cvt_pk_bf16_f32 v26, v72, v73
    v_mfma_f32_16x16x32_bf16 v[80:83], a[224:227], a[16:19], v[80:83]
    ds_read_b128 a[192:195], v1 offset:34560
    v_cvt_pk_bf16_f32 v27, v74, v75
    v_mfma_f32_16x16x32_bf16 v[80:83], a[228:231], a[20:23], v[80:83]
    buffer_load_dwordx4 v121, s[20:23], s49 offen offset:2112 lds
    v_accvgpr_read_b32 v12, a174
    v_mul_f32 v10, v10, v4
    v_mfma_f32_16x16x32_bf16 v[84:87], a[228:231], a[52:55], v[84:87]
    ds_read_b128 a[196:199], v1 offset:34624
    v_cvt_pk_bf16_f32 v30, v76, v77
    v_mfma_f32_16x16x32_bf16 v[84:87], a[224:227], a[48:51], v[84:87]
    v_cvt_pk_bf16_f32 v31, v78, v79
    v_mfma_f32_16x16x32_bf16 v[84:87], a[232:235], a[56:59], v[84:87]
    ds_read_b128 a[200:203], v1 offset:34688
    v_accvgpr_read_b32 v11, a119
    v_mfma_f32_16x16x32_bf16 v[84:87], a[236:239], a[60:63], v[84:87]
    buffer_load_dwordx4 v122, s[20:23], s49 offen offset:3168 lds
    s_add_u32 m0, s37, 33792
    v_mul_f32 v10, v10, v12
    v_mfma_f32_16x16x32_bf16 v[80:83], a[236:239], a[28:31], v[80:83]
    s_add_u32 s49, s49, 16384
    ds_read_b128 a[204:207], v1 offset:34752
    v_mfma_f32_16x16x32_bf16 v[80:83], a[232:235], a[24:27], v[80:83]
    s_waitcnt lgkmcnt(4)
    v_accvgpr_read_b32 v12, a175
    v_mul_f32 v11, v11, v4
    v_mul_f32 v11, v11, v12
    v_cvt_pk_bf16_f32 v125, v10, v11
    v_mfma_f32_16x16x32_bf16 v[88:91], a[240:243], a[0:3], v[96:99]
    ds_read_b128 a[208:211], v1 offset:50688
    buffer_store_dwordx2 v[124:125], v6, s[32:35], s15 offen offset:3072 sc1
    v_mfma_f32_16x16x32_bf16 v[88:91], a[244:247], a[4:7], v[88:91]
    v_accvgpr_read_b32 v7, a180
    v_accvgpr_read_b32 v8, a181
    v_accvgpr_read_b32 v9, a182
    v_mfma_f32_16x16x32_bf16 v[92:95], a[244:247], a[36:39], v[100:103]
    ds_read_b128 a[212:215], v1 offset:50752
    v_mfma_f32_16x16x32_bf16 v[92:95], a[240:243], a[32:35], v[92:95]
    v_exp_f32 v68, v84
    v_mfma_f32_16x16x32_bf16 v[92:95], a[248:251], a[40:43], v[92:95]
    ds_read_b128 a[216:219], v1 offset:50816
    v_mfma_f32_16x16x32_bf16 v[92:95], a[252:255], a[44:47], v[92:95]
    v_exp_f32 v69, v85
    v_mfma_f32_16x16x32_bf16 v[88:91], a[252:255], a[12:15], v[88:91]
    ds_read_b128 a[220:223], v1 offset:50880
    v_add_f32 v119, v68, v69
    v_mfma_f32_16x16x32_bf16 v[88:91], a[248:251], a[8:11], v[88:91]
    s_waitcnt lgkmcnt(4)
    v_exp_f32 v70, v86
    v_mfma_f32_16x16x32_bf16 v[88:91], a[192:195], a[16:19], v[88:91]
    ds_read_b128 a[224:227], v1 offset:50944
    v_cvt_pk_bf16_f32 v36, v68, v69
    v_mfma_f32_16x16x32_bf16 v[88:91], a[196:199], a[20:23], v[88:91]
    v_exp_f32 v71, v87
    v_cmp_gt_u32 vcc, 16, v15
    v_mfma_f32_16x16x32_bf16 v[92:95], a[196:199], a[52:55], v[92:95]
    ds_read_b128 a[228:231], v1 offset:51008
    v_add_f32 v119, v119, v70
    v_mfma_f32_16x16x32_bf16 v[92:95], a[192:195], a[48:51], v[92:95]
    s_cbranch_vccnz spin_c
ok_c:
    v_exp_f32 v64, v80
    v_mfma_f32_16x16x32_bf16 v[92:95], a[200:203], a[56:59], v[92:95]
    ds_read_b128 a[232:235], v1 offset:51072
    v_cvt_pk_bf16_f32 v37, v70, v71
    v_mfma_f32_16x16x32_bf16 v[92:95], a[204:207], a[60:63], v[92:95]
    v_exp_f32 v65, v81
    v_mov_b32 v5, 1
    v_mfma_f32_16x16x32_bf16 v[88:91], a[204:207], a[28:31], v[88:91]
    ds_read_b128 a[236:239], v1 offset:51136
    v_add_f32 v119, v119, v71
    v_mfma_f32_16x16x32_bf16 v[88:91], a[200:203], a[24:27], v[88:91]
    s_waitcnt lgkmcnt(4)
    v_exp_f32 v66, v82
    v_mfma_f32_16x16x32_bf16 v[48:51], a[208:211], a[0:3], v[96:99]
    ds_read_b128 a[240:243], v1 offset:51200
    v_add_f32 v118, v64, v65
    v_mfma_f32_16x16x32_bf16 v[48:51], a[212:215], a[4:7], v[48:51]
    v_exp_f32 v67, v83
    v_mfma_f32_16x16x32_bf16 v[52:55], a[212:215], a[36:39], v[100:103]
    ds_read_b128 a[244:247], v1 offset:51264
    v_cvt_pk_bf16_f32 v32, v64, v65
    v_mfma_f32_16x16x32_bf16 v[52:55], a[208:211], a[32:35], v[52:55]
    v_exp_f32 v76, v92
    v_mfma_f32_16x16x32_bf16 v[52:55], a[216:219], a[40:43], v[52:55]
    ds_read_b128 a[248:251], v1 offset:51328
    v_add_f32 v118, v118, v66
    v_mfma_f32_16x16x32_bf16 v[52:55], a[220:223], a[44:47], v[52:55]
    v_exp_f32 v77, v93
    v_mfma_f32_16x16x32_bf16 v[48:51], a[220:223], a[12:15], v[48:51]
    ds_read_b128 a[252:255], v1 offset:51392
    v_cvt_pk_bf16_f32 v33, v66, v67
    v_mfma_f32_16x16x32_bf16 v[48:51], a[216:219], a[8:11], v[48:51]
    s_waitcnt lgkmcnt(4)
    v_exp_f32 v78, v94
    v_mfma_f32_16x16x32_bf16 v[48:51], a[224:227], a[16:19], v[48:51]
    ds_read_b128 a[192:195], v1 offset:51456
    v_add_f32 v118, v118, v67
    v_mfma_f32_16x16x32_bf16 v[48:51], a[228:231], a[20:23], v[48:51]
    v_exp_f32 v79, v95
    v_mfma_f32_16x16x32_bf16 v[52:55], a[228:231], a[52:55], v[52:55]
    ds_read_b128 a[196:199], v1 offset:51520
    v_add_f32 v119, v119, v76
    v_mfma_f32_16x16x32_bf16 v[52:55], a[224:227], a[48:51], v[52:55]
    v_exp_f32 v72, v88
    v_mfma_f32_16x16x32_bf16 v[52:55], a[232:235], a[56:59], v[52:55]
    ds_read_b128 a[200:203], v1 offset:51584
    v_cvt_pk_bf16_f32 v38, v76, v77
    v_mfma_f32_16x16x32_bf16 v[52:55], a[236:239], a[60:63], v[52:55]
    v_exp_f32 v73, v89
    v_mfma_f32_16x16x32_bf16 v[48:51], a[236:239], a[28:31], v[48:51]
    ds_read_b128 a[204:207], v1 offset:51648
    v_add_f32 v119, v119, v77
    v_mfma_f32_16x16x32_bf16 v[48:51], a[232:235], a[24:27], v[48:51]
    s_waitcnt vmcnt(11) lgkmcnt(4)
    s_barrier
    v_add_f32 v119, v119, v78
    v_mfma_f32_16x16x32_bf16 v[56:59], a[240:243], a[0:3], v[96:99]
    ds_read_b64_tr_b16 a[208:209], v0 offset:0
    ds_read_b64_tr_b16 a[210:211], v0 offset:512
    v_mfma_f32_16x16x32_bf16 v[56:59], a[244:247], a[4:7], v[56:59]
    v_exp_f32 v74, v90
    v_mfma_f32_16x16x32_bf16 v[60:63], a[244:247], a[36:39], v[100:103]
    ds_read_b64_tr_b16 a[212:213], v0 offset:16896
    ds_read_b64_tr_b16 a[214:215], v0 offset:17408
    v_mfma_f32_16x16x32_bf16 v[60:63], a[240:243], a[32:35], v[60:63]
    v_exp_f32 v75, v91
    v_mfma_f32_16x16x32_bf16 v[60:63], a[248:251], a[40:43], v[60:63]
    ds_read_b64_tr_b16 a[216:217], v0 offset:32
    ds_read_b64_tr_b16 a[218:219], v0 offset:544
    v_mfma_f32_16x16x32_bf16 v[60:63], a[252:255], a[44:47], v[60:63]
    buffer_load_dwordx4 v114, s[24:27], s38 offen offset:0 lds
    v_mfma_f32_16x16x32_bf16 v[56:59], a[252:255], a[12:15], v[56:59]
    ds_read_b64_tr_b16 a[220:221], v0 offset:16928
    ds_read_b64_tr_b16 a[222:223], v0 offset:17440
    v_mfma_f32_16x16x32_bf16 v[56:59], a[248:251], a[8:11], v[56:59]
    s_waitcnt lgkmcnt(8)
    v_exp_f32 v68, v52
    v_mfma_f32_16x16x32_bf16 v[56:59], a[192:195], a[16:19], v[56:59]
    ds_read_b64_tr_b16 a[224:225], v0 offset:64
    ds_read_b64_tr_b16 a[226:227], v0 offset:576
    v_mfma_f32_16x16x32_bf16 v[56:59], a[196:199], a[20:23], v[56:59]
    buffer_load_dwordx4 v112, s[24:27], s38 offen offset:1056 lds
    v_mfma_f32_16x16x32_bf16 v[60:63], a[196:199], a[52:55], v[60:63]
    ds_read_b64_tr_b16 a[228:229], v0 offset:16960
    ds_read_b64_tr_b16 a[230:231], v0 offset:17472
    v_mfma_f32_16x16x32_bf16 v[60:63], a[192:195], a[48:51], v[60:63]
    v_exp_f32 v69, v53
    v_mfma_f32_16x16x32_bf16 v[60:63], a[200:203], a[56:59], v[60:63]
    ds_read_b64_tr_b16 a[232:233], v0 offset:96
    ds_read_b64_tr_b16 a[234:235], v0 offset:608
    v_mfma_f32_16x16x32_bf16 v[60:63], a[204:207], a[60:63], v[60:63]
    buffer_load_dwordx4 v121, s[24:27], s38 offen offset:2112 lds
    v_mfma_f32_16x16x32_bf16 v[56:59], a[204:207], a[28:31], v[56:59]
    ds_read_b64_tr_b16 a[236:237], v0 offset:16992
    ds_read_b64_tr_b16 a[238:239], v0 offset:17504
    v_mfma_f32_16x16x32_bf16 v[56:59], a[200:203], a[24:27], v[56:59]
    s_waitcnt lgkmcnt(8)
    v_exp_f32 v70, v54
    v_mfma_f32_16x16x32_bf16 v[128:131], a[208:211], v[16:19], v[128:131]
    ds_read_b64_tr_b16 a[240:241], v0 offset:128
    ds_read_b64_tr_b16 a[242:243], v0 offset:640
    v_mfma_f32_16x16x32_bf16 v[128:131], a[212:215], v[24:27], v[128:131]
    buffer_load_dwordx4 v122, s[24:27], s38 offen offset:3168 lds
    s_add_u32 m0, s37, 50688
    v_mfma_f32_16x16x32_bf16 v[132:135], a[212:215], v[28:31], v[132:135]
    ds_read_b64_tr_b16 a[244:245], v0 offset:17024
    ds_read_b64_tr_b16 a[246:247], v0 offset:17536
    v_mfma_f32_16x16x32_bf16 v[132:135], a[208:211], v[20:23], v[132:135]
    s_add_u32 s38, s38, 16384
    v_exp_f32 v71, v55
    v_mfma_f32_16x16x32_bf16 v[140:143], a[216:219], v[20:23], v[140:143]
    ds_read_b64_tr_b16 a[248:249], v0 offset:160
    ds_read_b64_tr_b16 a[250:251], v0 offset:672
    v_mfma_f32_16x16x32_bf16 v[140:143], a[220:223], v[28:31], v[140:143]
    buffer_load_dwordx4 v114, s[24:27], s38 offen offset:0 lds
    v_mfma_f32_16x16x32_bf16 v[136:139], a[220:223], v[24:27], v[136:139]
    ds_read_b64_tr_b16 a[252:253], v0 offset:17056
    ds_read_b64_tr_b16 a[254:255], v0 offset:17568
    v_mfma_f32_16x16x32_bf16 v[136:139], a[216:219], v[16:19], v[136:139]
    s_waitcnt lgkmcnt(8)
    v_exp_f32 v64, v48
    v_mfma_f32_16x16x32_bf16 v[144:147], a[224:227], v[16:19], v[144:147]
    ds_read_b64_tr_b16 a[192:193], v0 offset:192
    ds_read_b64_tr_b16 a[194:195], v0 offset:704
    v_mfma_f32_16x16x32_bf16 v[144:147], a[228:231], v[24:27], v[144:147]
    buffer_load_dwordx4 v112, s[24:27], s38 offen offset:1056 lds
    v_mfma_f32_16x16x32_bf16 v[148:151], a[228:231], v[28:31], v[148:151]
    ds_read_b64_tr_b16 a[196:197], v0 offset:17088
    ds_read_b64_tr_b16 a[198:199], v0 offset:17600
    v_mfma_f32_16x16x32_bf16 v[148:151], a[224:227], v[20:23], v[148:151]
    v_exp_f32 v65, v49
    v_mfma_f32_16x16x32_bf16 v[156:159], a[232:235], v[20:23], v[156:159]
    ds_read_b64_tr_b16 a[200:201], v0 offset:224
    ds_read_b64_tr_b16 a[202:203], v0 offset:736
    v_mfma_f32_16x16x32_bf16 v[156:159], a[236:239], v[28:31], v[156:159]
    buffer_load_dwordx4 v121, s[24:27], s38 offen offset:2112 lds
    v_mfma_f32_16x16x32_bf16 v[152:155], a[236:239], v[24:27], v[152:155]
    ds_read_b64_tr_b16 a[204:205], v0 offset:17120
    ds_read_b64_tr_b16 a[206:207], v0 offset:17632
    v_mfma_f32_16x16x32_bf16 v[152:155], a[232:235], v[16:19], v[152:155]
    s_waitcnt lgkmcnt(8)
    v_exp_f32 v66, v50
    v_mfma_f32_16x16x32_bf16 v[160:163], a[240:243], v[16:19], v[160:163]
    ds_read_b64_tr_b16 a[208:209], v0 offset:256
    ds_read_b64_tr_b16 a[210:211], v0 offset:768
    v_mfma_f32_16x16x32_bf16 v[160:163], a[244:247], v[24:27], v[160:163]
    buffer_load_dwordx4 v122, s[24:27], s38 offen offset:3168 lds
    s_add_u32 m0, s37, 101376
    v_mfma_f32_16x16x32_bf16 v[164:167], a[244:247], v[28:31], v[164:167]
    ds_read_b64_tr_b16 a[212:213], v0 offset:17152
    ds_read_b64_tr_b16 a[214:215], v0 offset:17664
    v_mfma_f32_16x16x32_bf16 v[164:167], a[240:243], v[20:23], v[164:167]
    s_add_u32 s38, s38, 16384
    v_exp_f32 v67, v51
    v_mfma_f32_16x16x32_bf16 v[172:175], a[248:251], v[20:23], v[172:175]
    ds_read_b64_tr_b16 a[216:217], v0 offset:288
    v_cvt_pk_bf16_f32 v39, v78, v79
    v_mfma_f32_16x16x32_bf16 v[172:175], a[252:255], v[28:31], v[172:175]
    ds_read_b64_tr_b16 a[218:219], v0 offset:800
    v_add_f32 v119, v119, v79
    v_mfma_f32_16x16x32_bf16 v[168:171], a[252:255], v[24:27], v[168:171]
    ds_read_b64_tr_b16 a[220:221], v0 offset:17184
    ds_read_b64_tr_b16 a[222:223], v0 offset:17696
    v_mfma_f32_16x16x32_bf16 v[168:171], a[248:251], v[16:19], v[168:171]
    s_waitcnt lgkmcnt(8)
    v_exp_f32 v76, v60
    v_mfma_f32_16x16x32_bf16 v[176:179], a[192:195], v[16:19], v[176:179]
    ds_read_b64_tr_b16 a[224:225], v0 offset:320
    v_add_f32 v118, v118, v72
    v_mfma_f32_16x16x32_bf16 v[176:179], a[196:199], v[24:27], v[176:179]
    ds_read_b64_tr_b16 a[226:227], v0 offset:832
    v_cvt_pk_bf16_f32 v34, v72, v73
    v_mfma_f32_16x16x32_bf16 v[180:183], a[196:199], v[28:31], v[180:183]
    ds_read_b64_tr_b16 a[228:229], v0 offset:17216
    ds_read_b64_tr_b16 a[230:231], v0 offset:17728
    v_mfma_f32_16x16x32_bf16 v[180:183], a[192:195], v[20:23], v[180:183]
    v_exp_f32 v77, v61
    v_mfma_f32_16x16x32_bf16 v[188:191], a[200:203], v[20:23], v[188:191]
    ds_read_b64_tr_b16 a[232:233], v0 offset:352
    v_add_f32 v118, v118, v73
    v_mfma_f32_16x16x32_bf16 v[188:191], a[204:207], v[28:31], v[188:191]
    ds_read_b64_tr_b16 a[234:235], v0 offset:864
    v_add_f32 v118, v118, v74
    v_mfma_f32_16x16x32_bf16 v[184:187], a[204:207], v[24:27], v[184:187]
    ds_read_b64_tr_b16 a[236:237], v0 offset:17248
    ds_read_b64_tr_b16 a[238:239], v0 offset:17760
    v_mfma_f32_16x16x32_bf16 v[184:187], a[200:203], v[16:19], v[184:187]
    s_waitcnt lgkmcnt(8)
    v_exp_f32 v78, v62
    v_mfma_f32_16x16x32_bf16 v[192:195], a[208:211], v[16:19], v[192:195]
    ds_read_b64_tr_b16 a[240:241], v0 offset:384
    v_cvt_pk_bf16_f32 v35, v74, v75
    v_mfma_f32_16x16x32_bf16 v[192:195], a[212:215], v[24:27], v[192:195]
    ds_read_b64_tr_b16 a[242:243], v0 offset:896
    v_add_f32 v118, v118, v75
    v_mfma_f32_16x16x32_bf16 v[196:199], a[212:215], v[28:31], v[196:199]
    ds_read_b64_tr_b16 a[244:245], v0 offset:17280
    ds_read_b64_tr_b16 a[246:247], v0 offset:17792
    v_mfma_f32_16x16x32_bf16 v[196:199], a[208:211], v[20:23], v[196:199]
    v_exp_f32 v79, v63
    v_mfma_f32_16x16x32_bf16 v[204:207], a[216:219], v[20:23], v[204:207]
    ds_read_b64_tr_b16 a[248:249], v0 offset:416
    v_add_f32 v119, v119, v68
    v_mfma_f32_16x16x32_bf16 v[204:207], a[220:223], v[28:31], v[204:207]
    ds_read_b64_tr_b16 a[250:251], v0 offset:928
    v_add_f32 v119, v119, v69
    v_mfma_f32_16x16x32_bf16 v[200:203], a[220:223], v[24:27], v[200:203]
    ds_read_b64_tr_b16 a[252:253], v0 offset:17312
    ds_read_b64_tr_b16 a[254:255], v0 offset:17824
    v_mfma_f32_16x16x32_bf16 v[200:203], a[216:219], v[16:19], v[200:203]
    s_waitcnt lgkmcnt(8)
    v_exp_f32 v72, v56
    v_mfma_f32_16x16x32_bf16 v[208:211], a[224:227], v[16:19], v[208:211]
    ds_read_b64_tr_b16 a[192:193], v0 offset:448
    v_add_f32 v119, v119, v70
    v_mfma_f32_16x16x32_bf16 v[208:211], a[228:231], v[24:27], v[208:211]
    ds_read_b64_tr_b16 a[194:195], v0 offset:960
    v_add_f32 v119, v119, v71
    v_mfma_f32_16x16x32_bf16 v[212:215], a[228:231], v[28:31], v[212:215]
    ds_read_b64_tr_b16 a[196:197], v0 offset:17344
    ds_read_b64_tr_b16 a[198:199], v0 offset:17856
    v_mfma_f32_16x16x32_bf16 v[212:215], a[224:227], v[20:23], v[212:215]
    v_exp_f32 v73, v57
    v_mfma_f32_16x16x32_bf16 v[220:223], a[232:235], v[20:23], v[220:223]
    ds_read_b64_tr_b16 a[200:201], v0 offset:480
    v_add_f32 v118, v118, v64
    v_mfma_f32_16x16x32_bf16 v[220:223], a[236:239], v[28:31], v[220:223]
    ds_read_b64_tr_b16 a[202:203], v0 offset:992
    v_add_f32 v118, v118, v65
    v_mfma_f32_16x16x32_bf16 v[216:219], a[236:239], v[24:27], v[216:219]
    ds_read_b64_tr_b16 a[204:205], v0 offset:17376
    ds_read_b64_tr_b16 a[206:207], v0 offset:17888
    v_mfma_f32_16x16x32_bf16 v[216:219], a[232:235], v[16:19], v[216:219]
    s_waitcnt vmcnt(9) lgkmcnt(8)
    s_barrier
    v_add_f32 v118, v118, v66
    v_mfma_f32_16x16x32_bf16 v[224:227], a[240:243], v[16:19], v[224:227]
    ds_read_b128 a[208:211], v1 offset:0
    v_add_f32 v118, v118, v67
    v_mfma_f32_16x16x32_bf16 v[224:227], a[244:247], v[24:27], v[224:227]
    buffer_load_dwordx4 v114, s[20:23], s49 offen offset:0 lds
    v_mfma_f32_16x16x32_bf16 v[228:231], a[244:247], v[28:31], v[228:231]
    ds_read_b128 a[212:215], v1 offset:64
    v_add_f32 v119, v119, v76
    v_mfma_f32_16x16x32_bf16 v[228:231], a[240:243], v[20:23], v[228:231]
    v_exp_f32 v74, v58
    v_mfma_f32_16x16x32_bf16 v[236:239], a[248:251], v[20:23], v[236:239]
    ds_read_b128 a[216:219], v1 offset:128
    v_add_f32 v119, v119, v77
    v_mfma_f32_16x16x32_bf16 v[236:239], a[252:255], v[28:31], v[236:239]
    buffer_load_dwordx4 v112, s[20:23], s49 offen offset:1056 lds
    v_mfma_f32_16x16x32_bf16 v[232:235], a[252:255], v[24:27], v[232:235]
    ds_read_b128 a[220:223], v1 offset:192
    v_add_f32 v119, v119, v78
    v_mfma_f32_16x16x32_bf16 v[232:235], a[248:251], v[16:19], v[232:235]
    s_waitcnt lgkmcnt(4)
    v_exp_f32 v75, v59
    v_mfma_f32_16x16x32_bf16 v[240:243], a[192:195], v[16:19], v[240:243]
    ds_read_b128 a[224:227], v1 offset:256
    v_add_f32 v119, v119, v79
    v_lshlrev_b32 v40, 7, v13
    s_lshl2_add_u32 s93, s60, s36
    s_mul_i32 s93, s93, 3584
    v_cmp_gt_u32 vcc, 5, v13
    v_mov_b32 v41, 0x80000000
    s_nop 0
    v_cndmask_b32 v41, v41, v40, vcc
    s_lshl2_add_u32 s94, s2, s36
    s_mul_i32 s94, s94, 1568
    v_cmp_gt_u32 vcc, 3, v13
    v_mov_b32 v42, 0x80000000
    s_nop 0
    v_cndmask_b32 v42, v42, v40, vcc
    v_cmp_gt_u32 vcc, 10, v13
    v_mov_b32 v43, 0x80000000
    s_nop 0
    v_cndmask_b32 v43, v43, v40, vcc
    v_mfma_f32_16x16x32_bf16 v[240:243], a[196:199], v[24:27], v[240:243]
    buffer_load_dwordx4 v121, s[20:23], s49 offen offset:2112 lds
    v_mfma_f32_16x16x32_bf16 v[244:247], a[196:199], v[28:31], v[244:247]
    ds_read_b128 a[228:231], v1 offset:320
    v_add_f32 v118, v118, v72
    v_mfma_f32_16x16x32_bf16 v[244:247], a[192:195], v[20:23], v[244:247]
    v_add_f32 v118, v118, v73
    v_add_f32 v118, v118, v75
    v_mfma_f32_16x16x32_bf16 v[252:255], a[200:203], v[20:23], v[252:255]
    ds_read_b128 a[232:235], v1 offset:384
    v_add_f32 v118, v118, v74
    v_mfma_f32_16x16x32_bf16 v[252:255], a[204:207], v[28:31], v[252:255]
    buffer_load_dwordx4 v122, s[20:23], s49 offen offset:3168 lds
    s_add_u32 m0, s37, 118272
    v_add_f32 v120, v118, v119
    v_mfma_f32_16x16x32_bf16 v[248:251], a[204:207], v[24:27], v[248:251]
    s_add_u32 s49, s49, 16384
    ds_read_b128 a[236:239], v1 offset:448
    v_cmp_nge_f32 vcc, s40, v120
    v_mfma_f32_16x16x32_bf16 v[248:251], a[200:203], v[16:19], v[248:251]
    s_waitcnt lgkmcnt(4)
    s_cbranch_vccnz slow_t7
back_t7:
    v_add_f32 v116, v116, v118
    s_mov_b32 s39, 6
.p2align 6
loop0:
    v_mfma_f32_16x16x32_bf16 v[80:83], a[208:211], a[0:3], v[96:99]
    ds_read_b128 a[240:243], v1 offset:512
    v_add_f32 v117, v117, v119
    v_mfma_f32_16x16x32_bf16 v[80:83], a[212:215], a[4:7], v[80:83]
    buffer_load_dwordx4 v114, s[20:23], s49 offen offset:0 lds
    v_mfma_f32_16x16x32_bf16 v[84:87], a[212:215], a[36:39], v[100:103]
    ds_read_b128 a[244:247], v1 offset:576
    v_cvt_pk_bf16_f32 v24, v64, v65
    v_mfma_f32_16x16x32_bf16 v[84:87], a[208:211], a[32:35], v[84:87]
    v_cvt_pk_bf16_f32 v25, v66, v67
    v_mfma_f32_16x16x32_bf16 v[84:87], a[216:219], a[40:43], v[84:87]
    ds_read_b128 a[248:251], v1 offset:640
    v_cvt_pk_bf16_f32 v28, v68, v69
    v_mfma_f32_16x16x32_bf16 v[84:87], a[220:223], a[44:47], v[84:87]
    buffer_load_dwordx4 v112, s[20:23], s49 offen offset:1056 lds
    v_mfma_f32_16x16x32_bf16 v[80:83], a[220:223], a[12:15], v[80:83]
    ds_read_b128 a[252:255], v1 offset:704
    v_cvt_pk_bf16_f32 v29, v70, v71
    v_mfma_f32_16x16x32_bf16 v[80:83], a[216:219], a[8:11], v[80:83]
    s_waitcnt lgkmcnt(4)
    v_cvt_pk_bf16_f32 v26, v72, v73
    v_mfma_f32_16x16x32_bf16 v[80:83], a[224:227], a[16:19], v[80:83]
    ds_read_b128 a[192:195], v1 offset:768
    v_cvt_pk_bf16_f32 v27, v74, v75
    v_mfma_f32_16x16x32_bf16 v[80:83], a[228:231], a[20:23], v[80:83]
    buffer_load_dwordx4 v121, s[20:23], s49 offen offset:2112 lds
    v_mfma_f32_16x16x32_bf16 v[84:87], a[228:231], a[52:55], v[84:87]
    ds_read_b128 a[196:199], v1 offset:832
    v_cvt_pk_bf16_f32 v30, v76, v77
    v_mfma_f32_16x16x32_bf16 v[84:87], a[224:227], a[48:51], v[84:87]
    v_cvt_pk_bf16_f32 v31, v78, v79
    v_mfma_f32_16x16x32_bf16 v[84:87], a[232:235], a[56:59], v[84:87]
    ds_read_b128 a[200:203], v1 offset:896
    v_mfma_f32_16x16x32_bf16 v[84:87], a[236:239], a[60:63], v[84:87]
    buffer_load_dwordx4 v122, s[20:23], s49 offen offset:3168 lds
    s_add_u32 m0, s37, 0
    v_mfma_f32_16x16x32_bf16 v[80:83], a[236:239], a[28:31], v[80:83]
    s_add_u32 s49, s49, 16384
    ds_read_b128 a[204:207], v1 offset:960
    v_mfma_f32_16x16x32_bf16 v[80:83], a[232:235], a[24:27], v[80:83]
    s_waitcnt lgkmcnt(4)
    v_mfma_f32_16x16x32_bf16 v[88:91], a[240:243], a[0:3], v[96:99]
    ds_read_b128 a[208:211], v1 offset:16896
    v_mfma_f32_16x16x32_bf16 v[88:91], a[244:247], a[4:7], v[88:91]
    buffer_load_dword v46, v41, s[28:31], s93 offen
    v_mfma_f32_16x16x32_bf16 v[92:95], a[244:247], a[36:39], v[100:103]
    s_add_u32 s93, s93, 640
    ds_read_b128 a[212:215], v1 offset:16960
    v_mfma_f32_16x16x32_bf16 v[92:95], a[240:243], a[32:35], v[92:95]
    v_exp_f32 v68, v84
    v_mfma_f32_16x16x32_bf16 v[92:95], a[248:251], a[40:43], v[92:95]
    ds_read_b128 a[216:219], v1 offset:17024
    v_mfma_f32_16x16x32_bf16 v[92:95], a[252:255], a[44:47], v[92:95]
    v_exp_f32 v69, v85
    v_mfma_f32_16x16x32_bf16 v[88:91], a[252:255], a[12:15], v[88:91]
    ds_read_b128 a[220:223], v1 offset:17088
    v_add_f32 v119, v68, v69
    v_mfma_f32_16x16x32_bf16 v[88:91], a[248:251], a[8:11], v[88:91]
    s_waitcnt lgkmcnt(4)
    v_exp_f32 v70, v86
    v_mfma_f32_16x16x32_bf16 v[88:91], a[192:195], a[16:19], v[88:91]
    ds_read_b128 a[224:227], v1 offset:17152
    v_cvt_pk_bf16_f32 v20, v68, v69
    v_mfma_f32_16x16x32_bf16 v[88:91], a[196:199], a[20:23], v[88:91]
    v_exp_f32 v71, v87
    v_mfma_f32_16x16x32_bf16 v[92:95], a[196:199], a[52:55], v[92:95]
    ds_read_b128 a[228:231], v1 offset:17216
    v_add_f32 v119, v119, v70
    v_mfma_f32_16x16x32_bf16 v[92:95], a[192:195], a[48:51], v[92:95]
    v_exp_f32 v64, v80
    v_mfma_f32_16x16x32_bf16 v[92:95], a[200:203], a[56:59], v[92:95]
    ds_read_b128 a[232:235], v1 offset:17280
    v_cvt_pk_bf16_f32 v21, v70, v71
    v_mfma_f32_16x16x32_bf16 v[92:95], a[204:207], a[60:63], v[92:95]
    v_exp_f32 v65, v81
    v_mfma_f32_16x16x32_bf16 v[88:91], a[204:207], a[28:31], v[88:91]
    ds_read_b128 a[236:239], v1 offset:17344
    v_add_f32 v119, v119, v71
    v_mfma_f32_16x16x32_bf16 v[88:91], a[200:203], a[24:27], v[88:91]
    s_waitcnt lgkmcnt(4)
    v_exp_f32 v66, v82
    v_mfma_f32_16x16x32_bf16 v[48:51], a[208:211], a[0:3], v[96:99]
    ds_read_b128 a[240:243], v1 offset:17408
    v_add_f32 v118, v64, v65
    v_mfma_f32_16x16x32_bf16 v[48:51], a[212:215], a[4:7], v[48:51]
    v_exp_f32 v67, v83
    v_mfma_f32_16x16x32_bf16 v[52:55], a[212:215], a[36:39], v[100:103]
    ds_read_b128 a[244:247], v1 offset:17472
    v_cvt_pk_bf16_f32 v16, v64, v65
    v_mfma_f32_16x16x32_bf16 v[52:55], a[208:211], a[32:35], v[52:55]
    v_exp_f32 v76, v92
    v_mfma_f32_16x16x32_bf16 v[52:55], a[216:219], a[40:43], v[52:55]
    ds_read_b128 a[248:251], v1 offset:17536
    v_add_f32 v118, v118, v66
    v_mfma_f32_16x16x32_bf16 v[52:55], a[220:223], a[44:47], v[52:55]
    v_exp_f32 v77, v93
    v_mfma_f32_16x16x32_bf16 v[48:51], a[220:223], a[12:15], v[48:51]
    ds_read_b128 a[252:255], v1 offset:17600
    v_cvt_pk_bf16_f32 v17, v66, v67
    v_mfma_f32_16x16x32_bf16 v[48:51], a[216:219], a[8:11], v[48:51]
    s_waitcnt lgkmcnt(4)
    v_exp_f32 v78, v94
    v_mfma_f32_16x16x32_bf16 v[48:51], a[224:227], a[16:19], v[48:51]
    ds_read_b128 a[192:195], v1 offset:17664
    v_add_f32 v118, v118, v67
    v_mfma_f32_16x16x32_bf16 v[48:51], a[228:231], a[20:23], v[48:51]
    v_exp_f32 v79, v95
    v_mfma_f32_16x16x32_bf16 v[52:55], a[228:231], a[52:55], v[52:55]
    ds_read_b128 a[196:199], v1 offset:17728
    v_add_f32 v119, v119, v76
    v_mfma_f32_16x16x32_bf16 v[52:55], a[224:227], a[48:51], v[52:55]
    v_exp_f32 v72, v88
    v_mfma_f32_16x16x32_bf16 v[52:55], a[232:235], a[56:59], v[52:55]
    ds_read_b128 a[200:203], v1 offset:17792
    v_cvt_pk_bf16_f32 v22, v76, v77
    v_mfma_f32_16x16x32_bf16 v[52:55], a[236:239], a[60:63], v[52:55]
    v_exp_f32 v73, v89
    v_mfma_f32_16x16x32_bf16 v[48:51], a[236:239], a[28:31], v[48:51]
    ds_read_b128 a[204:207], v1 offset:17856
    v_add_f32 v119, v119, v77
    v_mfma_f32_16x16x32_bf16 v[48:51], a[232:235], a[24:27], v[48:51]
    s_waitcnt vmcnt(9) lgkmcnt(4)
    s_barrier
    v_add_f32 v119, v119, v78
    v_mfma_f32_16x16x32_bf16 v[56:59], a[240:243], a[0:3], v[96:99]
    ds_read_b64_tr_b16 a[208:209], v0 offset:33792
    ds_read_b64_tr_b16 a[210:211], v0 offset:34304
    v_mfma_f32_16x16x32_bf16 v[56:59], a[244:247], a[4:7], v[56:59]
    v_exp_f32 v74, v90
    v_mfma_f32_16x16x32_bf16 v[60:63], a[244:247], a[36:39], v[100:103]
    ds_read_b64_tr_b16 a[212:213], v0 offset:50688
    ds_read_b64_tr_b16 a[214:215], v0 offset:51200
    v_mfma_f32_16x16x32_bf16 v[60:63], a[240:243], a[32:35], v[60:63]
    v_exp_f32 v75, v91
    v_mfma_f32_16x16x32_bf16 v[60:63], a[248:251], a[40:43], v[60:63]
    ds_read_b64_tr_b16 a[216:217], v0 offset:33824
    ds_read_b64_tr_b16 a[218:219], v0 offset:34336
    v_mfma_f32_16x16x32_bf16 v[60:63], a[252:255], a[44:47], v[60:63]
    buffer_load_dwordx4 v114, s[24:27], s38 offen offset:0 lds
    v_mfma_f32_16x16x32_bf16 v[56:59], a[252:255], a[12:15], v[56:59]
    ds_read_b64_tr_b16 a[220:221], v0 offset:50720
    ds_read_b64_tr_b16 a[222:223], v0 offset:51232
    v_mfma_f32_16x16x32_bf16 v[56:59], a[248:251], a[8:11], v[56:59]
    s_waitcnt lgkmcnt(8)
    v_exp_f32 v68, v52
    v_mfma_f32_16x16x32_bf16 v[56:59], a[192:195], a[16:19], v[56:59]
    ds_read_b64_tr_b16 a[224:225], v0 offset:33856
    ds_read_b64_tr_b16 a[226:227], v0 offset:34368
    v_mfma_f32_16x16x32_bf16 v[56:59], a[196:199], a[20:23], v[56:59]
    buffer_load_dwordx4 v112, s[24:27], s38 offen offset:1056 lds
    v_mfma_f32_16x16x32_bf16 v[60:63], a[196:199], a[52:55], v[60:63]
    ds_read_b64_tr_b16 a[228:229], v0 offset:50752
    ds_read_b64_tr_b16 a[230:231], v0 offset:51264
    v_mfma_f32_16x16x32_bf16 v[60:63], a[192:195], a[48:51], v[60:63]
    v_exp_f32 v69, v53
    v_mfma_f32_16x16x32_bf16 v[60:63], a[200:203], a[56:59], v[60:63]
    ds_read_b64_tr_b16 a[232:233], v0 offset:33888
    ds_read_b64_tr_b16 a[234:235], v0 offset:34400
    v_mfma_f32_16x16x32_bf16 v[60:63], a[204:207], a[60:63], v[60:63]
    buffer_load_dwordx4 v121, s[24:27], s38 offen offset:2112 lds
    v_mfma_f32_16x16x32_bf16 v[56:59], a[204:207], a[28:31], v[56:59]
    ds_read_b64_tr_b16 a[236:237], v0 offset:50784
    ds_read_b64_tr_b16 a[238:239], v0 offset:51296
    v_mfma_f32_16x16x32_bf16 v[56:59], a[200:203], a[24:27], v[56:59]
    s_waitcnt lgkmcnt(8)
    v_exp_f32 v70, v54
    v_mfma_f32_16x16x32_bf16 v[128:131], a[208:211], v[32:35], v[128:131]
    ds_read_b64_tr_b16 a[240:241], v0 offset:33920
    ds_read_b64_tr_b16 a[242:243], v0 offset:34432
    v_mfma_f32_16x16x32_bf16 v[128:131], a[212:215], v[24:27], v[128:131]
    buffer_load_dwordx4 v122, s[24:27], s38 offen offset:3168 lds
    s_add_u32 m0, s37, 16896
    v_mfma_f32_16x16x32_bf16 v[132:135], a[212:215], v[28:31], v[132:135]
    ds_read_b64_tr_b16 a[244:245], v0 offset:50816
    ds_read_b64_tr_b16 a[246:247], v0 offset:51328
    v_mfma_f32_16x16x32_bf16 v[132:135], a[208:211], v[36:39], v[132:135]
    s_add_u32 s38, s38, 16384
    v_exp_f32 v71, v55
    v_mfma_f32_16x16x32_bf16 v[140:143], a[216:219], v[36:39], v[140:143]
    ds_read_b64_tr_b16 a[248:249], v0 offset:33952
    ds_read_b64_tr_b16 a[250:251], v0 offset:34464
    v_mfma_f32_16x16x32_bf16 v[140:143], a[220:223], v[28:31], v[140:143]
    buffer_load_dwordx4 v114, s[24:27], s38 offen offset:0 lds
    v_mfma_f32_16x16x32_bf16 v[136:139], a[220:223], v[24:27], v[136:139]
    ds_read_b64_tr_b16 a[252:253], v0 offset:50848
    ds_read_b64_tr_b16 a[254:255], v0 offset:51360
    v_mfma_f32_16x16x32_bf16 v[136:139], a[216:219], v[32:35], v[136:139]
    s_waitcnt lgkmcnt(8)
    v_exp_f32 v64, v48
    v_mfma_f32_16x16x32_bf16 v[144:147], a[224:227], v[32:35], v[144:147]
    ds_read_b64_tr_b16 a[192:193], v0 offset:33984
    ds_read_b64_tr_b16 a[194:195], v0 offset:34496
    v_mfma_f32_16x16x32_bf16 v[144:147], a[228:231], v[24:27], v[144:147]
    buffer_load_dwordx4 v112, s[24:27], s38 offen offset:1056 lds
    v_mfma_f32_16x16x32_bf16 v[148:151], a[228:231], v[28:31], v[148:151]
    ds_read_b64_tr_b16 a[196:197], v0 offset:50880
    ds_read_b64_tr_b16 a[198:199], v0 offset:51392
    v_mfma_f32_16x16x32_bf16 v[148:151], a[224:227], v[36:39], v[148:151]
    v_exp_f32 v65, v49
    v_mfma_f32_16x16x32_bf16 v[156:159], a[232:235], v[36:39], v[156:159]
    ds_read_b64_tr_b16 a[200:201], v0 offset:34016
    ds_read_b64_tr_b16 a[202:203], v0 offset:34528
    v_mfma_f32_16x16x32_bf16 v[156:159], a[236:239], v[28:31], v[156:159]
    buffer_load_dwordx4 v121, s[24:27], s38 offen offset:2112 lds
    v_mfma_f32_16x16x32_bf16 v[152:155], a[236:239], v[24:27], v[152:155]
    ds_read_b64_tr_b16 a[204:205], v0 offset:50912
    ds_read_b64_tr_b16 a[206:207], v0 offset:51424
    v_mfma_f32_16x16x32_bf16 v[152:155], a[232:235], v[32:35], v[152:155]
    s_waitcnt lgkmcnt(8)
    v_exp_f32 v66, v50
    v_mfma_f32_16x16x32_bf16 v[160:163], a[240:243], v[32:35], v[160:163]
    ds_read_b64_tr_b16 a[208:209], v0 offset:34048
    ds_read_b64_tr_b16 a[210:211], v0 offset:34560
    v_mfma_f32_16x16x32_bf16 v[160:163], a[244:247], v[24:27], v[160:163]
    buffer_load_dwordx4 v122, s[24:27], s38 offen offset:3168 lds
    s_add_u32 m0, s37, 67584
    v_mfma_f32_16x16x32_bf16 v[164:167], a[244:247], v[28:31], v[164:167]
    ds_read_b64_tr_b16 a[212:213], v0 offset:50944
    ds_read_b64_tr_b16 a[214:215], v0 offset:51456
    v_mfma_f32_16x16x32_bf16 v[164:167], a[240:243], v[36:39], v[164:167]
    s_add_u32 s38, s38, 16384
    v_exp_f32 v67, v51
    v_mfma_f32_16x16x32_bf16 v[172:175], a[248:251], v[36:39], v[172:175]
    ds_read_b64_tr_b16 a[216:217], v0 offset:34080
    v_cvt_pk_bf16_f32 v23, v78, v79
    v_mfma_f32_16x16x32_bf16 v[172:175], a[252:255], v[28:31], v[172:175]
    ds_read_b64_tr_b16 a[218:219], v0 offset:34592
    v_add_f32 v119, v119, v79
    v_mfma_f32_16x16x32_bf16 v[168:171], a[252:255], v[24:27], v[168:171]
    ds_read_b64_tr_b16 a[220:221], v0 offset:50976
    ds_read_b64_tr_b16 a[222:223], v0 offset:51488
    v_mfma_f32_16x16x32_bf16 v[168:171], a[248:251], v[32:35], v[168:171]
    s_waitcnt lgkmcnt(8)
    v_exp_f32 v76, v60
    v_mfma_f32_16x16x32_bf16 v[176:179], a[192:195], v[32:35], v[176:179]
    ds_read_b64_tr_b16 a[224:225], v0 offset:34112
    buffer_load_dword v15, v7, s[32:35], 0 offen sc1
    v_add_f32 v118, v118, v72
    v_mfma_f32_16x16x32_bf16 v[176:179], a[196:199], v[24:27], v[176:179]
    ds_read_b64_tr_b16 a[226:227], v0 offset:34624
    v_cvt_pk_bf16_f32 v18, v72, v73
    v_mfma_f32_16x16x32_bf16 v[180:183], a[196:199], v[28:31], v[180:183]
    ds_read_b64_tr_b16 a[228:229], v0 offset:51008
    ds_read_b64_tr_b16 a[230:231], v0 offset:51520
    v_mfma_f32_16x16x32_bf16 v[180:183], a[192:195], v[36:39], v[180:183]
    v_exp_f32 v77, v61
    v_mfma_f32_16x16x32_bf16 v[188:191], a[200:203], v[36:39], v[188:191]
    ds_read_b64_tr_b16 a[232:233], v0 offset:34144
    v_add_f32 v118, v118, v73
    v_mfma_f32_16x16x32_bf16 v[188:191], a[204:207], v[28:31], v[188:191]
    ds_read_b64_tr_b16 a[234:235], v0 offset:34656
    v_add_f32 v118, v118, v74
    v_mfma_f32_16x16x32_bf16 v[184:187], a[204:207], v[24:27], v[184:187]
    ds_read_b64_tr_b16 a[236:237], v0 offset:51040
    ds_read_b64_tr_b16 a[238:239], v0 offset:51552
    v_mfma_f32_16x16x32_bf16 v[184:187], a[200:203], v[32:35], v[184:187]
    s_waitcnt lgkmcnt(8)
    v_exp_f32 v78, v62
    v_mfma_f32_16x16x32_bf16 v[192:195], a[208:211], v[32:35], v[192:195]
    ds_read_b64_tr_b16 a[240:241], v0 offset:34176
    v_cvt_pk_bf16_f32 v19, v74, v75
    v_mfma_f32_16x16x32_bf16 v[192:195], a[212:215], v[24:27], v[192:195]
    ds_read_b64_tr_b16 a[242:243], v0 offset:34688
    v_add_f32 v118, v118, v75
    v_mfma_f32_16x16x32_bf16 v[196:199], a[212:215], v[28:31], v[196:199]
    ds_read_b64_tr_b16 a[244:245], v0 offset:51072
    ds_read_b64_tr_b16 a[246:247], v0 offset:51584
    v_mfma_f32_16x16x32_bf16 v[196:199], a[208:211], v[36:39], v[196:199]
    v_exp_f32 v79, v63
    v_mfma_f32_16x16x32_bf16 v[204:207], a[216:219], v[36:39], v[204:207]
    ds_read_b64_tr_b16 a[248:249], v0 offset:34208
    v_add_f32 v119, v119, v68
    v_mfma_f32_16x16x32_bf16 v[204:207], a[220:223], v[28:31], v[204:207]
    ds_read_b64_tr_b16 a[250:251], v0 offset:34720
    v_add_f32 v119, v119, v69
    v_mfma_f32_16x16x32_bf16 v[200:203], a[220:223], v[24:27], v[200:203]
    ds_read_b64_tr_b16 a[252:253], v0 offset:51104
    ds_read_b64_tr_b16 a[254:255], v0 offset:51616
    v_mfma_f32_16x16x32_bf16 v[200:203], a[216:219], v[32:35], v[200:203]
    s_waitcnt lgkmcnt(8)
    v_exp_f32 v72, v56
    v_mfma_f32_16x16x32_bf16 v[208:211], a[224:227], v[32:35], v[208:211]
    ds_read_b64_tr_b16 a[192:193], v0 offset:34240
    v_add_f32 v119, v119, v70
    v_mfma_f32_16x16x32_bf16 v[208:211], a[228:231], v[24:27], v[208:211]
    ds_read_b64_tr_b16 a[194:195], v0 offset:34752
    v_add_f32 v119, v119, v71
    v_mfma_f32_16x16x32_bf16 v[212:215], a[228:231], v[28:31], v[212:215]
    ds_read_b64_tr_b16 a[196:197], v0 offset:51136
    ds_read_b64_tr_b16 a[198:199], v0 offset:51648
    v_mfma_f32_16x16x32_bf16 v[212:215], a[224:227], v[36:39], v[212:215]
    v_exp_f32 v73, v57
    v_mfma_f32_16x16x32_bf16 v[220:223], a[232:235], v[36:39], v[220:223]
    ds_read_b64_tr_b16 a[200:201], v0 offset:34272
    v_add_f32 v118, v118, v64
    v_mfma_f32_16x16x32_bf16 v[220:223], a[236:239], v[28:31], v[220:223]
    ds_read_b64_tr_b16 a[202:203], v0 offset:34784
    v_add_f32 v118, v118, v65
    v_mfma_f32_16x16x32_bf16 v[216:219], a[236:239], v[24:27], v[216:219]
    ds_read_b64_tr_b16 a[204:205], v0 offset:51168
    ds_read_b64_tr_b16 a[206:207], v0 offset:51680
    v_mfma_f32_16x16x32_bf16 v[216:219], a[232:235], v[32:35], v[216:219]
    s_waitcnt vmcnt(10) lgkmcnt(8)
    s_barrier
    v_add_f32 v118, v118, v66
    v_mfma_f32_16x16x32_bf16 v[224:227], a[240:243], v[32:35], v[224:227]
    ds_read_b128 a[208:211], v1 offset:33792
    v_add_f32 v118, v118, v67
    v_mfma_f32_16x16x32_bf16 v[224:227], a[244:247], v[24:27], v[224:227]
    buffer_load_dwordx4 v114, s[20:23], s49 offen offset:0 lds
    v_mfma_f32_16x16x32_bf16 v[228:231], a[244:247], v[28:31], v[228:231]
    ds_read_b128 a[212:215], v1 offset:33856
    v_add_f32 v119, v119, v76
    v_mfma_f32_16x16x32_bf16 v[228:231], a[240:243], v[36:39], v[228:231]
    v_exp_f32 v74, v58
    v_mfma_f32_16x16x32_bf16 v[236:239], a[248:251], v[36:39], v[236:239]
    ds_read_b128 a[216:219], v1 offset:33920
    v_add_f32 v119, v119, v77
    v_mfma_f32_16x16x32_bf16 v[236:239], a[252:255], v[28:31], v[236:239]
    buffer_load_dwordx4 v112, s[20:23], s49 offen offset:1056 lds
    v_mfma_f32_16x16x32_bf16 v[232:235], a[252:255], v[24:27], v[232:235]
    ds_read_b128 a[220:223], v1 offset:33984
    v_add_f32 v119, v119, v78
    v_mfma_f32_16x16x32_bf16 v[232:235], a[248:251], v[32:35], v[232:235]
    s_waitcnt lgkmcnt(4)
    v_exp_f32 v75, v59
    v_mfma_f32_16x16x32_bf16 v[240:243], a[192:195], v[32:35], v[240:243]
    ds_read_b128 a[224:227], v1 offset:34048
    v_add_f32 v119, v119, v79
    v_mfma_f32_16x16x32_bf16 v[240:243], a[196:199], v[24:27], v[240:243]
    buffer_load_dwordx4 v121, s[20:23], s49 offen offset:2112 lds
    v_mfma_f32_16x16x32_bf16 v[244:247], a[196:199], v[28:31], v[244:247]
    ds_read_b128 a[228:231], v1 offset:34112
    v_add_f32 v118, v118, v72
    v_mfma_f32_16x16x32_bf16 v[244:247], a[192:195], v[36:39], v[244:247]
    v_add_f32 v118, v118, v73
    v_add_f32 v118, v118, v75
    v_mfma_f32_16x16x32_bf16 v[252:255], a[200:203], v[36:39], v[252:255]
    ds_read_b128 a[232:235], v1 offset:34176
    v_add_f32 v118, v118, v74
    v_mfma_f32_16x16x32_bf16 v[252:255], a[204:207], v[28:31], v[252:255]
    buffer_load_dwordx4 v122, s[20:23], s49 offen offset:3168 lds
    s_add_u32 m0, s37, 84480
    v_add_f32 v120, v118, v119
    v_mfma_f32_16x16x32_bf16 v[248:251], a[204:207], v[24:27], v[248:251]
    s_add_u32 s49, s49, 16384
    ds_read_b128 a[236:239], v1 offset:34240
    v_cmp_nge_f32 vcc, s40, v120
    v_mfma_f32_16x16x32_bf16 v[248:251], a[200:203], v[32:35], v[248:251]
    s_waitcnt lgkmcnt(4)
    s_cbranch_vccnz slow_l01
back_l01:
    v_add_f32 v116, v116, v118
    v_mfma_f32_16x16x32_bf16 v[80:83], a[208:211], a[0:3], v[96:99]
    ds_read_b128 a[240:243], v1 offset:34304
    v_add_f32 v117, v117, v119
    v_mfma_f32_16x16x32_bf16 v[80:83], a[212:215], a[4:7], v[80:83]
    buffer_load_dwordx4 v114, s[20:23], s49 offen offset:0 lds
    v_mfma_f32_16x16x32_bf16 v[84:87], a[212:215], a[36:39], v[100:103]
    ds_read_b128 a[244:247], v1 offset:34368
    v_cvt_pk_bf16_f32 v24, v64, v65
    v_mfma_f32_16x16x32_bf16 v[84:87], a[208:211], a[32:35], v[84:87]
    v_cvt_pk_bf16_f32 v25, v66, v67
    v_mfma_f32_16x16x32_bf16 v[84:87], a[216:219], a[40:43], v[84:87]
    ds_read_b128 a[248:251], v1 offset:34432
    v_cvt_pk_bf16_f32 v28, v68, v69
    v_mfma_f32_16x16x32_bf16 v[84:87], a[220:223], a[44:47], v[84:87]
    buffer_load_dwordx4 v112, s[20:23], s49 offen offset:1056 lds
    v_mfma_f32_16x16x32_bf16 v[80:83], a[220:223], a[12:15], v[80:83]
    ds_read_b128 a[252:255], v1 offset:34496
    v_cvt_pk_bf16_f32 v29, v70, v71
    v_mfma_f32_16x16x32_bf16 v[80:83], a[216:219], a[8:11], v[80:83]
    s_waitcnt lgkmcnt(4)
    v_cvt_pk_bf16_f32 v26, v72, v73
    v_mfma_f32_16x16x32_bf16 v[80:83], a[224:227], a[16:19], v[80:83]
    ds_read_b128 a[192:195], v1 offset:34560
    v_cvt_pk_bf16_f32 v27, v74, v75
    v_mfma_f32_16x16x32_bf16 v[80:83], a[228:231], a[20:23], v[80:83]
    buffer_load_dwordx4 v121, s[20:23], s49 offen offset:2112 lds
    v_mfma_f32_16x16x32_bf16 v[84:87], a[228:231], a[52:55], v[84:87]
    ds_read_b128 a[196:199], v1 offset:34624
    v_cvt_pk_bf16_f32 v30, v76, v77
    v_mfma_f32_16x16x32_bf16 v[84:87], a[224:227], a[48:51], v[84:87]
    v_cvt_pk_bf16_f32 v31, v78, v79
    v_mfma_f32_16x16x32_bf16 v[84:87], a[232:235], a[56:59], v[84:87]
    ds_read_b128 a[200:203], v1 offset:34688
    v_mfma_f32_16x16x32_bf16 v[84:87], a[236:239], a[60:63], v[84:87]
    buffer_load_dwordx4 v122, s[20:23], s49 offen offset:3168 lds
    s_add_u32 m0, s37, 33792
    v_mfma_f32_16x16x32_bf16 v[80:83], a[236:239], a[28:31], v[80:83]
    s_add_u32 s49, s49, 16384
    ds_read_b128 a[204:207], v1 offset:34752
    v_mfma_f32_16x16x32_bf16 v[80:83], a[232:235], a[24:27], v[80:83]
    s_waitcnt lgkmcnt(4)
    v_mfma_f32_16x16x32_bf16 v[88:91], a[240:243], a[0:3], v[96:99]
    ds_read_b128 a[208:211], v1 offset:50688
    v_mfma_f32_16x16x32_bf16 v[88:91], a[244:247], a[4:7], v[88:91]
    buffer_load_dword v46, v42, s[16:19], s94 offen
    v_mfma_f32_16x16x32_bf16 v[92:95], a[244:247], a[36:39], v[100:103]
    s_add_u32 s94, s94, 384
    ds_read_b128 a[212:215], v1 offset:50752
    v_mfma_f32_16x16x32_bf16 v[92:95], a[240:243], a[32:35], v[92:95]
    v_exp_f32 v68, v84
    v_mfma_f32_16x16x32_bf16 v[92:95], a[248:251], a[40:43], v[92:95]
    ds_read_b128 a[216:219], v1 offset:50816
    v_mfma_f32_16x16x32_bf16 v[92:95], a[252:255], a[44:47], v[92:95]
    v_exp_f32 v69, v85
    v_mfma_f32_16x16x32_bf16 v[88:91], a[252:255], a[12:15], v[88:91]
    ds_read_b128 a[220:223], v1 offset:50880
    v_add_f32 v119, v68, v69
    v_mfma_f32_16x16x32_bf16 v[88:91], a[248:251], a[8:11], v[88:91]
    s_waitcnt lgkmcnt(4)
    v_exp_f32 v70, v86
    v_mfma_f32_16x16x32_bf16 v[88:91], a[192:195], a[16:19], v[88:91]
    ds_read_b128 a[224:227], v1 offset:50944
    v_cvt_pk_bf16_f32 v36, v68, v69
    v_mfma_f32_16x16x32_bf16 v[88:91], a[196:199], a[20:23], v[88:91]
    v_exp_f32 v71, v87
    v_mfma_f32_16x16x32_bf16 v[92:95], a[196:199], a[52:55], v[92:95]
    ds_read_b128 a[228:231], v1 offset:51008
    v_add_f32 v119, v119, v70
    v_mfma_f32_16x16x32_bf16 v[92:95], a[192:195], a[48:51], v[92:95]
    v_exp_f32 v64, v80
    v_mfma_f32_16x16x32_bf16 v[92:95], a[200:203], a[56:59], v[92:95]
    ds_read_b128 a[232:235], v1 offset:51072
    v_cvt_pk_bf16_f32 v37, v70, v71
    v_mfma_f32_16x16x32_bf16 v[92:95], a[204:207], a[60:63], v[92:95]
    v_exp_f32 v65, v81
    v_mfma_f32_16x16x32_bf16 v[88:91], a[204:207], a[28:31], v[88:91]
    ds_read_b128 a[236:239], v1 offset:51136
    v_add_f32 v119, v119, v71
    v_mfma_f32_16x16x32_bf16 v[88:91], a[200:203], a[24:27], v[88:91]
    s_waitcnt lgkmcnt(4)
    v_exp_f32 v66, v82
    v_mfma_f32_16x16x32_bf16 v[48:51], a[208:211], a[0:3], v[96:99]
    ds_read_b128 a[240:243], v1 offset:51200
    v_add_f32 v118, v64, v65
    v_mfma_f32_16x16x32_bf16 v[48:51], a[212:215], a[4:7], v[48:51]
    v_exp_f32 v67, v83
    v_mfma_f32_16x16x32_bf16 v[52:55], a[212:215], a[36:39], v[100:103]
    ds_read_b128 a[244:247], v1 offset:51264
    v_cvt_pk_bf16_f32 v32, v64, v65
    v_mfma_f32_16x16x32_bf16 v[52:55], a[208:211], a[32:35], v[52:55]
    v_exp_f32 v76, v92
    v_mfma_f32_16x16x32_bf16 v[52:55], a[216:219], a[40:43], v[52:55]
    ds_read_b128 a[248:251], v1 offset:51328
    v_add_f32 v118, v118, v66
    v_mfma_f32_16x16x32_bf16 v[52:55], a[220:223], a[44:47], v[52:55]
    v_exp_f32 v77, v93
    v_mfma_f32_16x16x32_bf16 v[48:51], a[220:223], a[12:15], v[48:51]
    ds_read_b128 a[252:255], v1 offset:51392
    v_cvt_pk_bf16_f32 v33, v66, v67
    v_mfma_f32_16x16x32_bf16 v[48:51], a[216:219], a[8:11], v[48:51]
    s_waitcnt lgkmcnt(4)
    v_exp_f32 v78, v94
    v_mfma_f32_16x16x32_bf16 v[48:51], a[224:227], a[16:19], v[48:51]
    ds_read_b128 a[192:195], v1 offset:51456
    v_add_f32 v118, v118, v67
    v_mfma_f32_16x16x32_bf16 v[48:51], a[228:231], a[20:23], v[48:51]
    v_exp_f32 v79, v95
    v_mfma_f32_16x16x32_bf16 v[52:55], a[228:231], a[52:55], v[52:55]
    ds_read_b128 a[196:199], v1 offset:51520
    v_add_f32 v119, v119, v76
    v_mfma_f32_16x16x32_bf16 v[52:55], a[224:227], a[48:51], v[52:55]
    v_exp_f32 v72, v88
    v_mfma_f32_16x16x32_bf16 v[52:55], a[232:235], a[56:59], v[52:55]
    ds_read_b128 a[200:203], v1 offset:51584
    v_cvt_pk_bf16_f32 v38, v76, v77
    v_mfma_f32_16x16x32_bf16 v[52:55], a[236:239], a[60:63], v[52:55]
    v_exp_f32 v73, v89
    v_mfma_f32_16x16x32_bf16 v[48:51], a[236:239], a[28:31], v[48:51]
    ds_read_b128 a[204:207], v1 offset:51648
    v_add_f32 v119, v119, v77
    v_mfma_f32_16x16x32_bf16 v[48:51], a[232:235], a[24:27], v[48:51]
    s_waitcnt vmcnt(10) lgkmcnt(4)
    s_barrier
    v_add_f32 v119, v119, v78
    v_mfma_f32_16x16x32_bf16 v[56:59], a[240:243], a[0:3], v[96:99]
    ds_read_b64_tr_b16 a[208:209], v0 offset:0
    ds_read_b64_tr_b16 a[210:211], v0 offset:512
    v_mfma_f32_16x16x32_bf16 v[56:59], a[244:247], a[4:7], v[56:59]
    v_exp_f32 v74, v90
    v_mfma_f32_16x16x32_bf16 v[60:63], a[244:247], a[36:39], v[100:103]
    ds_read_b64_tr_b16 a[212:213], v0 offset:16896
    ds_read_b64_tr_b16 a[214:215], v0 offset:17408
    v_mfma_f32_16x16x32_bf16 v[60:63], a[240:243], a[32:35], v[60:63]
    v_exp_f32 v75, v91
    v_mfma_f32_16x16x32_bf16 v[60:63], a[248:251], a[40:43], v[60:63]
    ds_read_b64_tr_b16 a[216:217], v0 offset:32
    ds_read_b64_tr_b16 a[218:219], v0 offset:544
    v_mfma_f32_16x16x32_bf16 v[60:63], a[252:255], a[44:47], v[60:63]
    buffer_load_dwordx4 v114, s[24:27], s38 offen offset:0 lds
    v_mfma_f32_16x16x32_bf16 v[56:59], a[252:255], a[12:15], v[56:59]
    ds_read_b64_tr_b16 a[220:221], v0 offset:16928
    ds_read_b64_tr_b16 a[222:223], v0 offset:17440
    v_mfma_f32_16x16x32_bf16 v[56:59], a[248:251], a[8:11], v[56:59]
    s_waitcnt lgkmcnt(8)
    v_exp_f32 v68, v52
    v_mfma_f32_16x16x32_bf16 v[56:59], a[192:195], a[16:19], v[56:59]
    ds_read_b64_tr_b16 a[224:225], v0 offset:64
    ds_read_b64_tr_b16 a[226:227], v0 offset:576
    v_mfma_f32_16x16x32_bf16 v[56:59], a[196:199], a[20:23], v[56:59]
    buffer_load_dwordx4 v112, s[24:27], s38 offen offset:1056 lds
    v_mfma_f32_16x16x32_bf16 v[60:63], a[196:199], a[52:55], v[60:63]
    ds_read_b64_tr_b16 a[228:229], v0 offset:16960
    ds_read_b64_tr_b16 a[230:231], v0 offset:17472
    v_mfma_f32_16x16x32_bf16 v[60:63], a[192:195], a[48:51], v[60:63]
    v_exp_f32 v69, v53
    v_mfma_f32_16x16x32_bf16 v[60:63], a[200:203], a[56:59], v[60:63]
    ds_read_b64_tr_b16 a[232:233], v0 offset:96
    ds_read_b64_tr_b16 a[234:235], v0 offset:608
    v_mfma_f32_16x16x32_bf16 v[60:63], a[204:207], a[60:63], v[60:63]
    buffer_load_dwordx4 v121, s[24:27], s38 offen offset:2112 lds
    v_mfma_f32_16x16x32_bf16 v[56:59], a[204:207], a[28:31], v[56:59]
    ds_read_b64_tr_b16 a[236:237], v0 offset:16992
    ds_read_b64_tr_b16 a[238:239], v0 offset:17504
    v_mfma_f32_16x16x32_bf16 v[56:59], a[200:203], a[24:27], v[56:59]
    s_waitcnt lgkmcnt(8)
    v_exp_f32 v70, v54
    v_mfma_f32_16x16x32_bf16 v[128:131], a[208:211], v[16:19], v[128:131]
    ds_read_b64_tr_b16 a[240:241], v0 offset:128
    ds_read_b64_tr_b16 a[242:243], v0 offset:640
    v_mfma_f32_16x16x32_bf16 v[128:131], a[212:215], v[24:27], v[128:131]
    buffer_load_dwordx4 v122, s[24:27], s38 offen offset:3168 lds
    s_add_u32 m0, s37, 50688
    v_mfma_f32_16x16x32_bf16 v[132:135], a[212:215], v[28:31], v[132:135]
    ds_read_b64_tr_b16 a[244:245], v0 offset:17024
    ds_read_b64_tr_b16 a[246:247], v0 offset:17536
    v_mfma_f32_16x16x32_bf16 v[132:135], a[208:211], v[20:23], v[132:135]
    s_add_u32 s38, s38, 16384
    v_exp_f32 v71, v55
    v_mfma_f32_16x16x32_bf16 v[140:143], a[216:219], v[20:23], v[140:143]
    ds_read_b64_tr_b16 a[248:249], v0 offset:160
    ds_read_b64_tr_b16 a[250:251], v0 offset:672
    v_mfma_f32_16x16x32_bf16 v[140:143], a[220:223], v[28:31], v[140:143]
    buffer_load_dwordx4 v114, s[24:27], s38 offen offset:0 lds
    v_mfma_f32_16x16x32_bf16 v[136:139], a[220:223], v[24:27], v[136:139]
    ds_read_b64_tr_b16 a[252:253], v0 offset:17056
    ds_read_b64_tr_b16 a[254:255], v0 offset:17568
    v_mfma_f32_16x16x32_bf16 v[136:139], a[216:219], v[16:19], v[136:139]
    s_waitcnt lgkmcnt(8)
    v_exp_f32 v64, v48
    v_mfma_f32_16x16x32_bf16 v[144:147], a[224:227], v[16:19], v[144:147]
    ds_read_b64_tr_b16 a[192:193], v0 offset:192
    ds_read_b64_tr_b16 a[194:195], v0 offset:704
    v_mfma_f32_16x16x32_bf16 v[144:147], a[228:231], v[24:27], v[144:147]
    buffer_load_dwordx4 v112, s[24:27], s38 offen offset:1056 lds
    v_mfma_f32_16x16x32_bf16 v[148:151], a[228:231], v[28:31], v[148:151]
    ds_read_b64_tr_b16 a[196:197], v0 offset:17088
    ds_read_b64_tr_b16 a[198:199], v0 offset:17600
    v_mfma_f32_16x16x32_bf16 v[148:151], a[224:227], v[20:23], v[148:151]
    v_exp_f32 v65, v49
    v_mfma_f32_16x16x32_bf16 v[156:159], a[232:235], v[20:23], v[156:159]
    ds_read_b64_tr_b16 a[200:201], v0 offset:224
    ds_read_b64_tr_b16 a[202:203], v0 offset:736
    v_mfma_f32_16x16x32_bf16 v[156:159], a[236:239], v[28:31], v[156:159]
    buffer_load_dwordx4 v121, s[24:27], s38 offen offset:2112 lds
    v_mfma_f32_16x16x32_bf16 v[152:155], a[236:239], v[24:27], v[152:155]
    ds_read_b64_tr_b16 a[204:205], v0 offset:17120
    ds_read_b64_tr_b16 a[206:207], v0 offset:17632
    v_mfma_f32_16x16x32_bf16 v[152:155], a[232:235], v[16:19], v[152:155]
    s_waitcnt lgkmcnt(8)
    v_exp_f32 v66, v50
    v_mfma_f32_16x16x32_bf16 v[160:163], a[240:243], v[16:19], v[160:163]
    ds_read_b64_tr_b16 a[208:209], v0 offset:256
    ds_read_b64_tr_b16 a[210:211], v0 offset:768
    v_mfma_f32_16x16x32_bf16 v[160:163], a[244:247], v[24:27], v[160:163]
    buffer_load_dwordx4 v122, s[24:27], s38 offen offset:3168 lds
    s_add_u32 m0, s37, 101376
    v_mfma_f32_16x16x32_bf16 v[164:167], a[244:247], v[28:31], v[164:167]
    ds_read_b64_tr_b16 a[212:213], v0 offset:17152
    ds_read_b64_tr_b16 a[214:215], v0 offset:17664
    v_mfma_f32_16x16x32_bf16 v[164:167], a[240:243], v[20:23], v[164:167]
    s_add_u32 s38, s38, 16384
    v_exp_f32 v67, v51
    v_mfma_f32_16x16x32_bf16 v[172:175], a[248:251], v[20:23], v[172:175]
    ds_read_b64_tr_b16 a[216:217], v0 offset:288
    v_cvt_pk_bf16_f32 v39, v78, v79
    v_mfma_f32_16x16x32_bf16 v[172:175], a[252:255], v[28:31], v[172:175]
    ds_read_b64_tr_b16 a[218:219], v0 offset:800
    v_add_f32 v119, v119, v79
    v_mfma_f32_16x16x32_bf16 v[168:171], a[252:255], v[24:27], v[168:171]
    ds_read_b64_tr_b16 a[220:221], v0 offset:17184
    ds_read_b64_tr_b16 a[222:223], v0 offset:17696
    v_mfma_f32_16x16x32_bf16 v[168:171], a[248:251], v[16:19], v[168:171]
    s_waitcnt lgkmcnt(8)
    v_exp_f32 v76, v60
    v_mfma_f32_16x16x32_bf16 v[176:179], a[192:195], v[16:19], v[176:179]
    ds_read_b64_tr_b16 a[224:225], v0 offset:320
    v_add_f32 v118, v118, v72
    v_mfma_f32_16x16x32_bf16 v[176:179], a[196:199], v[24:27], v[176:179]
    ds_read_b64_tr_b16 a[226:227], v0 offset:832
    v_cvt_pk_bf16_f32 v34, v72, v73
    v_mfma_f32_16x16x32_bf16 v[180:183], a[196:199], v[28:31], v[180:183]
    ds_read_b64_tr_b16 a[228:229], v0 offset:17216
    ds_read_b64_tr_b16 a[230:231], v0 offset:17728
    v_mfma_f32_16x16x32_bf16 v[180:183], a[192:195], v[20:23], v[180:183]
    v_exp_f32 v77, v61
    v_mfma_f32_16x16x32_bf16 v[188:191], a[200:203], v[20:23], v[188:191]
    ds_read_b64_tr_b16 a[232:233], v0 offset:352
    v_add_f32 v118, v118, v73
    v_mfma_f32_16x16x32_bf16 v[188:191], a[204:207], v[28:31], v[188:191]
    ds_read_b64_tr_b16 a[234:235], v0 offset:864
    v_add_f32 v118, v118, v74
    v_mfma_f32_16x16x32_bf16 v[184:187], a[204:207], v[24:27], v[184:187]
    ds_read_b64_tr_b16 a[236:237], v0 offset:17248
    ds_read_b64_tr_b16 a[238:239], v0 offset:17760
    v_mfma_f32_16x16x32_bf16 v[184:187], a[200:203], v[16:19], v[184:187]
    s_waitcnt lgkmcnt(8)
    v_exp_f32 v78, v62
    v_mfma_f32_16x16x32_bf16 v[192:195], a[208:211], v[16:19], v[192:195]
    ds_read_b64_tr_b16 a[240:241], v0 offset:384
    v_cvt_pk_bf16_f32 v35, v74, v75
    v_mfma_f32_16x16x32_bf16 v[192:195], a[212:215], v[24:27], v[192:195]
    ds_read_b64_tr_b16 a[242:243], v0 offset:896
    v_add_f32 v118, v118, v75
    v_mfma_f32_16x16x32_bf16 v[196:199], a[212:215], v[28:31], v[196:199]
    ds_read_b64_tr_b16 a[244:245], v0 offset:17280
    ds_read_b64_tr_b16 a[246:247], v0 offset:17792
    v_mfma_f32_16x16x32_bf16 v[196:199], a[208:211], v[20:23], v[196:199]
    v_exp_f32 v79, v63
    v_mfma_f32_16x16x32_bf16 v[204:207], a[216:219], v[20:23], v[204:207]
    ds_read_b64_tr_b16 a[248:249], v0 offset:416
    v_add_f32 v119, v119, v68
    v_mfma_f32_16x16x32_bf16 v[204:207], a[220:223], v[28:31], v[204:207]
    ds_read_b64_tr_b16 a[250:251], v0 offset:928
    v_add_f32 v119, v119, v69
    v_mfma_f32_16x16x32_bf16 v[200:203], a[220:223], v[24:27], v[200:203]
    ds_read_b64_tr_b16 a[252:253], v0 offset:17312
    ds_read_b64_tr_b16 a[254:255], v0 offset:17824
    v_mfma_f32_16x16x32_bf16 v[200:203], a[216:219], v[16:19], v[200:203]
    s_waitcnt lgkmcnt(8)
    v_exp_f32 v72, v56
    v_mfma_f32_16x16x32_bf16 v[208:211], a[224:227], v[16:19], v[208:211]
    ds_read_b64_tr_b16 a[192:193], v0 offset:448
    v_add_f32 v119, v119, v70
    v_mfma_f32_16x16x32_bf16 v[208:211], a[228:231], v[24:27], v[208:211]
    ds_read_b64_tr_b16 a[194:195], v0 offset:960
    v_add_f32 v119, v119, v71
    v_mfma_f32_16x16x32_bf16 v[212:215], a[228:231], v[28:31], v[212:215]
    ds_read_b64_tr_b16 a[196:197], v0 offset:17344
    ds_read_b64_tr_b16 a[198:199], v0 offset:17856
    v_mfma_f32_16x16x32_bf16 v[212:215], a[224:227], v[20:23], v[212:215]
    v_exp_f32 v73, v57
    v_mfma_f32_16x16x32_bf16 v[220:223], a[232:235], v[20:23], v[220:223]
    ds_read_b64_tr_b16 a[200:201], v0 offset:480
    v_add_f32 v118, v118, v64
    v_mfma_f32_16x16x32_bf16 v[220:223], a[236:239], v[28:31], v[220:223]
    ds_read_b64_tr_b16 a[202:203], v0 offset:992
    v_add_f32 v118, v118, v65
    v_mfma_f32_16x16x32_bf16 v[216:219], a[236:239], v[24:27], v[216:219]
    ds_read_b64_tr_b16 a[204:205], v0 offset:17376
    ds_read_b64_tr_b16 a[206:207], v0 offset:17888
    v_mfma_f32_16x16x32_bf16 v[216:219], a[232:235], v[16:19], v[216:219]
    s_waitcnt vmcnt(9) lgkmcnt(8)
    s_barrier
    v_add_f32 v118, v118, v66
    v_mfma_f32_16x16x32_bf16 v[224:227], a[240:243], v[16:19], v[224:227]
    ds_read_b128 a[208:211], v1 offset:0
    v_add_f32 v118, v118, v67
    v_mfma_f32_16x16x32_bf16 v[224:227], a[244:247], v[24:27], v[224:227]
    buffer_load_dwordx4 v114, s[20:23], s49 offen offset:0 lds
    v_mfma_f32_16x16x32_bf16 v[228:231], a[244:247], v[28:31], v[228:231]
    ds_read_b128 a[212:215], v1 offset:64
    buffer_store_dword v5, v8, s[32:35], 0 offen sc1
    v_add_f32 v119, v119, v76
    v_mfma_f32_16x16x32_bf16 v[228:231], a[240:243], v[20:23], v[228:231]
    v_exp_f32 v74, v58
    v_mfma_f32_16x16x32_bf16 v[236:239], a[248:251], v[20:23], v[236:239]
    ds_read_b128 a[216:219], v1 offset:128
    v_add_f32 v119, v119, v77
    v_mfma_f32_16x16x32_bf16 v[236:239], a[252:255], v[28:31], v[236:239]
    buffer_load_dwordx4 v112, s[20:23], s49 offen offset:1056 lds
    v_mfma_f32_16x16x32_bf16 v[232:235], a[252:255], v[24:27], v[232:235]
    ds_read_b128 a[220:223], v1 offset:192
    v_add_f32 v119, v119, v78
    v_mfma_f32_16x16x32_bf16 v[232:235], a[248:251], v[16:19], v[232:235]
    s_waitcnt lgkmcnt(4)
    v_exp_f32 v75, v59
    v_mfma_f32_16x16x32_bf16 v[240:243], a[192:195], v[16:19], v[240:243]
    ds_read_b128 a[224:227], v1 offset:256
    v_add_f32 v119, v119, v79
    v_mfma_f32_16x16x32_bf16 v[240:243], a[196:199], v[24:27], v[240:243]
    buffer_load_dwordx4 v121, s[20:23], s49 offen offset:2112 lds
    v_mfma_f32_16x16x32_bf16 v[244:247], a[196:199], v[28:31], v[244:247]
    ds_read_b128 a[228:231], v1 offset:320
    v_add_f32 v118, v118, v72
    v_mfma_f32_16x16x32_bf16 v[244:247], a[192:195], v[20:23], v[244:247]
    v_add_f32 v118, v118, v73
    v_add_f32 v118, v118, v75
    v_mfma_f32_16x16x32_bf16 v[252:255], a[200:203], v[20:23], v[252:255]
    ds_read_b128 a[232:235], v1 offset:384
    v_add_f32 v118, v118, v74
    v_mfma_f32_16x16x32_bf16 v[252:255], a[204:207], v[28:31], v[252:255]
    buffer_load_dwordx4 v122, s[20:23], s49 offen offset:3168 lds
    s_add_u32 m0, s37, 118272
    v_add_f32 v120, v118, v119
    v_mfma_f32_16x16x32_bf16 v[248:251], a[204:207], v[24:27], v[248:251]
    s_add_u32 s49, s49, 16384
    ds_read_b128 a[236:239], v1 offset:448
    v_cmp_nge_f32 vcc, s40, v120
    v_mfma_f32_16x16x32_bf16 v[248:251], a[200:203], v[16:19], v[248:251]
    s_waitcnt lgkmcnt(4)
    s_cbranch_vccnz slow_l03
back_l03:
    v_add_f32 v116, v116, v118
    s_sub_u32 s39, s39, 1
    s_cmp_lg_u32 s39, 0
    s_cbranch_scc1 loop0
    v_cmp_gt_u32 vcc, 1, v15
    s_cbranch_vccnz spin_f
ok_f:
    s_mov_b32 s39, 7
.p2align 6
loop1:
    v_mfma_f32_16x16x32_bf16 v[80:83], a[208:211], a[0:3], v[96:99]
    ds_read_b128 a[240:243], v1 offset:512
    v_add_f32 v117, v117, v119
    v_mfma_f32_16x16x32_bf16 v[80:83], a[212:215], a[4:7], v[80:83]
    buffer_load_dwordx4 v114, s[20:23], s49 offen offset:0 lds
    v_mfma_f32_16x16x32_bf16 v[84:87], a[212:215], a[36:39], v[100:103]
    ds_read_b128 a[244:247], v1 offset:576
    v_cvt_pk_bf16_f32 v24, v64, v65
    v_mfma_f32_16x16x32_bf16 v[84:87], a[208:211], a[32:35], v[84:87]
    v_cvt_pk_bf16_f32 v25, v66, v67
    v_mfma_f32_16x16x32_bf16 v[84:87], a[216:219], a[40:43], v[84:87]
    ds_read_b128 a[248:251], v1 offset:640
    v_cvt_pk_bf16_f32 v28, v68, v69
    v_mfma_f32_16x16x32_bf16 v[84:87], a[220:223], a[44:47], v[84:87]
    buffer_load_dwordx4 v112, s[20:23], s49 offen offset:1056 lds
    v_mfma_f32_16x16x32_bf16 v[80:83], a[220:223], a[12:15], v[80:83]
    ds_read_b128 a[252:255], v1 offset:704
    v_cvt_pk_bf16_f32 v29, v70, v71
    v_mfma_f32_16x16x32_bf16 v[80:83], a[216:219], a[8:11], v[80:83]
    s_waitcnt lgkmcnt(4)
    v_cvt_pk_bf16_f32 v26, v72, v73
    v_mfma_f32_16x16x32_bf16 v[80:83], a[224:227], a[16:19], v[80:83]
    ds_read_b128 a[192:195], v1 offset:768
    v_cvt_pk_bf16_f32 v27, v74, v75
    v_mfma_f32_16x16x32_bf16 v[80:83], a[228:231], a[20:23], v[80:83]
    buffer_load_dwordx4 v121, s[20:23], s49 offen offset:2112 lds
    v_mfma_f32_16x16x32_bf16 v[84:87], a[228:231], a[52:55], v[84:87]
    ds_read_b128 a[196:199], v1 offset:832
    v_cvt_pk_bf16_f32 v30, v76, v77
    v_mfma_f32_16x16x32_bf16 v[84:87], a[224:227], a[48:51], v[84:87]
    v_cvt_pk_bf16_f32 v31, v78, v79
    v_mfma_f32_16x16x32_bf16 v[84:87], a[232:235], a[56:59], v[84:87]
    ds_read_b128 a[200:203], v1 offset:896
    v_mfma_f32_16x16x32_bf16 v[84:87], a[236:239], a[60:63], v[84:87]
    buffer_load_dwordx4 v122, s[20:23], s49 offen offset:3168 lds
    s_add_u32 m0, s37, 0
    v_mfma_f32_16x16x32_bf16 v[80:83], a[236:239], a[28:31], v[80:83]
    s_add_u32 s49, s49, 16384
    ds_read_b128 a[204:207], v1 offset:960
    v_mfma_f32_16x16x32_bf16 v[80:83], a[232:235], a[24:27], v[80:83]
    s_waitcnt lgkmcnt(4)
    v_mfma_f32_16x16x32_bf16 v[88:91], a[240:243], a[0:3], v[96:99]
    ds_read_b128 a[208:211], v1 offset:16896
    v_mfma_f32_16x16x32_bf16 v[88:91], a[244:247], a[4:7], v[88:91]
    buffer_load_dword v46, v43, s[32:35], s92 offen sc1
    v_mfma_f32_16x16x32_bf16 v[92:95], a[244:247], a[36:39], v[100:103]
    s_add_u32 s92, s92, 1280
    ds_read_b128 a[212:215], v1 offset:16960
    v_mfma_f32_16x16x32_bf16 v[92:95], a[240:243], a[32:35], v[92:95]
    v_exp_f32 v68, v84
    v_mfma_f32_16x16x32_bf16 v[92:95], a[248:251], a[40:43], v[92:95]
    ds_read_b128 a[216:219], v1 offset:17024
    v_mfma_f32_16x16x32_bf16 v[92:95], a[252:255], a[44:47], v[92:95]
    v_exp_f32 v69, v85
    v_mfma_f32_16x16x32_bf16 v[88:91], a[252:255], a[12:15], v[88:91]
    ds_read_b128 a[220:223], v1 offset:17088
    v_add_f32 v119, v68, v69
    v_mfma_f32_16x16x32_bf16 v[88:91], a[248:251], a[8:11], v[88:91]
    s_waitcnt lgkmcnt(4)
    v_exp_f32 v70, v86
    v_mfma_f32_16x16x32_bf16 v[88:91], a[192:195], a[16:19], v[88:91]
    ds_read_b128 a[224:227], v1 offset:17152
    v_cvt_pk_bf16_f32 v20, v68, v69
    v_mfma_f32_16x16x32_bf16 v[88:91], a[196:199], a[20:23], v[88:91]
    v_exp_f32 v71, v87
    v_mfma_f32_16x16x32_bf16 v[92:95], a[196:199], a[52:55], v[92:95]
    ds_read_b128 a[228:231], v1 offset:17216
    v_add_f32 v119, v119, v70
    v_mfma_f32_16x16x32_bf16 v[92:95], a[192:195], a[48:51], v[92:95]
    v_exp_f32 v64, v80
    v_mfma_f32_16x16x32_bf16 v[92:95], a[200:203], a[56:59], v[92:95]
    ds_read_b128 a[232:235], v1 offset:17280
    v_cvt_pk_bf16_f32 v21, v70, v71
    v_mfma_f32_16x16x32_bf16 v[92:95], a[204:207], a[60:63], v[92:95]
    v_exp_f32 v65, v81
    v_mfma_f32_16x16x32_bf16 v[88:91], a[204:207], a[28:31], v[88:91]
    ds_read_b128 a[236:239], v1 offset:17344
    v_add_f32 v119, v119, v71
    v_mfma_f32_16x16x32_bf16 v[88:91], a[200:203], a[24:27], v[88:91]
    s_waitcnt lgkmcnt(4)
    v_exp_f32 v66, v82
    v_mfma_f32_16x16x32_bf16 v[48:51], a[208:211], a[0:3], v[96:99]
    ds_read_b128 a[240:243], v1 offset:17408
    v_add_f32 v118, v64, v65
    v_mfma_f32_16x16x32_bf16 v[48:51], a[212:215], a[4:7], v[48:51]
    v_exp_f32 v67, v83
    v_mfma_f32_16x16x32_bf16 v[52:55], a[212:215], a[36:39], v[100:103]
    ds_read_b128 a[244:247], v1 offset:17472
    v_cvt_pk_bf16_f32 v16, v64, v65
    v_mfma_f32_16x16x32_bf16 v[52:55], a[208:211], a[32:35], v[52:55]
    v_exp_f32 v76, v92
    v_mfma_f32_16x16x32_bf16 v[52:55], a[216:219], a[40:43], v[52:55]
    ds_read_b128 a[248:251], v1 offset:17536
    v_add_f32 v118, v118, v66
    v_mfma_f32_16x16x32_bf16 v[52:55], a[220:223], a[44:47], v[52:55]
    v_exp_f32 v77, v93
    v_mfma_f32_16x16x32_bf16 v[48:51], a[220:223], a[12:15], v[48:51]
    ds_read_b128 a[252:255], v1 offset:17600
    v_cvt_pk_bf16_f32 v17, v66, v67
    v_mfma_f32_16x16x32_bf16 v[48:51], a[216:219], a[8:11], v[48:51]
    s_waitcnt lgkmcnt(4)
    v_exp_f32 v78, v94
    v_mfma_f32_16x16x32_bf16 v[48:51], a[224:227], a[16:19], v[48:51]
    ds_read_b128 a[192:195], v1 offset:17664
    v_add_f32 v118, v118, v67
    v_mfma_f32_16x16x32_bf16 v[48:51], a[228:231], a[20:23], v[48:51]
    v_exp_f32 v79, v95
    v_mfma_f32_16x16x32_bf16 v[52:55], a[228:231], a[52:55], v[52:55]
    ds_read_b128 a[196:199], v1 offset:17728
    v_add_f32 v119, v119, v76
    v_mfma_f32_16x16x32_bf16 v[52:55], a[224:227], a[48:51], v[52:55]
    v_exp_f32 v72, v88
    v_mfma_f32_16x16x32_bf16 v[52:55], a[232:235], a[56:59], v[52:55]
    ds_read_b128 a[200:203], v1 offset:17792
    v_cvt_pk_bf16_f32 v22, v76, v77
    v_mfma_f32_16x16x32_bf16 v[52:55], a[236:239], a[60:63], v[52:55]
    v_exp_f32 v73, v89
    v_mfma_f32_16x16x32_bf16 v[48:51], a[236:239], a[28:31], v[48:51]
    ds_read_b128 a[204:207], v1 offset:17856
    v_add_f32 v119, v119, v77
    v_mfma_f32_16x16x32_bf16 v[48:51], a[232:235], a[24:27], v[48:51]
    s_waitcnt vmcnt(9) lgkmcnt(4)
    s_barrier
    v_add_f32 v119, v119, v78
    v_mfma_f32_16x16x32_bf16 v[56:59], a[240:243], a[0:3], v[96:99]
    ds_read_b64_tr_b16 a[208:209], v0 offset:33792
    ds_read_b64_tr_b16 a[210:211], v0 offset:34304
    v_mfma_f32_16x16x32_bf16 v[56:59], a[244:247], a[4:7], v[56:59]
    v_exp_f32 v74, v90
    v_mfma_f32_16x16x32_bf16 v[60:63], a[244:247], a[36:39], v[100:103]
    ds_read_b64_tr_b16 a[212:213], v0 offset:50688
    ds_read_b64_tr_b16 a[214:215], v0 offset:51200
    v_mfma_f32_16x16x32_bf16 v[60:63], a[240:243], a[32:35], v[60:63]
    v_exp_f32 v75, v91
    v_mfma_f32_16x16x32_bf16 v[60:63], a[248:251], a[40:43], v[60:63]
    ds_read_b64_tr_b16 a[216:217], v0 offset:33824
    ds_read_b64_tr_b16 a[218:219], v0 offset:34336
    v_mfma_f32_16x16x32_bf16 v[60:63], a[252:255], a[44:47], v[60:63]
    buffer_load_dwordx4 v114, s[24:27], s38 offen offset:0 lds
    v_mfma_f32_16x16x32_bf16 v[56:59], a[252:255], a[12:15], v[56:59]
    ds_read_b64_tr_b16 a[220:221], v0 offset:50720
    ds_read_b64_tr_b16 a[222:223], v0 offset:51232
    v_mfma_f32_16x16x32_bf16 v[56:59], a[248:251], a[8:11], v[56:59]
    s_waitcnt lgkmcnt(8)
    v_exp_f32 v68, v52
    v_mfma_f32_16x16x32_bf16 v[56:59], a[192:195], a[16:19], v[56:59]
    ds_read_b64_tr_b16 a[224:225], v0 offset:33856
    ds_read_b64_tr_b16 a[226:227], v0 offset:34368
    v_mfma_f32_16x16x32_bf16 v[56:59], a[196:199], a[20:23], v[56:59]
    buffer_load_dwordx4 v112, s[24:27], s38 offen offset:1056 lds
    v_mfma_f32_16x16x32_bf16 v[60:63], a[196:199], a[52:55], v[60:63]
    ds_read_b64_tr_b16 a[228:229], v0 offset:50752
    ds_read_b64_tr_b16 a[230:231], v0 offset:51264
    v_mfma_f32_16x16x32_bf16 v[60:63], a[192:195], a[48:51], v[60:63]
    v_exp_f32 v69, v53
    v_mfma_f32_16x16x32_bf16 v[60:63], a[200:203], a[56:59], v[60:63]
    ds_read_b64_tr_b16 a[232:233], v0 offset:33888
    ds_read_b64_tr_b16 a[234:235], v0 offset:34400
    v_mfma_f32_16x16x32_bf16 v[60:63], a[204:207], a[60:63], v[60:63]
    buffer_load_dwordx4 v121, s[24:27], s38 offen offset:2112 lds
    v_mfma_f32_16x16x32_bf16 v[56:59], a[204:207], a[28:31], v[56:59]
    ds_read_b64_tr_b16 a[236:237], v0 offset:50784
    ds_read_b64_tr_b16 a[238:239], v0 offset:51296
    v_mfma_f32_16x16x32_bf16 v[56:59], a[200:203], a[24:27], v[56:59]
    s_waitcnt lgkmcnt(8)
    v_exp_f32 v70, v54
    v_mfma_f32_16x16x32_bf16 v[128:131], a[208:211], v[32:35], v[128:131]
    ds_read_b64_tr_b16 a[240:241], v0 offset:33920
    ds_read_b64_tr_b16 a[242:243], v0 offset:34432
    v_mfma_f32_16x16x32_bf16 v[128:131], a[212:215], v[24:27], v[128:131]
    buffer_load_dwordx4 v122, s[24:27], s38 offen offset:3168 lds
    s_add_u32 m0, s37, 16896
    v_mfma_f32_16x16x32_bf16 v[132:135], a[212:215], v[28:31], v[132:135]
    ds_read_b64_tr_b16 a[244:245], v0 offset:50816
    ds_read_b64_tr_b16 a[246:247], v0 offset:51328
    v_mfma_f32_16x16x32_bf16 v[132:135], a[208:211], v[36:39], v[132:135]
    s_add_u32 s38, s38, 16384
    v_exp_f32 v71, v55
    v_mfma_f32_16x16x32_bf16 v[140:143], a[216:219], v[36:39], v[140:143]
    ds_read_b64_tr_b16 a[248:249], v0 offset:33952
    ds_read_b64_tr_b16 a[250:251], v0 offset:34464
    v_mfma_f32_16x16x32_bf16 v[140:143], a[220:223], v[28:31], v[140:143]
    buffer_load_dwordx4 v114, s[24:27], s38 offen offset:0 lds
    v_mfma_f32_16x16x32_bf16 v[136:139], a[220:223], v[24:27], v[136:139]
    ds_read_b64_tr_b16 a[252:253], v0 offset:50848
    ds_read_b64_tr_b16 a[254:255], v0 offset:51360
    v_mfma_f32_16x16x32_bf16 v[136:139], a[216:219], v[32:35], v[136:139]
    s_waitcnt lgkmcnt(8)
    v_exp_f32 v64, v48
    v_mfma_f32_16x16x32_bf16 v[144:147], a[224:227], v[32:35], v[144:147]
    ds_read_b64_tr_b16 a[192:193], v0 offset:33984
    ds_read_b64_tr_b16 a[194:195], v0 offset:34496
    v_mfma_f32_16x16x32_bf16 v[144:147], a[228:231], v[24:27], v[144:147]
    buffer_load_dwordx4 v112, s[24:27], s38 offen offset:1056 lds
    v_mfma_f32_16x16x32_bf16 v[148:151], a[228:231], v[28:31], v[148:151]
    ds_read_b64_tr_b16 a[196:197], v0 offset:50880
    ds_read_b64_tr_b16 a[198:199], v0 offset:51392
    v_mfma_f32_16x16x32_bf16 v[148:151], a[224:227], v[36:39], v[148:151]
    v_exp_f32 v65, v49
    v_mfma_f32_16x16x32_bf16 v[156:159], a[232:235], v[36:39], v[156:159]
    ds_read_b64_tr_b16 a[200:201], v0 offset:34016
    ds_read_b64_tr_b16 a[202:203], v0 offset:34528
    v_mfma_f32_16x16x32_bf16 v[156:159], a[236:239], v[28:31], v[156:159]
    buffer_load_dwordx4 v121, s[24:27], s38 offen offset:2112 lds
    v_mfma_f32_16x16x32_bf16 v[152:155], a[236:239], v[24:27], v[152:155]
    ds_read_b64_tr_b16 a[204:205], v0 offset:50912
    ds_read_b64_tr_b16 a[206:207], v0 offset:51424
    v_mfma_f32_16x16x32_bf16 v[152:155], a[232:235], v[32:35], v[152:155]
    s_waitcnt lgkmcnt(8)
    v_exp_f32 v66, v50
    v_mfma_f32_16x16x32_bf16 v[160:163], a[240:243], v[32:35], v[160:163]
    ds_read_b64_tr_b16 a[208:209], v0 offset:34048
    ds_read_b64_tr_b16 a[210:211], v0 offset:34560
    v_mfma_f32_16x16x32_bf16 v[160:163], a[244:247], v[24:27], v[160:163]
    buffer_load_dwordx4 v122, s[24:27], s38 offen offset:3168 lds
    s_add_u32 m0, s37, 67584
    v_mfma_f32_16x16x32_bf16 v[164:167], a[244:247], v[28:31], v[164:167]
    ds_read_b64_tr_b16 a[212:213], v0 offset:50944
    ds_read_b64_tr_b16 a[214:215], v0 offset:51456
    v_mfma_f32_16x16x32_bf16 v[164:167], a[240:243], v[36:39], v[164:167]
    s_add_u32 s38, s38, 16384
    v_exp_f32 v67, v51
    v_mfma_f32_16x16x32_bf16 v[172:175], a[248:251], v[36:39], v[172:175]
    ds_read_b64_tr_b16 a[216:217], v0 offset:34080
    v_cvt_pk_bf16_f32 v23, v78, v79
    v_mfma_f32_16x16x32_bf16 v[172:175], a[252:255], v[28:31], v[172:175]
    ds_read_b64_tr_b16 a[218:219], v0 offset:34592
    v_add_f32 v119, v119, v79
    v_mfma_f32_16x16x32_bf16 v[168:171], a[252:255], v[24:27], v[168:171]
    ds_read_b64_tr_b16 a[220:221], v0 offset:50976
    ds_read_b64_tr_b16 a[222:223], v0 offset:51488
    v_mfma_f32_16x16x32_bf16 v[168:171], a[248:251], v[32:35], v[168:171]
    s_waitcnt lgkmcnt(8)
    v_exp_f32 v76, v60
    v_mfma_f32_16x16x32_bf16 v[176:179], a[192:195], v[32:35], v[176:179]
    ds_read_b64_tr_b16 a[224:225], v0 offset:34112
    v_add_f32 v118, v118, v72
    v_mfma_f32_16x16x32_bf16 v[176:179], a[196:199], v[24:27], v[176:179]
    ds_read_b64_tr_b16 a[226:227], v0 offset:34624
    v_cvt_pk_bf16_f32 v18, v72, v73
    v_mfma_f32_16x16x32_bf16 v[180:183], a[196:199], v[28:31], v[180:183]
    ds_read_b64_tr_b16 a[228:229], v0 offset:51008
    ds_read_b64_tr_b16 a[230:231], v0 offset:51520
    v_mfma_f32_16x16x32_bf16 v[180:183], a[192:195], v[36:39], v[180:183]
    v_exp_f32 v77, v61
    v_mfma_f32_16x16x32_bf16 v[188:191], a[200:203], v[36:39], v[188:191]
    ds_read_b64_tr_b16 a[232:233], v0 offset:34144
    v_add_f32 v118, v118, v73
    v_mfma_f32_16x16x32_bf16 v[188:191], a[204:207], v[28:31], v[188:191]
    ds_read_b64_tr_b16 a[234:235], v0 offset:34656
    v_add_f32 v118, v118, v74
    v_mfma_f32_16x16x32_bf16 v[184:187], a[204:207], v[24:27], v[184:187]
    ds_read_b64_tr_b16 a[236:237], v0 offset:51040
    ds_read_b64_tr_b16 a[238:239], v0 offset:51552
    v_mfma_f32_16x16x32_bf16 v[184:187], a[200:203], v[32:35], v[184:187]
    s_waitcnt lgkmcnt(8)
    v_exp_f32 v78, v62
    v_mfma_f32_16x16x32_bf16 v[192:195], a[208:211], v[32:35], v[192:195]
    ds_read_b64_tr_b16 a[240:241], v0 offset:34176
    v_cvt_pk_bf16_f32 v19, v74, v75
    v_mfma_f32_16x16x32_bf16 v[192:195], a[212:215], v[24:27], v[192:195]
    ds_read_b64_tr_b16 a[242:243], v0 offset:34688
    v_add_f32 v118, v118, v75
    v_mfma_f32_16x16x32_bf16 v[196:199], a[212:215], v[28:31], v[196:199]
    ds_read_b64_tr_b16 a[244:245], v0 offset:51072
    ds_read_b64_tr_b16 a[246:247], v0 offset:51584
    v_mfma_f32_16x16x32_bf16 v[196:199], a[208:211], v[36:39], v[196:199]
    v_exp_f32 v79, v63
    v_mfma_f32_16x16x32_bf16 v[204:207], a[216:219], v[36:39], v[204:207]
    ds_read_b64_tr_b16 a[248:249], v0 offset:34208
    v_add_f32 v119, v119, v68
    v_mfma_f32_16x16x32_bf16 v[204:207], a[220:223], v[28:31], v[204:207]
    ds_read_b64_tr_b16 a[250:251], v0 offset:34720
    v_add_f32 v119, v119, v69
    v_mfma_f32_16x16x32_bf16 v[200:203], a[220:223], v[24:27], v[200:203]
    ds_read_b64_tr_b16 a[252:253], v0 offset:51104
    ds_read_b64_tr_b16 a[254:255], v0 offset:51616
    v_mfma_f32_16x16x32_bf16 v[200:203], a[216:219], v[32:35], v[200:203]
    s_waitcnt lgkmcnt(8)
    v_exp_f32 v72, v56
    v_mfma_f32_16x16x32_bf16 v[208:211], a[224:227], v[32:35], v[208:211]
    ds_read_b64_tr_b16 a[192:193], v0 offset:34240
    v_add_f32 v119, v119, v70
    v_mfma_f32_16x16x32_bf16 v[208:211], a[228:231], v[24:27], v[208:211]
    ds_read_b64_tr_b16 a[194:195], v0 offset:34752
    v_add_f32 v119, v119, v71
    v_mfma_f32_16x16x32_bf16 v[212:215], a[228:231], v[28:31], v[212:215]
    ds_read_b64_tr_b16 a[196:197], v0 offset:51136
    ds_read_b64_tr_b16 a[198:199], v0 offset:51648
    v_mfma_f32_16x16x32_bf16 v[212:215], a[224:227], v[36:39], v[212:215]
    v_exp_f32 v73, v57
    v_mfma_f32_16x16x32_bf16 v[220:223], a[232:235], v[36:39], v[220:223]
    ds_read_b64_tr_b16 a[200:201], v0 offset:34272
    v_add_f32 v118, v118, v64
    v_mfma_f32_16x16x32_bf16 v[220:223], a[236:239], v[28:31], v[220:223]
    ds_read_b64_tr_b16 a[202:203], v0 offset:34784
    v_add_f32 v118, v118, v65
    v_mfma_f32_16x16x32_bf16 v[216:219], a[236:239], v[24:27], v[216:219]
    ds_read_b64_tr_b16 a[204:205], v0 offset:51168
    ds_read_b64_tr_b16 a[206:207], v0 offset:51680
    v_mfma_f32_16x16x32_bf16 v[216:219], a[232:235], v[32:35], v[216:219]
    s_waitcnt vmcnt(9) lgkmcnt(8)
    s_barrier
    v_add_f32 v118, v118, v66
    v_mfma_f32_16x16x32_bf16 v[224:227], a[240:243], v[32:35], v[224:227]
    ds_read_b128 a[208:211], v1 offset:33792
    v_add_f32 v118, v118, v67
    v_mfma_f32_16x16x32_bf16 v[224:227], a[244:247], v[24:27], v[224:227]
    buffer_load_dwordx4 v114, s[20:23], s49 offen offset:0 lds
    v_mfma_f32_16x16x32_bf16 v[228:231], a[244:247], v[28:31], v[228:231]
    ds_read_b128 a[212:215], v1 offset:33856
    v_add_f32 v119, v119, v76
    v_mfma_f32_16x16x32_bf16 v[228:231], a[240:243], v[36:39], v[228:231]
    v_exp_f32 v74, v58
    v_mfma_f32_16x16x32_bf16 v[236:239], a[248:251], v[36:39], v[236:239]
    ds_read_b128 a[216:219], v1 offset:33920
    v_add_f32 v119, v119, v77
    v_mfma_f32_16x16x32_bf16 v[236:239], a[252:255], v[28:31], v[236:239]
    buffer_load_dwordx4 v112, s[20:23], s49 offen offset:1056 lds
    v_mfma_f32_16x16x32_bf16 v[232:235], a[252:255], v[24:27], v[232:235]
    ds_read_b128 a[220:223], v1 offset:33984
    v_add_f32 v119, v119, v78
    v_mfma_f32_16x16x32_bf16 v[232:235], a[248:251], v[32:35], v[232:235]
    s_waitcnt lgkmcnt(4)
    v_exp_f32 v75, v59
    v_mfma_f32_16x16x32_bf16 v[240:243], a[192:195], v[32:35], v[240:243]
    ds_read_b128 a[224:227], v1 offset:34048
    v_add_f32 v119, v119, v79
    v_mfma_f32_16x16x32_bf16 v[240:243], a[196:199], v[24:27], v[240:243]
    buffer_load_dwordx4 v121, s[20:23], s49 offen offset:2112 lds
    v_mfma_f32_16x16x32_bf16 v[244:247], a[196:199], v[28:31], v[244:247]
    ds_read_b128 a[228:231], v1 offset:34112
    v_add_f32 v118, v118, v72
    v_mfma_f32_16x16x32_bf16 v[244:247], a[192:195], v[36:39], v[244:247]
    v_add_f32 v118, v118, v73
    v_add_f32 v118, v118, v75
    v_mfma_f32_16x16x32_bf16 v[252:255], a[200:203], v[36:39], v[252:255]
    ds_read_b128 a[232:235], v1 offset:34176
    v_add_f32 v118, v118, v74
    v_mfma_f32_16x16x32_bf16 v[252:255], a[204:207], v[28:31], v[252:255]
    buffer_load_dwordx4 v122, s[20:23], s49 offen offset:3168 lds
    s_add_u32 m0, s37, 84480
    v_add_f32 v120, v118, v119
    v_mfma_f32_16x16x32_bf16 v[248:251], a[204:207], v[24:27], v[248:251]
    s_add_u32 s49, s49, 16384
    ds_read_b128 a[236:239], v1 offset:34240
    v_cmp_nge_f32 vcc, s40, v120
    v_mfma_f32_16x16x32_bf16 v[248:251], a[200:203], v[32:35], v[248:251]
    s_waitcnt lgkmcnt(4)
    s_cbranch_vccnz slow_l11
back_l11:
    v_add_f32 v116, v116, v118
    v_mfma_f32_16x16x32_bf16 v[80:83], a[208:211], a[0:3], v[96:99]
    ds_read_b128 a[240:243], v1 offset:34304
    v_add_f32 v117, v117, v119
    v_mfma_f32_16x16x32_bf16 v[80:83], a[212:215], a[4:7], v[80:83]
    buffer_load_dwordx4 v114, s[20:23], s49 offen offset:0 lds
    v_mfma_f32_16x16x32_bf16 v[84:87], a[212:215], a[36:39], v[100:103]
    ds_read_b128 a[244:247], v1 offset:34368
    v_cvt_pk_bf16_f32 v24, v64, v65
    v_mfma_f32_16x16x32_bf16 v[84:87], a[208:211], a[32:35], v[84:87]
    v_cvt_pk_bf16_f32 v25, v66, v67
    v_mfma_f32_16x16x32_bf16 v[84:87], a[216:219], a[40:43], v[84:87]
    ds_read_b128 a[248:251], v1 offset:34432
    v_cvt_pk_bf16_f32 v28, v68, v69
    v_mfma_f32_16x16x32_bf16 v[84:87], a[220:223], a[44:47], v[84:87]
    buffer_load_dwordx4 v112, s[20:23], s49 offen offset:1056 lds
    v_mfma_f32_16x16x32_bf16 v[80:83], a[220:223], a[12:15], v[80:83]
    ds_read_b128 a[252:255], v1 offset:34496
    v_cvt_pk_bf16_f32 v29, v70, v71
    v_mfma_f32_16x16x32_bf16 v[80:83], a[216:219], a[8:11], v[80:83]
    s_waitcnt lgkmcnt(4)
    v_cvt_pk_bf16_f32 v26, v72, v73
    v_mfma_f32_16x16x32_bf16 v[80:83], a[224:227], a[16:19], v[80:83]
    ds_read_b128 a[192:195], v1 offset:34560
    v_cvt_pk_bf16_f32 v27, v74, v75
    v_mfma_f32_16x16x32_bf16 v[80:83], a[228:231], a[20:23], v[80:83]
    buffer_load_dwordx4 v121, s[20:23], s49 offen offset:2112 lds
    v_mfma_f32_16x16x32_bf16 v[84:87], a[228:231], a[52:55], v[84:87]
    ds_read_b128 a[196:199], v1 offset:34624
    v_cvt_pk_bf16_f32 v30, v76, v77
    v_mfma_f32_16x16x32_bf16 v[84:87], a[224:227], a[48:51], v[84:87]
    v_cvt_pk_bf16_f32 v31, v78, v79
    v_mfma_f32_16x16x32_bf16 v[84:87], a[232:235], a[56:59], v[84:87]
    ds_read_b128 a[200:203], v1 offset:34688
    v_mfma_f32_16x16x32_bf16 v[84:87], a[236:239], a[60:63], v[84:87]
    buffer_load_dwordx4 v122, s[20:23], s49 offen offset:3168 lds
    s_add_u32 m0, s37, 33792
    v_mfma_f32_16x16x32_bf16 v[80:83], a[236:239], a[28:31], v[80:83]
    s_add_u32 s49, s49, 16384
    ds_read_b128 a[204:207], v1 offset:34752
    v_mfma_f32_16x16x32_bf16 v[80:83], a[232:235], a[24:27], v[80:83]
    s_waitcnt lgkmcnt(4)
    v_mfma_f32_16x16x32_bf16 v[88:91], a[240:243], a[0:3], v[96:99]
    ds_read_b128 a[208:211], v1 offset:50688
    v_mfma_f32_16x16x32_bf16 v[88:91], a[244:247], a[4:7], v[88:91]
    v_mfma_f32_16x16x32_bf16 v[92:95], a[244:247], a[36:39], v[100:103]
    ds_read_b128 a[212:215], v1 offset:50752
    v_mfma_f32_16x16x32_bf16 v[92:95], a[240:243], a[32:35], v[92:95]
    v_exp_f32 v68, v84
    v_mfma_f32_16x16x32_bf16 v[92:95], a[248:251], a[40:43], v[92:95]
    ds_read_b128 a[216:219], v1 offset:50816
    v_mfma_f32_16x16x32_bf16 v[92:95], a[252:255], a[44:47], v[92:95]
    v_exp_f32 v69, v85
    v_mfma_f32_16x16x32_bf16 v[88:91], a[252:255], a[12:15], v[88:91]
    ds_read_b128 a[220:223], v1 offset:50880
    v_add_f32 v119, v68, v69
    v_mfma_f32_16x16x32_bf16 v[88:91], a[248:251], a[8:11], v[88:91]
    s_waitcnt lgkmcnt(4)
    v_exp_f32 v70, v86
    v_mfma_f32_16x16x32_bf16 v[88:91], a[192:195], a[16:19], v[88:91]
    ds_read_b128 a[224:227], v1 offset:50944
    v_cvt_pk_bf16_f32 v36, v68, v69
    v_mfma_f32_16x16x32_bf16 v[88:91], a[196:199], a[20:23], v[88:91]
    v_exp_f32 v71, v87
    v_mfma_f32_16x16x32_bf16 v[92:95], a[196:199], a[52:55], v[92:95]
    ds_read_b128 a[228:231], v1 offset:51008
    v_add_f32 v119, v119, v70
    v_mfma_f32_16x16x32_bf16 v[92:95], a[192:195], a[48:51], v[92:95]
    v_exp_f32 v64, v80
    v_mfma_f32_16x16x32_bf16 v[92:95], a[200:203], a[56:59], v[92:95]
    ds_read_b128 a[232:235], v1 offset:51072
    v_cvt_pk_bf16_f32 v37, v70, v71
    v_mfma_f32_16x16x32_bf16 v[92:95], a[204:207], a[60:63], v[92:95]
    v_exp_f32 v65, v81
    v_mfma_f32_16x16x32_bf16 v[88:91], a[204:207], a[28:31], v[88:91]
    ds_read_b128 a[236:239], v1 offset:51136
    v_add_f32 v119, v119, v71
    v_mfma_f32_16x16x32_bf16 v[88:91], a[200:203], a[24:27], v[88:91]
    s_waitcnt lgkmcnt(4)
    v_exp_f32 v66, v82
    v_mfma_f32_16x16x32_bf16 v[48:51], a[208:211], a[0:3], v[96:99]
    ds_read_b128 a[240:243], v1 offset:51200
    v_add_f32 v118, v64, v65
    v_mfma_f32_16x16x32_bf16 v[48:51], a[212:215], a[4:7], v[48:51]
    v_exp_f32 v67, v83
    v_mfma_f32_16x16x32_bf16 v[52:55], a[212:215], a[36:39], v[100:103]
    ds_read_b128 a[244:247], v1 offset:51264
    v_cvt_pk_bf16_f32 v32, v64, v65
    v_mfma_f32_16x16x32_bf16 v[52:55], a[208:211], a[32:35], v[52:55]
    v_exp_f32 v76, v92
    v_mfma_f32_16x16x32_bf16 v[52:55], a[216:219], a[40:43], v[52:55]
    ds_read_b128 a[248:251], v1 offset:51328
    v_add_f32 v118, v118, v66
    v_mfma_f32_16x16x32_bf16 v[52:55], a[220:223], a[44:47], v[52:55]
    v_exp_f32 v77, v93
    v_mfma_f32_16x16x32_bf16 v[48:51], a[220:223], a[12:15], v[48:51]
    ds_read_b128 a[252:255], v1 offset:51392
    v_cvt_pk_bf16_f32 v33, v66, v67
    v_mfma_f32_16x16x32_bf16 v[48:51], a[216:219], a[8:11], v[48:51]
    s_waitcnt lgkmcnt(4)
    v_exp_f32 v78, v94
    v_mfma_f32_16x16x32_bf16 v[48:51], a[224:227], a[16:19], v[48:51]
    ds_read_b128 a[192:195], v1 offset:51456
    v_add_f32 v118, v118, v67
    v_mfma_f32_16x16x32_bf16 v[48:51], a[228:231], a[20:23], v[48:51]
    v_exp_f32 v79, v95
    v_mfma_f32_16x16x32_bf16 v[52:55], a[228:231], a[52:55], v[52:55]
    ds_read_b128 a[196:199], v1 offset:51520
    v_add_f32 v119, v119, v76
    v_mfma_f32_16x16x32_bf16 v[52:55], a[224:227], a[48:51], v[52:55]
    v_exp_f32 v72, v88
    v_mfma_f32_16x16x32_bf16 v[52:55], a[232:235], a[56:59], v[52:55]
    ds_read_b128 a[200:203], v1 offset:51584
    v_cvt_pk_bf16_f32 v38, v76, v77
    v_mfma_f32_16x16x32_bf16 v[52:55], a[236:239], a[60:63], v[52:55]
    v_exp_f32 v73, v89
    v_mfma_f32_16x16x32_bf16 v[48:51], a[236:239], a[28:31], v[48:51]
    ds_read_b128 a[204:207], v1 offset:51648
    v_add_f32 v119, v119, v77
    v_mfma_f32_16x16x32_bf16 v[48:51], a[232:235], a[24:27], v[48:51]
    s_waitcnt vmcnt(8) lgkmcnt(4)
    s_barrier
    v_add_f32 v119, v119, v78
    v_mfma_f32_16x16x32_bf16 v[56:59], a[240:243], a[0:3], v[96:99]
    ds_read_b64_tr_b16 a[208:209], v0 offset:0
    ds_read_b64_tr_b16 a[210:211], v0 offset:512
    v_mfma_f32_16x16x32_bf16 v[56:59], a[244:247], a[4:7], v[56:59]
    v_exp_f32 v74, v90
    v_mfma_f32_16x16x32_bf16 v[60:63], a[244:247], a[36:39], v[100:103]
    ds_read_b64_tr_b16 a[212:213], v0 offset:16896
    ds_read_b64_tr_b16 a[214:215], v0 offset:17408
    v_mfma_f32_16x16x32_bf16 v[60:63], a[240:243], a[32:35], v[60:63]
    v_exp_f32 v75, v91
    v_mfma_f32_16x16x32_bf16 v[60:63], a[248:251], a[40:43], v[60:63]
    ds_read_b64_tr_b16 a[216:217], v0 offset:32
    ds_read_b64_tr_b16 a[218:219], v0 offset:544
    v_mfma_f32_16x16x32_bf16 v[60:63], a[252:255], a[44:47], v[60:63]
    buffer_load_dwordx4 v114, s[24:27], s38 offen offset:0 lds
    v_mfma_f32_16x16x32_bf16 v[56:59], a[252:255], a[12:15], v[56:59]
    ds_read_b64_tr_b16 a[220:221], v0 offset:16928
    ds_read_b64_tr_b16 a[222:223], v0 offset:17440
    v_mfma_f32_16x16x32_bf16 v[56:59], a[248:251], a[8:11], v[56:59]
    s_waitcnt lgkmcnt(8)
    v_exp_f32 v68, v52
    v_mfma_f32_16x16x32_bf16 v[56:59], a[192:195], a[16:19], v[56:59]
    ds_read_b64_tr_b16 a[224:225], v0 offset:64
    ds_read_b64_tr_b16 a[226:227], v0 offset:576
    v_mfma_f32_16x16x32_bf16 v[56:59], a[196:199], a[20:23], v[56:59]
    buffer_load_dwordx4 v112, s[24:27], s38 offen offset:1056 lds
    v_mfma_f32_16x16x32_bf16 v[60:63], a[196:199], a[52:55], v[60:63]
    ds_read_b64_tr_b16 a[228:229], v0 offset:16960
    ds_read_b64_tr_b16 a[230:231], v0 offset:17472
    v_mfma_f32_16x16x32_bf16 v[60:63], a[192:195], a[48:51], v[60:63]
    v_exp_f32 v69, v53
    v_mfma_f32_16x16x32_bf16 v[60:63], a[200:203], a[56:59], v[60:63]
    ds_read_b64_tr_b16 a[232:233], v0 offset:96
    ds_read_b64_tr_b16 a[234:235], v0 offset:608
    v_mfma_f32_16x16x32_bf16 v[60:63], a[204:207], a[60:63], v[60:63]
    buffer_load_dwordx4 v121, s[24:27], s38 offen offset:2112 lds
    v_mfma_f32_16x16x32_bf16 v[56:59], a[204:207], a[28:31], v[56:59]
    ds_read_b64_tr_b16 a[236:237], v0 offset:16992
    ds_read_b64_tr_b16 a[238:239], v0 offset:17504
    v_mfma_f32_16x16x32_bf16 v[56:59], a[200:203], a[24:27], v[56:59]
    s_waitcnt lgkmcnt(8)
    v_exp_f32 v70, v54
    v_mfma_f32_16x16x32_bf16 v[128:131], a[208:211], v[16:19], v[128:131]
    ds_read_b64_tr_b16 a[240:241], v0 offset:128
    ds_read_b64_tr_b16 a[242:243], v0 offset:640
    v_mfma_f32_16x16x32_bf16 v[128:131], a[212:215], v[24:27], v[128:131]
    buffer_load_dwordx4 v122, s[24:27], s38 offen offset:3168 lds
    s_add_u32 m0, s37, 50688
    v_mfma_f32_16x16x32_bf16 v[132:135], a[212:215], v[28:31], v[132:135]
    ds_read_b64_tr_b16 a[244:245], v0 offset:17024
    ds_read_b64_tr_b16 a[246:247], v0 offset:17536
    v_mfma_f32_16x16x32_bf16 v[132:135], a[208:211], v[20:23], v[132:135]
    s_add_u32 s38, s38, 16384
    v_exp_f32 v71, v55
    v_mfma_f32_16x16x32_bf16 v[140:143], a[216:219], v[20:23], v[140:143]
    ds_read_b64_tr_b16 a[248:249], v0 offset:160
    ds_read_b64_tr_b16 a[250:251], v0 offset:672
    v_mfma_f32_16x16x32_bf16 v[140:143], a[220:223], v[28:31], v[140:143]
    buffer_load_dwordx4 v114, s[24:27], s38 offen offset:0 lds
    v_mfma_f32_16x16x32_bf16 v[136:139], a[220:223], v[24:27], v[136:139]
    ds_read_b64_tr_b16 a[252:253], v0 offset:17056
    ds_read_b64_tr_b16 a[254:255], v0 offset:17568
    v_mfma_f32_16x16x32_bf16 v[136:139], a[216:219], v[16:19], v[136:139]
    s_waitcnt lgkmcnt(8)
    v_exp_f32 v64, v48
    v_mfma_f32_16x16x32_bf16 v[144:147], a[224:227], v[16:19], v[144:147]
    ds_read_b64_tr_b16 a[192:193], v0 offset:192
    ds_read_b64_tr_b16 a[194:195], v0 offset:704
    v_mfma_f32_16x16x32_bf16 v[144:147], a[228:231], v[24:27], v[144:147]
    buffer_load_dwordx4 v112, s[24:27], s38 offen offset:1056 lds
    v_mfma_f32_16x16x32_bf16 v[148:151], a[228:231], v[28:31], v[148:151]
    ds_read_b64_tr_b16 a[196:197], v0 offset:17088
    ds_read_b64_tr_b16 a[198:199], v0 offset:17600
    v_mfma_f32_16x16x32_bf16 v[148:151], a[224:227], v[20:23], v[148:151]
    v_exp_f32 v65, v49
    v_mfma_f32_16x16x32_bf16 v[156:159], a[232:235], v[20:23], v[156:159]
    ds_read_b64_tr_b16 a[200:201], v0 offset:224
    ds_read_b64_tr_b16 a[202:203], v0 offset:736
    v_mfma_f32_16x16x32_bf16 v[156:159], a[236:239], v[28:31], v[156:159]
    buffer_load_dwordx4 v121, s[24:27], s38 offen offset:2112 lds
    v_mfma_f32_16x16x32_bf16 v[152:155], a[236:239], v[24:27], v[152:155]
    ds_read_b64_tr_b16 a[204:205], v0 offset:17120
    ds_read_b64_tr_b16 a[206:207], v0 offset:17632
    v_mfma_f32_16x16x32_bf16 v[152:155], a[232:235], v[16:19], v[152:155]
    s_waitcnt lgkmcnt(8)
    v_exp_f32 v66, v50
    v_mfma_f32_16x16x32_bf16 v[160:163], a[240:243], v[16:19], v[160:163]
    ds_read_b64_tr_b16 a[208:209], v0 offset:256
    ds_read_b64_tr_b16 a[210:211], v0 offset:768
    v_mfma_f32_16x16x32_bf16 v[160:163], a[244:247], v[24:27], v[160:163]
    buffer_load_dwordx4 v122, s[24:27], s38 offen offset:3168 lds
    s_add_u32 m0, s37, 101376
    v_mfma_f32_16x16x32_bf16 v[164:167], a[244:247], v[28:31], v[164:167]
    ds_read_b64_tr_b16 a[212:213], v0 offset:17152
    ds_read_b64_tr_b16 a[214:215], v0 offset:17664
    v_mfma_f32_16x16x32_bf16 v[164:167], a[240:243], v[20:23], v[164:167]
    s_add_u32 s38, s38, 16384
    v_exp_f32 v67, v51
    v_mfma_f32_16x16x32_bf16 v[172:175], a[248:251], v[20:23], v[172:175]
    ds_read_b64_tr_b16 a[216:217], v0 offset:288
    v_cvt_pk_bf16_f32 v39, v78, v79
    v_mfma_f32_16x16x32_bf16 v[172:175], a[252:255], v[28:31], v[172:175]
    ds_read_b64_tr_b16 a[218:219], v0 offset:800
    v_add_f32 v119, v119, v79
    v_mfma_f32_16x16x32_bf16 v[168:171], a[252:255], v[24:27], v[168:171]
    ds_read_b64_tr_b16 a[220:221], v0 offset:17184
    ds_read_b64_tr_b16 a[222:223], v0 offset:17696
    v_mfma_f32_16x16x32_bf16 v[168:171], a[248:251], v[16:19], v[168:171]
    s_waitcnt lgkmcnt(8)
    v_exp_f32 v76, v60
    v_mfma_f32_16x16x32_bf16 v[176:179], a[192:195], v[16:19], v[176:179]
    ds_read_b64_tr_b16 a[224:225], v0 offset:320
    v_add_f32 v118, v118, v72
    v_mfma_f32_16x16x32_bf16 v[176:179], a[196:199], v[24:27], v[176:179]
    ds_read_b64_tr_b16 a[226:227], v0 offset:832
    v_cvt_pk_bf16_f32 v34, v72, v73
    v_mfma_f32_16x16x32_bf16 v[180:183], a[196:199], v[28:31], v[180:183]
    ds_read_b64_tr_b16 a[228:229], v0 offset:17216
    ds_read_b64_tr_b16 a[230:231], v0 offset:17728
    v_mfma_f32_16x16x32_bf16 v[180:183], a[192:195], v[20:23], v[180:183]
    v_exp_f32 v77, v61
    v_mfma_f32_16x16x32_bf16 v[188:191], a[200:203], v[20:23], v[188:191]
    ds_read_b64_tr_b16 a[232:233], v0 offset:352
    v_add_f32 v118, v118, v73
    v_mfma_f32_16x16x32_bf16 v[188:191], a[204:207], v[28:31], v[188:191]
    ds_read_b64_tr_b16 a[234:235], v0 offset:864
    v_add_f32 v118, v118, v74
    v_mfma_f32_16x16x32_bf16 v[184:187], a[204:207], v[24:27], v[184:187]
    ds_read_b64_tr_b16 a[236:237], v0 offset:17248
    ds_read_b64_tr_b16 a[238:239], v0 offset:17760
    v_mfma_f32_16x16x32_bf16 v[184:187], a[200:203], v[16:19], v[184:187]
    s_waitcnt lgkmcnt(8)
    v_exp_f32 v78, v62
    v_mfma_f32_16x16x32_bf16 v[192:195], a[208:211], v[16:19], v[192:195]
    ds_read_b64_tr_b16 a[240:241], v0 offset:384
    v_cvt_pk_bf16_f32 v35, v74, v75
    v_mfma_f32_16x16x32_bf16 v[192:195], a[212:215], v[24:27], v[192:195]
    ds_read_b64_tr_b16 a[242:243], v0 offset:896
    v_add_f32 v118, v118, v75
    v_mfma_f32_16x16x32_bf16 v[196:199], a[212:215], v[28:31], v[196:199]
    ds_read_b64_tr_b16 a[244:245], v0 offset:17280
    ds_read_b64_tr_b16 a[246:247], v0 offset:17792
    v_mfma_f32_16x16x32_bf16 v[196:199], a[208:211], v[20:23], v[196:199]
    v_exp_f32 v79, v63
    v_mfma_f32_16x16x32_bf16 v[204:207], a[216:219], v[20:23], v[204:207]
    ds_read_b64_tr_b16 a[248:249], v0 offset:416
    v_add_f32 v119, v119, v68
    v_mfma_f32_16x16x32_bf16 v[204:207], a[220:223], v[28:31], v[204:207]
    ds_read_b64_tr_b16 a[250:251], v0 offset:928
    v_add_f32 v119, v119, v69
    v_mfma_f32_16x16x32_bf16 v[200:203], a[220:223], v[24:27], v[200:203]
    ds_read_b64_tr_b16 a[252:253], v0 offset:17312
    ds_read_b64_tr_b16 a[254:255], v0 offset:17824
    v_mfma_f32_16x16x32_bf16 v[200:203], a[216:219], v[16:19], v[200:203]
    s_waitcnt lgkmcnt(8)
    v_exp_f32 v72, v56
    v_mfma_f32_16x16x32_bf16 v[208:211], a[224:227], v[16:19], v[208:211]
    ds_read_b64_tr_b16 a[192:193], v0 offset:448
    v_add_f32 v119, v119, v70
    v_mfma_f32_16x16x32_bf16 v[208:211], a[228:231], v[24:27], v[208:211]
    ds_read_b64_tr_b16 a[194:195], v0 offset:960
    v_add_f32 v119, v119, v71
    v_mfma_f32_16x16x32_bf16 v[212:215], a[228:231], v[28:31], v[212:215]
    ds_read_b64_tr_b16 a[196:197], v0 offset:17344
    ds_read_b64_tr_b16 a[198:199], v0 offset:17856
    v_mfma_f32_16x16x32_bf16 v[212:215], a[224:227], v[20:23], v[212:215]
    v_exp_f32 v73, v57
    v_mfma_f32_16x16x32_bf16 v[220:223], a[232:235], v[20:23], v[220:223]
    ds_read_b64_tr_b16 a[200:201], v0 offset:480
    v_add_f32 v118, v118, v64
    v_mfma_f32_16x16x32_bf16 v[220:223], a[236:239], v[28:31], v[220:223]
    ds_read_b64_tr_b16 a[202:203], v0 offset:992
    v_add_f32 v118, v118, v65
    v_mfma_f32_16x16x32_bf16 v[216:219], a[236:239], v[24:27], v[216:219]
    ds_read_b64_tr_b16 a[204:205], v0 offset:17376
    ds_read_b64_tr_b16 a[206:207], v0 offset:17888
    v_mfma_f32_16x16x32_bf16 v[216:219], a[232:235], v[16:19], v[216:219]
    s_waitcnt vmcnt(8) lgkmcnt(8)
    s_barrier
    v_add_f32 v118, v118, v66
    v_mfma_f32_16x16x32_bf16 v[224:227], a[240:243], v[16:19], v[224:227]
    ds_read_b128 a[208:211], v1 offset:0
    v_add_f32 v118, v118, v67
    v_mfma_f32_16x16x32_bf16 v[224:227], a[244:247], v[24:27], v[224:227]
    buffer_load_dwordx4 v114, s[20:23], s49 offen offset:0 lds
    v_mfma_f32_16x16x32_bf16 v[228:231], a[244:247], v[28:31], v[228:231]
    ds_read_b128 a[212:215], v1 offset:64
    v_add_f32 v119, v119, v76
    v_mfma_f32_16x16x32_bf16 v[228:231], a[240:243], v[20:23], v[228:231]
    v_exp_f32 v74, v58
    v_mfma_f32_16x16x32_bf16 v[236:239], a[248:251], v[20:23], v[236:239]
    ds_read_b128 a[216:219], v1 offset:128
    v_add_f32 v119, v119, v77
    v_mfma_f32_16x16x32_bf16 v[236:239], a[252:255], v[28:31], v[236:239]
    buffer_load_dwordx4 v112, s[20:23], s49 offen offset:1056 lds
    v_mfma_f32_16x16x32_bf16 v[232:235], a[252:255], v[24:27], v[232:235]
    ds_read_b128 a[220:223], v1 offset:192
    v_add_f32 v119, v119, v78
    v_mfma_f32_16x16x32_bf16 v[232:235], a[248:251], v[16:19], v[232:235]
    s_waitcnt lgkmcnt(4)
    v_exp_f32 v75, v59
    v_mfma_f32_16x16x32_bf16 v[240:243], a[192:195], v[16:19], v[240:243]
    ds_read_b128 a[224:227], v1 offset:256
    v_add_f32 v119, v119, v79
    v_mfma_f32_16x16x32_bf16 v[240:243], a[196:199], v[24:27], v[240:243]
    buffer_load_dwordx4 v121, s[20:23], s49 offen offset:2112 lds
    v_mfma_f32_16x16x32_bf16 v[244:247], a[196:199], v[28:31], v[244:247]
    ds_read_b128 a[228:231], v1 offset:320
    v_add_f32 v118, v118, v72
    v_mfma_f32_16x16x32_bf16 v[244:247], a[192:195], v[20:23], v[244:247]
    v_add_f32 v118, v118, v73
    v_add_f32 v118, v118, v75
    v_mfma_f32_16x16x32_bf16 v[252:255], a[200:203], v[20:23], v[252:255]
    ds_read_b128 a[232:235], v1 offset:384
    v_add_f32 v118, v118, v74
    v_mfma_f32_16x16x32_bf16 v[252:255], a[204:207], v[28:31], v[252:255]
    buffer_load_dwordx4 v122, s[20:23], s49 offen offset:3168 lds
    s_add_u32 m0, s37, 118272
    v_add_f32 v120, v118, v119
    v_mfma_f32_16x16x32_bf16 v[248:251], a[204:207], v[24:27], v[248:251]
    s_add_u32 s49, s49, 16384
    ds_read_b128 a[236:239], v1 offset:448
    v_cmp_nge_f32 vcc, s40, v120
    v_mfma_f32_16x16x32_bf16 v[248:251], a[200:203], v[16:19], v[248:251]
    s_waitcnt lgkmcnt(4)
    s_cbranch_vccnz slow_l13
back_l13:
    v_add_f32 v116, v116, v118
    s_sub_u32 s39, s39, 1
    s_cmp_lg_u32 s39, 0
    s_cbranch_scc1 loop1
    v_mfma_f32_16x16x32_bf16 v[80:83], a[208:211], a[0:3], v[96:99]
    ds_read_b128 a[240:243], v1 offset:512
    v_add_f32 v117, v117, v119
    v_mfma_f32_16x16x32_bf16 v[80:83], a[212:215], a[4:7], v[80:83]
    buffer_load_dwordx4 v114, s[20:23], s49 offen offset:0 lds
    v_mfma_f32_16x16x32_bf16 v[84:87], a[212:215], a[36:39], v[100:103]
    ds_read_b128 a[244:247], v1 offset:576
    v_cvt_pk_bf16_f32 v24, v64, v65
    v_mfma_f32_16x16x32_bf16 v[84:87], a[208:211], a[32:35], v[84:87]
    v_cvt_pk_bf16_f32 v25, v66, v67
    v_mfma_f32_16x16x32_bf16 v[84:87], a[216:219], a[40:43], v[84:87]
    ds_read_b128 a[248:251], v1 offset:640
    v_cvt_pk_bf16_f32 v28, v68, v69
    v_mfma_f32_16x16x32_bf16 v[84:87], a[220:223], a[44:47], v[84:87]
    buffer_load_dwordx4 v112, s[20:23], s49 offen offset:1056 lds
    v_mfma_f32_16x16x32_bf16 v[80:83], a[220:223], a[12:15], v[80:83]
    ds_read_b128 a[252:255], v1 offset:704
    v_cvt_pk_bf16_f32 v29, v70, v71
    v_mfma_f32_16x16x32_bf16 v[80:83], a[216:219], a[8:11], v[80:83]
    s_waitcnt lgkmcnt(4)
    v_cvt_pk_bf16_f32 v26, v72, v73
    v_mfma_f32_16x16x32_bf16 v[80:83], a[224:227], a[16:19], v[80:83]
    ds_read_b128 a[192:195], v1 offset:768
    v_cvt_pk_bf16_f32 v27, v74, v75
    v_mfma_f32_16x16x32_bf16 v[80:83], a[228:231], a[20:23], v[80:83]
    buffer_load_dwordx4 v121, s[20:23], s49 offen offset:2112 lds
    v_accvgpr_read_b32 v113, a176
    v_add_u32 v115, 67584, v113
    v_mfma_f32_16x16x32_bf16 v[84:87], a[228:231], a[52:55], v[84:87]
    ds_read_b128 a[196:199], v1 offset:832
    v_cvt_pk_bf16_f32 v30, v76, v77
    v_mfma_f32_16x16x32_bf16 v[84:87], a[224:227], a[48:51], v[84:87]
    s_add_u32 s10, s50, 229376
    v_cvt_pk_bf16_f32 v31, v78, v79
    v_mfma_f32_16x16x32_bf16 v[84:87], a[232:235], a[56:59], v[84:87]
    ds_read_b128 a[200:203], v1 offset:896
    v_mfma_f32_16x16x32_bf16 v[84:87], a[236:239], a[60:63], v[84:87]
    buffer_load_dwordx4 v122, s[20:23], s49 offen offset:3168 lds
    s_add_u32 m0, s37, 0
    v_mfma_f32_16x16x32_bf16 v[80:83], a[236:239], a[28:31], v[80:83]
    s_add_u32 s49, s49, 16384
    ds_read_b128 a[204:207], v1 offset:960
    v_mfma_f32_16x16x32_bf16 v[80:83], a[232:235], a[24:27], v[80:83]
    s_waitcnt lgkmcnt(4)
    v_mfma_f32_16x16x32_bf16 v[88:91], a[240:243], a[0:3], v[96:99]
    ds_read_b128 a[208:211], v1 offset:16896
    buffer_load_dwordx4 a[64:67], v6, s[32:35], s8 offen offset:0 sc1
    v_mfma_f32_16x16x32_bf16 v[88:91], a[244:247], a[4:7], v[88:91]
    v_mfma_f32_16x16x32_bf16 v[92:95], a[244:247], a[36:39], v[100:103]
    ds_read_b128 a[212:215], v1 offset:16960
    v_mfma_f32_16x16x32_bf16 v[92:95], a[240:243], a[32:35], v[92:95]
    v_exp_f32 v68, v84
    v_mfma_f32_16x16x32_bf16 v[92:95], a[248:251], a[40:43], v[92:95]
    ds_read_b128 a[216:219], v1 offset:17024
    v_mfma_f32_16x16x32_bf16 v[92:95], a[252:255], a[44:47], v[92:95]
    v_exp_f32 v69, v85
    v_mfma_f32_16x16x32_bf16 v[88:91], a[252:255], a[12:15], v[88:91]
    ds_read_b128 a[220:223], v1 offset:17088
    v_add_f32 v119, v68, v69
    v_mfma_f32_16x16x32_bf16 v[88:91], a[248:251], a[8:11], v[88:91]
    s_waitcnt lgkmcnt(4)
    v_exp_f32 v70, v86
    v_mfma_f32_16x16x32_bf16 v[88:91], a[192:195], a[16:19], v[88:91]
    ds_read_b128 a[224:227], v1 offset:17152
    v_cvt_pk_bf16_f32 v20, v68, v69
    v_mfma_f32_16x16x32_bf16 v[88:91], a[196:199], a[20:23], v[88:91]
    buffer_load_dwordx4 a[68:71], v6, s[32:35], s9 offen offset:0 sc1
    v_exp_f32 v71, v87
    v_mfma_f32_16x16x32_bf16 v[92:95], a[196:199], a[52:55], v[92:95]
    ds_read_b128 a[228:231], v1 offset:17216
    v_add_f32 v119, v119, v70
    v_mfma_f32_16x16x32_bf16 v[92:95], a[192:195], a[48:51], v[92:95]
    v_exp_f32 v64, v80
    v_mfma_f32_16x16x32_bf16 v[92:95], a[200:203], a[56:59], v[92:95]
    ds_read_b128 a[232:235], v1 offset:17280
    v_cvt_pk_bf16_f32 v21, v70, v71
    v_mfma_f32_16x16x32_bf16 v[92:95], a[204:207], a[60:63], v[92:95]
    buffer_load_dwordx4 a[72:75], v6, s[32:35], s11 offen offset:0 sc1
    v_exp_f32 v65, v81
    v_mfma_f32_16x16x32_bf16 v[88:91], a[204:207], a[28:31], v[88:91]
    ds_read_b128 a[236:239], v1 offset:17344
    v_add_f32 v119, v119, v71
    v_mfma_f32_16x16x32_bf16 v[88:91], a[200:203], a[24:27], v[88:91]
    s_waitcnt lgkmcnt(4)
    v_exp_f32 v66, v82
    v_mfma_f32_16x16x32_bf16 v[48:51], a[208:211], a[0:3], v[96:99]
    ds_read_b128 a[240:243], v1 offset:17408
    v_add_f32 v118, v64, v65
    v_mfma_f32_16x16x32_bf16 v[48:51], a[212:215], a[4:7], v[48:51]
    v_exp_f32 v67, v83
    v_mfma_f32_16x16x32_bf16 v[52:55], a[212:215], a[36:39], v[100:103]
    ds_read_b128 a[244:247], v1 offset:17472
    v_cvt_pk_bf16_f32 v16, v64, v65
    v_mfma_f32_16x16x32_bf16 v[52:55], a[208:211], a[32:35], v[52:55]
    v_exp_f32 v76, v92
    v_mfma_f32_16x16x32_bf16 v[52:55], a[216:219], a[40:43], v[52:55]
    ds_read_b128 a[248:251], v1 offset:17536
    v_add_f32 v118, v118, v66
    v_mfma_f32_16x16x32_bf16 v[52:55], a[220:223], a[44:47], v[52:55]
    buffer_load_dwordx4 a[76:79], v6, s[32:35], s54 offen offset:0 sc1
    v_exp_f32 v77, v93
    v_mfma_f32_16x16x32_bf16 v[48:51], a[220:223], a[12:15], v[48:51]
    ds_read_b128 a[252:255], v1 offset:17600
    v_cvt_pk_bf16_f32 v17, v66, v67
    v_mfma_f32_16x16x32_bf16 v[48:51], a[216:219], a[8:11], v[48:51]
    s_waitcnt lgkmcnt(4)
    v_exp_f32 v78, v94
    v_mfma_f32_16x16x32_bf16 v[48:51], a[224:227], a[16:19], v[48:51]
    ds_read_b128 a[192:195], v1 offset:17664
    v_add_f32 v118, v118, v67
    v_mfma_f32_16x16x32_bf16 v[48:51], a[228:231], a[20:23], v[48:51]
    buffer_load_dwordx4 a[80:83], v6, s[32:35], s8 offen offset:1024 sc1
    v_exp_f32 v79, v95
    v_mfma_f32_16x16x32_bf16 v[52:55], a[228:231], a[52:55], v[52:55]
    ds_read_b128 a[196:199], v1 offset:17728
    v_add_f32 v119, v119, v76
    v_mfma_f32_16x16x32_bf16 v[52:55], a[224:227], a[48:51], v[52:55]
    v_exp_f32 v72, v88
    v_mfma_f32_16x16x32_bf16 v[52:55], a[232:235], a[56:59], v[52:55]
    ds_read_b128 a[200:203], v1 offset:17792
    v_cvt_pk_bf16_f32 v22, v76, v77
    v_mfma_f32_16x16x32_bf16 v[52:55], a[236:239], a[60:63], v[52:55]
    v_exp_f32 v73, v89
    v_mfma_f32_16x16x32_bf16 v[48:51], a[236:239], a[28:31], v[48:51]
    ds_read_b128 a[204:207], v1 offset:17856
    v_add_f32 v119, v119, v77
    v_mfma_f32_16x16x32_bf16 v[48:51], a[232:235], a[24:27], v[48:51]
    s_waitcnt vmcnt(13) lgkmcnt(4)
    s_barrier
    v_add_f32 v119, v119, v78
    v_mfma_f32_16x16x32_bf16 v[56:59], a[240:243], a[0:3], v[96:99]
    ds_read_b64_tr_b16 a[208:209], v0 offset:33792
    ds_read_b64_tr_b16 a[210:211], v0 offset:34304
    v_mfma_f32_16x16x32_bf16 v[56:59], a[244:247], a[4:7], v[56:59]
    buffer_load_dwordx4 a[84:87], v6, s[32:35], s9 offen offset:1024 sc1
    v_exp_f32 v74, v90
    v_mfma_f32_16x16x32_bf16 v[60:63], a[244:247], a[36:39], v[100:103]
    ds_read_b64_tr_b16 a[212:213], v0 offset:50688
    ds_read_b64_tr_b16 a[214:215], v0 offset:51200
    v_mfma_f32_16x16x32_bf16 v[60:63], a[240:243], a[32:35], v[60:63]
    v_exp_f32 v75, v91
    v_mfma_f32_16x16x32_bf16 v[60:63], a[248:251], a[40:43], v[60:63]
    ds_read_b64_tr_b16 a[216:217], v0 offset:33824
    ds_read_b64_tr_b16 a[218:219], v0 offset:34336
    v_mfma_f32_16x16x32_bf16 v[60:63], a[252:255], a[44:47], v[60:63]
    buffer_load_dwordx4 v114, s[24:27], s38 offen offset:0 lds
    buffer_load_dwordx4 a[88:91], v6, s[32:35], s11 offen offset:1024 sc1
    v_mfma_f32_16x16x32_bf16 v[56:59], a[252:255], a[12:15], v[56:59]
    ds_read_b64_tr_b16 a[220:221], v0 offset:50720
    ds_read_b64_tr_b16 a[222:223], v0 offset:51232
    v_mfma_f32_16x16x32_bf16 v[56:59], a[248:251], a[8:11], v[56:59]
    s_waitcnt lgkmcnt(8)
    v_exp_f32 v68, v52
    v_mfma_f32_16x16x32_bf16 v[56:59], a[192:195], a[16:19], v[56:59]
    ds_read_b64_tr_b16 a[224:225], v0 offset:33856
    ds_read_b64_tr_b16 a[226:227], v0 offset:34368
    v_mfma_f32_16x16x32_bf16 v[56:59], a[196:199], a[20:23], v[56:59]
    buffer_load_dwordx4 v112, s[24:27], s38 offen offset:1056 lds
    v_mfma_f32_16x16x32_bf16 v[60:63], a[196:199], a[52:55], v[60:63]
    ds_read_b64_tr_b16 a[228:229], v0 offset:50752
    ds_read_b64_tr_b16 a[230:231], v0 offset:51264
    v_mfma_f32_16x16x32_bf16 v[60:63], a[192:195], a[48:51], v[60:63]
    v_exp_f32 v69, v53
    v_mfma_f32_16x16x32_bf16 v[60:63], a[200:203], a[56:59], v[60:63]
    ds_read_b64_tr_b16 a[232:233], v0 offset:33888
    ds_read_b64_tr_b16 a[234:235], v0 offset:34400
    v_mfma_f32_16x16x32_bf16 v[60:63], a[204:207], a[60:63], v[60:63]
    buffer_load_dwordx4 v121, s[24:27], s38 offen offset:2112 lds
    buffer_load_dwordx4 a[92:95], v6, s[32:35], s54 offen offset:1024 sc1
    v_mfma_f32_16x16x32_bf16 v[56:59], a[204:207], a[28:31], v[56:59]
    ds_read_b64_tr_b16 a[236:237], v0 offset:50784
    ds_read_b64_tr_b16 a[238:239], v0 offset:51296
    v_mfma_f32_16x16x32_bf16 v[56:59], a[200:203], a[24:27], v[56:59]
    s_waitcnt lgkmcnt(8)
    v_exp_f32 v70, v54
    v_mfma_f32_16x16x32_bf16 v[128:131], a[208:211], v[32:35], v[128:131]
    ds_read_b64_tr_b16 a[240:241], v0 offset:33920
    ds_read_b64_tr_b16 a[242:243], v0 offset:34432
    v_mfma_f32_16x16x32_bf16 v[128:131], a[212:215], v[24:27], v[128:131]
    buffer_load_dwordx4 v122, s[24:27], s38 offen offset:3168 lds
    s_add_u32 m0, s37, 16896
    v_mfma_f32_16x16x32_bf16 v[132:135], a[212:215], v[28:31], v[132:135]
    ds_read_b64_tr_b16 a[244:245], v0 offset:50816
    ds_read_b64_tr_b16 a[246:247], v0 offset:51328
    v_mfma_f32_16x16x32_bf16 v[132:135], a[208:211], v[36:39], v[132:135]
    s_add_u32 s38, s38, 16384
    v_exp_f32 v71, v55
    v_mfma_f32_16x16x32_bf16 v[140:143], a[216:219], v[36:39], v[140:143]
    ds_read_b64_tr_b16 a[248:249], v0 offset:33952
    ds_read_b64_tr_b16 a[250:251], v0 offset:34464
    v_mfma_f32_16x16x32_bf16 v[140:143], a[220:223], v[28:31], v[140:143]
    buffer_load_dwordx4 v114, s[24:27], s38 offen offset:0 lds
    buffer_load_dwordx4 a[96:99], v6, s[32:35], s8 offen offset:2048 sc1
    v_mfma_f32_16x16x32_bf16 v[136:139], a[220:223], v[24:27], v[136:139]
    ds_read_b64_tr_b16 a[252:253], v0 offset:50848
    ds_read_b64_tr_b16 a[254:255], v0 offset:51360
    v_mfma_f32_16x16x32_bf16 v[136:139], a[216:219], v[32:35], v[136:139]
    s_waitcnt lgkmcnt(8)
    v_exp_f32 v64, v48
    v_mfma_f32_16x16x32_bf16 v[144:147], a[224:227], v[32:35], v[144:147]
    ds_read_b64_tr_b16 a[192:193], v0 offset:33984
    ds_read_b64_tr_b16 a[194:195], v0 offset:34496
    v_mfma_f32_16x16x32_bf16 v[144:147], a[228:231], v[24:27], v[144:147]
    buffer_load_dwordx4 v112, s[24:27], s38 offen offset:1056 lds
    buffer_load_dwordx4 a[100:103], v6, s[32:35], s9 offen offset:2048 sc1
    v_mfma_f32_16x16x32_bf16 v[148:151], a[228:231], v[28:31], v[148:151]
    ds_read_b64_tr_b16 a[196:197], v0 offset:50880
    ds_read_b64_tr_b16 a[198:199], v0 offset:51392
    v_mfma_f32_16x16x32_bf16 v[148:151], a[224:227], v[36:39], v[148:151]
    v_exp_f32 v65, v49
    v_mfma_f32_16x16x32_bf16 v[156:159], a[232:235], v[36:39], v[156:159]
    ds_read_b64_tr_b16 a[200:201], v0 offset:34016
    ds_read_b64_tr_b16 a[202:203], v0 offset:34528
    v_mfma_f32_16x16x32_bf16 v[156:159], a[236:239], v[28:31], v[156:159]
    buffer_load_dwordx4 v121, s[24:27], s38 offen offset:2112 lds
    buffer_load_dwordx4 a[104:107], v6, s[32:35], s11 offen offset:2048 sc1
    v_mfma_f32_16x16x32_bf16 v[152:155], a[236:239], v[24:27], v[152:155]
    ds_read_b64_tr_b16 a[204:205], v0 offset:50912
    ds_read_b64_tr_b16 a[206:207], v0 offset:51424
    v_mfma_f32_16x16x32_bf16 v[152:155], a[232:235], v[32:35], v[152:155]
    s_waitcnt lgkmcnt(8)
    v_exp_f32 v66, v50
    v_mfma_f32_16x16x32_bf16 v[160:163], a[240:243], v[32:35], v[160:163]
    ds_read_b64_tr_b16 a[208:209], v0 offset:34048
    ds_read_b64_tr_b16 a[210:211], v0 offset:34560
    v_mfma_f32_16x16x32_bf16 v[160:163], a[244:247], v[24:27], v[160:163]
    buffer_load_dwordx4 v122, s[24:27], s38 offen offset:3168 lds
    s_add_u32 m0, s37, 67584
    v_mfma_f32_16x16x32_bf16 v[164:167], a[244:247], v[28:31], v[164:167]
    ds_read_b64_tr_b16 a[212:213], v0 offset:50944
    ds_read_b64_tr_b16 a[214:215], v0 offset:51456
    buffer_load_dwordx4 a[108:111], v6, s[32:35], s54 offen offset:2048 sc1
    v_mfma_f32_16x16x32_bf16 v[164:167], a[240:243], v[36:39], v[164:167]
    s_add_u32 s38, s38, 16384
    v_exp_f32 v67, v51
    v_mfma_f32_16x16x32_bf16 v[172:175], a[248:251], v[36:39], v[172:175]
    ds_read_b64_tr_b16 a[216:217], v0 offset:34080
    v_cvt_pk_bf16_f32 v23, v78, v79
    v_mfma_f32_16x16x32_bf16 v[172:175], a[252:255], v[28:31], v[172:175]
    ds_read_b64_tr_b16 a[218:219], v0 offset:34592
    v_add_f32 v119, v119, v79
    v_mfma_f32_16x16x32_bf16 v[168:171], a[252:255], v[24:27], v[168:171]
    ds_read_b64_tr_b16 a[220:221], v0 offset:50976
    ds_read_b64_tr_b16 a[222:223], v0 offset:51488
    v_mfma_f32_16x16x32_bf16 v[168:171], a[248:251], v[32:35], v[168:171]
    s_waitcnt lgkmcnt(8)
    v_exp_f32 v76, v60
    v_mfma_f32_16x16x32_bf16 v[176:179], a[192:195], v[32:35], v[176:179]
    ds_read_b64_tr_b16 a[224:225], v0 offset:34112
    v_add_f32 v118, v118, v72
    v_mfma_f32_16x16x32_bf16 v[176:179], a[196:199], v[24:27], v[176:179]
    ds_read_b64_tr_b16 a[226:227], v0 offset:34624
    v_cvt_pk_bf16_f32 v18, v72, v73
    v_mfma_f32_16x16x32_bf16 v[180:183], a[196:199], v[28:31], v[180:183]
    ds_read_b64_tr_b16 a[228:229], v0 offset:51008
    ds_read_b64_tr_b16 a[230:231], v0 offset:51520
    v_mfma_f32_16x16x32_bf16 v[180:183], a[192:195], v[36:39], v[180:183]
    buffer_load_dwordx4 a[112:115], v6, s[32:35], s8 offen offset:3072 sc1
    s_add_u32 s8, s8, 4096
    v_exp_f32 v77, v61
    v_mfma_f32_16x16x32_bf16 v[188:191], a[200:203], v[36:39], v[188:191]
    ds_read_b64_tr_b16 a[232:233], v0 offset:34144
    v_add_f32 v118, v118, v73
    v_mfma_f32_16x16x32_bf16 v[188:191], a[204:207], v[28:31], v[188:191]
    ds_read_b64_tr_b16 a[234:235], v0 offset:34656
    v_add_f32 v118, v118, v74
    v_mfma_f32_16x16x32_bf16 v[184:187], a[204:207], v[24:27], v[184:187]
    ds_read_b64_tr_b16 a[236:237], v0 offset:51040
    ds_read_b64_tr_b16 a[238:239], v0 offset:51552
    v_mfma_f32_16x16x32_bf16 v[184:187], a[200:203], v[32:35], v[184:187]
    s_waitcnt lgkmcnt(8)
    v_exp_f32 v78, v62
    v_mfma_f32_16x16x32_bf16 v[192:195], a[208:211], v[32:35], v[192:195]
    ds_read_b64_tr_b16 a[240:241], v0 offset:34176
    v_cvt_pk_bf16_f32 v19, v74, v75
    v_mfma_f32_16x16x32_bf16 v[192:195], a[212:215], v[24:27], v[192:195]
    ds_read_b64_tr_b16 a[242:243], v0 offset:34688
    v_add_f32 v118, v118, v75
    v_mfma_f32_16x16x32_bf16 v[196:199], a[212:215], v[28:31], v[196:199]
    ds_read_b64_tr_b16 a[244:245], v0 offset:51072
    ds_read_b64_tr_b16 a[246:247], v0 offset:51584
    v_mfma_f32_16x16x32_bf16 v[196:199], a[208:211], v[36:39], v[196:199]
    buffer_load_dwordx4 a[116:119], v6, s[32:35], s9 offen offset:3072 sc1
    s_add_u32 s9, s9, 4096
    v_exp_f32 v79, v63
    v_mfma_f32_16x16x32_bf16 v[204:207], a[216:219], v[36:39], v[204:207]
    ds_read_b64_tr_b16 a[248:249], v0 offset:34208
    v_add_f32 v119, v119, v68
    v_mfma_f32_16x16x32_bf16 v[204:207], a[220:223], v[28:31], v[204:207]
    ds_read_b64_tr_b16 a[250:251], v0 offset:34720
    v_add_f32 v119, v119, v69
    v_mfma_f32_16x16x32_bf16 v[200:203], a[220:223], v[24:27], v[200:203]
    ds_read_b64_tr_b16 a[252:253], v0 offset:51104
    ds_read_b64_tr_b16 a[254:255], v0 offset:51616
    buffer_load_dwordx4 a[120:123], v6, s[32:35], s11 offen offset:3072 sc1
    s_add_u32 s11, s11, 4096
    v_mfma_f32_16x16x32_bf16 v[200:203], a[216:219], v[32:35], v[200:203]
    s_waitcnt lgkmcnt(8)
    v_exp_f32 v72, v56
    v_mfma_f32_16x16x32_bf16 v[208:211], a[224:227], v[32:35], v[208:211]
    ds_read_b64_tr_b16 a[192:193], v0 offset:34240
    v_add_f32 v119, v119, v70
    v_mfma_f32_16x16x32_bf16 v[208:211], a[228:231], v[24:27], v[208:211]
    ds_read_b64_tr_b16 a[194:195], v0 offset:34752
    v_add_f32 v119, v119, v71
    v_mfma_f32_16x16x32_bf16 v[212:215], a[228:231], v[28:31], v[212:215]
    ds_read_b64_tr_b16 a[196:197], v0 offset:51136
    ds_read_b64_tr_b16 a[198:199], v0 offset:51648
    v_mfma_f32_16x16x32_bf16 v[212:215], a[224:227], v[36:39], v[212:215]
    buffer_load_dwordx4 a[124:127], v6, s[32:35], s54 offen offset:3072 sc1
    s_add_u32 s54, s54, 4096
    v_exp_f32 v73, v57
    v_mfma_f32_16x16x32_bf16 v[220:223], a[232:235], v[36:39], v[220:223]
    ds_read_b64_tr_b16 a[200:201], v0 offset:34272
    v_add_f32 v118, v118, v64
    v_mfma_f32_16x16x32_bf16 v[220:223], a[236:239], v[28:31], v[220:223]
    ds_read_b64_tr_b16 a[202:203], v0 offset:34784
    v_add_f32 v118, v118, v65
    v_mfma_f32_16x16x32_bf16 v[216:219], a[236:239], v[24:27], v[216:219]
    ds_read_b64_tr_b16 a[204:205], v0 offset:51168
    ds_read_b64_tr_b16 a[206:207], v0 offset:51680
    v_mfma_f32_16x16x32_bf16 v[216:219], a[232:235], v[32:35], v[216:219]
    s_waitcnt vmcnt(28) lgkmcnt(8)
    s_barrier
    v_add_f32 v118, v118, v66
    v_mfma_f32_16x16x32_bf16 v[224:227], a[240:243], v[32:35], v[224:227]
    ds_read_b128 a[208:211], v1 offset:33792
    v_add_f32 v118, v118, v67
    v_mfma_f32_16x16x32_bf16 v[224:227], a[244:247], v[24:27], v[224:227]
    buffer_load_dwordx4 v14, s[28:31], 0 offen offset:0 lds
    buffer_load_dwordx4 a[128:131], v6, s[32:35], s8 offen offset:0 sc1
    s_add_u32 m0, s37, 67744
    v_mfma_f32_16x16x32_bf16 v[228:231], a[244:247], v[28:31], v[228:231]
    ds_read_b128 a[212:215], v1 offset:33856
    v_add_f32 v119, v119, v76
    v_mfma_f32_16x16x32_bf16 v[228:231], a[240:243], v[36:39], v[228:231]
    v_exp_f32 v74, v58
    v_mfma_f32_16x16x32_bf16 v[236:239], a[248:251], v[36:39], v[236:239]
    ds_read_b128 a[216:219], v1 offset:33920
    v_add_f32 v119, v119, v77
    v_mfma_f32_16x16x32_bf16 v[236:239], a[252:255], v[28:31], v[236:239]
    buffer_load_dwordx4 v14, s[28:31], 0 offen offset:896 lds
    s_add_u32 m0, s37, 67904
    v_mfma_f32_16x16x32_bf16 v[232:235], a[252:255], v[24:27], v[232:235]
    ds_read_b128 a[220:223], v1 offset:33984
    v_add_f32 v119, v119, v78
    v_mfma_f32_16x16x32_bf16 v[232:235], a[248:251], v[32:35], v[232:235]
    s_waitcnt lgkmcnt(4)
    v_exp_f32 v75, v59
    v_mfma_f32_16x16x32_bf16 v[240:243], a[192:195], v[32:35], v[240:243]
    ds_read_b128 a[224:227], v1 offset:34048
    v_add_f32 v119, v119, v79
    v_mfma_f32_16x16x32_bf16 v[240:243], a[196:199], v[24:27], v[240:243]
    buffer_load_dwordx4 v14, s[28:31], 0 offen offset:1792 lds
    buffer_load_dwordx4 a[132:135], v6, s[32:35], s9 offen offset:0 sc1
    s_add_u32 m0, s37, 68064
    v_mfma_f32_16x16x32_bf16 v[244:247], a[196:199], v[28:31], v[244:247]
    ds_read_b128 a[228:231], v1 offset:34112
    v_add_f32 v118, v118, v72
    v_mfma_f32_16x16x32_bf16 v[244:247], a[192:195], v[36:39], v[244:247]
    v_add_f32 v118, v118, v73
    v_add_f32 v118, v118, v75
    v_mfma_f32_16x16x32_bf16 v[252:255], a[200:203], v[36:39], v[252:255]
    ds_read_b128 a[232:235], v1 offset:34176
    v_add_f32 v118, v118, v74
    v_mfma_f32_16x16x32_bf16 v[252:255], a[204:207], v[28:31], v[252:255]
    buffer_load_dwordx4 v14, s[28:31], 0 offen offset:2688 lds
    s_add_u32 m0, s37, 33792
    v_add_f32 v120, v118, v119
    v_mfma_f32_16x16x32_bf16 v[248:251], a[204:207], v[24:27], v[248:251]
    ds_read_b128 a[236:239], v1 offset:34240
    v_add_u32 v14, 114688, v14
    v_cmp_nge_f32 vcc, s40, v120
    v_mfma_f32_16x16x32_bf16 v[248:251], a[200:203], v[32:35], v[248:251]
    s_waitcnt lgkmcnt(4)
    s_cbranch_vccnz slow_t61
back_t61:
    v_add_f32 v116, v116, v118
    v_mfma_f32_16x16x32_bf16 v[80:83], a[208:211], a[0:3], v[96:99]
    ds_read_b128 a[240:243], v1 offset:34304
    v_add_f32 v117, v117, v119
    v_mfma_f32_16x16x32_bf16 v[80:83], a[212:215], a[4:7], v[80:83]
    buffer_load_dwordx4 a[136:139], v6, s[32:35], s11 offen offset:0 sc1
    v_cvt_pk_bf16_f32 v24, v64, v65
    v_accvgpr_read_b32 v3, a184
    v_mfma_f32_16x16x32_bf16 v[84:87], a[212:215], a[36:39], v[100:103]
    ds_read_b128 a[244:247], v1 offset:34368
    v_cvt_pk_bf16_f32 v25, v66, v67
    v_mfma_f32_16x16x32_bf16 v[84:87], a[208:211], a[32:35], v[84:87]
    s_mul_i32 s58, s36, 401408
    s_and_b32 s41, s53, 0x80000000
    v_cvt_pk_bf16_f32 v28, v68, v69
    v_mfma_f32_16x16x32_bf16 v[84:87], a[216:219], a[40:43], v[84:87]
    ds_read_b128 a[248:251], v1 offset:34432
    v_cvt_pk_bf16_f32 v29, v70, v71
    v_mfma_f32_16x16x32_bf16 v[84:87], a[220:223], a[44:47], v[84:87]
    s_or_b32 s58, s58, s41
    buffer_load_dwordx4 a[140:143], v6, s[32:35], s54 offen offset:0 sc1
    v_cvt_pk_bf16_f32 v26, v72, v73
    v_mfma_f32_16x16x32_bf16 v[80:83], a[220:223], a[12:15], v[80:83]
    ds_read_b128 a[252:255], v1 offset:34496
    v_cvt_pk_bf16_f32 v27, v74, v75
    v_mfma_f32_16x16x32_bf16 v[80:83], a[216:219], a[8:11], v[80:83]
    s_waitcnt vmcnt(32) lgkmcnt(4)
    s_barrier
    v_cvt_pk_bf16_f32 v30, v76, v77
    v_mfma_f32_16x16x32_bf16 v[80:83], a[224:227], a[16:19], v[80:83]
    ds_read_b128 a[192:195], v1 offset:34560
    v_cvt_pk_bf16_f32 v31, v78, v79
    v_mfma_f32_16x16x32_bf16 v[80:83], a[228:231], a[20:23], v[80:83]
    buffer_load_dwordx4 v114, s[24:27], s38 offen offset:0 lds
    buffer_load_dwordx4 a[144:147], v6, s[32:35], s8 offen offset:1024 sc1
    v_mfma_f32_16x16x32_bf16 v[84:87], a[228:231], a[52:55], v[84:87]
    ds_read_b128 a[196:199], v1 offset:34624
    v_mfma_f32_16x16x32_bf16 v[84:87], a[224:227], a[48:51], v[84:87]
    buffer_load_dwordx4 v112, s[24:27], s38 offen offset:1056 lds
    v_mfma_f32_16x16x32_bf16 v[84:87], a[232:235], a[56:59], v[84:87]
    ds_read_b128 a[200:203], v1 offset:34688
    v_mfma_f32_16x16x32_bf16 v[84:87], a[236:239], a[60:63], v[84:87]
    buffer_load_dwordx4 v121, s[24:27], s38 offen offset:2112 lds
    v_mfma_f32_16x16x32_bf16 v[80:83], a[236:239], a[28:31], v[80:83]
    ds_read_b128 a[204:207], v1 offset:34752
    buffer_load_dwordx4 a[148:151], v6, s[32:35], s9 offen offset:1024 sc1
    v_mfma_f32_16x16x32_bf16 v[80:83], a[232:235], a[24:27], v[80:83]
    s_waitcnt lgkmcnt(4)
    buffer_load_dwordx4 v122, s[24:27], s38 offen offset:3168 lds
    s_add_u32 m0, s37, 50688
    v_mfma_f32_16x16x32_bf16 v[88:91], a[240:243], a[0:3], v[96:99]
    s_add_u32 s38, s38, 16384
    ds_read_b128 a[208:211], v1 offset:50688
    v_mfma_f32_16x16x32_bf16 v[88:91], a[244:247], a[4:7], v[88:91]
    buffer_load_dwordx4 v114, s[24:27], s38 offen offset:0 lds
    v_mfma_f32_16x16x32_bf16 v[92:95], a[244:247], a[36:39], v[100:103]
    ds_read_b128 a[212:215], v1 offset:50752
    v_mfma_f32_16x16x32_bf16 v[92:95], a[240:243], a[32:35], v[92:95]
    buffer_load_dwordx4 v112, s[24:27], s38 offen offset:1056 lds
    v_exp_f32 v68, v84
    v_mfma_f32_16x16x32_bf16 v[92:95], a[248:251], a[40:43], v[92:95]
    ds_read_b128 a[216:219], v1 offset:50816
    buffer_load_dwordx4 a[152:155], v6, s[32:35], s11 offen offset:1024 sc1
    v_mfma_f32_16x16x32_bf16 v[92:95], a[252:255], a[44:47], v[92:95]
    buffer_load_dwordx4 v121, s[24:27], s38 offen offset:2112 lds
    v_exp_f32 v69, v85
    v_mfma_f32_16x16x32_bf16 v[88:91], a[252:255], a[12:15], v[88:91]
    ds_read_b128 a[220:223], v1 offset:50880
    v_add_f32 v119, v68, v69
    v_mfma_f32_16x16x32_bf16 v[88:91], a[248:251], a[8:11], v[88:91]
    s_waitcnt lgkmcnt(4)
    buffer_load_dwordx4 v122, s[24:27], s38 offen offset:3168 lds
    s_add_u32 m0, s37, 84480
    v_exp_f32 v70, v86
    v_mfma_f32_16x16x32_bf16 v[88:91], a[192:195], a[16:19], v[88:91]
    s_add_u32 s38, s38, 16384
    ds_read_b128 a[224:227], v1 offset:50944
    v_mfma_f32_16x16x32_bf16 v[88:91], a[196:199], a[20:23], v[88:91]
    v_exp_f32 v71, v87
    v_mfma_f32_16x16x32_bf16 v[92:95], a[196:199], a[52:55], v[92:95]
    ds_read_b128 a[228:231], v1 offset:51008
    v_cvt_pk_bf16_f32 v36, v68, v69
    v_mfma_f32_16x16x32_bf16 v[92:95], a[192:195], a[48:51], v[92:95]
    v_exp_f32 v64, v80
    v_mfma_f32_16x16x32_bf16 v[92:95], a[200:203], a[56:59], v[92:95]
    ds_read_b128 a[232:235], v1 offset:51072
    v_add_f32 v119, v119, v70
    v_mfma_f32_16x16x32_bf16 v[92:95], a[204:207], a[60:63], v[92:95]
    buffer_load_dwordx4 a[156:159], v6, s[32:35], s54 offen offset:1024 sc1
    v_exp_f32 v65, v81
    v_mfma_f32_16x16x32_bf16 v[88:91], a[204:207], a[28:31], v[88:91]
    ds_read_b128 a[236:239], v1 offset:51136
    v_cvt_pk_bf16_f32 v37, v70, v71
    v_mfma_f32_16x16x32_bf16 v[88:91], a[200:203], a[24:27], v[88:91]
    s_waitcnt lgkmcnt(4)
    v_exp_f32 v66, v82
    v_mfma_f32_16x16x32_bf16 v[48:51], a[208:211], a[0:3], v[96:99]
    ds_read_b128 a[240:243], v1 offset:51200
    v_add_f32 v119, v119, v71
    v_mfma_f32_16x16x32_bf16 v[48:51], a[212:215], a[4:7], v[48:51]
    buffer_load_dwordx4 a[160:163], v6, s[32:35], s8 offen offset:2048 sc1
    v_exp_f32 v67, v83
    v_mfma_f32_16x16x32_bf16 v[52:55], a[212:215], a[36:39], v[100:103]
    ds_read_b128 a[244:247], v1 offset:51264
    v_add_f32 v118, v64, v65
    v_mfma_f32_16x16x32_bf16 v[52:55], a[208:211], a[32:35], v[52:55]
    v_exp_f32 v76, v92
    v_mfma_f32_16x16x32_bf16 v[52:55], a[216:219], a[40:43], v[52:55]
    ds_read_b128 a[248:251], v1 offset:51328
    v_cvt_pk_bf16_f32 v32, v64, v65
    v_mfma_f32_16x16x32_bf16 v[52:55], a[220:223], a[44:47], v[52:55]
    v_exp_f32 v77, v93
    v_mfma_f32_16x16x32_bf16 v[48:51], a[220:223], a[12:15], v[48:51]
    ds_read_b128 a[252:255], v1 offset:51392
    v_add_f32 v118, v118, v66
    v_mfma_f32_16x16x32_bf16 v[48:51], a[216:219], a[8:11], v[48:51]
    s_waitcnt lgkmcnt(4)
    v_exp_f32 v78, v94
    v_mfma_f32_16x16x32_bf16 v[48:51], a[224:227], a[16:19], v[48:51]
    ds_read_b128 a[192:195], v1 offset:51456
    v_cvt_pk_bf16_f32 v33, v66, v67
    v_mfma_f32_16x16x32_bf16 v[48:51], a[228:231], a[20:23], v[48:51]
    buffer_load_dwordx4 a[164:167], v6, s[32:35], s9 offen offset:2048 sc1
    v_exp_f32 v79, v95
    v_mfma_f32_16x16x32_bf16 v[52:55], a[228:231], a[52:55], v[52:55]
    ds_read_b128 a[196:199], v1 offset:51520
    v_add_f32 v118, v118, v67
    v_mfma_f32_16x16x32_bf16 v[52:55], a[224:227], a[48:51], v[52:55]
    v_exp_f32 v72, v88
    v_mfma_f32_16x16x32_bf16 v[52:55], a[232:235], a[56:59], v[52:55]
    ds_read_b128 a[200:203], v1 offset:51584
    v_add_f32 v119, v119, v76
    v_mfma_f32_16x16x32_bf16 v[52:55], a[236:239], a[60:63], v[52:55]
    buffer_load_dwordx4 a[168:171], v6, s[32:35], s11 offen offset:2048 sc1
    v_exp_f32 v73, v89
    v_mfma_f32_16x16x32_bf16 v[48:51], a[236:239], a[28:31], v[48:51]
    ds_read_b128 a[204:207], v1 offset:51648
    v_cvt_pk_bf16_f32 v38, v76, v77
    v_mfma_f32_16x16x32_bf16 v[48:51], a[232:235], a[24:27], v[48:51]
    s_waitcnt vmcnt(28) lgkmcnt(4)
    s_barrier
    v_add_f32 v119, v119, v77
    v_mfma_f32_16x16x32_bf16 v[56:59], a[240:243], a[0:3], v[96:99]
    ds_read_b64_tr_b16 a[208:209], v0 offset:0
    ds_read_b64_tr_b16 a[210:211], v0 offset:512
    v_mfma_f32_16x16x32_bf16 v[56:59], a[244:247], a[4:7], v[56:59]
    v_exp_f32 v74, v90
    v_mfma_f32_16x16x32_bf16 v[60:63], a[244:247], a[36:39], v[100:103]
    ds_read_b64_tr_b16 a[212:213], v0 offset:16896
    ds_read_b64_tr_b16 a[214:215], v0 offset:17408
    v_mfma_f32_16x16x32_bf16 v[60:63], a[240:243], a[32:35], v[60:63]
    v_exp_f32 v75, v91
    v_mfma_f32_16x16x32_bf16 v[60:63], a[248:251], a[40:43], v[60:63]
    ds_read_b64_tr_b16 a[216:217], v0 offset:32
    ds_read_b64_tr_b16 a[218:219], v0 offset:544
    v_mfma_f32_16x16x32_bf16 v[60:63], a[252:255], a[44:47], v[60:63]
    buffer_load_dwordx4 v14, s[28:31], 0 offen offset:0 lds
    buffer_load_dwordx4 a[172:175], v6, s[32:35], s54 offen offset:2048 sc1
    s_add_u32 m0, s37, 84640
    v_mfma_f32_16x16x32_bf16 v[56:59], a[252:255], a[12:15], v[56:59]
    ds_read_b64_tr_b16 a[220:221], v0 offset:16928
    ds_read_b64_tr_b16 a[222:223], v0 offset:17440
    v_mfma_f32_16x16x32_bf16 v[56:59], a[248:251], a[8:11], v[56:59]
    s_waitcnt lgkmcnt(8)
    v_exp_f32 v68, v52
    v_mfma_f32_16x16x32_bf16 v[56:59], a[192:195], a[16:19], v[56:59]
    ds_read_b64_tr_b16 a[224:225], v0 offset:64
    ds_read_b64_tr_b16 a[226:227], v0 offset:576
    v_mfma_f32_16x16x32_bf16 v[56:59], a[196:199], a[20:23], v[56:59]
    buffer_load_dwordx4 v14, s[28:31], 0 offen offset:896 lds
    s_add_u32 m0, s37, 84800
    v_mfma_f32_16x16x32_bf16 v[60:63], a[196:199], a[52:55], v[60:63]
    ds_read_b64_tr_b16 a[228:229], v0 offset:16960
    ds_read_b64_tr_b16 a[230:231], v0 offset:17472
    v_mfma_f32_16x16x32_bf16 v[60:63], a[192:195], a[48:51], v[60:63]
    v_exp_f32 v69, v53
    v_mfma_f32_16x16x32_bf16 v[60:63], a[200:203], a[56:59], v[60:63]
    ds_read_b64_tr_b16 a[232:233], v0 offset:96
    ds_read_b64_tr_b16 a[234:235], v0 offset:608
    v_mfma_f32_16x16x32_bf16 v[60:63], a[204:207], a[60:63], v[60:63]
    buffer_load_dwordx4 v14, s[28:31], 0 offen offset:1792 lds
    s_add_u32 m0, s37, 84960
    v_mfma_f32_16x16x32_bf16 v[56:59], a[204:207], a[28:31], v[56:59]
    ds_read_b64_tr_b16 a[236:237], v0 offset:16992
    ds_read_b64_tr_b16 a[238:239], v0 offset:17504
    v_mfma_f32_16x16x32_bf16 v[56:59], a[200:203], a[24:27], v[56:59]
    s_waitcnt lgkmcnt(8)
    v_exp_f32 v70, v54
    v_mfma_f32_16x16x32_bf16 v[128:131], a[208:211], v[16:19], v[128:131]
    ds_read_b64_tr_b16 a[240:241], v0 offset:128
    ds_read_b64_tr_b16 a[242:243], v0 offset:640
    v_mfma_f32_16x16x32_bf16 v[128:131], a[212:215], v[24:27], v[128:131]
    buffer_load_dwordx4 v14, s[28:31], 0 offen offset:2688 lds
    buffer_load_dwordx4 a[0:3], v6, s[32:35], s8 offen offset:3072 sc1
    s_add_u32 m0, s37, 101376
    s_add_u32 s8, s8, 4096
    v_mfma_f32_16x16x32_bf16 v[132:135], a[212:215], v[28:31], v[132:135]
    ds_read_b64_tr_b16 a[244:245], v0 offset:17024
    ds_read_b64_tr_b16 a[246:247], v0 offset:17536
    v_mfma_f32_16x16x32_bf16 v[132:135], a[208:211], v[20:23], v[132:135]
    v_add_u32 v14, 4294852736, v14
    v_exp_f32 v71, v55
    v_cvt_pk_bf16_f32 v44, v68, v69
    v_mfma_f32_16x16x32_bf16 v[140:143], a[216:219], v[20:23], v[140:143]
    ds_read_b64_tr_b16 a[248:249], v0 offset:160
    v_add_f32 v119, v119, v78
    v_mfma_f32_16x16x32_bf16 v[140:143], a[220:223], v[28:31], v[140:143]
    ds_read_b64_tr_b16 a[250:251], v0 offset:672
    v_cvt_pk_bf16_f32 v39, v78, v79
    v_cvt_pk_bf16_f32 v45, v70, v71
    v_mfma_f32_16x16x32_bf16 v[136:139], a[220:223], v[24:27], v[136:139]
    ds_read_b64_tr_b16 a[252:253], v0 offset:17056
    ds_read_b64_tr_b16 a[254:255], v0 offset:17568
    buffer_load_dwordx4 a[4:7], v6, s[32:35], s9 offen offset:3072 sc1
    s_add_u32 s9, s9, 4096
    v_mfma_f32_16x16x32_bf16 v[136:139], a[216:219], v[16:19], v[136:139]
    s_waitcnt lgkmcnt(8)
    v_exp_f32 v64, v48
    v_mfma_f32_16x16x32_bf16 v[144:147], a[224:227], v[16:19], v[144:147]
    ds_read_b64_tr_b16 a[192:193], v0 offset:192
    v_add_f32 v119, v119, v79
    v_mfma_f32_16x16x32_bf16 v[144:147], a[228:231], v[24:27], v[144:147]
    ds_read_b64_tr_b16 a[194:195], v0 offset:704
    v_add_f32 v118, v118, v72
    v_mfma_f32_16x16x32_bf16 v[148:151], a[228:231], v[28:31], v[148:151]
    ds_read_b64_tr_b16 a[196:197], v0 offset:17088
    ds_read_b64_tr_b16 a[198:199], v0 offset:17600
    v_mfma_f32_16x16x32_bf16 v[148:151], a[224:227], v[20:23], v[148:151]
    buffer_load_dwordx4 a[8:11], v6, s[32:35], s11 offen offset:3072 sc1
    s_add_u32 s11, s11, 4096
    v_exp_f32 v65, v49
    v_mfma_f32_16x16x32_bf16 v[156:159], a[232:235], v[20:23], v[156:159]
    ds_read_b64_tr_b16 a[200:201], v0 offset:224
    v_cvt_pk_bf16_f32 v34, v72, v73
    v_mfma_f32_16x16x32_bf16 v[156:159], a[236:239], v[28:31], v[156:159]
    ds_read_b64_tr_b16 a[202:203], v0 offset:736
    v_add_f32 v118, v118, v73
    v_cvt_pk_bf16_f32 v40, v64, v65
    v_mfma_f32_16x16x32_bf16 v[152:155], a[236:239], v[24:27], v[152:155]
    ds_read_b64_tr_b16 a[204:205], v0 offset:17120
    ds_read_b64_tr_b16 a[206:207], v0 offset:17632
    buffer_load_dwordx4 a[12:15], v6, s[32:35], s54 offen offset:3072 sc1
    s_add_u32 s54, s54, 4096
    v_mfma_f32_16x16x32_bf16 v[152:155], a[232:235], v[16:19], v[152:155]
    s_waitcnt lgkmcnt(8)
    v_exp_f32 v66, v50
    v_mfma_f32_16x16x32_bf16 v[160:163], a[240:243], v[16:19], v[160:163]
    ds_read_b64_tr_b16 a[208:209], v0 offset:256
    v_add_f32 v118, v118, v74
    v_mfma_f32_16x16x32_bf16 v[160:163], a[244:247], v[24:27], v[160:163]
    ds_read_b64_tr_b16 a[210:211], v0 offset:768
    v_cvt_pk_bf16_f32 v35, v74, v75
    v_mfma_f32_16x16x32_bf16 v[164:167], a[244:247], v[28:31], v[164:167]
    ds_read_b64_tr_b16 a[212:213], v0 offset:17152
    ds_read_b64_tr_b16 a[214:215], v0 offset:17664
    v_mfma_f32_16x16x32_bf16 v[164:167], a[240:243], v[20:23], v[164:167]
    buffer_load_dwordx4 a[16:19], v6, s[32:35], s8 offen offset:0 sc1
    v_exp_f32 v67, v51
    v_mfma_f32_16x16x32_bf16 v[172:175], a[248:251], v[20:23], v[172:175]
    ds_read_b64_tr_b16 a[216:217], v0 offset:288
    v_add_f32 v118, v118, v75
    v_mfma_f32_16x16x32_bf16 v[172:175], a[252:255], v[28:31], v[172:175]
    ds_read_b64_tr_b16 a[218:219], v0 offset:800
    v_add_f32 v119, v119, v68
    v_cvt_pk_bf16_f32 v41, v66, v67
    v_mfma_f32_16x16x32_bf16 v[168:171], a[252:255], v[24:27], v[168:171]
    ds_read_b64_tr_b16 a[220:221], v0 offset:17184
    ds_read_b64_tr_b16 a[222:223], v0 offset:17696
    buffer_load_dwordx4 a[20:23], v6, s[32:35], s9 offen offset:0 sc1
    v_mfma_f32_16x16x32_bf16 v[168:171], a[248:251], v[16:19], v[168:171]
    s_waitcnt lgkmcnt(8)
    v_exp_f32 v76, v60
    v_mfma_f32_16x16x32_bf16 v[176:179], a[192:195], v[16:19], v[176:179]
    ds_read_b64_tr_b16 a[224:225], v0 offset:320
    v_add_f32 v119, v119, v69
    v_mfma_f32_16x16x32_bf16 v[176:179], a[196:199], v[24:27], v[176:179]
    ds_read_b64_tr_b16 a[226:227], v0 offset:832
    v_add_f32 v119, v119, v70
    v_mfma_f32_16x16x32_bf16 v[180:183], a[196:199], v[28:31], v[180:183]
    ds_read_b64_tr_b16 a[228:229], v0 offset:17216
    ds_read_b64_tr_b16 a[230:231], v0 offset:17728
    v_mfma_f32_16x16x32_bf16 v[180:183], a[192:195], v[20:23], v[180:183]
    buffer_load_dwordx4 a[24:27], v6, s[32:35], s11 offen offset:0 sc1
    v_exp_f32 v77, v61
    v_mfma_f32_16x16x32_bf16 v[188:191], a[200:203], v[20:23], v[188:191]
    ds_read_b64_tr_b16 a[232:233], v0 offset:352
    v_add_f32 v119, v119, v71
    v_mfma_f32_16x16x32_bf16 v[188:191], a[204:207], v[28:31], v[188:191]
    ds_read_b64_tr_b16 a[234:235], v0 offset:864
    v_add_f32 v118, v118, v64
    v_cvt_pk_bf16_f32 v46, v76, v77
    v_mfma_f32_16x16x32_bf16 v[184:187], a[204:207], v[24:27], v[184:187]
    ds_read_b64_tr_b16 a[236:237], v0 offset:17248
    ds_read_b64_tr_b16 a[238:239], v0 offset:17760
    buffer_load_dwordx4 a[28:31], v6, s[32:35], s54 offen offset:0 sc1
    v_mfma_f32_16x16x32_bf16 v[184:187], a[200:203], v[16:19], v[184:187]
    s_waitcnt lgkmcnt(8)
    v_exp_f32 v78, v62
    v_mfma_f32_16x16x32_bf16 v[192:195], a[208:211], v[16:19], v[192:195]
    ds_read_b64_tr_b16 a[240:241], v0 offset:384
    v_add_f32 v118, v118, v65
    v_mfma_f32_16x16x32_bf16 v[192:195], a[212:215], v[24:27], v[192:195]
    ds_read_b64_tr_b16 a[242:243], v0 offset:896
    v_add_f32 v118, v118, v66
    v_mfma_f32_16x16x32_bf16 v[196:199], a[212:215], v[28:31], v[196:199]
    ds_read_b64_tr_b16 a[244:245], v0 offset:17280
    ds_read_b64_tr_b16 a[246:247], v0 offset:17792
    v_mfma_f32_16x16x32_bf16 v[196:199], a[208:211], v[20:23], v[196:199]
    buffer_load_dwordx4 a[32:35], v6, s[32:35], s8 offen offset:1024 sc1
    v_exp_f32 v79, v63
    v_mfma_f32_16x16x32_bf16 v[204:207], a[216:219], v[20:23], v[204:207]
    ds_read_b64_tr_b16 a[248:249], v0 offset:416
    v_add_f32 v118, v118, v67
    v_mfma_f32_16x16x32_bf16 v[204:207], a[220:223], v[28:31], v[204:207]
    ds_read_b64_tr_b16 a[250:251], v0 offset:928
    v_add_f32 v119, v119, v76
    v_cvt_pk_bf16_f32 v47, v78, v79
    v_mfma_f32_16x16x32_bf16 v[200:203], a[220:223], v[24:27], v[200:203]
    ds_read_b64_tr_b16 a[252:253], v0 offset:17312
    ds_read_b64_tr_b16 a[254:255], v0 offset:17824
    buffer_load_dwordx4 a[36:39], v6, s[32:35], s9 offen offset:1024 sc1
    v_mfma_f32_16x16x32_bf16 v[200:203], a[216:219], v[16:19], v[200:203]
    s_waitcnt lgkmcnt(8)
    v_exp_f32 v72, v56
    v_mfma_f32_16x16x32_bf16 v[208:211], a[224:227], v[16:19], v[208:211]
    ds_read_b64_tr_b16 a[192:193], v0 offset:448
    v_add_f32 v119, v119, v77
    v_mfma_f32_16x16x32_bf16 v[208:211], a[228:231], v[24:27], v[208:211]
    ds_read_b64_tr_b16 a[194:195], v0 offset:960
    v_add_f32 v119, v119, v78
    v_mfma_f32_16x16x32_bf16 v[212:215], a[228:231], v[28:31], v[212:215]
    ds_read_b64_tr_b16 a[196:197], v0 offset:17344
    ds_read_b64_tr_b16 a[198:199], v0 offset:17856
    v_mfma_f32_16x16x32_bf16 v[212:215], a[224:227], v[20:23], v[212:215]
    buffer_load_dwordx4 a[40:43], v6, s[32:35], s11 offen offset:1024 sc1
    v_exp_f32 v73, v57
    v_mfma_f32_16x16x32_bf16 v[220:223], a[232:235], v[20:23], v[220:223]
    ds_read_b64_tr_b16 a[200:201], v0 offset:480
    v_add_f32 v119, v119, v79
    v_mfma_f32_16x16x32_bf16 v[220:223], a[236:239], v[28:31], v[220:223]
    ds_read_b64_tr_b16 a[202:203], v0 offset:992
    v_add_f32 v118, v118, v72
    v_cvt_pk_bf16_f32 v42, v72, v73
    v_mfma_f32_16x16x32_bf16 v[216:219], a[236:239], v[24:27], v[216:219]
    ds_read_b64_tr_b16 a[204:205], v0 offset:17376
    ds_read_b64_tr_b16 a[206:207], v0 offset:17888
    buffer_load_dwordx4 a[44:47], v6, s[32:35], s54 offen offset:1024 sc1
    v_mfma_f32_16x16x32_bf16 v[216:219], a[232:235], v[16:19], v[216:219]
    s_waitcnt vmcnt(21) lgkmcnt(8)
    s_barrier
    v_add_f32 v118, v118, v73
    v_mfma_f32_16x16x32_bf16 v[224:227], a[240:243], v[16:19], v[224:227]
    ds_read_b64_tr_b16 a[208:209], v0 offset:33792
    ds_read_b64_tr_b16 a[210:211], v0 offset:34304
    v_mfma_f32_16x16x32_bf16 v[224:227], a[244:247], v[24:27], v[224:227]
    buffer_load_dwordx4 v14, s[28:31], 0 offen offset:0 lds
    buffer_load_dwordx4 a[48:51], v6, s[32:35], s8 offen offset:2048 sc1
    s_add_u32 m0, s37, 101536
    v_mfma_f32_16x16x32_bf16 v[228:231], a[244:247], v[28:31], v[228:231]
    v_exp_f32 v74, v58
    v_mfma_f32_16x16x32_bf16 v[228:231], a[240:243], v[20:23], v[228:231]
    ds_read_b64_tr_b16 a[212:213], v0 offset:50688
    ds_read_b64_tr_b16 a[214:215], v0 offset:51200
    v_mfma_f32_16x16x32_bf16 v[236:239], a[248:251], v[20:23], v[236:239]
    ds_read_b64_tr_b16 a[216:217], v0 offset:33824
    ds_read_b64_tr_b16 a[218:219], v0 offset:34336
    v_mfma_f32_16x16x32_bf16 v[236:239], a[252:255], v[28:31], v[236:239]
    buffer_load_dwordx4 v14, s[28:31], 0 offen offset:896 lds
    buffer_load_dwordx4 a[52:55], v6, s[32:35], s9 offen offset:2048 sc1
    s_add_u32 m0, s37, 101696
    v_mfma_f32_16x16x32_bf16 v[232:235], a[252:255], v[24:27], v[232:235]
    s_waitcnt lgkmcnt(6)
    v_exp_f32 v75, v59
    v_mfma_f32_16x16x32_bf16 v[232:235], a[248:251], v[16:19], v[232:235]
    ds_read_b64_tr_b16 a[220:221], v0 offset:50720
    ds_read_b64_tr_b16 a[222:223], v0 offset:51232
    v_mfma_f32_16x16x32_bf16 v[240:243], a[192:195], v[16:19], v[240:243]
    ds_read_b64_tr_b16 a[224:225], v0 offset:33856
    ds_read_b64_tr_b16 a[226:227], v0 offset:34368
    v_mfma_f32_16x16x32_bf16 v[240:243], a[196:199], v[24:27], v[240:243]
    buffer_load_dwordx4 v14, s[28:31], 0 offen offset:1792 lds
    buffer_load_dwordx4 a[56:59], v6, s[32:35], s11 offen offset:2048 sc1
    s_add_u32 m0, s37, 101856
    v_mfma_f32_16x16x32_bf16 v[244:247], a[196:199], v[28:31], v[244:247]
    ds_read_b64_tr_b16 a[228:229], v0 offset:50752
    v_add_f32 v118, v118, v74
    v_mfma_f32_16x16x32_bf16 v[244:247], a[192:195], v[20:23], v[244:247]
    ds_read_b64_tr_b16 a[230:231], v0 offset:51264
    v_add_f32 v118, v118, v75
    v_cvt_pk_bf16_f32 v43, v74, v75
    v_mfma_f32_16x16x32_bf16 v[252:255], a[200:203], v[20:23], v[252:255]
    ds_read_b64_tr_b16 a[232:233], v0 offset:33888
    ds_read_b64_tr_b16 a[234:235], v0 offset:34400
    v_mfma_f32_16x16x32_bf16 v[252:255], a[204:207], v[28:31], v[252:255]
    buffer_load_dwordx4 v14, s[28:31], 0 offen offset:2688 lds
    buffer_load_dwordx4 a[60:63], v6, s[32:35], s54 offen offset:2048 sc1
    s_add_u32 m0, s37, 118272
    v_add_f32 v120, v118, v119
    v_mfma_f32_16x16x32_bf16 v[248:251], a[204:207], v[24:27], v[248:251]
    ds_read_b64_tr_b16 a[236:237], v0 offset:50784
    v_add_u32 v14, 114688, v14
    v_cmp_nge_f32 vcc, s40, v120
    v_mfma_f32_16x16x32_bf16 v[248:251], a[200:203], v[16:19], v[248:251]
    s_waitcnt lgkmcnt(7)
    s_cbranch_vccnz slow_t63
back_t63:
    ds_read_b64_tr_b16 a[238:239], v0 offset:51296
    v_add_f32 v122, v116, v118
    v_add_f32 v123, v117, v119
    v_mfma_f32_16x16x32_bf16 v[128:131], a[208:211], v[32:35], v[128:131]
    ds_read_b64_tr_b16 a[240:241], v0 offset:33920
    ds_read_b64_tr_b16 a[242:243], v0 offset:34432
    v_mfma_f32_16x16x32_bf16 v[128:131], a[212:215], v[40:43], v[128:131]
    buffer_load_dwordx4 v14, s[28:31], 0 offen offset:0 lds
    s_add_u32 m0, s37, 118432
    v_mov_b32 v124, v122
    v_mfma_f32_16x16x32_bf16 v[132:135], a[212:215], v[44:47], v[132:135]
    ds_read_b64_tr_b16 a[244:245], v0 offset:50816
    v_mov_b32 v125, v123
    v_mfma_f32_16x16x32_bf16 v[132:135], a[208:211], v[36:39], v[132:135]
    ds_read_b64_tr_b16 a[246:247], v0 offset:51328
    v_permlane32_swap_b32 v122, v124
    v_mfma_f32_16x16x32_bf16 v[140:143], a[216:219], v[36:39], v[140:143]
    ds_read_b64_tr_b16 a[248:249], v0 offset:33952
    ds_read_b64_tr_b16 a[250:251], v0 offset:34464
    v_mfma_f32_16x16x32_bf16 v[140:143], a[220:223], v[44:47], v[140:143]
    buffer_load_dwordx4 v14, s[28:31], 0 offen offset:896 lds
    s_add_u32 m0, s37, 118592
    v_mfma_f32_16x16x32_bf16 v[136:139], a[220:223], v[40:43], v[136:139]
    ds_read_b64_tr_b16 a[252:253], v0 offset:50848
    v_mfma_f32_16x16x32_bf16 v[136:139], a[216:219], v[32:35], v[136:139]
    s_waitcnt lgkmcnt(7)
    ds_read_b64_tr_b16 a[254:255], v0 offset:51360
    v_permlane32_swap_b32 v123, v125
    v_mfma_f32_16x16x32_bf16 v[144:147], a[224:227], v[32:35], v[144:147]
    ds_read_b64_tr_b16 a[192:193], v0 offset:33984
    ds_read_b64_tr_b16 a[194:195], v0 offset:34496
    v_mfma_f32_16x16x32_bf16 v[144:147], a[228:231], v[40:43], v[144:147]
    buffer_load_dwordx4 v14, s[28:31], 0 offen offset:1792 lds
    s_add_u32 m0, s37, 118752
    v_add_f32 v122, v122, v124
    v_mfma_f32_16x16x32_bf16 v[148:151], a[228:231], v[44:47], v[148:151]
    ds_read_b64_tr_b16 a[196:197], v0 offset:50880
    v_add_f32 v123, v123, v125
    v_mfma_f32_16x16x32_bf16 v[148:151], a[224:227], v[36:39], v[148:151]
    ds_read_b64_tr_b16 a[198:199], v0 offset:51392
    v_mov_b32 v124, v122
    v_mfma_f32_16x16x32_bf16 v[156:159], a[232:235], v[36:39], v[156:159]
    ds_read_b64_tr_b16 a[200:201], v0 offset:34016
    ds_read_b64_tr_b16 a[202:203], v0 offset:34528
    v_mfma_f32_16x16x32_bf16 v[156:159], a[236:239], v[44:47], v[156:159]
    buffer_load_dwordx4 v14, s[28:31], 0 offen offset:2688 lds
    s_add_u32 m0, s37, 0
    v_mov_b32 v125, v123
    v_mfma_f32_16x16x32_bf16 v[152:155], a[236:239], v[40:43], v[152:155]
    ds_read_b64_tr_b16 a[204:205], v0 offset:50912
    v_add_u32 v14, 4294852736, v14
    v_mfma_f32_16x16x32_bf16 v[152:155], a[232:235], v[32:35], v[152:155]
    s_waitcnt lgkmcnt(7)
    ds_read_b64_tr_b16 a[206:207], v0 offset:51424
    v_permlane16_swap_b32 v122, v124
    v_mfma_f32_16x16x32_bf16 v[160:163], a[240:243], v[32:35], v[160:163]
    ds_read_b64_tr_b16 a[208:209], v0 offset:34048
    v_mfma_f32_16x16x32_bf16 v[160:163], a[244:247], v[40:43], v[160:163]
    ds_read_b64_tr_b16 a[210:211], v0 offset:34560
    v_permlane16_swap_b32 v123, v125
    v_mfma_f32_16x16x32_bf16 v[164:167], a[244:247], v[44:47], v[164:167]
    ds_read_b64_tr_b16 a[212:213], v0 offset:50944
    v_add_f32 v122, v122, v124
    v_mfma_f32_16x16x32_bf16 v[164:167], a[240:243], v[36:39], v[164:167]
    ds_read_b64_tr_b16 a[214:215], v0 offset:51456
    v_add_f32 v123, v123, v125
    v_mfma_f32_16x16x32_bf16 v[172:175], a[248:251], v[36:39], v[172:175]
    ds_read_b64_tr_b16 a[216:217], v0 offset:34080
    v_mfma_f32_16x16x32_bf16 v[172:175], a[252:255], v[44:47], v[172:175]
    ds_read_b64_tr_b16 a[218:219], v0 offset:34592
    v_rcp_f32 v122, v122
    v_mfma_f32_16x16x32_bf16 v[168:171], a[252:255], v[40:43], v[168:171]
    ds_read_b64_tr_b16 a[220:221], v0 offset:50976
    v_mfma_f32_16x16x32_bf16 v[168:171], a[248:251], v[32:35], v[168:171]
    s_waitcnt lgkmcnt(7)
    ds_read_b64_tr_b16 a[222:223], v0 offset:51488
    v_rcp_f32 v123, v123
    v_mfma_f32_16x16x32_bf16 v[176:179], a[192:195], v[32:35], v[176:179]
    ds_read_b64_tr_b16 a[224:225], v0 offset:34112
    v_mul_f32 v128, v128, v122
    v_mfma_f32_16x16x32_bf16 v[176:179], a[196:199], v[40:43], v[176:179]
    ds_read_b64_tr_b16 a[226:227], v0 offset:34624
    v_mul_f32 v129, v129, v122
    v_mul_f32 v130, v130, v122
    v_mul_f32 v131, v131, v122
    v_mfma_f32_16x16x32_bf16 v[180:183], a[196:199], v[44:47], v[180:183]
    ds_read_b64_tr_b16 a[228:229], v0 offset:51008
    v_cvt_pk_bf16_f32 v128, v128, v129
    v_mfma_f32_16x16x32_bf16 v[180:183], a[192:195], v[36:39], v[180:183]
    ds_read_b64_tr_b16 a[230:231], v0 offset:51520
    v_cvt_pk_bf16_f32 v129, v130, v131
    v_mul_f32 v136, v136, v122
    v_mul_f32 v137, v137, v122
    v_mfma_f32_16x16x32_bf16 v[188:191], a[200:203], v[36:39], v[188:191]
    ds_read_b64_tr_b16 a[232:233], v0 offset:34144
    v_mul_f32 v138, v138, v122
    v_mfma_f32_16x16x32_bf16 v[188:191], a[204:207], v[44:47], v[188:191]
    ds_read_b64_tr_b16 a[234:235], v0 offset:34656
    v_mul_f32 v139, v139, v122
    v_cvt_pk_bf16_f32 v130, v136, v137
    v_cvt_pk_bf16_f32 v131, v138, v139
    v_mfma_f32_16x16x32_bf16 v[184:187], a[204:207], v[40:43], v[184:187]
    ds_read_b64_tr_b16 a[236:237], v0 offset:51040
    v_mul_f32 v132, v132, v123
    v_mfma_f32_16x16x32_bf16 v[184:187], a[200:203], v[32:35], v[184:187]
    s_waitcnt lgkmcnt(7)
    ds_read_b64_tr_b16 a[238:239], v0 offset:51552
    v_mul_f32 v133, v133, v123
    v_mul_f32 v134, v134, v123
    v_mfma_f32_16x16x32_bf16 v[192:195], a[208:211], v[32:35], v[192:195]
    ds_read_b64_tr_b16 a[240:241], v0 offset:34176
    v_mul_f32 v135, v135, v123
    v_mfma_f32_16x16x32_bf16 v[192:195], a[212:215], v[40:43], v[192:195]
    ds_read_b64_tr_b16 a[242:243], v0 offset:34688
    v_cvt_pk_bf16_f32 v132, v132, v133
    v_cvt_pk_bf16_f32 v133, v134, v135
    v_mul_f32 v140, v140, v123
    v_mfma_f32_16x16x32_bf16 v[196:199], a[212:215], v[44:47], v[196:199]
    ds_read_b64_tr_b16 a[244:245], v0 offset:51072
    v_mul_f32 v141, v141, v123
    v_mfma_f32_16x16x32_bf16 v[196:199], a[208:211], v[36:39], v[196:199]
    ds_read_b64_tr_b16 a[246:247], v0 offset:51584
    v_mul_f32 v142, v142, v123
    v_mul_f32 v143, v143, v123
    v_cvt_pk_bf16_f32 v134, v140, v141
    v_mfma_f32_16x16x32_bf16 v[204:207], a[216:219], v[36:39], v[204:207]
    ds_read_b64_tr_b16 a[248:249], v0 offset:34208
    v_cvt_pk_bf16_f32 v135, v142, v143
    v_mfma_f32_16x16x32_bf16 v[204:207], a[220:223], v[44:47], v[204:207]
    ds_read_b64_tr_b16 a[250:251], v0 offset:34720
    v_mul_f32 v144, v144, v122
    v_mul_f32 v145, v145, v122
    v_mul_f32 v146, v146, v122
    v_mfma_f32_16x16x32_bf16 v[200:203], a[220:223], v[40:43], v[200:203]
    ds_read_b64_tr_b16 a[252:253], v0 offset:51104
    v_mul_f32 v147, v147, v122
    v_mfma_f32_16x16x32_bf16 v[200:203], a[216:219], v[32:35], v[200:203]
    s_waitcnt lgkmcnt(7)
    ds_read_b64_tr_b16 a[254:255], v0 offset:51616
    v_cvt_pk_bf16_f32 v144, v144, v145
    v_cvt_pk_bf16_f32 v145, v146, v147
    v_mfma_f32_16x16x32_bf16 v[208:211], a[224:227], v[32:35], v[208:211]
    ds_read_b64_tr_b16 a[192:193], v0 offset:34240
    v_mul_f32 v152, v152, v122
    v_mfma_f32_16x16x32_bf16 v[208:211], a[228:231], v[40:43], v[208:211]
    ds_read_b64_tr_b16 a[194:195], v0 offset:34752
    v_mul_f32 v153, v153, v122
    v_mul_f32 v154, v154, v122
    v_mul_f32 v155, v155, v122
    v_mfma_f32_16x16x32_bf16 v[212:215], a[228:231], v[44:47], v[212:215]
    ds_read_b64_tr_b16 a[196:197], v0 offset:51136
    v_cvt_pk_bf16_f32 v146, v152, v153
    v_mfma_f32_16x16x32_bf16 v[212:215], a[224:227], v[36:39], v[212:215]
    ds_read_b64_tr_b16 a[198:199], v0 offset:51648
    v_cvt_pk_bf16_f32 v147, v154, v155
    v_mul_f32 v148, v148, v123
    v_mul_f32 v149, v149, v123
    v_mfma_f32_16x16x32_bf16 v[220:223], a[232:235], v[36:39], v[220:223]
    ds_read_b64_tr_b16 a[200:201], v0 offset:34272
    v_mul_f32 v150, v150, v123
    v_mfma_f32_16x16x32_bf16 v[220:223], a[236:239], v[44:47], v[220:223]
    ds_read_b64_tr_b16 a[202:203], v0 offset:34784
    v_mul_f32 v151, v151, v123
    v_cvt_pk_bf16_f32 v148, v148, v149
    v_cvt_pk_bf16_f32 v149, v150, v151
    v_mfma_f32_16x16x32_bf16 v[216:219], a[236:239], v[40:43], v[216:219]
    ds_read_b64_tr_b16 a[204:205], v0 offset:51168
    ds_read_b64_tr_b16 a[206:207], v0 offset:51680
    v_mfma_f32_16x16x32_bf16 v[216:219], a[232:235], v[32:35], v[216:219]
    s_waitcnt vmcnt(63) lgkmcnt(8)
    s_barrier
    v_mul_f32 v156, v156, v123
    v_mul_f32 v157, v157, v123
    v_mul_f32 v158, v158, v123
    v_mfma_f32_16x16x32_bf16 v[224:227], a[240:243], v[32:35], v[224:227]
    ds_read_b64_tr_b16 a[208:209], v115 offset:0
    ds_read_b64_tr_b16 a[210:211], v115 offset:256
    v_mfma_f32_16x16x32_bf16 v[224:227], a[244:247], v[40:43], v[224:227]
    buffer_load_dwordx4 v14, s[28:31], 0 offen offset:0 lds
    s_add_u32 m0, s37, 160
    v_mul_f32 v159, v159, v123
    v_mfma_f32_16x16x32_bf16 v[228:231], a[244:247], v[44:47], v[228:231]
    ds_read_b64_tr_b16 a[212:213], v115 offset:32
    v_cvt_pk_bf16_f32 v150, v156, v157
    v_mfma_f32_16x16x32_bf16 v[228:231], a[240:243], v[36:39], v[228:231]
    ds_read_b64_tr_b16 a[214:215], v115 offset:288
    v_cvt_pk_bf16_f32 v151, v158, v159
    v_mul_f32 v160, v160, v122
    v_mul_f32 v161, v161, v122
    v_mfma_f32_16x16x32_bf16 v[236:239], a[248:251], v[36:39], v[236:239]
    ds_read_b64_tr_b16 a[216:217], v115 offset:64
    ds_read_b64_tr_b16 a[218:219], v115 offset:320
    v_mfma_f32_16x16x32_bf16 v[236:239], a[252:255], v[44:47], v[236:239]
    buffer_load_dwordx4 v14, s[28:31], 0 offen offset:896 lds
    s_add_u32 m0, s37, 320
    v_mul_f32 v162, v162, v122
    v_mfma_f32_16x16x32_bf16 v[232:235], a[252:255], v[40:43], v[232:235]
    ds_read_b64_tr_b16 a[220:221], v115 offset:96
    v_mul_f32 v163, v163, v122
    v_mfma_f32_16x16x32_bf16 v[232:235], a[248:251], v[32:35], v[232:235]
    s_waitcnt lgkmcnt(7)
    ds_read_b64_tr_b16 a[222:223], v115 offset:352
    v_cvt_pk_bf16_f32 v160, v160, v161
    v_cvt_pk_bf16_f32 v161, v162, v163
    v_mfma_f32_16x16x32_bf16 v[240:243], a[192:195], v[32:35], v[240:243]
    ds_read_b64_tr_b16 a[224:225], v115 offset:512
    ds_read_b64_tr_b16 a[226:227], v115 offset:768
    v_mfma_f32_16x16x32_bf16 v[240:243], a[196:199], v[40:43], v[240:243]
    buffer_load_dwordx4 v14, s[28:31], 0 offen offset:1792 lds
    s_add_u32 m0, s37, 480
    v_mul_f32 v168, v168, v122
    v_mfma_f32_16x16x32_bf16 v[244:247], a[196:199], v[44:47], v[244:247]
    ds_read_b64_tr_b16 a[228:229], v115 offset:544
    v_mul_f32 v169, v169, v122
    v_mfma_f32_16x16x32_bf16 v[244:247], a[192:195], v[36:39], v[244:247]
    ds_read_b64_tr_b16 a[230:231], v115 offset:800
    v_mul_f32 v170, v170, v122
    v_mul_f32 v171, v171, v122
    v_cvt_pk_bf16_f32 v162, v168, v169
    v_mfma_f32_16x16x32_bf16 v[252:255], a[200:203], v[36:39], v[252:255]
    ds_read_b64_tr_b16 a[232:233], v115 offset:576
    ds_read_b64_tr_b16 a[234:235], v115 offset:832
    v_mfma_f32_16x16x32_bf16 v[252:255], a[204:207], v[44:47], v[252:255]
    buffer_load_dwordx4 v14, s[28:31], 0 offen offset:2688 lds
    s_add_u32 m0, s37, 16896
    v_cvt_pk_bf16_f32 v163, v170, v171
    v_mfma_f32_16x16x32_bf16 v[248:251], a[204:207], v[40:43], v[248:251]
    ds_read_b64_tr_b16 a[236:237], v115 offset:608
    v_add_u32 v14, 114688, v14
    v_mfma_f32_16x16x32_bf16 v[248:251], a[200:203], v[32:35], v[248:251]
    s_waitcnt lgkmcnt(7)
    ds_read_b64_tr_b16 a[238:239], v115 offset:864
    v_mul_f32 v164, v164, v123
    v_mul_f32 v165, v165, v123
    v_mfma_f32_16x16x32_bf16 v[48:51], a[208:211], v[128:131], 0
    ds_read_b64_tr_b16 a[240:241], v115 offset:8448
    ds_read_b64_tr_b16 a[242:243], v115 offset:8704
    v_mul_f32 v166, v166, v123
    v_mfma_f32_16x16x32_bf16 v[52:55], a[208:211], v[132:135], 0
    buffer_load_dwordx4 v14, s[28:31], 0 offen offset:0 lds
    s_add_u32 m0, s37, 17056
    v_mul_f32 v167, v167, v123
    v_mfma_f32_16x16x32_bf16 v[60:63], a[212:215], v[132:135], 0
    ds_read_b64_tr_b16 a[244:245], v115 offset:8480
    v_cvt_pk_bf16_f32 v164, v164, v165
    v_cvt_pk_bf16_f32 v165, v166, v167
    v_mul_f32 v172, v172, v123
    v_mfma_f32_16x16x32_bf16 v[56:59], a[212:215], v[128:131], 0
    ds_read_b64_tr_b16 a[246:247], v115 offset:8736
    v_mul_f32 v173, v173, v123
    v_mul_f32 v174, v174, v123
    v_mul_f32 v175, v175, v123
    v_mfma_f32_16x16x32_bf16 v[64:67], a[216:219], v[128:131], 0
    ds_read_b64_tr_b16 a[248:249], v115 offset:8512
    ds_read_b64_tr_b16 a[250:251], v115 offset:8768
    v_cvt_pk_bf16_f32 v166, v172, v173
    v_mfma_f32_16x16x32_bf16 v[68:71], a[216:219], v[132:135], 0
    buffer_load_dwordx4 v14, s[28:31], 0 offen offset:896 lds
    s_add_u32 m0, s37, 17216
    v_cvt_pk_bf16_f32 v167, v174, v175
    v_mfma_f32_16x16x32_bf16 v[76:79], a[220:223], v[132:135], 0
    ds_read_b64_tr_b16 a[252:253], v115 offset:8544
    v_mul_f32 v176, v176, v122
    v_mul_f32 v177, v177, v122
    v_mul_f32 v178, v178, v122
    v_mfma_f32_16x16x32_bf16 v[72:75], a[220:223], v[128:131], 0
    s_waitcnt lgkmcnt(7)
    ds_read_b64_tr_b16 a[254:255], v115 offset:8800
    v_mul_f32 v179, v179, v122
    v_cvt_pk_bf16_f32 v176, v176, v177
    v_mfma_f32_16x16x32_bf16 v[48:51], a[224:227], v[144:147], v[48:51]
    ds_read_b64_tr_b16 a[192:193], v115 offset:8960
    ds_read_b64_tr_b16 a[194:195], v115 offset:9216
    v_cvt_pk_bf16_f32 v177, v178, v179
    v_mfma_f32_16x16x32_bf16 v[52:55], a[224:227], v[148:151], v[52:55]
    buffer_load_dwordx4 v14, s[28:31], 0 offen offset:1792 lds
    s_add_u32 m0, s37, 17376
    v_mul_f32 v184, v184, v122
    v_mfma_f32_16x16x32_bf16 v[60:63], a[228:231], v[148:151], v[60:63]
    ds_read_b64_tr_b16 a[196:197], v115 offset:8992
    v_mul_f32 v185, v185, v122
    v_mul_f32 v186, v186, v122
    v_mul_f32 v187, v187, v122
    v_mfma_f32_16x16x32_bf16 v[56:59], a[228:231], v[144:147], v[56:59]
    ds_read_b64_tr_b16 a[198:199], v115 offset:9248
    v_cvt_pk_bf16_f32 v178, v184, v185
    v_cvt_pk_bf16_f32 v179, v186, v187
    v_mul_f32 v180, v180, v123
    v_mfma_f32_16x16x32_bf16 v[64:67], a[232:235], v[144:147], v[64:67]
    ds_read_b64_tr_b16 a[200:201], v115 offset:9024
    ds_read_b64_tr_b16 a[202:203], v115 offset:9280
    v_mul_f32 v181, v181, v123
    v_mfma_f32_16x16x32_bf16 v[68:71], a[232:235], v[148:151], v[68:71]
    buffer_load_dwordx4 v14, s[28:31], 0 offen offset:2688 lds
    s_add_u32 m0, s37, 33792
    v_mul_f32 v182, v182, v123
    v_mfma_f32_16x16x32_bf16 v[76:79], a[236:239], v[148:151], v[76:79]
    ds_read_b64_tr_b16 a[204:205], v115 offset:9056
    ds_read_b64_tr_b16 a[206:207], v115 offset:9312
    v_mul_f32 v183, v183, v123
    v_mfma_f32_16x16x32_bf16 v[72:75], a[236:239], v[144:147], v[72:75]
    s_waitcnt vmcnt(32) lgkmcnt(8)
    s_barrier
    v_add_u32 v14, 4294852736, v14
    v_cvt_pk_bf16_f32 v180, v180, v181
    v_cvt_pk_bf16_f32 v181, v182, v183
    v_mfma_f32_16x16x32_bf16 v[48:51], a[240:243], v[160:163], v[48:51]
    ds_read_b64_tr_b16 a[208:209], v115 offset:16896
    ds_read_b64_tr_b16 a[210:211], v115 offset:17152
    v_mul_f32 v188, v188, v123
    v_mfma_f32_16x16x32_bf16 v[52:55], a[240:243], v[164:167], v[52:55]
    buffer_load_dwordx4 v14, s[28:31], 0 offen offset:0 lds
    s_add_u32 m0, s37, 33952
    v_mul_f32 v189, v189, v123
    v_mfma_f32_16x16x32_bf16 v[60:63], a[244:247], v[164:167], v[60:63]
    ds_read_b64_tr_b16 a[212:213], v115 offset:16928
    v_mul_f32 v190, v190, v123
    v_mul_f32 v191, v191, v123
    v_cvt_pk_bf16_f32 v182, v188, v189
    v_mfma_f32_16x16x32_bf16 v[56:59], a[244:247], v[160:163], v[56:59]
    ds_read_b64_tr_b16 a[214:215], v115 offset:17184
    v_cvt_pk_bf16_f32 v183, v190, v191
    v_mul_f32 v192, v192, v122
    v_mul_f32 v193, v193, v122
    v_mfma_f32_16x16x32_bf16 v[64:67], a[248:251], v[160:163], v[64:67]
    ds_read_b64_tr_b16 a[216:217], v115 offset:16960
    ds_read_b64_tr_b16 a[218:219], v115 offset:17216
    v_mul_f32 v194, v194, v122
    v_mfma_f32_16x16x32_bf16 v[68:71], a[248:251], v[164:167], v[68:71]
    buffer_load_dwordx4 v14, s[28:31], 0 offen offset:896 lds
    s_add_u32 m0, s37, 34112
    v_mul_f32 v195, v195, v122
    v_mfma_f32_16x16x32_bf16 v[76:79], a[252:255], v[164:167], v[76:79]
    ds_read_b64_tr_b16 a[220:221], v115 offset:16992
    v_cvt_pk_bf16_f32 v192, v192, v193
    v_cvt_pk_bf16_f32 v193, v194, v195
    v_mul_f32 v200, v200, v122
    v_mfma_f32_16x16x32_bf16 v[72:75], a[252:255], v[160:163], v[72:75]
    s_waitcnt lgkmcnt(7)
    ds_read_b64_tr_b16 a[222:223], v115 offset:17248
    v_mul_f32 v201, v201, v122
    v_mul_f32 v202, v202, v122
    v_mfma_f32_16x16x32_bf16 v[48:51], a[192:195], v[176:179], v[48:51]
    ds_read_b64_tr_b16 a[224:225], v115 offset:17408
    ds_read_b64_tr_b16 a[226:227], v115 offset:17664
    v_mul_f32 v203, v203, v122
    v_mfma_f32_16x16x32_bf16 v[52:55], a[192:195], v[180:183], v[52:55]
    buffer_load_dwordx4 v14, s[28:31], 0 offen offset:1792 lds
    s_add_u32 m0, s37, 34272
    v_cvt_pk_bf16_f32 v194, v200, v201
    v_mfma_f32_16x16x32_bf16 v[60:63], a[196:199], v[180:183], v[60:63]
    ds_read_b64_tr_b16 a[228:229], v115 offset:17440
    v_cvt_pk_bf16_f32 v195, v202, v203
    v_mul_f32 v196, v196, v123
    v_mul_f32 v197, v197, v123
    v_mfma_f32_16x16x32_bf16 v[56:59], a[196:199], v[176:179], v[56:59]
    ds_read_b64_tr_b16 a[230:231], v115 offset:17696
    v_mul_f32 v198, v198, v123
    v_mul_f32 v199, v199, v123
    v_cvt_pk_bf16_f32 v196, v196, v197
    v_mfma_f32_16x16x32_bf16 v[64:67], a[200:203], v[176:179], v[64:67]
    ds_read_b64_tr_b16 a[232:233], v115 offset:17472
    ds_read_b64_tr_b16 a[234:235], v115 offset:17728
    v_cvt_pk_bf16_f32 v197, v198, v199
    v_mfma_f32_16x16x32_bf16 v[68:71], a[200:203], v[180:183], v[68:71]
    buffer_load_dwordx4 v14, s[28:31], 0 offen offset:2688 lds
    s_add_u32 m0, s37, 50688
    v_mul_f32 v204, v204, v123
    v_mfma_f32_16x16x32_bf16 v[76:79], a[204:207], v[180:183], v[76:79]
    ds_read_b64_tr_b16 a[236:237], v115 offset:17504
    v_add_u32 v14, 114688, v14
    v_mul_f32 v205, v205, v123
    v_mul_f32 v206, v206, v123
    v_mul_f32 v207, v207, v123
    v_cvt_pk_bf16_f32 v198, v204, v205
    v_cvt_pk_bf16_f32 v199, v206, v207
    v_mfma_f32_16x16x32_bf16 v[72:75], a[204:207], v[176:179], v[72:75]
    s_waitcnt lgkmcnt(7)
    ds_read_b64_tr_b16 a[238:239], v115 offset:17760
    v_mul_f32 v208, v208, v122
    v_mul_f32 v209, v209, v122
    v_mfma_f32_16x16x32_bf16 v[48:51], a[208:211], v[192:195], v[48:51]
    ds_read_b64_tr_b16 a[240:241], v115 offset:25344
    ds_read_b64_tr_b16 a[242:243], v115 offset:25600
    v_mul_f32 v210, v210, v122
    v_mfma_f32_16x16x32_bf16 v[52:55], a[208:211], v[196:199], v[52:55]
    buffer_load_dwordx4 v14, s[28:31], 0 offen offset:0 lds
    s_add_u32 m0, s37, 50848
    v_mul_f32 v211, v211, v122
    v_mfma_f32_16x16x32_bf16 v[60:63], a[212:215], v[196:199], v[60:63]
    ds_read_b64_tr_b16 a[244:245], v115 offset:25376
    v_cvt_pk_bf16_f32 v208, v208, v209
    v_cvt_pk_bf16_f32 v209, v210, v211
    v_mul_f32 v216, v216, v122
    v_mfma_f32_16x16x32_bf16 v[56:59], a[212:215], v[192:195], v[56:59]
    ds_read_b64_tr_b16 a[246:247], v115 offset:25632
    v_mul_f32 v217, v217, v122
    v_mul_f32 v218, v218, v122
    v_mul_f32 v219, v219, v122
    v_mfma_f32_16x16x32_bf16 v[64:67], a[216:219], v[192:195], v[64:67]
    ds_read_b64_tr_b16 a[248:249], v115 offset:25408
    ds_read_b64_tr_b16 a[250:251], v115 offset:25664
    v_cvt_pk_bf16_f32 v210, v216, v217
    v_mfma_f32_16x16x32_bf16 v[68:71], a[216:219], v[196:199], v[68:71]
    buffer_load_dwordx4 v14, s[28:31], 0 offen offset:896 lds
    s_add_u32 m0, s37, 51008
    v_cvt_pk_bf16_f32 v211, v218, v219
    v_mfma_f32_16x16x32_bf16 v[76:79], a[220:223], v[196:199], v[76:79]
    ds_read_b64_tr_b16 a[252:253], v115 offset:25440
    v_mul_f32 v212, v212, v123
    v_mul_f32 v213, v213, v123
    v_mul_f32 v214, v214, v123
    v_mul_f32 v215, v215, v123
    v_cvt_pk_bf16_f32 v212, v212, v213
    v_cvt_pk_bf16_f32 v213, v214, v215
    v_mul_f32 v220, v220, v123
    v_mul_f32 v221, v221, v123
    v_mul_f32 v222, v222, v123
    v_mul_f32 v223, v223, v123
    v_cvt_pk_bf16_f32 v214, v220, v221
    v_cvt_pk_bf16_f32 v215, v222, v223
    v_mfma_f32_16x16x32_bf16 v[72:75], a[220:223], v[192:195], v[72:75]
    s_waitcnt lgkmcnt(7)
    ds_read_b64_tr_b16 a[254:255], v115 offset:25696
    v_mul_f32 v224, v224, v122
    v_mul_f32 v225, v225, v122
    v_mfma_f32_16x16x32_bf16 v[48:51], a[224:227], v[208:211], v[48:51]
    ds_read_b64_tr_b16 a[192:193], v115 offset:25856
    ds_read_b64_tr_b16 a[194:195], v115 offset:26112
    v_mul_f32 v226, v226, v122
    v_mfma_f32_16x16x32_bf16 v[52:55], a[224:227], v[212:215], v[52:55]
    buffer_load_dwordx4 v14, s[28:31], 0 offen offset:1792 lds
    s_add_u32 m0, s37, 51168
    v_mul_f32 v227, v227, v122
    v_mfma_f32_16x16x32_bf16 v[60:63], a[228:231], v[212:215], v[60:63]
    ds_read_b64_tr_b16 a[196:197], v115 offset:25888
    v_cvt_pk_bf16_f32 v224, v224, v225
    v_cvt_pk_bf16_f32 v225, v226, v227
    v_mul_f32 v232, v232, v122
    v_mfma_f32_16x16x32_bf16 v[56:59], a[228:231], v[208:211], v[56:59]
    ds_read_b64_tr_b16 a[198:199], v115 offset:26144
    v_mul_f32 v233, v233, v122
    v_mul_f32 v234, v234, v122
    v_mul_f32 v235, v235, v122
    v_mfma_f32_16x16x32_bf16 v[64:67], a[232:235], v[208:211], v[64:67]
    ds_read_b64_tr_b16 a[200:201], v115 offset:25920
    ds_read_b64_tr_b16 a[202:203], v115 offset:26176
    v_cvt_pk_bf16_f32 v226, v232, v233
    v_mfma_f32_16x16x32_bf16 v[68:71], a[232:235], v[212:215], v[68:71]
    buffer_load_dwordx4 v14, s[28:31], 0 offen offset:2688 lds
    s_add_u32 m0, s37, 67584
    v_cvt_pk_bf16_f32 v227, v234, v235
    v_mfma_f32_16x16x32_bf16 v[76:79], a[236:239], v[212:215], v[76:79]
    ds_read_b64_tr_b16 a[204:205], v115 offset:25952
    ds_read_b64_tr_b16 a[206:207], v115 offset:26208
    v_mul_f32 v228, v228, v123
    v_mul_f32 v229, v229, v123
    v_mul_f32 v230, v230, v123
    v_mul_f32 v231, v231, v123
    v_cvt_pk_bf16_f32 v228, v228, v229
    v_cvt_pk_bf16_f32 v229, v230, v231
    v_mul_f32 v236, v236, v123
    v_mul_f32 v237, v237, v123
    v_mul_f32 v238, v238, v123
    v_mul_f32 v239, v239, v123
    v_cvt_pk_bf16_f32 v230, v236, v237
    v_cvt_pk_bf16_f32 v231, v238, v239
    v_mfma_f32_16x16x32_bf16 v[72:75], a[236:239], v[208:211], v[72:75]
    s_waitcnt vmcnt(21) lgkmcnt(8)
    s_barrier
    v_add_u32 v14, 4294852736, v14
    v_mul_f32 v240, v240, v122
    v_mul_f32 v241, v241, v122
    v_mfma_f32_16x16x32_bf16 v[48:51], a[240:243], v[224:227], v[48:51]
    ds_read_b64_tr_b16 a[208:209], v115 offset:33792
    ds_read_b64_tr_b16 a[210:211], v115 offset:34048
    v_mul_f32 v242, v242, v122
    v_mfma_f32_16x16x32_bf16 v[52:55], a[240:243], v[228:231], v[52:55]
    buffer_load_dwordx4 v14, s[28:31], 0 offen offset:0 lds
    s_add_u32 m0, s37, 67744
    v_mul_f32 v243, v243, v122
    v_mfma_f32_16x16x32_bf16 v[60:63], a[244:247], v[228:231], v[60:63]
    ds_read_b64_tr_b16 a[212:213], v115 offset:34304
    v_cvt_pk_bf16_f32 v240, v240, v241
    v_cvt_pk_bf16_f32 v241, v242, v243
    v_mul_f32 v248, v248, v122
    v_mfma_f32_16x16x32_bf16 v[56:59], a[244:247], v[224:227], v[56:59]
    ds_read_b64_tr_b16 a[214:215], v115 offset:34560
    v_mul_f32 v249, v249, v122
    v_mul_f32 v250, v250, v122
    v_mul_f32 v251, v251, v122
    v_mfma_f32_16x16x32_bf16 v[64:67], a[248:251], v[224:227], v[64:67]
    ds_read_b64_tr_b16 a[216:217], v115 offset:42240
    ds_read_b64_tr_b16 a[218:219], v115 offset:42496
    v_cvt_pk_bf16_f32 v242, v248, v249
    v_mfma_f32_16x16x32_bf16 v[68:71], a[248:251], v[228:231], v[68:71]
    buffer_load_dwordx4 v14, s[28:31], 0 offen offset:896 lds
    s_add_u32 m0, s37, 67904
    v_cvt_pk_bf16_f32 v243, v250, v251
    v_mfma_f32_16x16x32_bf16 v[76:79], a[252:255], v[228:231], v[76:79]
    ds_read_b64_tr_b16 a[220:221], v115 offset:42752
    v_mul_f32 v244, v244, v123
    v_mul_f32 v245, v245, v123
    v_mul_f32 v246, v246, v123
    v_mul_f32 v247, v247, v123
    v_cvt_pk_bf16_f32 v244, v244, v245
    v_cvt_pk_bf16_f32 v245, v246, v247
    v_mul_f32 v252, v252, v123
    v_mul_f32 v253, v253, v123
    v_mul_f32 v254, v254, v123
    v_mul_f32 v255, v255, v123
    v_cvt_pk_bf16_f32 v246, v252, v253
    v_cvt_pk_bf16_f32 v247, v254, v255
    v_mfma_f32_16x16x32_bf16 v[72:75], a[252:255], v[224:227], v[72:75]
    s_waitcnt lgkmcnt(7)
    ds_read_b64_tr_b16 a[222:223], v115 offset:43008
    v_mfma_f32_16x16x32_bf16 v[48:51], a[192:195], v[240:243], v[48:51]
    ds_read_b64_tr_b16 a[224:225], v115 offset:33824
    ds_read_b64_tr_b16 a[226:227], v115 offset:34080
    v_mfma_f32_16x16x32_bf16 v[52:55], a[192:195], v[244:247], v[52:55]
    buffer_load_dwordx4 v14, s[28:31], 0 offen offset:1792 lds
    s_add_u32 m0, s37, 68064
    v_mfma_f32_16x16x32_bf16 v[60:63], a[196:199], v[244:247], v[60:63]
    ds_read_b64_tr_b16 a[228:229], v115 offset:34336
    v_mfma_f32_16x16x32_bf16 v[56:59], a[196:199], v[240:243], v[56:59]
    ds_read_b64_tr_b16 a[230:231], v115 offset:34592
    v_mfma_f32_16x16x32_bf16 v[64:67], a[200:203], v[240:243], v[64:67]
    ds_read_b64_tr_b16 a[232:233], v115 offset:42272
    ds_read_b64_tr_b16 a[234:235], v115 offset:42528
    v_mfma_f32_16x16x32_bf16 v[68:71], a[200:203], v[244:247], v[68:71]
    buffer_load_dwordx4 v14, s[28:31], 0 offen offset:2688 lds
    s_add_u32 m0, s37, 84480
    v_mfma_f32_16x16x32_bf16 v[76:79], a[204:207], v[244:247], v[76:79]
    ds_read_b64_tr_b16 a[236:237], v115 offset:42784
    v_add_u32 v14, 114688, v14
    v_mfma_f32_16x16x32_bf16 v[72:75], a[204:207], v[240:243], v[72:75]
    s_waitcnt lgkmcnt(7)
    ds_read_b64_tr_b16 a[238:239], v115 offset:43040
    v_mfma_f32_16x16x32_bf16 v[20:23], a[208:211], v[132:135], 0
    ds_read_b64_tr_b16 a[240:241], v115 offset:33856
    v_mfma_f32_16x16x32_bf16 v[20:23], a[212:215], v[148:151], v[20:23]
    ds_read_b64_tr_b16 a[242:243], v115 offset:34112
    v_mfma_f32_16x16x32_bf16 v[20:23], a[216:219], v[164:167], v[20:23]
    ds_read_b64_tr_b16 a[244:245], v115 offset:34368
    v_mfma_f32_16x16x32_bf16 v[20:23], a[220:223], v[180:183], v[20:23]
    ds_read_b64_tr_b16 a[246:247], v115 offset:34624
    v_mfma_f32_16x16x32_bf16 v[16:19], a[220:223], v[176:179], 0
    ds_read_b64_tr_b16 a[248:249], v115 offset:42304
    v_cvt_pk_bf16_f32 v48, v48, v49
    v_mfma_f32_16x16x32_bf16 v[16:19], a[216:219], v[160:163], v[16:19]
    ds_read_b64_tr_b16 a[250:251], v115 offset:42560
    v_cvt_pk_bf16_f32 v49, v50, v51
    v_mfma_f32_16x16x32_bf16 v[16:19], a[212:215], v[144:147], v[16:19]
    ds_read_b64_tr_b16 a[252:253], v115 offset:42816
    v_cvt_pk_bf16_f32 v50, v56, v57
    v_mfma_f32_16x16x32_bf16 v[16:19], a[208:211], v[128:131], v[16:19]
    s_waitcnt lgkmcnt(7)
    ds_read_b64_tr_b16 a[254:255], v115 offset:43072
    v_cvt_pk_bf16_f32 v51, v58, v59
    v_mfma_f32_16x16x32_bf16 v[24:27], a[224:227], v[128:131], 0
    ds_read_b64_tr_b16 a[192:193], v115 offset:33888
    buffer_store_dwordx4 v[48:51], v6, s[32:35], s50 offen sc1
    v_mfma_f32_16x16x32_bf16 v[24:27], a[228:231], v[144:147], v[24:27]
    s_add_u32 s50, s50, 16384
    ds_read_b64_tr_b16 a[194:195], v115 offset:34144
    v_mfma_f32_16x16x32_bf16 v[24:27], a[232:235], v[160:163], v[24:27]
    ds_read_b64_tr_b16 a[196:197], v115 offset:34400
    v_cvt_pk_bf16_f32 v52, v52, v53
    v_mfma_f32_16x16x32_bf16 v[24:27], a[236:239], v[176:179], v[24:27]
    ds_read_b64_tr_b16 a[198:199], v115 offset:34656
    v_cvt_pk_bf16_f32 v53, v54, v55
    v_cvt_pk_bf16_f32 v54, v60, v61
    v_mfma_f32_16x16x32_bf16 v[28:31], a[236:239], v[180:183], 0
    ds_read_b64_tr_b16 a[200:201], v115 offset:42336
    v_cvt_pk_bf16_f32 v55, v62, v63
    v_mfma_f32_16x16x32_bf16 v[28:31], a[232:235], v[164:167], v[28:31]
    ds_read_b64_tr_b16 a[202:203], v115 offset:42592
    buffer_store_dwordx4 v[52:55], v6, s[32:35], s10 offen sc1
    v_mfma_f32_16x16x32_bf16 v[28:31], a[228:231], v[148:151], v[28:31]
    ds_read_b64_tr_b16 a[204:205], v115 offset:42848
    ds_read_b64_tr_b16 a[206:207], v115 offset:43104
    v_mfma_f32_16x16x32_bf16 v[28:31], a[224:227], v[132:135], v[28:31]
    s_waitcnt vmcnt(22) lgkmcnt(8)
    s_barrier
    s_add_u32 s10, s10, 16384
    v_cvt_pk_bf16_f32 v64, v64, v65
    v_mfma_f32_16x16x32_bf16 v[36:39], a[240:243], v[132:135], 0
    ds_read_b64_tr_b16 a[208:209], v115 offset:50688
    ds_read_b64_tr_b16 a[210:211], v115 offset:50944
    buffer_load_dwordx4 v[136:139], v6, s[32:35], s8 offen offset:3072 sc1
    s_add_u32 s8, s8, 4096
    v_mfma_f32_16x16x32_bf16 v[36:39], a[244:247], v[148:151], v[36:39]
    buffer_load_dwordx4 v14, s[28:31], 0 offen offset:0 lds
    s_add_u32 m0, s37, 84640
    v_mfma_f32_16x16x32_bf16 v[36:39], a[248:251], v[164:167], v[36:39]
    ds_read_b64_tr_b16 a[212:213], v115 offset:51200
    v_cvt_pk_bf16_f32 v65, v66, v67
    v_mfma_f32_16x16x32_bf16 v[36:39], a[252:255], v[180:183], v[36:39]
    ds_read_b64_tr_b16 a[214:215], v115 offset:51456
    v_cvt_pk_bf16_f32 v66, v72, v73
    v_cvt_pk_bf16_f32 v67, v74, v75
    v_mfma_f32_16x16x32_bf16 v[32:35], a[252:255], v[176:179], 0
    ds_read_b64_tr_b16 a[216:217], v115 offset:59136
    ds_read_b64_tr_b16 a[218:219], v115 offset:59392
    buffer_load_dwordx4 v[140:143], v6, s[32:35], s9 offen offset:3072 sc1
    s_add_u32 s9, s9, 4096
    v_mfma_f32_16x16x32_bf16 v[32:35], a[248:251], v[160:163], v[32:35]
    buffer_load_dwordx4 v14, s[28:31], 0 offen offset:896 lds
    s_add_u32 m0, s37, 84800
    v_mfma_f32_16x16x32_bf16 v[32:35], a[244:247], v[144:147], v[32:35]
    ds_read_b64_tr_b16 a[220:221], v115 offset:59648
    buffer_store_dwordx4 v[64:67], v6, s[32:35], s50 offen sc1
    v_mfma_f32_16x16x32_bf16 v[32:35], a[240:243], v[128:131], v[32:35]
    s_waitcnt lgkmcnt(7)
    s_add_u32 s50, s50, 16384
    ds_read_b64_tr_b16 a[222:223], v115 offset:59904
    v_cvt_pk_bf16_f32 v68, v68, v69
    v_mfma_f32_16x16x32_bf16 v[40:43], a[192:195], v[128:131], 0
    ds_read_b64_tr_b16 a[224:225], v115 offset:50720
    ds_read_b64_tr_b16 a[226:227], v115 offset:50976
    buffer_load_dwordx4 v[152:155], v6, s[32:35], s11 offen offset:3072 sc1
    s_add_u32 s11, s11, 4096
    v_mfma_f32_16x16x32_bf16 v[40:43], a[196:199], v[144:147], v[40:43]
    buffer_load_dwordx4 v14, s[28:31], 0 offen offset:1792 lds
    s_add_u32 m0, s37, 84960
    v_mfma_f32_16x16x32_bf16 v[40:43], a[200:203], v[160:163], v[40:43]
    ds_read_b64_tr_b16 a[228:229], v115 offset:51232
    v_cvt_pk_bf16_f32 v69, v70, v71
    v_mfma_f32_16x16x32_bf16 v[40:43], a[204:207], v[176:179], v[40:43]
    ds_read_b64_tr_b16 a[230:231], v115 offset:51488
    v_cvt_pk_bf16_f32 v70, v76, v77
    v_cvt_pk_bf16_f32 v71, v78, v79
    v_mfma_f32_16x16x32_bf16 v[44:47], a[204:207], v[180:183], 0
    ds_read_b64_tr_b16 a[232:233], v115 offset:59168
    ds_read_b64_tr_b16 a[234:235], v115 offset:59424
    v_mfma_f32_16x16x32_bf16 v[44:47], a[200:203], v[164:167], v[44:47]
    buffer_load_dwordx4 v14, s[28:31], 0 offen offset:2688 lds
    s_add_u32 m0, s37, 0
    v_mfma_f32_16x16x32_bf16 v[44:47], a[196:199], v[148:151], v[44:47]
    ds_read_b64_tr_b16 a[236:237], v115 offset:59680
    v_add_u32 v14, 4294852736, v14
    v_mfma_f32_16x16x32_bf16 v[44:47], a[192:195], v[132:135], v[44:47]
    s_waitcnt lgkmcnt(7)
    ds_read_b64_tr_b16 a[238:239], v115 offset:59936
    buffer_store_dwordx4 v[68:71], v6, s[32:35], s10 offen sc1
    buffer_load_dwordx4 v[156:159], v6, s[32:35], s54 offen offset:3072 sc1
    s_add_u32 s54, s54, 4096
    v_mfma_f32_16x16x32_bf16 v[20:23], a[208:211], v[196:199], v[20:23]
    s_add_u32 s10, s10, 16384
    ds_read_b64_tr_b16 a[240:241], v115 offset:50752
    buffer_load_dwordx4 v[168:171], v6, s[32:35], s8 offen offset:0 sc1
    v_mfma_f32_16x16x32_bf16 v[20:23], a[212:215], v[212:215], v[20:23]
    ds_read_b64_tr_b16 a[242:243], v115 offset:51008
    v_bfe_u32 v86, v13, 2, 2
    v_mfma_f32_16x16x32_bf16 v[20:23], a[216:219], v[228:231], v[20:23]
    ds_read_b64_tr_b16 a[244:245], v115 offset:51264
    v_lshrrev_b32 v87, 4, v13
    v_mfma_f32_16x16x32_bf16 v[20:23], a[220:223], v[244:247], v[20:23]
    ds_read_b64_tr_b16 a[246:247], v115 offset:51520
    v_cmp_eq_u32 vcc, v86, v87
    v_mfma_f32_16x16x32_bf16 v[16:19], a[220:223], v[240:243], v[16:19]
    ds_read_b64_tr_b16 a[248:249], v115 offset:59200
    v_and_b32 v86, 1, v13
    v_mfma_f32_16x16x32_bf16 v[16:19], a[216:219], v[224:227], v[16:19]
    ds_read_b64_tr_b16 a[250:251], v115 offset:59456
    v_lshlrev_b32 v86, 4, v86
    v_mfma_f32_16x16x32_bf16 v[16:19], a[212:215], v[208:211], v[16:19]
    ds_read_b64_tr_b16 a[252:253], v115 offset:59712
    v_lshlrev_b32_e64 v86, v86, s47
    v_mfma_f32_16x16x32_bf16 v[16:19], a[208:211], v[192:195], v[16:19]
    s_waitcnt lgkmcnt(7)
    ds_read_b64_tr_b16 a[254:255], v115 offset:59968
    buffer_load_dwordx4 v[172:175], v6, s[32:35], s9 offen offset:0 sc1
    v_cndmask_b32 v86, 0, v86, vcc
    v_mfma_f32_16x16x32_bf16 v[24:27], a[224:227], v[192:195], v[24:27]
    ds_read_b64_tr_b16 a[192:193], v115 offset:50784
    v_and_b32 v87, 2, v13
    v_mfma_f32_16x16x32_bf16 v[24:27], a[228:231], v[208:211], v[24:27]
    ds_read_b64_tr_b16 a[194:195], v115 offset:51040
    v_cmp_eq_u32 vcc, 0, v87
    v_mfma_f32_16x16x32_bf16 v[24:27], a[232:235], v[224:227], v[24:27]
    ds_read_b64_tr_b16 a[196:197], v115 offset:51296
    v_mov_b32 v80, 0
    v_mfma_f32_16x16x32_bf16 v[24:27], a[236:239], v[240:243], v[24:27]
    ds_read_b64_tr_b16 a[198:199], v115 offset:51552
    buffer_load_dwordx4 v[184:187], v6, s[32:35], s11 offen offset:0 sc1
    v_mov_b32 v81, 0
    v_mov_b32 v84, 0
    v_mfma_f32_16x16x32_bf16 v[28:31], a[236:239], v[244:247], v[28:31]
    ds_read_b64_tr_b16 a[200:201], v115 offset:59232
    v_mov_b32 v85, 0
    v_mfma_f32_16x16x32_bf16 v[28:31], a[232:235], v[228:231], v[28:31]
    ds_read_b64_tr_b16 a[202:203], v115 offset:59488
    v_cndmask_b32 v82, 0, v86, vcc
    v_mfma_f32_16x16x32_bf16 v[28:31], a[228:231], v[212:215], v[28:31]
    ds_read_b64_tr_b16 a[204:205], v115 offset:59744
    ds_read_b64_tr_b16 a[206:207], v115 offset:60000
    buffer_load_dwordx4 v[188:191], v6, s[32:35], s54 offen offset:0 sc1
    v_mfma_f32_16x16x32_bf16 v[28:31], a[224:227], v[196:199], v[28:31]
    s_waitcnt vmcnt(32) lgkmcnt(8)
    s_barrier
    v_sub_u32 v83, v86, v82
    v_mfma_f32_16x16x32_bf16 v[36:39], a[240:243], v[196:199], v[36:39]
    ds_read_b64_tr_b16 a[208:209], v113 offset:0
    buffer_load_dwordx4 v[200:203], v6, s[32:35], s8 offen offset:1024 sc1
    v_mfma_f32_16x16x32_bf16 v[36:39], a[244:247], v[212:215], v[36:39]
    ds_read_b64_tr_b16 a[210:211], v113 offset:256
    v_accvgpr_read_b32 v97, a183
    v_mfma_f32_16x16x32_bf16 v[36:39], a[248:251], v[228:231], v[36:39]
    ds_read_b64_tr_b16 a[212:213], v113 offset:512
    v_add_u32 v98, 67584, v97
    v_mfma_f32_16x16x32_bf16 v[36:39], a[252:255], v[244:247], v[36:39]
    ds_read_b64_tr_b16 a[214:215], v113 offset:768
    v_add_u32 v99, 135168, v97
    v_mfma_f32_16x16x32_bf16 v[32:35], a[252:255], v[240:243], v[32:35]
    ds_read_b64_tr_b16 a[216:217], v113 offset:8448
    buffer_load_dwordx4 v[204:207], v6, s[32:35], s9 offen offset:1024 sc1
    v_mfma_f32_16x16x32_bf16 v[32:35], a[248:251], v[224:227], v[32:35]
    s_lshl_b32 s41, s36, 10
    ds_read_b64_tr_b16 a[218:219], v113 offset:8704
    v_mfma_f32_16x16x32_bf16 v[32:35], a[244:247], v[208:211], v[32:35]
    ds_read_b64_tr_b16 a[220:221], v113 offset:8960
    v_add_u32 v100, s41, v6
    v_mfma_f32_16x16x32_bf16 v[32:35], a[240:243], v[192:195], v[32:35]
    s_waitcnt lgkmcnt(7)
    ds_read_b64_tr_b16 a[222:223], v113 offset:9216
    v_add_u32 v101, s37, v6
    v_mfma_f32_16x16x32_bf16 v[40:43], a[192:195], v[192:195], v[40:43]
    ds_read_b64_tr_b16 a[224:225], v113 offset:32
    buffer_load_dwordx4 v[216:219], v6, s[32:35], s11 offen offset:1024 sc1
    v_mfma_f32_16x16x32_bf16 v[40:43], a[196:199], v[208:211], v[40:43]
    ds_read_b64_tr_b16 a[226:227], v113 offset:288
    v_add_u32 v102, 101376, v100
    v_mfma_f32_16x16x32_bf16 v[40:43], a[200:203], v[224:227], v[40:43]
    ds_read_b64_tr_b16 a[228:229], v113 offset:544
    v_add_u32 v103, 101376, v101
    v_mfma_f32_16x16x32_bf16 v[40:43], a[204:207], v[240:243], v[40:43]
    s_mov_b32 s20, s44
    s_mov_b32 s21, s45
    s_mov_b32 s22, 1835008
    ds_read_b64_tr_b16 a[230:231], v113 offset:800
    v_mfma_f32_16x16x32_bf16 v[44:47], a[204:207], v[244:247], v[44:47]
    ds_read_b64_tr_b16 a[232:233], v113 offset:8480
    buffer_load_dwordx4 v[220:223], v6, s[32:35], s54 offen offset:1024 sc1
    v_mfma_f32_16x16x32_bf16 v[44:47], a[200:203], v[228:231], v[44:47]
    s_mov_b32 s23, 0x20000
    ds_read_b64_tr_b16 a[234:235], v113 offset:8736
    v_mfma_f32_16x16x32_bf16 v[44:47], a[196:199], v[212:215], v[44:47]
    ds_read_b64_tr_b16 a[236:237], v113 offset:8992
    v_mfma_f32_16x16x32_bf16 v[44:47], a[192:195], v[196:199], v[44:47]
    s_waitcnt lgkmcnt(7)
    ds_read_b64_tr_b16 a[238:239], v113 offset:9248
    v_mfma_f32_16x16x32_bf16 v[52:55], a[208:211], v[132:135], 0
    ds_read_b64_tr_b16 a[240:241], v113 offset:64
    v_mfma_f32_16x16x32_bf16 v[52:55], a[212:215], v[148:151], v[52:55]
    ds_read_b64_tr_b16 a[242:243], v113 offset:320
    buffer_load_dwordx2 v[88:89], v9, s[4:7], 0 offen offset:0
    v_mfma_f32_16x16x32_bf16 v[52:55], a[216:219], v[164:167], v[52:55]
    ds_read_b64_tr_b16 a[244:245], v113 offset:576
    buffer_load_dwordx2 v[90:91], v9, s[4:7], 0 offen offset:32
    v_mfma_f32_16x16x32_bf16 v[52:55], a[220:223], v[180:183], v[52:55]
    ds_read_b64_tr_b16 a[246:247], v113 offset:832
    buffer_load_dwordx2 v[92:93], v9, s[4:7], 0 offen offset:64
    v_mfma_f32_16x16x32_bf16 v[48:51], a[220:223], v[176:179], 0
    ds_read_b64_tr_b16 a[248:249], v113 offset:8512
    v_cvt_pk_bf16_f32 v16, v16, v17
    v_mfma_f32_16x16x32_bf16 v[48:51], a[216:219], v[160:163], v[48:51]
    ds_read_b64_tr_b16 a[250:251], v113 offset:8768
    v_cvt_pk_bf16_f32 v17, v18, v19
    v_mfma_f32_16x16x32_bf16 v[48:51], a[212:215], v[144:147], v[48:51]
    ds_read_b64_tr_b16 a[252:253], v113 offset:9024
    v_cvt_pk_bf16_f32 v18, v24, v25
    v_mfma_f32_16x16x32_bf16 v[48:51], a[208:211], v[128:131], v[48:51]
    s_waitcnt lgkmcnt(7)
    ds_read_b64_tr_b16 a[254:255], v113 offset:9280
    v_cvt_pk_bf16_f32 v19, v26, v27
    v_mfma_f32_16x16x32_bf16 v[56:59], a[224:227], v[128:131], 0
    ds_read_b64_tr_b16 a[192:193], v113 offset:96
    buffer_store_dwordx4 v[16:19], v6, s[32:35], s50 offen sc1
    buffer_load_dwordx2 v[94:95], v9, s[4:7], 0 offen offset:96
    v_mfma_f32_16x16x32_bf16 v[56:59], a[228:231], v[144:147], v[56:59]
    s_add_u32 s50, s50, 16384
    ds_read_b64_tr_b16 a[194:195], v113 offset:352
    v_mfma_f32_16x16x32_bf16 v[56:59], a[232:235], v[160:163], v[56:59]
    ds_read_b64_tr_b16 a[196:197], v113 offset:608
    v_cvt_pk_bf16_f32 v20, v20, v21
    v_mfma_f32_16x16x32_bf16 v[56:59], a[236:239], v[176:179], v[56:59]
    ds_read_b64_tr_b16 a[198:199], v113 offset:864
    v_cvt_pk_bf16_f32 v21, v22, v23
    v_cvt_pk_bf16_f32 v22, v28, v29
    v_mfma_f32_16x16x32_bf16 v[60:63], a[236:239], v[180:183], 0
    ds_read_b64_tr_b16 a[200:201], v113 offset:8544
    v_cvt_pk_bf16_f32 v23, v30, v31
    v_mfma_f32_16x16x32_bf16 v[60:63], a[232:235], v[164:167], v[60:63]
    ds_read_b64_tr_b16 a[202:203], v113 offset:8800
    buffer_store_dwordx4 v[20:23], v6, s[32:35], s10 offen sc1
    v_mfma_f32_16x16x32_bf16 v[60:63], a[228:231], v[148:151], v[60:63]
    ds_read_b64_tr_b16 a[204:205], v113 offset:9056
    ds_read_b64_tr_b16 a[206:207], v113 offset:9312
    v_mfma_f32_16x16x32_bf16 v[60:63], a[224:227], v[132:135], v[60:63]
    s_waitcnt vmcnt(38) lgkmcnt(8)
    s_barrier
    s_add_u32 s10, s10, 16384
    v_cvt_pk_bf16_f32 v32, v32, v33
    v_mfma_f32_16x16x32_bf16 v[68:71], a[240:243], v[132:135], 0
    ds_read_b64_tr_b16 a[208:209], v113 offset:16896
    v_cvt_pk_bf16_f32 v33, v34, v35
    v_mfma_f32_16x16x32_bf16 v[68:71], a[244:247], v[148:151], v[68:71]
    ds_read_b64_tr_b16 a[210:211], v113 offset:17152
    v_cvt_pk_bf16_f32 v34, v40, v41
    v_mfma_f32_16x16x32_bf16 v[68:71], a[248:251], v[164:167], v[68:71]
    ds_read_b64_tr_b16 a[212:213], v113 offset:17408
    v_cvt_pk_bf16_f32 v35, v42, v43
    v_mfma_f32_16x16x32_bf16 v[68:71], a[252:255], v[180:183], v[68:71]
    ds_read_b64_tr_b16 a[214:215], v113 offset:17664
    buffer_store_dwordx4 v[32:35], v6, s[32:35], s50 offen sc1
    v_mfma_f32_16x16x32_bf16 v[64:67], a[252:255], v[176:179], 0
    s_add_u32 s50, s50, 16384
    ds_read_b64_tr_b16 a[216:217], v113 offset:25344
    v_mfma_f32_16x16x32_bf16 v[64:67], a[248:251], v[160:163], v[64:67]
    ds_read_b64_tr_b16 a[218:219], v113 offset:25600
    v_cvt_pk_bf16_f32 v36, v36, v37
    v_mfma_f32_16x16x32_bf16 v[64:67], a[244:247], v[144:147], v[64:67]
    ds_read_b64_tr_b16 a[220:221], v113 offset:25856
    v_cvt_pk_bf16_f32 v37, v38, v39
    v_mfma_f32_16x16x32_bf16 v[64:67], a[240:243], v[128:131], v[64:67]
    s_waitcnt lgkmcnt(7)
    ds_read_b64_tr_b16 a[222:223], v113 offset:26112
    v_cvt_pk_bf16_f32 v38, v44, v45
    v_mfma_f32_16x16x32_bf16 v[72:75], a[192:195], v[128:131], 0
    ds_read_b64_tr_b16 a[224:225], v113 offset:16928
    v_cvt_pk_bf16_f32 v39, v46, v47
    v_mfma_f32_16x16x32_bf16 v[72:75], a[196:199], v[144:147], v[72:75]
    ds_read_b64_tr_b16 a[226:227], v113 offset:17184
    buffer_store_dwordx4 v[36:39], v6, s[32:35], s10 offen sc1
    v_mfma_f32_16x16x32_bf16 v[72:75], a[200:203], v[160:163], v[72:75]
    s_add_u32 s10, s10, 16384
    ds_read_b64_tr_b16 a[228:229], v113 offset:17440
    v_mfma_f32_16x16x32_bf16 v[72:75], a[204:207], v[176:179], v[72:75]
    ds_read_b64_tr_b16 a[230:231], v113 offset:17696
    v_mfma_f32_16x16x32_bf16 v[76:79], a[204:207], v[180:183], 0
    ds_read_b64_tr_b16 a[232:233], v113 offset:25376
    v_mfma_f32_16x16x32_bf16 v[76:79], a[200:203], v[164:167], v[76:79]
    ds_read_b64_tr_b16 a[234:235], v113 offset:25632
    v_mfma_f32_16x16x32_bf16 v[76:79], a[196:199], v[148:151], v[76:79]
    ds_read_b64_tr_b16 a[236:237], v113 offset:25888
    v_mfma_f32_16x16x32_bf16 v[76:79], a[192:195], v[132:135], v[76:79]
    s_waitcnt lgkmcnt(7)
    ds_read_b64_tr_b16 a[238:239], v113 offset:26144
    v_mfma_f32_16x16x32_bf16 v[52:55], a[208:211], v[196:199], v[52:55]
    ds_read_b64_tr_b16 a[240:241], v113 offset:16960
    v_mfma_f32_16x16x32_bf16 v[52:55], a[212:215], v[212:215], v[52:55]
    ds_read_b64_tr_b16 a[242:243], v113 offset:17216
    v_mfma_f32_16x16x32_bf16 v[52:55], a[216:219], v[228:231], v[52:55]
    ds_read_b64_tr_b16 a[244:245], v113 offset:17472
    v_mfma_f32_16x16x32_bf16 v[52:55], a[220:223], v[244:247], v[52:55]
    ds_read_b64_tr_b16 a[246:247], v113 offset:17728
    v_mfma_f32_16x16x32_bf16 v[48:51], a[220:223], v[240:243], v[48:51]
    ds_read_b64_tr_b16 a[248:249], v113 offset:25408
    v_mfma_f32_16x16x32_bf16 v[48:51], a[216:219], v[224:227], v[48:51]
    ds_read_b64_tr_b16 a[250:251], v113 offset:25664
    v_mfma_f32_16x16x32_bf16 v[48:51], a[212:215], v[208:211], v[48:51]
    ds_read_b64_tr_b16 a[252:253], v113 offset:25920
    v_mov_b32 v5, 2
    v_mfma_f32_16x16x32_bf16 v[48:51], a[208:211], v[192:195], v[48:51]
    s_waitcnt lgkmcnt(7)
    ds_read_b64_tr_b16 a[254:255], v113 offset:26176
    v_mfma_f32_16x16x32_bf16 v[56:59], a[224:227], v[192:195], v[56:59]
    ds_read_b64_tr_b16 a[192:193], v113 offset:16992
    v_mfma_f32_16x16x32_bf16 v[56:59], a[228:231], v[208:211], v[56:59]
    ds_read_b64_tr_b16 a[194:195], v113 offset:17248
    v_mfma_f32_16x16x32_bf16 v[56:59], a[232:235], v[224:227], v[56:59]
    ds_read_b64_tr_b16 a[196:197], v113 offset:17504
    v_mfma_f32_16x16x32_bf16 v[56:59], a[236:239], v[240:243], v[56:59]
    ds_read_b64_tr_b16 a[198:199], v113 offset:17760
    v_mfma_f32_16x16x32_bf16 v[60:63], a[236:239], v[244:247], v[60:63]
    ds_read_b64_tr_b16 a[200:201], v113 offset:25440
    v_mfma_f32_16x16x32_bf16 v[60:63], a[232:235], v[228:231], v[60:63]
    ds_read_b64_tr_b16 a[202:203], v113 offset:25696
    v_mfma_f32_16x16x32_bf16 v[60:63], a[228:231], v[212:215], v[60:63]
    ds_read_b64_tr_b16 a[204:205], v113 offset:25952
    ds_read_b64_tr_b16 a[206:207], v113 offset:26208
    v_mfma_f32_16x16x32_bf16 v[60:63], a[224:227], v[196:199], v[60:63]
    s_waitcnt vmcnt(17) lgkmcnt(8)
    s_barrier
    v_mfma_f32_16x16x32_bf16 v[68:71], a[240:243], v[196:199], v[68:71]
    ds_read_b64_tr_b16 a[208:209], v113 offset:33792
    ds_read_b64_tr_b16 a[210:211], v113 offset:34048
    buffer_store_dword v5, v8, s[32:35], 0 offen sc1
    v_mfma_f32_16x16x32_bf16 v[68:71], a[244:247], v[212:215], v[68:71]
    buffer_load_dwordx4 v14, s[28:31], 0 offen offset:0 lds
    s_add_u32 m0, s37, 160
    v_mfma_f32_16x16x32_bf16 v[68:71], a[248:251], v[228:231], v[68:71]
    ds_read_b64_tr_b16 a[212:213], v113 offset:34304
    v_mfma_f32_16x16x32_bf16 v[68:71], a[252:255], v[244:247], v[68:71]
    ds_read_b64_tr_b16 a[214:215], v113 offset:34560
    v_mfma_f32_16x16x32_bf16 v[64:67], a[252:255], v[240:243], v[64:67]
    ds_read_b64_tr_b16 a[216:217], v113 offset:42240
    ds_read_b64_tr_b16 a[218:219], v113 offset:42496
    v_mfma_f32_16x16x32_bf16 v[64:67], a[248:251], v[224:227], v[64:67]
    buffer_load_dwordx4 v14, s[28:31], 0 offen offset:896 lds
    s_add_u32 m0, s37, 320
    v_mfma_f32_16x16x32_bf16 v[64:67], a[244:247], v[208:211], v[64:67]
    ds_read_b64_tr_b16 a[220:221], v113 offset:42752
    v_mfma_f32_16x16x32_bf16 v[64:67], a[240:243], v[192:195], v[64:67]
    s_waitcnt lgkmcnt(7)
    ds_read_b64_tr_b16 a[222:223], v113 offset:43008
    v_mfma_f32_16x16x32_bf16 v[72:75], a[192:195], v[192:195], v[72:75]
    ds_read_b64_tr_b16 a[224:225], v113 offset:33824
    ds_read_b64_tr_b16 a[226:227], v113 offset:34080
    v_mfma_f32_16x16x32_bf16 v[72:75], a[196:199], v[208:211], v[72:75]
    buffer_load_dwordx4 v14, s[28:31], 0 offen offset:1792 lds
    s_add_u32 m0, s37, 480
    v_mfma_f32_16x16x32_bf16 v[72:75], a[200:203], v[224:227], v[72:75]
    ds_read_b64_tr_b16 a[228:229], v113 offset:34336
    v_mfma_f32_16x16x32_bf16 v[72:75], a[204:207], v[240:243], v[72:75]
    ds_read_b64_tr_b16 a[230:231], v113 offset:34592
    v_mfma_f32_16x16x32_bf16 v[76:79], a[204:207], v[244:247], v[76:79]
    ds_read_b64_tr_b16 a[232:233], v113 offset:42272
    ds_read_b64_tr_b16 a[234:235], v113 offset:42528
    v_mfma_f32_16x16x32_bf16 v[76:79], a[200:203], v[228:231], v[76:79]
    buffer_load_dwordx4 v14, s[28:31], 0 offen offset:2688 lds
    s_add_u32 m0, s37, 16896
    v_mfma_f32_16x16x32_bf16 v[76:79], a[196:199], v[212:215], v[76:79]
    ds_read_b64_tr_b16 a[236:237], v113 offset:42784
    v_add_u32 v14, 114688, v14
    v_mfma_f32_16x16x32_bf16 v[76:79], a[192:195], v[196:199], v[76:79]
    s_waitcnt lgkmcnt(7)
    ds_read_b64_tr_b16 a[238:239], v113 offset:43040
    v_mfma_f32_16x16x32_bf16 v[20:23], a[208:211], v[132:135], 0
    ds_read_b64_tr_b16 a[240:241], v113 offset:33856
    v_mfma_f32_16x16x32_bf16 v[20:23], a[212:215], v[148:151], v[20:23]
    ds_read_b64_tr_b16 a[242:243], v113 offset:34112
    v_mfma_f32_16x16x32_bf16 v[20:23], a[216:219], v[164:167], v[20:23]
    ds_read_b64_tr_b16 a[244:245], v113 offset:34368
    v_mfma_f32_16x16x32_bf16 v[20:23], a[220:223], v[180:183], v[20:23]
    ds_read_b64_tr_b16 a[246:247], v113 offset:34624
    v_mfma_f32_16x16x32_bf16 v[16:19], a[220:223], v[176:179], 0
    ds_read_b64_tr_b16 a[248:249], v113 offset:42304
    v_cvt_pk_bf16_f32 v48, v48, v49
    v_mfma_f32_16x16x32_bf16 v[16:19], a[216:219], v[160:163], v[16:19]
    ds_read_b64_tr_b16 a[250:251], v113 offset:42560
    v_cvt_pk_bf16_f32 v49, v50, v51
    v_mfma_f32_16x16x32_bf16 v[16:19], a[212:215], v[144:147], v[16:19]
    ds_read_b64_tr_b16 a[252:253], v113 offset:42816
    v_cvt_pk_bf16_f32 v50, v56, v57
    v_mfma_f32_16x16x32_bf16 v[16:19], a[208:211], v[128:131], v[16:19]
    s_waitcnt lgkmcnt(7)
    ds_read_b64_tr_b16 a[254:255], v113 offset:43072
    v_cvt_pk_bf16_f32 v51, v58, v59
    v_mfma_f32_16x16x32_bf16 v[24:27], a[224:227], v[128:131], 0
    ds_read_b64_tr_b16 a[192:193], v113 offset:33888
    buffer_store_dwordx4 v[48:51], v6, s[32:35], s50 offen sc1
    v_mfma_f32_16x16x32_bf16 v[24:27], a[228:231], v[144:147], v[24:27]
    s_add_u32 s50, s50, 16384
    ds_read_b64_tr_b16 a[194:195], v113 offset:34144
    v_mfma_f32_16x16x32_bf16 v[24:27], a[232:235], v[160:163], v[24:27]
    ds_read_b64_tr_b16 a[196:197], v113 offset:34400
    v_cvt_pk_bf16_f32 v52, v52, v53
    v_mfma_f32_16x16x32_bf16 v[24:27], a[236:239], v[176:179], v[24:27]
    ds_read_b64_tr_b16 a[198:199], v113 offset:34656
    v_cvt_pk_bf16_f32 v53, v54, v55
    v_cvt_pk_bf16_f32 v54, v60, v61
    v_mfma_f32_16x16x32_bf16 v[28:31], a[236:239], v[180:183], 0
    ds_read_b64_tr_b16 a[200:201], v113 offset:42336
    v_cvt_pk_bf16_f32 v55, v62, v63
    v_mfma_f32_16x16x32_bf16 v[28:31], a[232:235], v[164:167], v[28:31]
    ds_read_b64_tr_b16 a[202:203], v113 offset:42592
    buffer_store_dwordx4 v[52:55], v6, s[32:35], s10 offen sc1
    v_mfma_f32_16x16x32_bf16 v[28:31], a[228:231], v[148:151], v[28:31]
    ds_read_b64_tr_b16 a[204:205], v113 offset:42848
    ds_read_b64_tr_b16 a[206:207], v113 offset:43104
    v_mfma_f32_16x16x32_bf16 v[28:31], a[224:227], v[132:135], v[28:31]
    s_waitcnt vmcnt(63) lgkmcnt(8)
    s_barrier
    s_add_u32 s10, s10, 16384
    v_cvt_pk_bf16_f32 v64, v64, v65
    v_mfma_f32_16x16x32_bf16 v[36:39], a[240:243], v[132:135], 0
    ds_read_b64_tr_b16 a[208:209], v113 offset:50688
    ds_read_b64_tr_b16 a[210:211], v113 offset:50944
    v_mfma_f32_16x16x32_bf16 v[36:39], a[244:247], v[148:151], v[36:39]
    buffer_load_dwordx4 v14, s[28:31], 0 offen offset:0 lds
    s_add_u32 m0, s37, 17056
    v_mfma_f32_16x16x32_bf16 v[36:39], a[248:251], v[164:167], v[36:39]
    ds_read_b64_tr_b16 a[212:213], v113 offset:51200
    v_cvt_pk_bf16_f32 v65, v66, v67
    v_mfma_f32_16x16x32_bf16 v[36:39], a[252:255], v[180:183], v[36:39]
    ds_read_b64_tr_b16 a[214:215], v113 offset:51456
    v_cvt_pk_bf16_f32 v66, v72, v73
    v_cvt_pk_bf16_f32 v67, v74, v75
    v_mfma_f32_16x16x32_bf16 v[32:35], a[252:255], v[176:179], 0
    ds_read_b64_tr_b16 a[216:217], v113 offset:59136
    ds_read_b64_tr_b16 a[218:219], v113 offset:59392
    v_mfma_f32_16x16x32_bf16 v[32:35], a[248:251], v[160:163], v[32:35]
    buffer_load_dwordx4 v14, s[28:31], 0 offen offset:896 lds
    s_add_u32 m0, s37, 17216
    v_mfma_f32_16x16x32_bf16 v[32:35], a[244:247], v[144:147], v[32:35]
    ds_read_b64_tr_b16 a[220:221], v113 offset:59648
    buffer_store_dwordx4 v[64:67], v6, s[32:35], s50 offen sc1
    v_mfma_f32_16x16x32_bf16 v[32:35], a[240:243], v[128:131], v[32:35]
    s_waitcnt lgkmcnt(7)
    s_add_u32 s50, s50, 16384
    ds_read_b64_tr_b16 a[222:223], v113 offset:59904
    v_cvt_pk_bf16_f32 v68, v68, v69
    v_mfma_f32_16x16x32_bf16 v[40:43], a[192:195], v[128:131], 0
    ds_read_b64_tr_b16 a[224:225], v113 offset:50720
    ds_read_b64_tr_b16 a[226:227], v113 offset:50976
    v_mfma_f32_16x16x32_bf16 v[40:43], a[196:199], v[144:147], v[40:43]
    buffer_load_dwordx4 v14, s[28:31], 0 offen offset:1792 lds
    s_add_u32 m0, s37, 17376
    v_mfma_f32_16x16x32_bf16 v[40:43], a[200:203], v[160:163], v[40:43]
    ds_read_b64_tr_b16 a[228:229], v113 offset:51232
    v_cvt_pk_bf16_f32 v69, v70, v71
    v_mfma_f32_16x16x32_bf16 v[40:43], a[204:207], v[176:179], v[40:43]
    ds_read_b64_tr_b16 a[230:231], v113 offset:51488
    v_cvt_pk_bf16_f32 v70, v76, v77
    v_cvt_pk_bf16_f32 v71, v78, v79
    v_mfma_f32_16x16x32_bf16 v[44:47], a[204:207], v[180:183], 0
    ds_read_b64_tr_b16 a[232:233], v113 offset:59168
    ds_read_b64_tr_b16 a[234:235], v113 offset:59424
    v_mfma_f32_16x16x32_bf16 v[44:47], a[200:203], v[164:167], v[44:47]
    buffer_load_dwordx4 v14, s[28:31], 0 offen offset:2688 lds
    s_add_u32 m0, s37, 101376
    v_mfma_f32_16x16x32_bf16 v[44:47], a[196:199], v[148:151], v[44:47]
    ds_read_b64_tr_b16 a[236:237], v113 offset:59680
    v_add_u32 v14, 4294852736, v14
    v_mfma_f32_16x16x32_bf16 v[44:47], a[192:195], v[132:135], v[44:47]
    s_waitcnt lgkmcnt(7)
    ds_read_b64_tr_b16 a[238:239], v113 offset:59936
    buffer_store_dwordx4 v[68:71], v6, s[32:35], s10 offen sc1
    v_mfma_f32_16x16x32_bf16 v[20:23], a[208:211], v[196:199], v[20:23]
    ds_read_b64_tr_b16 a[240:241], v113 offset:50752
    ds_read_b64_tr_b16 a[242:243], v113 offset:51008
    v_mfma_f32_16x16x32_bf16 v[20:23], a[212:215], v[212:215], v[20:23]
    buffer_load_dwordx4 v14, s[28:31], 0 offen offset:0 lds
    s_add_u32 m0, s37, 101536
    v_mfma_f32_16x16x32_bf16 v[20:23], a[216:219], v[228:231], v[20:23]
    s_add_u32 s10, s10, 16384
    ds_read_b64_tr_b16 a[244:245], v113 offset:51264
    v_mfma_f32_16x16x32_bf16 v[20:23], a[220:223], v[244:247], v[20:23]
    ds_read_b64_tr_b16 a[246:247], v113 offset:51520
    v_mfma_f32_16x16x32_bf16 v[16:19], a[220:223], v[240:243], v[16:19]
    ds_read_b64_tr_b16 a[248:249], v113 offset:59200
    ds_read_b64_tr_b16 a[250:251], v113 offset:59456
    v_mfma_f32_16x16x32_bf16 v[16:19], a[216:219], v[224:227], v[16:19]
    buffer_load_dwordx4 v14, s[28:31], 0 offen offset:896 lds
    s_add_u32 m0, s37, 101696
    v_mfma_f32_16x16x32_bf16 v[16:19], a[212:215], v[208:211], v[16:19]
    ds_read_b64_tr_b16 a[252:253], v113 offset:59712
    v_mov_b32 v5, 3
    v_mfma_f32_16x16x32_bf16 v[16:19], a[208:211], v[192:195], v[16:19]
    s_waitcnt lgkmcnt(7)
    ds_read_b64_tr_b16 a[254:255], v113 offset:59968
    v_mfma_f32_16x16x32_bf16 v[24:27], a[224:227], v[192:195], v[24:27]
    ds_read_b64_tr_b16 a[192:193], v113 offset:50784
    ds_read_b64_tr_b16 a[194:195], v113 offset:51040
    v_mfma_f32_16x16x32_bf16 v[24:27], a[228:231], v[208:211], v[24:27]
    buffer_load_dwordx4 v14, s[28:31], 0 offen offset:1792 lds
    s_add_u32 m0, s37, 101856
    v_mfma_f32_16x16x32_bf16 v[24:27], a[232:235], v[224:227], v[24:27]
    ds_read_b64_tr_b16 a[196:197], v113 offset:51296
    v_mfma_f32_16x16x32_bf16 v[24:27], a[236:239], v[240:243], v[24:27]
    ds_read_b64_tr_b16 a[198:199], v113 offset:51552
    v_mfma_f32_16x16x32_bf16 v[28:31], a[236:239], v[244:247], v[28:31]
    ds_read_b64_tr_b16 a[200:201], v113 offset:59232
    ds_read_b64_tr_b16 a[202:203], v113 offset:59488
    v_mfma_f32_16x16x32_bf16 v[28:31], a[232:235], v[228:231], v[28:31]
    buffer_load_dwordx4 v14, s[28:31], 0 offen offset:2688 lds
    s_add_u32 m0, s37, 118272
    v_mfma_f32_16x16x32_bf16 v[28:31], a[228:231], v[212:215], v[28:31]
    ds_read_b64_tr_b16 a[204:205], v113 offset:59744
    ds_read_b64_tr_b16 a[206:207], v113 offset:60000
    v_mfma_f32_16x16x32_bf16 v[28:31], a[224:227], v[196:199], v[28:31]
    s_waitcnt vmcnt(17) lgkmcnt(8)
    s_barrier
    v_add_u32 v14, 114688, v14
    v_mfma_f32_16x16x32_bf16 v[36:39], a[240:243], v[196:199], v[36:39]
    ds_read_b64_tr_b16 a[208:209], v115 offset:0
    ds_read_b64_tr_b16 a[210:211], v115 offset:256
    buffer_store_dword v5, v8, s[32:35], 0 offen sc1
    v_mfma_f32_16x16x32_bf16 v[36:39], a[244:247], v[212:215], v[36:39]
    buffer_load_dwordx4 v14, s[28:31], 0 offen offset:0 lds
    s_add_u32 m0, s37, 118432
    v_mfma_f32_16x16x32_bf16 v[36:39], a[248:251], v[228:231], v[36:39]
    ds_read_b64_tr_b16 a[212:213], v115 offset:512
    v_mfma_f32_16x16x32_bf16 v[36:39], a[252:255], v[244:247], v[36:39]
    ds_read_b64_tr_b16 a[214:215], v115 offset:768
    v_mfma_f32_16x16x32_bf16 v[32:35], a[252:255], v[240:243], v[32:35]
    ds_read_b64_tr_b16 a[216:217], v115 offset:8448
    ds_read_b64_tr_b16 a[218:219], v115 offset:8704
    v_mfma_f32_16x16x32_bf16 v[32:35], a[248:251], v[224:227], v[32:35]
    buffer_load_dwordx4 v14, s[28:31], 0 offen offset:896 lds
    s_add_u32 m0, s37, 118592
    v_mfma_f32_16x16x32_bf16 v[32:35], a[244:247], v[208:211], v[32:35]
    ds_read_b64_tr_b16 a[220:221], v115 offset:8960
    v_mfma_f32_16x16x32_bf16 v[32:35], a[240:243], v[192:195], v[32:35]
    s_waitcnt lgkmcnt(7)
    ds_read_b64_tr_b16 a[222:223], v115 offset:9216
    v_mfma_f32_16x16x32_bf16 v[40:43], a[192:195], v[192:195], v[40:43]
    ds_read_b64_tr_b16 a[224:225], v115 offset:32
    ds_read_b64_tr_b16 a[226:227], v115 offset:288
    v_mfma_f32_16x16x32_bf16 v[40:43], a[196:199], v[208:211], v[40:43]
    buffer_load_dwordx4 v14, s[28:31], 0 offen offset:1792 lds
    s_add_u32 m0, s37, 118752
    v_mfma_f32_16x16x32_bf16 v[40:43], a[200:203], v[224:227], v[40:43]
    ds_read_b64_tr_b16 a[228:229], v115 offset:544
    v_mfma_f32_16x16x32_bf16 v[40:43], a[204:207], v[240:243], v[40:43]
    ds_read_b64_tr_b16 a[230:231], v115 offset:800
    v_mfma_f32_16x16x32_bf16 v[44:47], a[204:207], v[244:247], v[44:47]
    ds_read_b64_tr_b16 a[232:233], v115 offset:8480
    ds_read_b64_tr_b16 a[234:235], v115 offset:8736
    v_mfma_f32_16x16x32_bf16 v[44:47], a[200:203], v[228:231], v[44:47]
    buffer_load_dwordx4 v14, s[28:31], 0 offen offset:2688 lds
    s_add_u32 m0, s37, 135168
    v_mfma_f32_16x16x32_bf16 v[44:47], a[196:199], v[212:215], v[44:47]
    ds_read_b64_tr_b16 a[236:237], v115 offset:8992
    v_mfma_f32_16x16x32_bf16 v[44:47], a[192:195], v[196:199], v[44:47]
    s_waitcnt lgkmcnt(7)
    ds_read_b64_tr_b16 a[238:239], v115 offset:9248
    v_mfma_f32_16x16x32_bf16 v[52:55], a[208:211], v[132:135], 0
    ds_read_b64_tr_b16 a[240:241], v115 offset:64
    ds_read_b64_tr_b16 a[242:243], v115 offset:320
    v_mfma_f32_16x16x32_bf16 v[52:55], a[212:215], v[148:151], v[52:55]
    buffer_load_dwordx4 v3, s[16:19], s58 offen offset:0 lds
    s_add_u32 m0, s37, 135328
    v_mfma_f32_16x16x32_bf16 v[52:55], a[216:219], v[164:167], v[52:55]
    ds_read_b64_tr_b16 a[244:245], v115 offset:576
    v_mfma_f32_16x16x32_bf16 v[52:55], a[220:223], v[180:183], v[52:55]
    ds_read_b64_tr_b16 a[246:247], v115 offset:832
    v_mfma_f32_16x16x32_bf16 v[48:51], a[220:223], v[176:179], 0
    ds_read_b64_tr_b16 a[248:249], v115 offset:8512
    ds_read_b64_tr_b16 a[250:251], v115 offset:8768
    v_mfma_f32_16x16x32_bf16 v[48:51], a[216:219], v[160:163], v[48:51]
    buffer_load_dwordx4 v3, s[16:19], s58 offen offset:896 lds
    s_add_u32 m0, s37, 135488
    v_mfma_f32_16x16x32_bf16 v[48:51], a[212:215], v[144:147], v[48:51]
    ds_read_b64_tr_b16 a[252:253], v115 offset:9024
    v_cvt_pk_bf16_f32 v16, v16, v17
    v_mfma_f32_16x16x32_bf16 v[48:51], a[208:211], v[128:131], v[48:51]
    s_waitcnt lgkmcnt(7)
    ds_read_b64_tr_b16 a[254:255], v115 offset:9280
    v_cvt_pk_bf16_f32 v17, v18, v19
    v_mfma_f32_16x16x32_bf16 v[56:59], a[224:227], v[128:131], 0
    ds_read_b64_tr_b16 a[192:193], v115 offset:96
    ds_read_b64_tr_b16 a[194:195], v115 offset:352
    v_mfma_f32_16x16x32_bf16 v[56:59], a[228:231], v[144:147], v[56:59]
    buffer_load_dwordx4 v3, s[16:19], s58 offen offset:1792 lds
    s_add_u32 m0, s37, 135648
    v_mfma_f32_16x16x32_bf16 v[56:59], a[232:235], v[160:163], v[56:59]
    ds_read_b64_tr_b16 a[196:197], v115 offset:608
    v_cvt_pk_bf16_f32 v18, v24, v25
    v_mfma_f32_16x16x32_bf16 v[56:59], a[236:239], v[176:179], v[56:59]
    ds_read_b64_tr_b16 a[198:199], v115 offset:864
    v_cvt_pk_bf16_f32 v19, v26, v27
    v_mfma_f32_16x16x32_bf16 v[60:63], a[236:239], v[180:183], 0
    ds_read_b64_tr_b16 a[200:201], v115 offset:8544
    ds_read_b64_tr_b16 a[202:203], v115 offset:8800
    v_mfma_f32_16x16x32_bf16 v[60:63], a[232:235], v[164:167], v[60:63]
    buffer_load_dwordx4 v3, s[16:19], s58 offen offset:2688 lds
    s_add_u32 m0, s37, 33792
    v_mfma_f32_16x16x32_bf16 v[60:63], a[228:231], v[148:151], v[60:63]
    ds_read_b64_tr_b16 a[204:205], v115 offset:9056
    ds_read_b64_tr_b16 a[206:207], v115 offset:9312
    v_mfma_f32_16x16x32_bf16 v[60:63], a[224:227], v[132:135], v[60:63]
    s_waitcnt vmcnt(63) lgkmcnt(8)
    s_barrier
    s_add_u32 s58, s58, 28672
    buffer_store_dwordx4 v[16:19], v6, s[32:35], s50 offen sc1
    v_mfma_f32_16x16x32_bf16 v[68:71], a[240:243], v[132:135], 0
    ds_read_b64_tr_b16 a[208:209], v115 offset:16896
    ds_read_b64_tr_b16 a[210:211], v115 offset:17152
    v_mfma_f32_16x16x32_bf16 v[68:71], a[244:247], v[148:151], v[68:71]
    buffer_load_dwordx4 v3, s[16:19], s58 offen offset:0 lds
    s_add_u32 m0, s37, 33952
    v_mfma_f32_16x16x32_bf16 v[68:71], a[248:251], v[164:167], v[68:71]
    s_add_u32 s50, s50, 16384
    ds_read_b64_tr_b16 a[212:213], v115 offset:17408
    v_mfma_f32_16x16x32_bf16 v[68:71], a[252:255], v[180:183], v[68:71]
    ds_read_b64_tr_b16 a[214:215], v115 offset:17664
    v_cvt_pk_bf16_f32 v20, v20, v21
    v_cvt_pk_bf16_f32 v21, v22, v23
    v_mfma_f32_16x16x32_bf16 v[64:67], a[252:255], v[176:179], 0
    ds_read_b64_tr_b16 a[216:217], v115 offset:25344
    ds_read_b64_tr_b16 a[218:219], v115 offset:25600
    v_mfma_f32_16x16x32_bf16 v[64:67], a[248:251], v[160:163], v[64:67]
    buffer_load_dwordx4 v3, s[16:19], s58 offen offset:896 lds
    s_add_u32 m0, s37, 34112
    v_mfma_f32_16x16x32_bf16 v[64:67], a[244:247], v[144:147], v[64:67]
    ds_read_b64_tr_b16 a[220:221], v115 offset:25856
    v_cvt_pk_bf16_f32 v22, v28, v29
    v_mfma_f32_16x16x32_bf16 v[64:67], a[240:243], v[128:131], v[64:67]
    s_waitcnt lgkmcnt(7)
    ds_read_b64_tr_b16 a[222:223], v115 offset:26112
    v_cvt_pk_bf16_f32 v23, v30, v31
    v_mfma_f32_16x16x32_bf16 v[72:75], a[192:195], v[128:131], 0
    ds_read_b64_tr_b16 a[224:225], v115 offset:16928
    ds_read_b64_tr_b16 a[226:227], v115 offset:17184
    v_mfma_f32_16x16x32_bf16 v[72:75], a[196:199], v[144:147], v[72:75]
    buffer_load_dwordx4 v3, s[16:19], s58 offen offset:1792 lds
    s_add_u32 m0, s37, 34272
    v_mfma_f32_16x16x32_bf16 v[72:75], a[200:203], v[160:163], v[72:75]
    ds_read_b64_tr_b16 a[228:229], v115 offset:17440
    buffer_store_dwordx4 v[20:23], v6, s[32:35], s10 offen sc1
    v_mfma_f32_16x16x32_bf16 v[72:75], a[204:207], v[176:179], v[72:75]
    s_add_u32 s10, s10, 16384
    ds_read_b64_tr_b16 a[230:231], v115 offset:17696
    v_cvt_pk_bf16_f32 v32, v32, v33
    v_mfma_f32_16x16x32_bf16 v[76:79], a[204:207], v[180:183], 0
    ds_read_b64_tr_b16 a[232:233], v115 offset:25376
    ds_read_b64_tr_b16 a[234:235], v115 offset:25632
    v_mfma_f32_16x16x32_bf16 v[76:79], a[200:203], v[164:167], v[76:79]
    buffer_load_dwordx4 v3, s[16:19], s58 offen offset:2688 lds
    s_add_u32 m0, s37, 50688
    v_mfma_f32_16x16x32_bf16 v[76:79], a[196:199], v[148:151], v[76:79]
    s_add_u32 s58, s58, 28672
    ds_read_b64_tr_b16 a[236:237], v115 offset:25888
    v_mfma_f32_16x16x32_bf16 v[76:79], a[192:195], v[132:135], v[76:79]
    s_waitcnt lgkmcnt(7)
    ds_read_b64_tr_b16 a[238:239], v115 offset:26144
    v_cvt_pk_bf16_f32 v33, v34, v35
    v_mfma_f32_16x16x32_bf16 v[52:55], a[208:211], v[196:199], v[52:55]
    ds_read_b64_tr_b16 a[240:241], v115 offset:16960
    ds_read_b64_tr_b16 a[242:243], v115 offset:17216
    v_mfma_f32_16x16x32_bf16 v[52:55], a[212:215], v[212:215], v[52:55]
    buffer_load_dwordx4 v3, s[16:19], s58 offen offset:0 lds
    s_add_u32 m0, s37, 50848
    v_mfma_f32_16x16x32_bf16 v[52:55], a[216:219], v[228:231], v[52:55]
    ds_read_b64_tr_b16 a[244:245], v115 offset:17472
    v_cvt_pk_bf16_f32 v34, v40, v41
    v_mfma_f32_16x16x32_bf16 v[52:55], a[220:223], v[244:247], v[52:55]
    ds_read_b64_tr_b16 a[246:247], v115 offset:17728
    v_cvt_pk_bf16_f32 v35, v42, v43
    v_mfma_f32_16x16x32_bf16 v[48:51], a[220:223], v[240:243], v[48:51]
    ds_read_b64_tr_b16 a[248:249], v115 offset:25408
    ds_read_b64_tr_b16 a[250:251], v115 offset:25664
    v_mfma_f32_16x16x32_bf16 v[48:51], a[216:219], v[224:227], v[48:51]
    buffer_load_dwordx4 v3, s[16:19], s58 offen offset:896 lds
    s_add_u32 m0, s37, 51008
    v_mfma_f32_16x16x32_bf16 v[48:51], a[212:215], v[208:211], v[48:51]
    ds_read_b64_tr_b16 a[252:253], v115 offset:25920
    buffer_store_dwordx4 v[32:35], v6, s[32:35], s50 offen sc1
    v_mfma_f32_16x16x32_bf16 v[48:51], a[208:211], v[192:195], v[48:51]
    s_waitcnt lgkmcnt(7)
    s_add_u32 s50, s50, 16384
    ds_read_b64_tr_b16 a[254:255], v115 offset:26176
    v_cvt_pk_bf16_f32 v36, v36, v37
    v_mfma_f32_16x16x32_bf16 v[56:59], a[224:227], v[192:195], v[56:59]
    ds_read_b64_tr_b16 a[192:193], v115 offset:16992
    ds_read_b64_tr_b16 a[194:195], v115 offset:17248
    v_mfma_f32_16x16x32_bf16 v[56:59], a[228:231], v[208:211], v[56:59]
    buffer_load_dwordx4 v3, s[16:19], s58 offen offset:1792 lds
    s_add_u32 m0, s37, 51168
    v_mfma_f32_16x16x32_bf16 v[56:59], a[232:235], v[224:227], v[56:59]
    ds_read_b64_tr_b16 a[196:197], v115 offset:17504
    v_cvt_pk_bf16_f32 v37, v38, v39
    v_mfma_f32_16x16x32_bf16 v[56:59], a[236:239], v[240:243], v[56:59]
    ds_read_b64_tr_b16 a[198:199], v115 offset:17760
    v_cvt_pk_bf16_f32 v38, v44, v45
    v_cvt_pk_bf16_f32 v39, v46, v47
    v_mov_b32 v5, 4
    v_mfma_f32_16x16x32_bf16 v[60:63], a[236:239], v[244:247], v[60:63]
    ds_read_b64_tr_b16 a[200:201], v115 offset:25440
    ds_read_b64_tr_b16 a[202:203], v115 offset:25696
    v_mfma_f32_16x16x32_bf16 v[60:63], a[232:235], v[228:231], v[60:63]
    buffer_load_dwordx4 v3, s[16:19], s58 offen offset:2688 lds
    s_add_u32 m0, s37, 67584
    v_mfma_f32_16x16x32_bf16 v[60:63], a[228:231], v[212:215], v[60:63]
    ds_read_b64_tr_b16 a[204:205], v115 offset:25952
    ds_read_b64_tr_b16 a[206:207], v115 offset:26208
    v_mfma_f32_16x16x32_bf16 v[60:63], a[224:227], v[196:199], v[60:63]
    s_waitcnt vmcnt(24) lgkmcnt(8)
    s_barrier
    s_add_u32 s58, s58, 28672
    buffer_store_dwordx4 v[36:39], v6, s[32:35], s10 offen sc1
    v_mfma_f32_16x16x32_bf16 v[68:71], a[240:243], v[196:199], v[68:71]
    ds_read_b64_tr_b16 a[208:209], v113 offset:0
    ds_read_b64_tr_b16 a[210:211], v113 offset:256
    buffer_store_dword v5, v8, s[32:35], 0 offen sc1
    v_mfma_f32_16x16x32_bf16 v[68:71], a[244:247], v[212:215], v[68:71]
    buffer_load_dwordx4 v3, s[16:19], s58 offen offset:0 lds
    s_add_u32 m0, s37, 67744
    v_mfma_f32_16x16x32_bf16 v[68:71], a[248:251], v[228:231], v[68:71]
    s_add_u32 s10, s10, 16384
    ds_read_b64_tr_b16 a[212:213], v113 offset:512
    v_mfma_f32_16x16x32_bf16 v[68:71], a[252:255], v[244:247], v[68:71]
    ds_read_b64_tr_b16 a[214:215], v113 offset:768
    v_mfma_f32_16x16x32_bf16 v[64:67], a[252:255], v[240:243], v[64:67]
    ds_read_b64_tr_b16 a[216:217], v113 offset:8448
    ds_read_b64_tr_b16 a[218:219], v113 offset:8704
    v_mfma_f32_16x16x32_bf16 v[64:67], a[248:251], v[224:227], v[64:67]
    buffer_load_dwordx4 v3, s[16:19], s58 offen offset:896 lds
    s_add_u32 m0, s37, 67904
    v_mfma_f32_16x16x32_bf16 v[64:67], a[244:247], v[208:211], v[64:67]
    ds_read_b64_tr_b16 a[220:221], v113 offset:8960
    v_mfma_f32_16x16x32_bf16 v[64:67], a[240:243], v[192:195], v[64:67]
    s_waitcnt lgkmcnt(7)
    ds_read_b64_tr_b16 a[222:223], v113 offset:9216
    v_mfma_f32_16x16x32_bf16 v[72:75], a[192:195], v[192:195], v[72:75]
    ds_read_b64_tr_b16 a[224:225], v113 offset:32
    ds_read_b64_tr_b16 a[226:227], v113 offset:288
    v_mfma_f32_16x16x32_bf16 v[72:75], a[196:199], v[208:211], v[72:75]
    buffer_load_dwordx4 v3, s[16:19], s58 offen offset:1792 lds
    s_add_u32 m0, s37, 68064
    v_mfma_f32_16x16x32_bf16 v[72:75], a[200:203], v[224:227], v[72:75]
    ds_read_b64_tr_b16 a[228:229], v113 offset:544
    v_mfma_f32_16x16x32_bf16 v[72:75], a[204:207], v[240:243], v[72:75]
    ds_read_b64_tr_b16 a[230:231], v113 offset:800
    v_mfma_f32_16x16x32_bf16 v[76:79], a[204:207], v[244:247], v[76:79]
    ds_read_b64_tr_b16 a[232:233], v113 offset:8480
    ds_read_b64_tr_b16 a[234:235], v113 offset:8736
    v_mfma_f32_16x16x32_bf16 v[76:79], a[200:203], v[228:231], v[76:79]
    buffer_load_dwordx4 v3, s[16:19], s58 offen offset:2688 lds
    s_add_u32 m0, s37, 84480
    v_mfma_f32_16x16x32_bf16 v[76:79], a[196:199], v[212:215], v[76:79]
    s_add_u32 s58, s58, 28672
    ds_read_b64_tr_b16 a[236:237], v113 offset:8992
    v_mfma_f32_16x16x32_bf16 v[76:79], a[192:195], v[196:199], v[76:79]
    s_waitcnt lgkmcnt(7)
    ds_read_b64_tr_b16 a[238:239], v113 offset:9248
    v_mfma_f32_16x16x32_bf16 v[20:23], a[208:211], v[132:135], 0
    ds_read_b64_tr_b16 a[240:241], v113 offset:64
    v_mfma_f32_16x16x32_bf16 v[20:23], a[212:215], v[148:151], v[20:23]
    ds_read_b64_tr_b16 a[242:243], v113 offset:320
    v_mfma_f32_16x16x32_bf16 v[20:23], a[216:219], v[164:167], v[20:23]
    ds_read_b64_tr_b16 a[244:245], v113 offset:576
    v_mfma_f32_16x16x32_bf16 v[20:23], a[220:223], v[180:183], v[20:23]
    ds_read_b64_tr_b16 a[246:247], v113 offset:832
    v_mfma_f32_16x16x32_bf16 v[16:19], a[220:223], v[176:179], 0
    ds_read_b64_tr_b16 a[248:249], v113 offset:8512
    v_cvt_pk_bf16_f32 v48, v48, v49
    v_mfma_f32_16x16x32_bf16 v[16:19], a[216:219], v[160:163], v[16:19]
    ds_read_b64_tr_b16 a[250:251], v113 offset:8768
    v_cvt_pk_bf16_f32 v49, v50, v51
    v_mfma_f32_16x16x32_bf16 v[16:19], a[212:215], v[144:147], v[16:19]
    ds_read_b64_tr_b16 a[252:253], v113 offset:9024
    v_cvt_pk_bf16_f32 v50, v56, v57
    v_mfma_f32_16x16x32_bf16 v[16:19], a[208:211], v[128:131], v[16:19]
    s_waitcnt lgkmcnt(7)
    ds_read_b64_tr_b16 a[254:255], v113 offset:9280
    v_cvt_pk_bf16_f32 v51, v58, v59
    v_mfma_f32_16x16x32_bf16 v[24:27], a[224:227], v[128:131], 0
    ds_read_b64_tr_b16 a[192:193], v113 offset:96
    buffer_store_dwordx4 v[48:51], v6, s[32:35], s50 offen sc1
    v_mfma_f32_16x16x32_bf16 v[24:27], a[228:231], v[144:147], v[24:27]
    s_add_u32 s50, s50, 16384
    ds_read_b64_tr_b16 a[194:195], v113 offset:352
    v_mfma_f32_16x16x32_bf16 v[24:27], a[232:235], v[160:163], v[24:27]
    ds_read_b64_tr_b16 a[196:197], v113 offset:608
    v_cvt_pk_bf16_f32 v52, v52, v53
    v_mfma_f32_16x16x32_bf16 v[24:27], a[236:239], v[176:179], v[24:27]
    ds_read_b64_tr_b16 a[198:199], v113 offset:864
    v_cvt_pk_bf16_f32 v53, v54, v55
    v_cvt_pk_bf16_f32 v54, v60, v61
    v_mfma_f32_16x16x32_bf16 v[28:31], a[236:239], v[180:183], 0
    ds_read_b64_tr_b16 a[200:201], v113 offset:8544
    v_cvt_pk_bf16_f32 v55, v62, v63
    v_mfma_f32_16x16x32_bf16 v[28:31], a[232:235], v[164:167], v[28:31]
    ds_read_b64_tr_b16 a[202:203], v113 offset:8800
    buffer_store_dwordx4 v[52:55], v6, s[32:35], s10 offen sc1
    v_mfma_f32_16x16x32_bf16 v[28:31], a[228:231], v[148:151], v[28:31]
    ds_read_b64_tr_b16 a[204:205], v113 offset:9056
    ds_read_b64_tr_b16 a[206:207], v113 offset:9312
    v_mfma_f32_16x16x32_bf16 v[28:31], a[224:227], v[132:135], v[28:31]
    s_waitcnt vmcnt(63) lgkmcnt(8)
    s_barrier
    s_add_u32 s10, s10, 16384
    v_cvt_pk_bf16_f32 v64, v64, v65
    v_mfma_f32_16x16x32_bf16 v[36:39], a[240:243], v[132:135], 0
    ds_read_b64_tr_b16 a[208:209], v113 offset:16896
    ds_read_b64_tr_b16 a[210:211], v113 offset:17152
    v_mfma_f32_16x16x32_bf16 v[36:39], a[244:247], v[148:151], v[36:39]
    buffer_load_dwordx4 v3, s[16:19], s58 offen offset:0 lds
    s_add_u32 m0, s37, 84640
    v_mfma_f32_16x16x32_bf16 v[36:39], a[248:251], v[164:167], v[36:39]
    ds_read_b64_tr_b16 a[212:213], v113 offset:17408
    v_cvt_pk_bf16_f32 v65, v66, v67
    v_mfma_f32_16x16x32_bf16 v[36:39], a[252:255], v[180:183], v[36:39]
    ds_read_b64_tr_b16 a[214:215], v113 offset:17664
    v_cvt_pk_bf16_f32 v66, v72, v73
    v_cvt_pk_bf16_f32 v67, v74, v75
    v_mfma_f32_16x16x32_bf16 v[32:35], a[252:255], v[176:179], 0
    ds_read_b64_tr_b16 a[216:217], v113 offset:25344
    ds_read_b64_tr_b16 a[218:219], v113 offset:25600
    v_mfma_f32_16x16x32_bf16 v[32:35], a[248:251], v[160:163], v[32:35]
    buffer_load_dwordx4 v3, s[16:19], s58 offen offset:896 lds
    s_add_u32 m0, s37, 84800
    v_mfma_f32_16x16x32_bf16 v[32:35], a[244:247], v[144:147], v[32:35]
    ds_read_b64_tr_b16 a[220:221], v113 offset:25856
    buffer_store_dwordx4 v[64:67], v6, s[32:35], s50 offen sc1
    v_mfma_f32_16x16x32_bf16 v[32:35], a[240:243], v[128:131], v[32:35]
    s_waitcnt lgkmcnt(7)
    s_add_u32 s50, s50, 16384
    ds_read_b64_tr_b16 a[222:223], v113 offset:26112
    v_cvt_pk_bf16_f32 v68, v68, v69
    v_mfma_f32_16x16x32_bf16 v[40:43], a[192:195], v[128:131], 0
    ds_read_b64_tr_b16 a[224:225], v113 offset:16928
    ds_read_b64_tr_b16 a[226:227], v113 offset:17184
    v_mfma_f32_16x16x32_bf16 v[40:43], a[196:199], v[144:147], v[40:43]
    buffer_load_dwordx4 v3, s[16:19], s58 offen offset:1792 lds
    s_add_u32 m0, s37, 84960
    v_mfma_f32_16x16x32_bf16 v[40:43], a[200:203], v[160:163], v[40:43]
    ds_read_b64_tr_b16 a[228:229], v113 offset:17440
    v_cvt_pk_bf16_f32 v69, v70, v71
    v_mfma_f32_16x16x32_bf16 v[40:43], a[204:207], v[176:179], v[40:43]
    ds_read_b64_tr_b16 a[230:231], v113 offset:17696
    v_cvt_pk_bf16_f32 v70, v76, v77
    v_cvt_pk_bf16_f32 v71, v78, v79
    v_mfma_f32_16x16x32_bf16 v[44:47], a[204:207], v[180:183], 0
    ds_read_b64_tr_b16 a[232:233], v113 offset:25376
    ds_read_b64_tr_b16 a[234:235], v113 offset:25632
    v_mfma_f32_16x16x32_bf16 v[44:47], a[200:203], v[164:167], v[44:47]
    buffer_load_dwordx4 v3, s[16:19], s58 offen offset:2688 lds
    s_add_u32 m0, s37, 0
    v_mfma_f32_16x16x32_bf16 v[44:47], a[196:199], v[148:151], v[44:47]
    s_add_u32 s58, s58, 28672
    ds_read_b64_tr_b16 a[236:237], v113 offset:25888
    v_mfma_f32_16x16x32_bf16 v[44:47], a[192:195], v[132:135], v[44:47]
    s_waitcnt lgkmcnt(7)
    ds_read_b64_tr_b16 a[238:239], v113 offset:26144
    buffer_store_dwordx4 v[68:71], v6, s[32:35], s10 offen sc1
    v_mfma_f32_16x16x32_bf16 v[20:23], a[208:211], v[196:199], v[20:23]
    s_add_u32 s10, s10, 16384
    ds_read_b64_tr_b16 a[240:241], v113 offset:16960
    v_mfma_f32_16x16x32_bf16 v[20:23], a[212:215], v[212:215], v[20:23]
    ds_read_b64_tr_b16 a[242:243], v113 offset:17216
    v_mfma_f32_16x16x32_bf16 v[20:23], a[216:219], v[228:231], v[20:23]
    ds_read_b64_tr_b16 a[244:245], v113 offset:17472
    v_mfma_f32_16x16x32_bf16 v[20:23], a[220:223], v[244:247], v[20:23]
    ds_read_b64_tr_b16 a[246:247], v113 offset:17728
    v_mfma_f32_16x16x32_bf16 v[16:19], a[220:223], v[240:243], v[16:19]
    ds_read_b64_tr_b16 a[248:249], v113 offset:25408
    v_mfma_f32_16x16x32_bf16 v[16:19], a[216:219], v[224:227], v[16:19]
    ds_read_b64_tr_b16 a[250:251], v113 offset:25664
    v_mfma_f32_16x16x32_bf16 v[16:19], a[212:215], v[208:211], v[16:19]
    ds_read_b64_tr_b16 a[252:253], v113 offset:25920
    v_mov_b32 v5, 5
    v_mfma_f32_16x16x32_bf16 v[16:19], a[208:211], v[192:195], v[16:19]
    s_waitcnt lgkmcnt(7)
    ds_read_b64_tr_b16 a[254:255], v113 offset:26176
    v_mfma_f32_16x16x32_bf16 v[24:27], a[224:227], v[192:195], v[24:27]
    ds_read_b64_tr_b16 a[192:193], v113 offset:16992
    v_mfma_f32_16x16x32_bf16 v[24:27], a[228:231], v[208:211], v[24:27]
    ds_read_b64_tr_b16 a[194:195], v113 offset:17248
    v_mfma_f32_16x16x32_bf16 v[24:27], a[232:235], v[224:227], v[24:27]
    ds_read_b64_tr_b16 a[196:197], v113 offset:17504
    v_mfma_f32_16x16x32_bf16 v[24:27], a[236:239], v[240:243], v[24:27]
    ds_read_b64_tr_b16 a[198:199], v113 offset:17760
    v_mfma_f32_16x16x32_bf16 v[28:31], a[236:239], v[244:247], v[28:31]
    ds_read_b64_tr_b16 a[200:201], v113 offset:25440
    v_mfma_f32_16x16x32_bf16 v[28:31], a[232:235], v[228:231], v[28:31]
    ds_read_b64_tr_b16 a[202:203], v113 offset:25696
    v_mfma_f32_16x16x32_bf16 v[28:31], a[228:231], v[212:215], v[28:31]
    ds_read_b64_tr_b16 a[204:205], v113 offset:25952
    ds_read_b64_tr_b16 a[206:207], v113 offset:26208
    v_mfma_f32_16x16x32_bf16 v[28:31], a[224:227], v[196:199], v[28:31]
    s_waitcnt vmcnt(13) lgkmcnt(8)
    s_barrier
    v_mfma_f32_16x16x32_bf16 v[36:39], a[240:243], v[196:199], v[36:39]
    ds_read_b64_tr_b16 a[208:209], v115 offset:33792
    ds_read_b64_tr_b16 a[210:211], v115 offset:34048
    buffer_store_dword v5, v8, s[32:35], 0 offen sc1
    v_mfma_f32_16x16x32_bf16 v[36:39], a[244:247], v[212:215], v[36:39]
    buffer_load_dwordx4 v3, s[16:19], s58 offen offset:0 lds
    s_add_u32 m0, s37, 160
    v_mfma_f32_16x16x32_bf16 v[36:39], a[248:251], v[228:231], v[36:39]
    ds_read_b64_tr_b16 a[212:213], v115 offset:34304
    v_mfma_f32_16x16x32_bf16 v[36:39], a[252:255], v[244:247], v[36:39]
    ds_read_b64_tr_b16 a[214:215], v115 offset:34560
    v_mfma_f32_16x16x32_bf16 v[32:35], a[252:255], v[240:243], v[32:35]
    ds_read_b64_tr_b16 a[216:217], v115 offset:42240
    ds_read_b64_tr_b16 a[218:219], v115 offset:42496
    v_mfma_f32_16x16x32_bf16 v[32:35], a[248:251], v[224:227], v[32:35]
    buffer_load_dwordx4 v3, s[16:19], s58 offen offset:896 lds
    s_add_u32 m0, s37, 320
    v_mfma_f32_16x16x32_bf16 v[32:35], a[244:247], v[208:211], v[32:35]
    ds_read_b64_tr_b16 a[220:221], v115 offset:42752
    v_mfma_f32_16x16x32_bf16 v[32:35], a[240:243], v[192:195], v[32:35]
    s_waitcnt lgkmcnt(7)
    ds_read_b64_tr_b16 a[222:223], v115 offset:43008
    v_mfma_f32_16x16x32_bf16 v[40:43], a[192:195], v[192:195], v[40:43]
    ds_read_b64_tr_b16 a[224:225], v115 offset:33824
    ds_read_b64_tr_b16 a[226:227], v115 offset:34080
    v_mfma_f32_16x16x32_bf16 v[40:43], a[196:199], v[208:211], v[40:43]
    buffer_load_dwordx4 v3, s[16:19], s58 offen offset:1792 lds
    s_add_u32 m0, s37, 480
    v_mfma_f32_16x16x32_bf16 v[40:43], a[200:203], v[224:227], v[40:43]
    ds_read_b64_tr_b16 a[228:229], v115 offset:34336
    v_mfma_f32_16x16x32_bf16 v[40:43], a[204:207], v[240:243], v[40:43]
    ds_read_b64_tr_b16 a[230:231], v115 offset:34592
    v_mfma_f32_16x16x32_bf16 v[44:47], a[204:207], v[244:247], v[44:47]
    ds_read_b64_tr_b16 a[232:233], v115 offset:42272
    ds_read_b64_tr_b16 a[234:235], v115 offset:42528
    v_mfma_f32_16x16x32_bf16 v[44:47], a[200:203], v[228:231], v[44:47]
    buffer_load_dwordx4 v3, s[16:19], s58 offen offset:2688 lds
    s_add_u32 m0, s37, 16896
    v_mfma_f32_16x16x32_bf16 v[44:47], a[196:199], v[212:215], v[44:47]
    s_add_u32 s58, s58, 28672
    ds_read_b64_tr_b16 a[236:237], v115 offset:42784
    v_mfma_f32_16x16x32_bf16 v[44:47], a[192:195], v[196:199], v[44:47]
    s_waitcnt lgkmcnt(7)
    ds_read_b64_tr_b16 a[238:239], v115 offset:43040
    v_mfma_f32_16x16x32_bf16 v[52:55], a[208:211], v[132:135], 0
    ds_read_b64_tr_b16 a[240:241], v115 offset:33856
    v_mfma_f32_16x16x32_bf16 v[52:55], a[212:215], v[148:151], v[52:55]
    ds_read_b64_tr_b16 a[242:243], v115 offset:34112
    v_mfma_f32_16x16x32_bf16 v[52:55], a[216:219], v[164:167], v[52:55]
    ds_read_b64_tr_b16 a[244:245], v115 offset:34368
    v_mfma_f32_16x16x32_bf16 v[52:55], a[220:223], v[180:183], v[52:55]
    ds_read_b64_tr_b16 a[246:247], v115 offset:34624
    v_mfma_f32_16x16x32_bf16 v[48:51], a[220:223], v[176:179], 0
    ds_read_b64_tr_b16 a[248:249], v115 offset:42304
    v_cvt_pk_bf16_f32 v16, v16, v17
    v_mfma_f32_16x16x32_bf16 v[48:51], a[216:219], v[160:163], v[48:51]
    ds_read_b64_tr_b16 a[250:251], v115 offset:42560
    v_cvt_pk_bf16_f32 v17, v18, v19
    v_mfma_f32_16x16x32_bf16 v[48:51], a[212:215], v[144:147], v[48:51]
    ds_read_b64_tr_b16 a[252:253], v115 offset:42816
    v_cvt_pk_bf16_f32 v18, v24, v25
    v_mfma_f32_16x16x32_bf16 v[48:51], a[208:211], v[128:131], v[48:51]
    s_waitcnt lgkmcnt(7)
    ds_read_b64_tr_b16 a[254:255], v115 offset:43072
    v_cvt_pk_bf16_f32 v19, v26, v27
    v_mfma_f32_16x16x32_bf16 v[56:59], a[224:227], v[128:131], 0
    ds_read_b64_tr_b16 a[192:193], v115 offset:33888
    buffer_store_dwordx4 v[16:19], v6, s[32:35], s50 offen sc1
    v_mfma_f32_16x16x32_bf16 v[56:59], a[228:231], v[144:147], v[56:59]
    s_add_u32 s50, s50, 16384
    ds_read_b64_tr_b16 a[194:195], v115 offset:34144
    v_mfma_f32_16x16x32_bf16 v[56:59], a[232:235], v[160:163], v[56:59]
    ds_read_b64_tr_b16 a[196:197], v115 offset:34400
    v_cvt_pk_bf16_f32 v20, v20, v21
    v_mfma_f32_16x16x32_bf16 v[56:59], a[236:239], v[176:179], v[56:59]
    ds_read_b64_tr_b16 a[198:199], v115 offset:34656
    v_cvt_pk_bf16_f32 v21, v22, v23
    v_cvt_pk_bf16_f32 v22, v28, v29
    v_mfma_f32_16x16x32_bf16 v[60:63], a[236:239], v[180:183], 0
    ds_read_b64_tr_b16 a[200:201], v115 offset:42336
    v_cvt_pk_bf16_f32 v23, v30, v31
    v_mfma_f32_16x16x32_bf16 v[60:63], a[232:235], v[164:167], v[60:63]
    ds_read_b64_tr_b16 a[202:203], v115 offset:42592
    buffer_store_dwordx4 v[20:23], v6, s[32:35], s10 offen sc1
    v_mfma_f32_16x16x32_bf16 v[60:63], a[228:231], v[148:151], v[60:63]
    ds_read_b64_tr_b16 a[204:205], v115 offset:42848
    ds_read_b64_tr_b16 a[206:207], v115 offset:43104
    v_mfma_f32_16x16x32_bf16 v[60:63], a[224:227], v[132:135], v[60:63]
    s_waitcnt vmcnt(63) lgkmcnt(8)
    s_barrier
    s_add_u32 s10, s10, 16384
    v_cvt_pk_bf16_f32 v32, v32, v33
    v_mfma_f32_16x16x32_bf16 v[68:71], a[240:243], v[132:135], 0
    ds_read_b64_tr_b16 a[208:209], v115 offset:50688
    ds_read_b64_tr_b16 a[210:211], v115 offset:50944
    v_mfma_f32_16x16x32_bf16 v[68:71], a[244:247], v[148:151], v[68:71]
    buffer_load_dwordx4 v3, s[16:19], s58 offen offset:0 lds
    s_add_u32 m0, s37, 17056
    v_mfma_f32_16x16x32_bf16 v[68:71], a[248:251], v[164:167], v[68:71]
    ds_read_b64_tr_b16 a[212:213], v115 offset:51200
    v_cvt_pk_bf16_f32 v33, v34, v35
    v_mfma_f32_16x16x32_bf16 v[68:71], a[252:255], v[180:183], v[68:71]
    ds_read_b64_tr_b16 a[214:215], v115 offset:51456
    v_cvt_pk_bf16_f32 v34, v40, v41
    v_cvt_pk_bf16_f32 v35, v42, v43
    v_mfma_f32_16x16x32_bf16 v[64:67], a[252:255], v[176:179], 0
    ds_read_b64_tr_b16 a[216:217], v115 offset:59136
    ds_read_b64_tr_b16 a[218:219], v115 offset:59392
    v_mfma_f32_16x16x32_bf16 v[64:67], a[248:251], v[160:163], v[64:67]
    buffer_load_dwordx4 v3, s[16:19], s58 offen offset:896 lds
    s_add_u32 m0, s37, 17216
    v_mfma_f32_16x16x32_bf16 v[64:67], a[244:247], v[144:147], v[64:67]
    ds_read_b64_tr_b16 a[220:221], v115 offset:59648
    buffer_store_dwordx4 v[32:35], v6, s[32:35], s50 offen sc1
    v_mfma_f32_16x16x32_bf16 v[64:67], a[240:243], v[128:131], v[64:67]
    s_waitcnt lgkmcnt(7)
    s_add_u32 s50, s50, 16384
    ds_read_b64_tr_b16 a[222:223], v115 offset:59904
    v_cvt_pk_bf16_f32 v36, v36, v37
    v_mfma_f32_16x16x32_bf16 v[72:75], a[192:195], v[128:131], 0
    ds_read_b64_tr_b16 a[224:225], v115 offset:50720
    ds_read_b64_tr_b16 a[226:227], v115 offset:50976
    v_mfma_f32_16x16x32_bf16 v[72:75], a[196:199], v[144:147], v[72:75]
    buffer_load_dwordx4 v3, s[16:19], s58 offen offset:1792 lds
    s_add_u32 m0, s37, 17376
    v_mfma_f32_16x16x32_bf16 v[72:75], a[200:203], v[160:163], v[72:75]
    ds_read_b64_tr_b16 a[228:229], v115 offset:51232
    v_cvt_pk_bf16_f32 v37, v38, v39
    v_mfma_f32_16x16x32_bf16 v[72:75], a[204:207], v[176:179], v[72:75]
    ds_read_b64_tr_b16 a[230:231], v115 offset:51488
    v_cvt_pk_bf16_f32 v38, v44, v45
    v_cvt_pk_bf16_f32 v39, v46, v47
    v_mfma_f32_16x16x32_bf16 v[76:79], a[204:207], v[180:183], 0
    ds_read_b64_tr_b16 a[232:233], v115 offset:59168
    ds_read_b64_tr_b16 a[234:235], v115 offset:59424
    v_mfma_f32_16x16x32_bf16 v[76:79], a[200:203], v[164:167], v[76:79]
    buffer_load_dwordx4 v3, s[16:19], s58 offen offset:2688 lds
    s_add_u32 m0, s37, 101376
    v_mfma_f32_16x16x32_bf16 v[76:79], a[196:199], v[148:151], v[76:79]
    s_add_u32 s58, s58, 28672
    ds_read_b64_tr_b16 a[236:237], v115 offset:59680
    v_mfma_f32_16x16x32_bf16 v[76:79], a[192:195], v[132:135], v[76:79]
    s_waitcnt lgkmcnt(7)
    ds_read_b64_tr_b16 a[238:239], v115 offset:59936
    buffer_store_dwordx4 v[36:39], v6, s[32:35], s10 offen sc1
    v_mfma_f32_16x16x32_bf16 v[52:55], a[208:211], v[196:199], v[52:55]
    s_add_u32 s10, s10, 16384
    ds_read_b64_tr_b16 a[240:241], v115 offset:50752
    v_mfma_f32_16x16x32_bf16 v[52:55], a[212:215], v[212:215], v[52:55]
    ds_read_b64_tr_b16 a[242:243], v115 offset:51008
    v_mfma_f32_16x16x32_bf16 v[52:55], a[216:219], v[228:231], v[52:55]
    ds_read_b64_tr_b16 a[244:245], v115 offset:51264
    v_mfma_f32_16x16x32_bf16 v[52:55], a[220:223], v[244:247], v[52:55]
    ds_read_b64_tr_b16 a[246:247], v115 offset:51520
    v_mfma_f32_16x16x32_bf16 v[48:51], a[220:223], v[240:243], v[48:51]
    ds_read_b64_tr_b16 a[248:249], v115 offset:59200
    v_mfma_f32_16x16x32_bf16 v[48:51], a[216:219], v[224:227], v[48:51]
    ds_read_b64_tr_b16 a[250:251], v115 offset:59456
    v_mfma_f32_16x16x32_bf16 v[48:51], a[212:215], v[208:211], v[48:51]
    ds_read_b64_tr_b16 a[252:253], v115 offset:59712
    v_mfma_f32_16x16x32_bf16 v[48:51], a[208:211], v[192:195], v[48:51]
    s_waitcnt lgkmcnt(7)
    ds_read_b64_tr_b16 a[254:255], v115 offset:59968
    v_mfma_f32_16x16x32_bf16 v[56:59], a[224:227], v[192:195], v[56:59]
    ds_read_b64_tr_b16 a[192:193], v115 offset:50784
    v_mfma_f32_16x16x32_bf16 v[56:59], a[228:231], v[208:211], v[56:59]
    ds_read_b64_tr_b16 a[194:195], v115 offset:51040
    v_mfma_f32_16x16x32_bf16 v[56:59], a[232:235], v[224:227], v[56:59]
    ds_read_b64_tr_b16 a[196:197], v115 offset:51296
    v_mfma_f32_16x16x32_bf16 v[56:59], a[236:239], v[240:243], v[56:59]
    ds_read_b64_tr_b16 a[198:199], v115 offset:51552
    v_mfma_f32_16x16x32_bf16 v[60:63], a[236:239], v[244:247], v[60:63]
    ds_read_b64_tr_b16 a[200:201], v115 offset:59232
    v_mfma_f32_16x16x32_bf16 v[60:63], a[232:235], v[228:231], v[60:63]
    ds_read_b64_tr_b16 a[202:203], v115 offset:59488
    v_mfma_f32_16x16x32_bf16 v[60:63], a[228:231], v[212:215], v[60:63]
    ds_read_b64_tr_b16 a[204:205], v115 offset:59744
    ds_read_b64_tr_b16 a[206:207], v115 offset:60000
    v_mfma_f32_16x16x32_bf16 v[60:63], a[224:227], v[196:199], v[60:63]
    s_waitcnt vmcnt(63) lgkmcnt(8)
    s_barrier
    v_mfma_f32_16x16x32_bf16 v[68:71], a[240:243], v[196:199], v[68:71]
    ds_read_b64_tr_b16 a[208:209], v99 offset:0
    ds_read_b64_tr_b16 a[210:211], v99 offset:512
    v_mfma_f32_16x16x32_bf16 v[68:71], a[244:247], v[212:215], v[68:71]
    buffer_load_dwordx4 v3, s[16:19], s58 offen offset:0 lds
    s_add_u32 m0, s37, 101536
    v_mfma_f32_16x16x32_bf16 v[68:71], a[248:251], v[228:231], v[68:71]
    v_mfma_f32_16x16x32_bf16 v[68:71], a[252:255], v[244:247], v[68:71]
    v_mfma_f32_16x16x32_bf16 v[64:67], a[252:255], v[240:243], v[64:67]
    ds_read_b64_tr_b16 a[216:217], v99 offset:32
    ds_read_b64_tr_b16 a[218:219], v99 offset:544
    v_mfma_f32_16x16x32_bf16 v[64:67], a[248:251], v[224:227], v[64:67]
    buffer_load_dwordx4 v3, s[16:19], s58 offen offset:896 lds
    s_add_u32 m0, s37, 101696
    v_mfma_f32_16x16x32_bf16 v[64:67], a[244:247], v[208:211], v[64:67]
    v_mfma_f32_16x16x32_bf16 v[64:67], a[240:243], v[192:195], v[64:67]
    s_waitcnt lgkmcnt(4)
    v_mfma_f32_16x16x32_bf16 v[72:75], a[192:195], v[192:195], v[72:75]
    ds_read_b64_tr_b16 a[224:225], v99 offset:64
    ds_read_b64_tr_b16 a[226:227], v99 offset:576
    v_mfma_f32_16x16x32_bf16 v[72:75], a[196:199], v[208:211], v[72:75]
    buffer_load_dwordx4 v3, s[16:19], s58 offen offset:1792 lds
    s_add_u32 m0, s37, 101856
    v_mfma_f32_16x16x32_bf16 v[72:75], a[200:203], v[224:227], v[72:75]
    v_mfma_f32_16x16x32_bf16 v[72:75], a[204:207], v[240:243], v[72:75]
    v_mfma_f32_16x16x32_bf16 v[76:79], a[204:207], v[244:247], v[76:79]
    ds_read_b64_tr_b16 a[232:233], v99 offset:96
    ds_read_b64_tr_b16 a[234:235], v99 offset:608
    v_mfma_f32_16x16x32_bf16 v[76:79], a[200:203], v[228:231], v[76:79]
    buffer_load_dwordx4 v3, s[16:19], s58 offen offset:2688 lds
    s_add_u32 m0, s37, 118272
    v_mfma_f32_16x16x32_bf16 v[76:79], a[196:199], v[212:215], v[76:79]
    s_add_u32 s58, s58, 28672
    v_mfma_f32_16x16x32_bf16 v[76:79], a[192:195], v[196:199], v[76:79]
    s_waitcnt vmcnt(63) lgkmcnt(4)
    s_barrier
    v_mfma_f32_16x16x32_bf16 v[128:131], a[208:211], a[64:67], 0
    ds_read_b64_tr_b16 a[240:241], v97 offset:33792
    ds_read_b64_tr_b16 a[242:243], v97 offset:34304
    v_mfma_f32_16x16x32_bf16 v[132:135], a[208:211], a[68:71], 0
    buffer_load_dwordx4 v3, s[16:19], s58 offen offset:0 lds
    s_add_u32 m0, s37, 118432
    v_mfma_f32_16x16x32_bf16 v[144:147], a[208:211], a[72:75], 0
    v_mfma_f32_16x16x32_bf16 v[148:151], a[208:211], a[76:79], 0
    v_mfma_f32_16x16x32_bf16 v[180:183], a[216:219], a[76:79], 0
    ds_read_b64_tr_b16 a[248:249], v97 offset:33824
    ds_read_b64_tr_b16 a[250:251], v97 offset:34336
    v_cvt_pk_bf16_f32 v48, v48, v49
    v_cvt_pk_bf16_f32 v49, v50, v51
    v_mfma_f32_16x16x32_bf16 v[176:179], a[216:219], a[72:75], 0
    buffer_load_dwordx4 v3, s[16:19], s58 offen offset:896 lds
    s_add_u32 m0, s37, 118592
    v_cvt_pk_bf16_f32 v50, v56, v57
    v_cvt_pk_bf16_f32 v51, v58, v59
    v_mfma_f32_16x16x32_bf16 v[164:167], a[216:219], a[68:71], 0
    buffer_store_dwordx4 v[48:51], v6, s[32:35], s50 offen sc1
    v_mfma_f32_16x16x32_bf16 v[160:163], a[216:219], a[64:67], 0
    s_waitcnt lgkmcnt(4)
    s_add_u32 s50, s50, 16384
    v_cvt_pk_bf16_f32 v52, v52, v53
    v_cvt_pk_bf16_f32 v53, v54, v55
    v_cvt_pk_bf16_f32 v54, v60, v61
    v_cvt_pk_bf16_f32 v55, v62, v63
    v_mfma_f32_16x16x32_bf16 v[192:195], a[224:227], a[64:67], 0
    ds_read_b64_tr_b16 a[192:193], v97 offset:33856
    ds_read_b64_tr_b16 a[194:195], v97 offset:34368
    buffer_store_dwordx4 v[52:55], v6, s[32:35], s10 offen sc1
    v_mfma_f32_16x16x32_bf16 v[196:199], a[224:227], a[68:71], 0
    s_add_u32 s10, s10, 16384
    buffer_load_dwordx4 v3, s[16:19], s58 offen offset:1792 lds
    s_add_u32 m0, s37, 118752
    v_cvt_pk_bf16_f32 v64, v64, v65
    v_mfma_f32_16x16x32_bf16 v[208:211], a[224:227], a[72:75], 0
    v_cvt_pk_bf16_f32 v65, v66, v67
    v_cvt_pk_bf16_f32 v66, v72, v73
    v_cvt_pk_bf16_f32 v67, v74, v75
    v_mfma_f32_16x16x32_bf16 v[212:215], a[224:227], a[76:79], 0
    buffer_store_dwordx4 v[64:67], v6, s[32:35], s50 offen sc1
    v_mfma_f32_16x16x32_bf16 v[244:247], a[232:235], a[76:79], 0
    s_add_u32 s50, s50, 16384
    ds_read_b64_tr_b16 a[200:201], v97 offset:33888
    ds_read_b64_tr_b16 a[202:203], v97 offset:34400
    v_cvt_pk_bf16_f32 v68, v68, v69
    v_mfma_f32_16x16x32_bf16 v[240:243], a[232:235], a[72:75], 0
    buffer_load_dwordx4 v3, s[16:19], s58 offen offset:2688 lds
    s_add_u32 m0, s37, 135168
    v_cvt_pk_bf16_f32 v69, v70, v71
    v_cvt_pk_bf16_f32 v70, v76, v77
    v_mfma_f32_16x16x32_bf16 v[228:231], a[232:235], a[68:71], 0
    s_add_u32 s58, s58, 28672
    v_cvt_pk_bf16_f32 v71, v78, v79
    v_mfma_f32_16x16x32_bf16 v[224:227], a[232:235], a[64:67], 0
    s_waitcnt lgkmcnt(4)
    buffer_store_dwordx4 v[68:71], v6, s[32:35], s10 offen sc1
    v_mfma_f32_16x16x32_bf16 v[128:131], a[240:243], a[80:83], v[128:131]
    s_add_u32 s10, s10, 16384
    ds_read_b64_tr_b16 a[208:209], v97 offset:50688
    ds_read_b64_tr_b16 a[210:211], v97 offset:51200
    v_mfma_f32_16x16x32_bf16 v[132:135], a[240:243], a[84:87], v[132:135]
    buffer_load_dwordx4 v3, s[16:19], s58 offen offset:0 lds
    s_add_u32 m0, s37, 135328
    v_mfma_f32_16x16x32_bf16 v[144:147], a[240:243], a[88:91], v[144:147]
    v_mfma_f32_16x16x32_bf16 v[148:151], a[240:243], a[92:95], v[148:151]
    v_mfma_f32_16x16x32_bf16 v[180:183], a[248:251], a[92:95], v[180:183]
    ds_read_b64_tr_b16 a[216:217], v97 offset:50720
    ds_read_b64_tr_b16 a[218:219], v97 offset:51232
    v_mfma_f32_16x16x32_bf16 v[176:179], a[248:251], a[88:91], v[176:179]
    buffer_load_dwordx4 v3, s[16:19], s58 offen offset:896 lds
    s_add_u32 m0, s37, 135488
    v_mfma_f32_16x16x32_bf16 v[164:167], a[248:251], a[84:87], v[164:167]
    v_mfma_f32_16x16x32_bf16 v[160:163], a[248:251], a[80:83], v[160:163]
    s_waitcnt lgkmcnt(4)
    v_mfma_f32_16x16x32_bf16 v[192:195], a[192:195], a[80:83], v[192:195]
    ds_read_b64_tr_b16 a[224:225], v97 offset:50752
    ds_read_b64_tr_b16 a[226:227], v97 offset:51264
    v_mfma_f32_16x16x32_bf16 v[196:199], a[192:195], a[84:87], v[196:199]
    buffer_load_dwordx4 v3, s[16:19], s58 offen offset:1792 lds
    s_add_u32 m0, s37, 135648
    v_mfma_f32_16x16x32_bf16 v[208:211], a[192:195], a[88:91], v[208:211]
    v_mfma_f32_16x16x32_bf16 v[212:215], a[192:195], a[92:95], v[212:215]
    v_mfma_f32_16x16x32_bf16 v[244:247], a[200:203], a[92:95], v[244:247]
    ds_read_b64_tr_b16 a[232:233], v97 offset:50784
    ds_read_b64_tr_b16 a[234:235], v97 offset:51296
    v_mfma_f32_16x16x32_bf16 v[240:243], a[200:203], a[88:91], v[240:243]
    buffer_load_dwordx4 v3, s[16:19], s58 offen offset:2688 lds
    s_add_u32 m0, s37, 33792
    v_mfma_f32_16x16x32_bf16 v[228:231], a[200:203], a[84:87], v[228:231]
    s_add_u32 s58, s58, 28672
    v_mfma_f32_16x16x32_bf16 v[224:227], a[200:203], a[80:83], v[224:227]
    s_waitcnt lgkmcnt(4)
    s_waitcnt vmcnt(37)
    v_mfma_f32_16x16x32_bf16 v[128:131], a[208:211], a[96:99], v[128:131]
    ds_read_b64_tr_b16 a[240:241], v98 offset:0
    ds_read_b64_tr_b16 a[242:243], v98 offset:512
    v_mfma_f32_16x16x32_bf16 v[132:135], a[208:211], a[100:103], v[132:135]
    buffer_load_dwordx4 v3, s[16:19], s58 offen offset:0 lds
    s_add_u32 m0, s37, 33952
    v_mfma_f32_16x16x32_bf16 v[144:147], a[208:211], a[104:107], v[144:147]
    v_mfma_f32_16x16x32_bf16 v[148:151], a[208:211], a[108:111], v[148:151]
    v_mfma_f32_16x16x32_bf16 v[180:183], a[216:219], a[108:111], v[180:183]
    ds_read_b64_tr_b16 a[248:249], v98 offset:32
    ds_read_b64_tr_b16 a[250:251], v98 offset:544
    v_mfma_f32_16x16x32_bf16 v[176:179], a[216:219], a[104:107], v[176:179]
    buffer_load_dwordx4 v3, s[16:19], s58 offen offset:896 lds
    s_add_u32 m0, s37, 34112
    v_mfma_f32_16x16x32_bf16 v[164:167], a[216:219], a[100:103], v[164:167]
    v_mov_b32 v5, 8
    v_mfma_f32_16x16x32_bf16 v[160:163], a[216:219], a[96:99], v[160:163]
    s_waitcnt lgkmcnt(4)
    v_mfma_f32_16x16x32_bf16 v[192:195], a[224:227], a[96:99], v[192:195]
    ds_read_b64_tr_b16 a[192:193], v98 offset:64
    ds_read_b64_tr_b16 a[194:195], v98 offset:576
    v_mfma_f32_16x16x32_bf16 v[196:199], a[224:227], a[100:103], v[196:199]
    buffer_load_dwordx4 v3, s[16:19], s58 offen offset:1792 lds
    s_add_u32 m0, s37, 34272
    v_mfma_f32_16x16x32_bf16 v[208:211], a[224:227], a[104:107], v[208:211]
    v_mfma_f32_16x16x32_bf16 v[212:215], a[224:227], a[108:111], v[212:215]
    v_mfma_f32_16x16x32_bf16 v[244:247], a[232:235], a[108:111], v[244:247]
    ds_read_b64_tr_b16 a[200:201], v98 offset:96
    ds_read_b64_tr_b16 a[202:203], v98 offset:608
    v_mfma_f32_16x16x32_bf16 v[240:243], a[232:235], a[104:107], v[240:243]
    buffer_load_dwordx4 v3, s[16:19], s58 offen offset:2688 lds
    s_add_u32 m0, s37, 50688
    v_mfma_f32_16x16x32_bf16 v[228:231], a[232:235], a[100:103], v[228:231]
    s_add_u32 s58, s58, 28672
    v_mfma_f32_16x16x32_bf16 v[224:227], a[232:235], a[96:99], v[224:227]
    s_waitcnt lgkmcnt(4)
    s_waitcnt vmcnt(34)
    s_waitcnt vmcnt(8)
    s_barrier
    v_mfma_f32_16x16x32_bf16 v[128:131], a[240:243], a[112:115], v[128:131]
    ds_read_b64_tr_b16 a[208:209], v98 offset:16896
    ds_read_b64_tr_b16 a[210:211], v98 offset:17408
    buffer_store_dword v5, v8, s[32:35], 0 offen sc1
    v_mfma_f32_16x16x32_bf16 v[132:135], a[240:243], a[116:119], v[132:135]
    buffer_load_dwordx4 v3, s[16:19], s58 offen offset:0 lds
    s_add_u32 m0, s37, 50848
    s_bitcmp1_b32 s53, 31
    s_cbranch_scc1 done
    v_mfma_f32_16x16x32_bf16 v[144:147], a[240:243], a[120:123], v[144:147]
    v_lshrrev_b32 v11, 4, v13
    v_lshl_add_u32 v11, v11, 3, v9
    v_lshlrev_b32 v48, 16, v88
    v_mfma_f32_16x16x32_bf16 v[148:151], a[240:243], a[124:127], v[148:151]
    v_and_b32 v49, 0xffff0000, v88
    v_lshlrev_b32 v50, 16, v89
    v_and_b32 v51, 0xffff0000, v89
    v_mfma_f32_16x16x32_bf16 v[180:183], a[248:251], a[124:127], v[180:183]
    ds_read_b64_tr_b16 a[216:217], v98 offset:16928
    ds_read_b64_tr_b16 a[218:219], v98 offset:17440
    v_lshlrev_b32 v52, 16, v90
    v_mfma_f32_16x16x32_bf16 v[176:179], a[248:251], a[120:123], v[176:179]
    buffer_load_dwordx4 v3, s[16:19], s58 offen offset:896 lds
    s_add_u32 m0, s37, 51008
    v_and_b32 v53, 0xffff0000, v90
    v_mfma_f32_16x16x32_bf16 v[164:167], a[248:251], a[116:119], v[164:167]
    v_lshlrev_b32 v54, 16, v91
    v_and_b32 v55, 0xffff0000, v91
    v_lshlrev_b32 v56, 16, v92
    v_mfma_f32_16x16x32_bf16 v[160:163], a[248:251], a[112:115], v[160:163]
    s_waitcnt lgkmcnt(4)
    v_and_b32 v57, 0xffff0000, v92
    v_lshlrev_b32 v58, 16, v93
    v_and_b32 v59, 0xffff0000, v93
    v_mfma_f32_16x16x32_bf16 v[192:195], a[192:195], a[112:115], v[192:195]
    ds_read_b64_tr_b16 a[224:225], v98 offset:16960
    ds_read_b64_tr_b16 a[226:227], v98 offset:17472
    v_lshlrev_b32 v60, 16, v94
    v_mfma_f32_16x16x32_bf16 v[196:199], a[192:195], a[116:119], v[196:199]
    buffer_load_dwordx4 v3, s[16:19], s58 offen offset:1792 lds
    s_add_u32 m0, s37, 51168
    v_and_b32 v61, 0xffff0000, v94
    v_mfma_f32_16x16x32_bf16 v[208:211], a[192:195], a[120:123], v[208:211]
    v_lshlrev_b32 v62, 16, v95
    v_and_b32 v63, 0xffff0000, v95
    v_mfma_f32_16x16x32_bf16 v[212:215], a[192:195], a[124:127], v[212:215]
    v_mfma_f32_16x16x32_bf16 v[244:247], a[200:203], a[124:127], v[244:247]
    ds_read_b64_tr_b16 a[232:233], v98 offset:16992
    ds_read_b64_tr_b16 a[234:235], v98 offset:17504
    v_mfma_f32_16x16x32_bf16 v[240:243], a[200:203], a[120:123], v[240:243]
    buffer_load_dwordx4 v3, s[16:19], s58 offen offset:2688 lds
    s_add_u32 m0, s37, 67584
    v_mfma_f32_16x16x32_bf16 v[228:231], a[200:203], a[116:119], v[228:231]
    s_add_u32 s58, s58, 28672
    v_mfma_f32_16x16x32_bf16 v[224:227], a[200:203], a[112:115], v[224:227]
    s_waitcnt lgkmcnt(4)
    v_mfma_f32_16x16x32_bf16 v[128:131], a[208:211], a[128:131], v[128:131]
    ds_read_b64_tr_b16 a[240:241], v97 offset:0
    ds_read_b64_tr_b16 a[242:243], v97 offset:512
    v_mfma_f32_16x16x32_bf16 v[132:135], a[208:211], a[132:135], v[132:135]
    buffer_load_dwordx4 v3, s[16:19], s58 offen offset:0 lds
    s_add_u32 m0, s37, 67744
    v_mfma_f32_16x16x32_bf16 v[144:147], a[208:211], a[136:139], v[144:147]
    v_mfma_f32_16x16x32_bf16 v[148:151], a[208:211], a[140:143], v[148:151]
    v_mfma_f32_16x16x32_bf16 v[180:183], a[216:219], a[140:143], v[180:183]
    ds_read_b64_tr_b16 a[248:249], v97 offset:32
    ds_read_b64_tr_b16 a[250:251], v97 offset:544
    v_mfma_f32_16x16x32_bf16 v[176:179], a[216:219], a[136:139], v[176:179]
    buffer_load_dwordx4 v3, s[16:19], s58 offen offset:896 lds
    s_add_u32 m0, s37, 67904
    v_mfma_f32_16x16x32_bf16 v[164:167], a[216:219], a[132:135], v[164:167]
    v_mfma_f32_16x16x32_bf16 v[160:163], a[216:219], a[128:131], v[160:163]
    s_waitcnt lgkmcnt(4)
    v_mfma_f32_16x16x32_bf16 v[192:195], a[224:227], a[128:131], v[192:195]
    ds_read_b64_tr_b16 a[192:193], v97 offset:64
    ds_read_b64_tr_b16 a[194:195], v97 offset:576
    v_mfma_f32_16x16x32_bf16 v[196:199], a[224:227], a[132:135], v[196:199]
    buffer_load_dwordx4 v3, s[16:19], s58 offen offset:1792 lds
    s_add_u32 m0, s37, 68064
    v_mfma_f32_16x16x32_bf16 v[208:211], a[224:227], a[136:139], v[208:211]
    v_mfma_f32_16x16x32_bf16 v[212:215], a[224:227], a[140:143], v[212:215]
    v_mfma_f32_16x16x32_bf16 v[244:247], a[232:235], a[140:143], v[244:247]
    ds_read_b64_tr_b16 a[200:201], v97 offset:96
    ds_read_b64_tr_b16 a[202:203], v97 offset:608
    v_mfma_f32_16x16x32_bf16 v[240:243], a[232:235], a[136:139], v[240:243]
    buffer_load_dwordx4 v3, s[16:19], s58 offen offset:2688 lds
    s_add_u32 m0, s37, 84480
    v_mfma_f32_16x16x32_bf16 v[228:231], a[232:235], a[132:135], v[228:231]
    s_add_u32 s58, s58, 28672
    v_mfma_f32_16x16x32_bf16 v[224:227], a[232:235], a[128:131], v[224:227]
    s_waitcnt lgkmcnt(4)
    v_mfma_f32_16x16x32_bf16 v[128:131], a[240:243], a[144:147], v[128:131]
    ds_read_b64_tr_b16 a[208:209], v97 offset:16896
    ds_read_b64_tr_b16 a[210:211], v97 offset:17408
    v_mfma_f32_16x16x32_bf16 v[132:135], a[240:243], a[148:151], v[132:135]
    buffer_load_dwordx4 v3, s[16:19], s58 offen offset:0 lds
    s_add_u32 m0, s37, 84640
    v_mfma_f32_16x16x32_bf16 v[144:147], a[240:243], a[152:155], v[144:147]
    v_mfma_f32_16x16x32_bf16 v[148:151], a[240:243], a[156:159], v[148:151]
    v_mfma_f32_16x16x32_bf16 v[180:183], a[248:251], a[156:159], v[180:183]
    ds_read_b64_tr_b16 a[216:217], v97 offset:16928
    ds_read_b64_tr_b16 a[218:219], v97 offset:17440
    v_mfma_f32_16x16x32_bf16 v[176:179], a[248:251], a[152:155], v[176:179]
    buffer_load_dwordx4 v3, s[16:19], s58 offen offset:896 lds
    buffer_load_dword v15, v7, s[32:35], 0 offen sc1
    s_add_u32 m0, s37, 84800
    v_mfma_f32_16x16x32_bf16 v[164:167], a[248:251], a[148:151], v[164:167]
    v_mfma_f32_16x16x32_bf16 v[160:163], a[248:251], a[144:147], v[160:163]
    s_waitcnt lgkmcnt(4)
    v_mfma_f32_16x16x32_bf16 v[192:195], a[192:195], a[144:147], v[192:195]
    ds_read_b64_tr_b16 a[224:225], v97 offset:16960
    ds_read_b64_tr_b16 a[226:227], v97 offset:17472
    v_mfma_f32_16x16x32_bf16 v[196:199], a[192:195], a[148:151], v[196:199]
    buffer_load_dwordx4 v3, s[16:19], s58 offen offset:1792 lds
    s_add_u32 m0, s37, 84960
    v_mfma_f32_16x16x32_bf16 v[208:211], a[192:195], a[152:155], v[208:211]
    v_mfma_f32_16x16x32_bf16 v[212:215], a[192:195], a[156:159], v[212:215]
    v_mfma_f32_16x16x32_bf16 v[244:247], a[200:203], a[156:159], v[244:247]
    ds_read_b64_tr_b16 a[232:233], v97 offset:16992
    ds_read_b64_tr_b16 a[234:235], v97 offset:17504
    v_mfma_f32_16x16x32_bf16 v[240:243], a[200:203], a[152:155], v[240:243]
    buffer_load_dwordx4 v3, s[16:19], s58 offen offset:2688 lds
    v_mfma_f32_16x16x32_bf16 v[228:231], a[200:203], a[148:151], v[228:231]
    s_add_u32 s58, s58, 28672
    v_mfma_f32_16x16x32_bf16 v[224:227], a[200:203], a[144:147], v[224:227]
    s_waitcnt lgkmcnt(4)
    v_mfma_f32_16x16x32_bf16 v[128:131], a[208:211], a[160:163], v[128:131]
    ds_read_b64_tr_b16 a[240:241], v98 offset:33792
    v_mfma_f32_16x16x32_bf16 v[132:135], a[208:211], a[164:167], v[132:135]
    ds_read_b64_tr_b16 a[242:243], v98 offset:34304
    v_mfma_f32_16x16x32_bf16 v[144:147], a[208:211], a[168:171], v[144:147]
    v_mfma_f32_16x16x32_bf16 v[148:151], a[208:211], a[172:175], v[148:151]
    v_mfma_f32_16x16x32_bf16 v[180:183], a[216:219], a[172:175], v[180:183]
    ds_read_b64_tr_b16 a[248:249], v98 offset:33824
    v_mfma_f32_16x16x32_bf16 v[176:179], a[216:219], a[168:171], v[176:179]
    ds_read_b64_tr_b16 a[250:251], v98 offset:34336
    v_mfma_f32_16x16x32_bf16 v[164:167], a[216:219], a[164:167], v[164:167]
    v_mfma_f32_16x16x32_bf16 v[160:163], a[216:219], a[160:163], v[160:163]
    s_waitcnt lgkmcnt(4)
    v_mfma_f32_16x16x32_bf16 v[192:195], a[224:227], a[160:163], v[192:195]
    ds_read_b64_tr_b16 a[192:193], v98 offset:33856
    v_mfma_f32_16x16x32_bf16 v[196:199], a[224:227], a[164:167], v[196:199]
    ds_read_b64_tr_b16 a[194:195], v98 offset:34368
    v_mfma_f32_16x16x32_bf16 v[208:211], a[224:227], a[168:171], v[208:211]
    v_mfma_f32_16x16x32_bf16 v[212:215], a[224:227], a[172:175], v[212:215]
    v_mfma_f32_16x16x32_bf16 v[244:247], a[232:235], a[172:175], v[244:247]
    s_waitcnt vmcnt(2)
    ds_read_b64_tr_b16 a[200:201], v98 offset:33888
    v_mfma_f32_16x16x32_bf16 v[240:243], a[232:235], a[168:171], v[240:243]
    ds_read_b64_tr_b16 a[202:203], v98 offset:34400
    v_cmp_gt_u32 vcc, s51, v15
    v_mfma_f32_16x16x32_bf16 v[228:231], a[232:235], a[164:167], v[228:231]
    s_cbranch_vccnz spin_a
ok_a:
    v_mfma_f32_16x16x32_bf16 v[224:227], a[232:235], a[160:163], v[224:227]
    s_waitcnt lgkmcnt(4)
    v_mfma_f32_16x16x32_bf16 v[128:131], a[240:243], a[0:3], v[128:131]
    ds_read_b64_tr_b16 a[208:209], v98 offset:50688
    v_mfma_f32_16x16x32_bf16 v[132:135], a[240:243], a[4:7], v[132:135]
    ds_read_b64_tr_b16 a[210:211], v98 offset:51200
    v_mfma_f32_16x16x32_bf16 v[144:147], a[240:243], a[8:11], v[144:147]
    v_mfma_f32_16x16x32_bf16 v[148:151], a[240:243], a[12:15], v[148:151]
    v_mfma_f32_16x16x32_bf16 v[180:183], a[248:251], a[12:15], v[180:183]
    ds_read_b64_tr_b16 a[216:217], v98 offset:50720
    v_mfma_f32_16x16x32_bf16 v[176:179], a[248:251], a[8:11], v[176:179]
    ds_read_b64_tr_b16 a[218:219], v98 offset:51232
    buffer_load_dwordx4 v[72:75], v6, s[32:35], s53 offen offset:0 sc1
    v_mfma_f32_16x16x32_bf16 v[164:167], a[248:251], a[4:7], v[164:167]
    v_mfma_f32_16x16x32_bf16 v[160:163], a[248:251], a[0:3], v[160:163]
    s_waitcnt lgkmcnt(4)
    v_mfma_f32_16x16x32_bf16 v[192:195], a[192:195], a[0:3], v[192:195]
    ds_read_b64_tr_b16 a[224:225], v98 offset:50752
    v_mfma_f32_16x16x32_bf16 v[196:199], a[192:195], a[4:7], v[196:199]
    ds_read_b64_tr_b16 a[226:227], v98 offset:51264
    v_mfma_f32_16x16x32_bf16 v[208:211], a[192:195], a[8:11], v[208:211]
    v_mfma_f32_16x16x32_bf16 v[212:215], a[192:195], a[12:15], v[212:215]
    v_mfma_f32_16x16x32_bf16 v[244:247], a[200:203], a[12:15], v[244:247]
    ds_read_b64_tr_b16 a[232:233], v98 offset:50784
    buffer_load_dwordx4 v[76:79], v6, s[32:35], s53 offen offset:1024 sc1
    v_mfma_f32_16x16x32_bf16 v[240:243], a[200:203], a[8:11], v[240:243]
    ds_read_b64_tr_b16 a[234:235], v98 offset:51296
    v_mfma_f32_16x16x32_bf16 v[228:231], a[200:203], a[4:7], v[228:231]
    v_mfma_f32_16x16x32_bf16 v[224:227], a[200:203], a[0:3], v[224:227]
    s_waitcnt lgkmcnt(4)
    v_mfma_f32_16x16x32_bf16 v[128:131], a[208:211], a[16:19], v[128:131]
    ds_read_b64_tr_b16 a[240:241], v99 offset:0
    v_mfma_f32_16x16x32_bf16 v[132:135], a[208:211], a[20:23], v[132:135]
    ds_read_b64_tr_b16 a[242:243], v99 offset:512
    v_mfma_f32_16x16x32_bf16 v[144:147], a[208:211], a[24:27], v[144:147]
    v_mfma_f32_16x16x32_bf16 v[148:151], a[208:211], a[28:31], v[148:151]
    buffer_load_dwordx4 v[104:107], v6, s[32:35], s53 offen offset:2048 sc1
    v_mfma_f32_16x16x32_bf16 v[180:183], a[216:219], a[28:31], v[180:183]
    ds_read_b64_tr_b16 a[248:249], v99 offset:32
    v_mfma_f32_16x16x32_bf16 v[176:179], a[216:219], a[24:27], v[176:179]
    ds_read_b64_tr_b16 a[250:251], v99 offset:544
    v_mfma_f32_16x16x32_bf16 v[164:167], a[216:219], a[20:23], v[164:167]
    v_mfma_f32_16x16x32_bf16 v[160:163], a[216:219], a[16:19], v[160:163]
    s_waitcnt lgkmcnt(4)
    v_mfma_f32_16x16x32_bf16 v[192:195], a[224:227], a[16:19], v[192:195]
    ds_read_b64_tr_b16 a[192:193], v97 offset:33792
    v_mfma_f32_16x16x32_bf16 v[196:199], a[224:227], a[20:23], v[196:199]
    ds_read_b64_tr_b16 a[194:195], v97 offset:34304
    v_mfma_f32_16x16x32_bf16 v[208:211], a[224:227], a[24:27], v[208:211]
    buffer_load_dwordx4 v[108:111], v6, s[32:35], s53 offen offset:3072 sc1
    s_add_u32 s53, s53, 4096
    v_mfma_f32_16x16x32_bf16 v[212:215], a[224:227], a[28:31], v[212:215]
    v_mfma_f32_16x16x32_bf16 v[244:247], a[232:235], a[28:31], v[244:247]
    ds_read_b64_tr_b16 a[200:201], v97 offset:33824
    v_mfma_f32_16x16x32_bf16 v[240:243], a[232:235], a[24:27], v[240:243]
    ds_read_b64_tr_b16 a[202:203], v97 offset:34336
    v_mfma_f32_16x16x32_bf16 v[228:231], a[232:235], a[20:23], v[228:231]
    v_mfma_f32_16x16x32_bf16 v[224:227], a[232:235], a[16:19], v[224:227]
    s_waitcnt lgkmcnt(4)
    v_mfma_f32_16x16x32_bf16 v[128:131], a[240:243], a[32:35], v[128:131]
    ds_read_b64_tr_b16 a[208:209], v97 offset:50688
    v_mfma_f32_16x16x32_bf16 v[132:135], a[240:243], a[36:39], v[132:135]
    ds_read_b64_tr_b16 a[210:211], v97 offset:51200
    buffer_load_dwordx4 v[116:119], v6, s[32:35], s53 offen offset:0 sc1
    v_mfma_f32_16x16x32_bf16 v[144:147], a[240:243], a[40:43], v[144:147]
    v_mfma_f32_16x16x32_bf16 v[148:151], a[240:243], a[44:47], v[148:151]
    v_mfma_f32_16x16x32_bf16 v[180:183], a[248:251], a[44:47], v[180:183]
    ds_read_b64_tr_b16 a[216:217], v97 offset:50720
    v_mfma_f32_16x16x32_bf16 v[176:179], a[248:251], a[40:43], v[176:179]
    ds_read_b64_tr_b16 a[218:219], v97 offset:51232
    v_mfma_f32_16x16x32_bf16 v[164:167], a[248:251], a[36:39], v[164:167]
    v_mfma_f32_16x16x32_bf16 v[160:163], a[248:251], a[32:35], v[160:163]
    s_waitcnt lgkmcnt(4)
    v_mfma_f32_16x16x32_bf16 v[128:131], a[192:195], a[48:51], v[128:131]
    ds_read_b64_tr_b16 a[224:225], v98 offset:0
    buffer_load_dwordx4 v[120:123], v6, s[32:35], s53 offen offset:1024 sc1
    v_mfma_f32_16x16x32_bf16 v[132:135], a[192:195], a[52:55], v[132:135]
    ds_read_b64_tr_b16 a[226:227], v98 offset:512
    v_mfma_f32_16x16x32_bf16 v[144:147], a[192:195], a[56:59], v[144:147]
    v_mfma_f32_16x16x32_bf16 v[148:151], a[192:195], a[60:63], v[148:151]
    v_mfma_f32_16x16x32_bf16 v[180:183], a[200:203], a[60:63], v[180:183]
    ds_read_b64_tr_b16 a[232:233], v98 offset:32
    v_mfma_f32_16x16x32_bf16 v[176:179], a[200:203], a[56:59], v[176:179]
    ds_read_b64_tr_b16 a[234:235], v98 offset:544
    v_mfma_f32_16x16x32_bf16 v[164:167], a[200:203], a[52:55], v[164:167]
    v_mfma_f32_16x16x32_bf16 v[160:163], a[200:203], a[48:51], v[160:163]
    s_waitcnt lgkmcnt(4)
    buffer_load_dwordx4 v[124:127], v6, s[32:35], s53 offen offset:2048 sc1
    s_waitcnt vmcnt(7)
    v_mfma_f32_16x16x32_bf16 v[128:131], a[208:211], v[136:139], v[128:131]
    ds_read_b64_tr_b16 a[240:241], v98 offset:16896
    v_mfma_f32_16x16x32_bf16 v[132:135], a[208:211], v[140:143], v[132:135]
    ds_read_b64_tr_b16 a[242:243], v98 offset:17408
    v_mfma_f32_16x16x32_bf16 v[144:147], a[208:211], v[152:155], v[144:147]
    v_mfma_f32_16x16x32_bf16 v[148:151], a[208:211], v[156:159], v[148:151]
    v_mfma_f32_16x16x32_bf16 v[180:183], a[216:219], v[156:159], v[180:183]
    ds_read_b64_tr_b16 a[248:249], v98 offset:16928
    v_mfma_f32_16x16x32_bf16 v[176:179], a[216:219], v[152:155], v[176:179]
    ds_read_b64_tr_b16 a[250:251], v98 offset:17440
    v_mfma_f32_16x16x32_bf16 v[164:167], a[216:219], v[140:143], v[164:167]
    buffer_load_dwordx4 a[176:179], v6, s[32:35], s53 offen offset:3072 sc1
    s_add_u32 s53, s53, 4096
    v_mfma_f32_16x16x32_bf16 v[160:163], a[216:219], v[136:139], v[160:163]
    s_waitcnt lgkmcnt(4)
    v_mfma_f32_16x16x32_bf16 v[128:131], a[224:227], v[168:171], v[128:131]
    ds_read_b64_tr_b16 a[192:193], v99 offset:64
    v_mfma_f32_16x16x32_bf16 v[132:135], a[224:227], v[172:175], v[132:135]
    ds_read_b64_tr_b16 a[194:195], v99 offset:576
    v_mfma_f32_16x16x32_bf16 v[144:147], a[224:227], v[184:187], v[144:147]
    v_mfma_f32_16x16x32_bf16 v[148:151], a[224:227], v[188:191], v[148:151]
    v_mfma_f32_16x16x32_bf16 v[180:183], a[232:235], v[188:191], v[180:183]
    ds_read_b64_tr_b16 a[200:201], v99 offset:96
    v_mfma_f32_16x16x32_bf16 v[176:179], a[232:235], v[184:187], v[176:179]
    ds_read_b64_tr_b16 a[202:203], v99 offset:608
    buffer_load_dwordx4 a[180:183], v6, s[32:35], s53 offen offset:0 sc1
    v_mfma_f32_16x16x32_bf16 v[164:167], a[232:235], v[172:175], v[164:167]
    v_mfma_f32_16x16x32_bf16 v[160:163], a[232:235], v[168:171], v[160:163]
    s_waitcnt lgkmcnt(4)
    v_mfma_f32_16x16x32_bf16 v[128:131], a[240:243], v[200:203], v[128:131]
    ds_read_b64_tr_b16 a[208:209], v97 offset:33856
    v_mfma_f32_16x16x32_bf16 v[132:135], a[240:243], v[204:207], v[132:135]
    ds_read_b64_tr_b16 a[210:211], v97 offset:34368
    v_mfma_f32_16x16x32_bf16 v[144:147], a[240:243], v[216:219], v[144:147]
    v_mfma_f32_16x16x32_bf16 v[148:151], a[240:243], v[220:223], v[148:151]
    v_mfma_f32_16x16x32_bf16 v[180:183], a[248:251], v[220:223], v[180:183]
    ds_read_b64_tr_b16 a[216:217], v97 offset:33888
    buffer_load_dwordx4 a[184:187], v6, s[32:35], s53 offen offset:1024 sc1
    v_mfma_f32_16x16x32_bf16 v[176:179], a[248:251], v[216:219], v[176:179]
    ds_read_b64_tr_b16 a[218:219], v97 offset:34400
    v_mfma_f32_16x16x32_bf16 v[164:167], a[248:251], v[204:207], v[164:167]
    v_mfma_f32_16x16x32_bf16 v[160:163], a[248:251], v[200:203], v[160:163]
    s_waitcnt lgkmcnt(4)
    v_mfma_f32_16x16x32_bf16 v[192:195], a[192:195], a[32:35], v[192:195]
    ds_read_b64_tr_b16 a[224:225], v97 offset:50752
    v_mfma_f32_16x16x32_bf16 v[196:199], a[192:195], a[36:39], v[196:199]
    ds_read_b64_tr_b16 a[226:227], v97 offset:51264
    v_mfma_f32_16x16x32_bf16 v[208:211], a[192:195], a[40:43], v[208:211]
    v_mfma_f32_16x16x32_bf16 v[212:215], a[192:195], a[44:47], v[212:215]
    buffer_load_dwordx4 a[188:191], v6, s[32:35], s53 offen offset:2048 sc1
    v_mfma_f32_16x16x32_bf16 v[244:247], a[200:203], a[44:47], v[244:247]
    ds_read_b64_tr_b16 a[232:233], v97 offset:50784
    v_mfma_f32_16x16x32_bf16 v[240:243], a[200:203], a[40:43], v[240:243]
    ds_read_b64_tr_b16 a[234:235], v97 offset:51296
    ds_write_b128 v103, v[128:131] offset:0
    v_mfma_f32_16x16x32_bf16 v[228:231], a[200:203], a[36:39], v[228:231]
    ds_write_b128 v103, v[132:135] offset:1024
    v_mfma_f32_16x16x32_bf16 v[224:227], a[200:203], a[32:35], v[224:227]
    s_waitcnt lgkmcnt(6)
    ds_write_b128 v103, v[144:147] offset:2048
    v_mfma_f32_16x16x32_bf16 v[192:195], a[208:211], a[48:51], v[192:195]
    ds_read_b64_tr_b16 a[240:241], v98 offset:64
    ds_write_b128 v103, v[148:151] offset:3072
    v_mfma_f32_16x16x32_bf16 v[196:199], a[208:211], a[52:55], v[196:199]
    ds_read_b64_tr_b16 a[242:243], v98 offset:576
    ds_write_b128 v103, v[160:163] offset:16896
    v_mfma_f32_16x16x32_bf16 v[208:211], a[208:211], a[56:59], v[208:211]
    buffer_load_dwordx4 a[64:67], v6, s[32:35], s53 offen offset:3072 sc1
    ds_write_b128 v103, v[164:167] offset:17920
    s_add_u32 s53, s53, 4096
    v_mfma_f32_16x16x32_bf16 v[212:215], a[208:211], a[60:63], v[212:215]
    ds_write_b128 v103, v[176:179] offset:18944
    v_mfma_f32_16x16x32_bf16 v[244:247], a[216:219], a[60:63], v[244:247]
    ds_read_b64_tr_b16 a[248:249], v98 offset:96
    ds_write_b128 v103, v[180:183] offset:19968
    v_mfma_f32_16x16x32_bf16 v[240:243], a[216:219], a[56:59], v[240:243]
    ds_read_b64_tr_b16 a[250:251], v98 offset:608
    v_mfma_f32_16x16x32_bf16 v[228:231], a[216:219], a[52:55], v[228:231]
    v_mfma_f32_16x16x32_bf16 v[224:227], a[216:219], a[48:51], v[224:227]
    s_waitcnt lgkmcnt(12)
    v_mfma_f32_16x16x32_bf16 v[192:195], a[224:227], v[136:139], v[192:195]
    ds_read_b64_tr_b16 a[192:193], v98 offset:16960
    v_mfma_f32_16x16x32_bf16 v[196:199], a[224:227], v[140:143], v[196:199]
    ds_read_b64_tr_b16 a[194:195], v98 offset:17472
    buffer_load_dwordx4 a[68:71], v6, s[32:35], s53 offen offset:0 sc1
    s_waitcnt lgkmcnt(0)
    s_barrier
    ds_read_b128 v[32:35], v102 offset:0
    ds_read_b128 v[128:131], v102 offset:4224
    ds_read_b128 v[132:135], v102 offset:8448
    ds_read_b128 v[144:147], v102 offset:12672
    ds_read_b128 v[36:39], v102 offset:16896
    ds_read_b128 v[160:163], v102 offset:21120
    ds_read_b128 v[164:167], v102 offset:25344
    ds_read_b128 v[176:179], v102 offset:29568
    v_mfma_f32_16x16x32_bf16 v[208:211], a[224:227], v[152:155], v[208:211]
    v_mfma_f32_16x16x32_bf16 v[212:215], a[224:227], v[156:159], v[212:215]
    v_mfma_f32_16x16x32_bf16 v[244:247], a[232:235], v[156:159], v[244:247]
    ds_read_b64_tr_b16 a[200:201], v98 offset:16992
    s_waitcnt lgkmcnt(7)
    v_add_f32 v32, v32, v128
    s_waitcnt lgkmcnt(5)
    v_add_f32 v132, v132, v144
    v_add_f32 v33, v33, v129
    v_mfma_f32_16x16x32_bf16 v[240:243], a[232:235], v[152:155], v[240:243]
    ds_read_b64_tr_b16 a[202:203], v98 offset:17504
    v_add_f32 v133, v133, v145
    v_add_f32 v34, v34, v130
    v_add_f32 v134, v134, v146
    v_mfma_f32_16x16x32_bf16 v[228:231], a[232:235], v[140:143], v[228:231]
    v_add_f32 v35, v35, v131
    v_add_f32 v135, v135, v147
    v_add_f32 v32, v32, v132
    v_mfma_f32_16x16x32_bf16 v[224:227], a[232:235], v[136:139], v[224:227]
    v_add_f32 v33, v33, v133
    v_add_f32 v34, v34, v134
    v_add_f32 v35, v35, v135
    v_mfma_f32_16x16x32_bf16 v[192:195], a[240:243], v[168:171], v[192:195]
    buffer_load_dwordx4 a[72:75], v6, s[32:35], s53 offen offset:1024 sc1
    s_waitcnt lgkmcnt(4)
    v_add_f32 v36, v36, v160
    s_waitcnt lgkmcnt(2)
    v_add_f32 v164, v164, v176
    v_add_f32 v37, v37, v161
    v_mfma_f32_16x16x32_bf16 v[196:199], a[240:243], v[172:175], v[196:199]
    v_add_f32 v165, v165, v177
    v_add_f32 v38, v38, v162
    v_add_f32 v166, v166, v178
    v_mfma_f32_16x16x32_bf16 v[208:211], a[240:243], v[184:187], v[208:211]
    v_add_f32 v39, v39, v163
    v_add_f32 v167, v167, v179
    v_add_f32 v36, v36, v164
    v_mfma_f32_16x16x32_bf16 v[212:215], a[240:243], v[188:191], v[212:215]
    v_add_f32 v37, v37, v165
    v_add_f32 v38, v38, v166
    v_add_f32 v39, v39, v167
    v_mfma_f32_16x16x32_bf16 v[244:247], a[248:251], v[188:191], v[244:247]
    v_mul_f32 v64, 0xbfb8aa3b, v32
    v_mul_f32 v65, 0xbfb8aa3b, v33
    v_mul_f32 v66, 0xbfb8aa3b, v34
    v_mfma_f32_16x16x32_bf16 v[240:243], a[248:251], v[184:187], v[240:243]
    v_mul_f32 v67, 0xbfb8aa3b, v35
    v_mul_f32 v68, 0xbfb8aa3b, v36
    v_mul_f32 v69, 0xbfb8aa3b, v37
    v_mfma_f32_16x16x32_bf16 v[228:231], a[248:251], v[172:175], v[228:231]
    v_mul_f32 v70, 0xbfb8aa3b, v38
    v_mul_f32 v71, 0xbfb8aa3b, v39
    v_exp_f32 v64, v64
    v_mfma_f32_16x16x32_bf16 v[224:227], a[248:251], v[168:171], v[224:227]
    s_waitcnt lgkmcnt(0)
    buffer_load_dwordx4 a[76:79], v6, s[32:35], s53 offen offset:2048 sc1
    v_exp_f32 v65, v65
    v_exp_f32 v66, v66
    v_exp_f32 v67, v67
    v_mfma_f32_16x16x32_bf16 v[192:195], a[192:195], v[200:203], v[192:195]
    v_exp_f32 v68, v68
    v_exp_f32 v69, v69
    v_exp_f32 v70, v70
    v_mfma_f32_16x16x32_bf16 v[196:199], a[192:195], v[204:207], v[196:199]
    v_exp_f32 v71, v71
    v_add_f32 v64, 1.0, v64
    v_add_f32 v65, 1.0, v65
    v_mfma_f32_16x16x32_bf16 v[208:211], a[192:195], v[216:219], v[208:211]
    v_add_f32 v66, 1.0, v66
    v_add_f32 v67, 1.0, v67
    v_add_f32 v68, 1.0, v68
    v_mfma_f32_16x16x32_bf16 v[212:215], a[192:195], v[220:223], v[212:215]
    v_add_f32 v69, 1.0, v69
    v_add_f32 v70, 1.0, v70
    v_add_f32 v71, 1.0, v71
    v_mfma_f32_16x16x32_bf16 v[244:247], a[200:203], v[220:223], v[244:247]
    v_rcp_f32 v64, v64
    v_rcp_f32 v65, v65
    v_rcp_f32 v66, v66
    v_mfma_f32_16x16x32_bf16 v[240:243], a[200:203], v[216:219], v[240:243]
    v_rcp_f32 v67, v67
    v_rcp_f32 v68, v68
    v_rcp_f32 v69, v69
    v_mfma_f32_16x16x32_bf16 v[228:231], a[200:203], v[204:207], v[228:231]
    buffer_load_dwordx4 a[80:83], v6, s[32:35], s53 offen offset:3072 sc1
    s_add_u32 s53, s53, 4096
    v_rcp_f32 v70, v70
    v_rcp_f32 v71, v71
    v_mul_f32 v32, v32, v64
    v_mfma_f32_16x16x32_bf16 v[224:227], a[200:203], v[200:203], v[224:227]
    s_nop 4
    buffer_load_dwordx4 a[84:87], v6, s[32:35], s53 offen offset:0 sc1
    ds_write_b128 v101, v[192:195] offset:0
    ds_write_b128 v101, v[196:199] offset:1024
    ds_write_b128 v101, v[208:211] offset:2048
    buffer_load_dwordx4 a[88:91], v6, s[32:35], s53 offen offset:1024 sc1
    ds_write_b128 v101, v[212:215] offset:3072
    ds_write_b128 v101, v[224:227] offset:16896
    ds_write_b128 v101, v[228:231] offset:17920
    buffer_load_dwordx4 a[92:95], v6, s[32:35], s53 offen offset:2048 sc1
    ds_write_b128 v101, v[240:243] offset:18944
    ds_write_b128 v101, v[244:247] offset:19968
    v_mul_f32 v33, v33, v65
    buffer_load_dwordx4 a[96:99], v6, s[32:35], s53 offen offset:3072 sc1
    s_add_u32 s53, s53, 4096
    v_mul_f32 v34, v34, v66
    v_mul_f32 v35, v35, v67
    v_mul_f32 v36, v36, v68
    buffer_load_dwordx4 a[100:103], v6, s[32:35], s53 offen offset:0 sc1
    v_mul_f32 v37, v37, v69
    v_mul_f32 v38, v38, v70
    v_mul_f32 v39, v39, v71
    buffer_load_dwordx4 a[104:107], v6, s[32:35], s53 offen offset:1024 sc1
    buffer_load_dwordx4 a[108:111], v6, s[32:35], s53 offen offset:2048 sc1
    buffer_load_dwordx4 a[112:115], v6, s[32:35], s53 offen offset:3072 sc1
    s_add_u32 s53, s53, 4096
    s_waitcnt lgkmcnt(0)
    s_barrier
    ds_read_b128 v[40:43], v100 offset:0
    ds_read_b128 v[192:195], v100 offset:4224
    ds_read_b128 v[196:199], v100 offset:8448
    ds_read_b128 v[208:211], v100 offset:12672
    ds_read_b128 v[44:47], v100 offset:16896
    ds_read_b128 v[224:227], v100 offset:21120
    ds_read_b128 v[228:231], v100 offset:25344
    ds_read_b128 v[240:243], v100 offset:29568
    buffer_load_dwordx4 a[116:119], v6, s[32:35], s53 offen offset:0 sc1
    s_waitcnt lgkmcnt(6)
    v_add_f32 v40, v40, v192
    s_waitcnt lgkmcnt(4)
    v_add_f32 v196, v196, v208
    v_add_f32 v41, v41, v193
    s_waitcnt vmcnt(23)
    v_mfma_f32_16x16x32_bf16 v[16:19], v[82:85], v[72:75], 0
    v_add_f32 v197, v197, v209
    v_add_f32 v42, v42, v194
    v_add_f32 v198, v198, v210
    v_mfma_f32_16x16x32_bf16 v[20:23], v[80:83], v[72:75], 0
    buffer_load_dwordx4 a[120:123], v6, s[32:35], s53 offen offset:1024 sc1
    v_add_f32 v43, v43, v195
    v_add_f32 v199, v199, v211
    v_mfma_f32_16x16x32_bf16 v[16:19], v[82:85], v[76:79], v[16:19]
    v_add_f32 v40, v40, v196
    v_add_f32 v41, v41, v197
    v_add_f32 v42, v42, v198
    v_mfma_f32_16x16x32_bf16 v[20:23], v[80:83], v[76:79], v[20:23]
    v_add_f32 v43, v43, v199
    buffer_load_dwordx4 a[124:127], v6, s[32:35], s53 offen offset:2048 sc1
    s_waitcnt lgkmcnt(2)
    v_add_f32 v44, v44, v224
    s_waitcnt vmcnt(23)
    v_mfma_f32_16x16x32_bf16 v[16:19], v[82:85], v[104:107], v[16:19]
    s_waitcnt lgkmcnt(0)
    v_add_f32 v228, v228, v240
    v_add_f32 v45, v45, v225
    v_add_f32 v229, v229, v241
    v_mfma_f32_16x16x32_bf16 v[20:23], v[80:83], v[104:107], v[20:23]
    v_add_f32 v46, v46, v226
    v_add_f32 v230, v230, v242
    buffer_load_dwordx4 a[128:131], v6, s[32:35], s53 offen offset:3072 sc1
    v_mfma_f32_16x16x32_bf16 v[16:19], v[82:85], v[108:111], v[16:19]
    s_add_u32 s53, s53, 4096
    v_add_f32 v47, v47, v227
    v_add_f32 v231, v231, v243
    v_mfma_f32_16x16x32_bf16 v[20:23], v[80:83], v[108:111], v[20:23]
    v_add_f32 v44, v44, v228
    v_add_f32 v45, v45, v229
    v_add_f32 v46, v46, v230
    s_waitcnt vmcnt(22)
    v_mfma_f32_16x16x32_bf16 v[16:19], v[82:85], v[116:119], v[16:19]
    v_add_f32 v47, v47, v231
    buffer_load_dwordx4 a[132:135], v6, s[32:35], s53 offen offset:0 sc1
    v_mul_f32 v64, 0xbfb8aa3b, v40
    v_mfma_f32_16x16x32_bf16 v[20:23], v[80:83], v[116:119], v[20:23]
    v_mul_f32 v65, 0xbfb8aa3b, v41
    v_mul_f32 v66, 0xbfb8aa3b, v42
    v_mul_f32 v67, 0xbfb8aa3b, v43
    v_mfma_f32_16x16x32_bf16 v[16:19], v[82:85], v[120:123], v[16:19]
    v_mul_f32 v68, 0xbfb8aa3b, v44
    v_mul_f32 v69, 0xbfb8aa3b, v45
    buffer_load_dwordx4 a[136:139], v6, s[32:35], s53 offen offset:1024 sc1
    v_mfma_f32_16x16x32_bf16 v[20:23], v[80:83], v[120:123], v[20:23]
    v_mul_f32 v70, 0xbfb8aa3b, v46
    v_mul_f32 v71, 0xbfb8aa3b, v47
    v_exp_f32 v64, v64
    s_waitcnt vmcnt(22)
    v_mfma_f32_16x16x32_bf16 v[16:19], v[82:85], v[124:127], v[16:19]
    v_exp_f32 v65, v65
    v_exp_f32 v66, v66
    v_exp_f32 v67, v67
    v_mfma_f32_16x16x32_bf16 v[20:23], v[80:83], v[124:127], v[20:23]
    buffer_load_dwordx4 a[140:143], v6, s[32:35], s53 offen offset:2048 sc1
    v_exp_f32 v68, v68
    v_exp_f32 v69, v69
    v_mfma_f32_16x16x32_bf16 v[16:19], v[82:85], a[176:179], v[16:19]
    v_exp_f32 v70, v70
    v_exp_f32 v71, v71
    v_add_f32 v64, 1.0, v64
    v_mfma_f32_16x16x32_bf16 v[20:23], v[80:83], a[176:179], v[20:23]
    v_add_f32 v65, 1.0, v65
    buffer_load_dwordx4 a[144:147], v6, s[32:35], s53 offen offset:3072 sc1
    s_add_u32 s53, s53, 4096
    s_waitcnt vmcnt(22)
    v_mfma_f32_16x16x32_bf16 v[16:19], v[82:85], a[180:183], v[16:19]
    v_add_f32 v66, 1.0, v66
    v_add_f32 v67, 1.0, v67
    v_add_f32 v68, 1.0, v68
    v_mfma_f32_16x16x32_bf16 v[20:23], v[80:83], a[180:183], v[20:23]
    v_add_f32 v69, 1.0, v69
    v_add_f32 v70, 1.0, v70
    v_add_f32 v71, 1.0, v71
    v_mfma_f32_16x16x32_bf16 v[16:19], v[82:85], a[184:187], v[16:19]
    v_rcp_f32 v64, v64
    v_rcp_f32 v65, v65
    v_rcp_f32 v66, v66
    v_mfma_f32_16x16x32_bf16 v[20:23], v[80:83], a[184:187], v[20:23]
    v_rcp_f32 v67, v67
    v_rcp_f32 v68, v68
    v_rcp_f32 v69, v69
    s_waitcnt vmcnt(20)
    v_mfma_f32_16x16x32_bf16 v[16:19], v[82:85], a[188:191], v[16:19]
    v_rcp_f32 v70, v70
    v_rcp_f32 v71, v71
    v_mul_f32 v40, v40, v64
    v_mfma_f32_16x16x32_bf16 v[20:23], v[80:83], a[188:191], v[20:23]
    v_mul_f32 v41, v41, v65
    v_mul_f32 v42, v42, v66
    v_mul_f32 v43, v43, v67
    v_mfma_f32_16x16x32_bf16 v[16:19], v[82:85], a[64:67], v[16:19]
    v_mul_f32 v44, v44, v68
    v_mul_f32 v45, v45, v69
    v_mul_f32 v46, v46, v70
    v_mfma_f32_16x16x32_bf16 v[20:23], v[80:83], a[64:67], v[20:23]
    v_mul_f32 v47, v47, v71
    s_waitcnt vmcnt(18)
    v_mfma_f32_16x16x32_bf16 v[16:19], v[82:85], a[68:71], v[16:19]
    v_mfma_f32_16x16x32_bf16 v[20:23], v[80:83], a[68:71], v[20:23]
    v_mfma_f32_16x16x32_bf16 v[16:19], v[82:85], a[72:75], v[16:19]
    v_mfma_f32_16x16x32_bf16 v[20:23], v[80:83], a[72:75], v[20:23]
    s_waitcnt vmcnt(16)
    v_mfma_f32_16x16x32_bf16 v[16:19], v[82:85], a[76:79], v[16:19]
    v_mfma_f32_16x16x32_bf16 v[20:23], v[80:83], a[76:79], v[20:23]
    v_mfma_f32_16x16x32_bf16 v[16:19], v[82:85], a[80:83], v[16:19]
    v_mfma_f32_16x16x32_bf16 v[20:23], v[80:83], a[80:83], v[20:23]
    s_waitcnt vmcnt(14)
    v_mfma_f32_16x16x32_bf16 v[24:27], v[82:85], a[84:87], 0
    v_mfma_f32_16x16x32_bf16 v[28:31], v[80:83], a[84:87], 0
    v_mfma_f32_16x16x32_bf16 v[24:27], v[82:85], a[88:91], v[24:27]
    v_mfma_f32_16x16x32_bf16 v[28:31], v[80:83], a[88:91], v[28:31]
    s_waitcnt vmcnt(12)
    v_mfma_f32_16x16x32_bf16 v[24:27], v[82:85], a[92:95], v[24:27]
    v_mfma_f32_16x16x32_bf16 v[28:31], v[80:83], a[92:95], v[28:31]
    v_mfma_f32_16x16x32_bf16 v[24:27], v[82:85], a[96:99], v[24:27]
    v_mfma_f32_16x16x32_bf16 v[28:31], v[80:83], a[96:99], v[28:31]
    v_fma_f32 v48, v16, v32, v48
    v_fma_f32 v49, v17, v33, v49
    v_fma_f32 v50, v18, v34, v50
    v_fma_f32 v51, v19, v35, v51
    v_fma_f32 v52, v20, v36, v52
    v_fma_f32 v53, v21, v37, v53
    v_fma_f32 v54, v22, v38, v54
    v_fma_f32 v55, v23, v39, v55
    v_cvt_pk_bf16_f32 v88, v48, v49
    v_cvt_pk_bf16_f32 v89, v50, v51
    v_cvt_pk_bf16_f32 v90, v52, v53
    v_cvt_pk_bf16_f32 v91, v54, v55
    s_nop 0
    v_permlane32_swap_b32 v88, v90
    v_permlane32_swap_b32 v89, v91
    s_nop 0
    v_permlane16_swap_b32 v88, v90
    v_permlane16_swap_b32 v89, v91
    buffer_store_dwordx4 v[88:91], v11, s[20:23], 0 offen offset:0 sc1
    s_waitcnt vmcnt(11)
    v_mfma_f32_16x16x32_bf16 v[24:27], v[82:85], a[100:103], v[24:27]
    v_mfma_f32_16x16x32_bf16 v[28:31], v[80:83], a[100:103], v[28:31]
    v_mfma_f32_16x16x32_bf16 v[24:27], v[82:85], a[104:107], v[24:27]
    v_mfma_f32_16x16x32_bf16 v[28:31], v[80:83], a[104:107], v[28:31]
    s_waitcnt vmcnt(9)
    v_mfma_f32_16x16x32_bf16 v[24:27], v[82:85], a[108:111], v[24:27]
    v_mfma_f32_16x16x32_bf16 v[28:31], v[80:83], a[108:111], v[28:31]
    v_mfma_f32_16x16x32_bf16 v[24:27], v[82:85], a[112:115], v[24:27]
    v_mfma_f32_16x16x32_bf16 v[28:31], v[80:83], a[112:115], v[28:31]
    s_waitcnt vmcnt(7)
    v_mfma_f32_16x16x32_bf16 v[24:27], v[82:85], a[116:119], v[24:27]
    v_mfma_f32_16x16x32_bf16 v[28:31], v[80:83], a[116:119], v[28:31]
    v_mfma_f32_16x16x32_bf16 v[24:27], v[82:85], a[120:123], v[24:27]
    v_mfma_f32_16x16x32_bf16 v[28:31], v[80:83], a[120:123], v[28:31]
    s_waitcnt vmcnt(5)
    v_mfma_f32_16x16x32_bf16 v[24:27], v[82:85], a[124:127], v[24:27]
    v_mfma_f32_16x16x32_bf16 v[28:31], v[80:83], a[124:127], v[28:31]
    v_mfma_f32_16x16x32_bf16 v[24:27], v[82:85], a[128:131], v[24:27]
    v_mfma_f32_16x16x32_bf16 v[28:31], v[80:83], a[128:131], v[28:31]
    s_waitcnt vmcnt(3)
    v_mfma_f32_16x16x32_bf16 v[24:27], v[82:85], a[132:135], v[24:27]
    v_mfma_f32_16x16x32_bf16 v[28:31], v[80:83], a[132:135], v[28:31]
    v_mfma_f32_16x16x32_bf16 v[24:27], v[82:85], a[136:139], v[24:27]
    v_mfma_f32_16x16x32_bf16 v[28:31], v[80:83], a[136:139], v[28:31]
    s_waitcnt vmcnt(1)
    v_mfma_f32_16x16x32_bf16 v[24:27], v[82:85], a[140:143], v[24:27]
    v_mfma_f32_16x16x32_bf16 v[28:31], v[80:83], a[140:143], v[28:31]
    v_mfma_f32_16x16x32_bf16 v[24:27], v[82:85], a[144:147], v[24:27]
    v_mfma_f32_16x16x32_bf16 v[28:31], v[80:83], a[144:147], v[28:31]
    s_nop 6
    v_fma_f32 v56, v24, v40, v56
    v_fma_f32 v57, v25, v41, v57
    v_fma_f32 v58, v26, v42, v58
    v_fma_f32 v59, v27, v43, v59
    v_fma_f32 v60, v28, v44, v60
    v_fma_f32 v61, v29, v45, v61
    v_fma_f32 v62, v30, v46, v62
    v_fma_f32 v63, v31, v47, v63
    v_cvt_pk_bf16_f32 v92, v56, v57
    v_cvt_pk_bf16_f32 v93, v58, v59
    v_cvt_pk_bf16_f32 v94, v60, v61
    v_cvt_pk_bf16_f32 v95, v62, v63
    s_nop 0
    v_permlane32_swap_b32 v92, v94
    v_permlane32_swap_b32 v93, v95
    s_nop 0
    v_permlane16_swap_b32 v92, v94
    v_permlane16_swap_b32 v93, v95
    buffer_store_dwordx4 v[92:95], v11, s[20:23], 0 offen offset:64 sc1
done:
    s_endpgm
slow_t1:
    s_nop 15
    v_max_f32 v104, v48, v49
    v_max_f32 v105, v52, v53
    v_max3_f32 v104, v104, v50, v51
    v_max3_f32 v105, v105, v54, v55
    v_max3_f32 v104, v104, v56, v57
    v_max3_f32 v105, v105, v60, v61
    v_max3_f32 v104, v104, v58, v59
    v_max3_f32 v105, v105, v62, v63
    v_mov_b32 v106, v104
    v_mov_b32 v107, v105
    s_nop 0
    v_permlane32_swap_b32 v104, v106
    v_permlane32_swap_b32 v105, v107
    v_max_f32 v104, v104, v106
    v_max_f32 v105, v105, v107
    v_mov_b32 v106, v104
    v_mov_b32 v107, v105
    s_nop 0
    v_permlane16_swap_b32 v104, v106
    v_permlane16_swap_b32 v105, v107
    v_max3_f32 v104, v104, v106, 0
    v_max3_f32 v105, v105, v107, 0
    v_ceil_f32 v104, v104
    v_ceil_f32 v105, v105
    v_sub_f32 v106, 0, v104
    v_sub_f32 v107, 0, v105
    v_exp_f32 v106, v106
    v_exp_f32 v107, v107
    v_sub_f32 v96, v96, v104
    v_sub_f32 v97, v97, v104
    v_sub_f32 v98, v98, v104
    v_sub_f32 v99, v99, v104
    v_sub_f32 v100, v100, v105
    v_sub_f32 v101, v101, v105
    v_sub_f32 v102, v102, v105
    v_sub_f32 v103, v103, v105
    v_sub_f32 v80, v80, v104
    v_sub_f32 v81, v81, v104
    v_sub_f32 v82, v82, v104
    v_sub_f32 v83, v83, v104
    v_sub_f32 v84, v84, v105
    v_sub_f32 v85, v85, v105
    v_sub_f32 v86, v86, v105
    v_sub_f32 v87, v87, v105
    v_sub_f32 v88, v88, v104
    v_sub_f32 v89, v89, v104
    v_sub_f32 v90, v90, v104
    v_sub_f32 v91, v91, v104
    v_sub_f32 v48, v48, v104
    v_sub_f32 v49, v49, v104
    v_sub_f32 v50, v50, v104
    v_sub_f32 v51, v51, v104
    v_sub_f32 v52, v52, v105
    v_sub_f32 v53, v53, v105
    v_sub_f32 v54, v54, v105
    v_sub_f32 v55, v55, v105
    v_sub_f32 v56, v56, v104
    v_sub_f32 v57, v57, v104
    v_sub_f32 v58, v58, v104
    v_sub_f32 v59, v59, v104
    v_sub_f32 v60, v60, v105
    v_sub_f32 v61, v61, v105
    v_sub_f32 v62, v62, v105
    v_sub_f32 v63, v63, v105
    v_mul_f32 v116, v116, v106
    v_mul_f32 v117, v117, v107
    v_lshlrev_b32 v64, 16, v16
    v_and_b32 v65, 0xffff0000, v16
    v_mul_f32 v64, v64, v106
    v_mul_f32 v65, v65, v106
    v_cvt_pk_bf16_f32 v16, v64, v65
    v_lshlrev_b32 v64, 16, v17
    v_and_b32 v65, 0xffff0000, v17
    v_mul_f32 v64, v64, v106
    v_mul_f32 v65, v65, v106
    v_cvt_pk_bf16_f32 v17, v64, v65
    v_lshlrev_b32 v64, 16, v18
    v_and_b32 v65, 0xffff0000, v18
    v_mul_f32 v64, v64, v106
    v_mul_f32 v65, v65, v106
    v_cvt_pk_bf16_f32 v18, v64, v65
    v_lshlrev_b32 v64, 16, v19
    v_and_b32 v65, 0xffff0000, v19
    v_mul_f32 v64, v64, v106
    v_mul_f32 v65, v65, v106
    v_cvt_pk_bf16_f32 v19, v64, v65
    v_lshlrev_b32 v64, 16, v20
    v_and_b32 v65, 0xffff0000, v20
    v_mul_f32 v64, v64, v107
    v_mul_f32 v65, v65, v107
    v_cvt_pk_bf16_f32 v20, v64, v65
    v_lshlrev_b32 v64, 16, v21
    v_and_b32 v65, 0xffff0000, v21
    v_mul_f32 v64, v64, v107
    v_mul_f32 v65, v65, v107
    v_cvt_pk_bf16_f32 v21, v64, v65
    v_lshlrev_b32 v64, 16, v22
    v_and_b32 v65, 0xffff0000, v22
    v_mul_f32 v64, v64, v107
    v_mul_f32 v65, v65, v107
    v_cvt_pk_bf16_f32 v22, v64, v65
    v_lshlrev_b32 v64, 16, v23
    v_and_b32 v65, 0xffff0000, v23
    v_mul_f32 v64, v64, v107
    v_mul_f32 v65, v65, v107
    v_cvt_pk_bf16_f32 v23, v64, v65
    v_exp_f32 v64, v48
    v_exp_f32 v65, v49
    v_exp_f32 v66, v50
    v_exp_f32 v67, v51
    v_exp_f32 v68, v52
    v_exp_f32 v69, v53
    v_exp_f32 v70, v54
    v_exp_f32 v71, v55
    v_exp_f32 v72, v56
    v_exp_f32 v73, v57
    v_exp_f32 v74, v58
    v_exp_f32 v75, v59
    v_exp_f32 v76, v60
    v_exp_f32 v77, v61
    v_exp_f32 v78, v62
    v_exp_f32 v79, v63
    v_add_f32 v118, v64, v65
    v_add_f32 v118, v118, v66
    v_add_f32 v118, v118, v67
    v_add_f32 v119, v68, v69
    v_add_f32 v119, v119, v70
    v_add_f32 v119, v119, v71
    v_add_f32 v118, v118, v72
    v_add_f32 v118, v118, v73
    v_add_f32 v118, v118, v74
    v_add_f32 v118, v118, v75
    v_add_f32 v119, v119, v76
    v_add_f32 v119, v119, v77
    v_add_f32 v119, v119, v78
    v_add_f32 v119, v119, v79
    v_cvt_pk_bf16_f32 v24, v64, v65
    v_cvt_pk_bf16_f32 v25, v66, v67
    v_cvt_pk_bf16_f32 v28, v68, v69
    v_cvt_pk_bf16_f32 v29, v70, v71
    v_cvt_pk_bf16_f32 v26, v72, v73
    v_cvt_pk_bf16_f32 v27, v74, v75
    v_cvt_pk_bf16_f32 v30, v76, v77
    v_cvt_pk_bf16_f32 v31, v78, v79
    s_nop 1
    s_branch back_t1
slow_t3:
    s_nop 15
    v_max_f32 v104, v80, v81
    v_max_f32 v105, v84, v85
    v_max3_f32 v104, v104, v82, v83
    v_max3_f32 v105, v105, v86, v87
    v_max3_f32 v104, v104, v88, v89
    v_max3_f32 v105, v105, v92, v93
    v_max3_f32 v104, v104, v90, v91
    v_max3_f32 v105, v105, v94, v95
    v_max3_f32 v104, v104, v48, v49
    v_max3_f32 v105, v105, v52, v53
    v_max3_f32 v104, v104, v50, v51
    v_max3_f32 v105, v105, v54, v55
    v_max3_f32 v104, v104, v56, v57
    v_max3_f32 v105, v105, v60, v61
    v_max3_f32 v104, v104, v58, v59
    v_max3_f32 v105, v105, v62, v63
    v_mov_b32 v106, v104
    v_mov_b32 v107, v105
    s_nop 0
    v_permlane32_swap_b32 v104, v106
    v_permlane32_swap_b32 v105, v107
    v_max_f32 v104, v104, v106
    v_max_f32 v105, v105, v107
    v_mov_b32 v106, v104
    v_mov_b32 v107, v105
    s_nop 0
    v_permlane16_swap_b32 v104, v106
    v_permlane16_swap_b32 v105, v107
    v_max3_f32 v104, v104, v106, 0
    v_max3_f32 v105, v105, v107, 0
    v_ceil_f32 v104, v104
    v_ceil_f32 v105, v105
    v_sub_f32 v106, 0, v104
    v_sub_f32 v107, 0, v105
    v_exp_f32 v106, v106
    v_exp_f32 v107, v107
    v_sub_f32 v96, v96, v104
    v_sub_f32 v97, v97, v104
    v_sub_f32 v98, v98, v104
    v_sub_f32 v99, v99, v104
    v_sub_f32 v100, v100, v105
    v_sub_f32 v101, v101, v105
    v_sub_f32 v102, v102, v105
    v_sub_f32 v103, v103, v105
    v_sub_f32 v80, v80, v104
    v_sub_f32 v81, v81, v104
    v_sub_f32 v82, v82, v104
    v_sub_f32 v83, v83, v104
    v_sub_f32 v84, v84, v105
    v_sub_f32 v85, v85, v105
    v_sub_f32 v86, v86, v105
    v_sub_f32 v87, v87, v105
    v_sub_f32 v88, v88, v104
    v_sub_f32 v89, v89, v104
    v_sub_f32 v90, v90, v104
    v_sub_f32 v91, v91, v104
    v_sub_f32 v92, v92, v105
    v_sub_f32 v93, v93, v105
    v_sub_f32 v94, v94, v105
    v_sub_f32 v95, v95, v105
    v_sub_f32 v48, v48, v104
    v_sub_f32 v49, v49, v104
    v_sub_f32 v50, v50, v104
    v_sub_f32 v51, v51, v104
    v_sub_f32 v52, v52, v105
    v_sub_f32 v53, v53, v105
    v_sub_f32 v54, v54, v105
    v_sub_f32 v55, v55, v105
    v_sub_f32 v56, v56, v104
    v_sub_f32 v57, v57, v104
    v_sub_f32 v58, v58, v104
    v_sub_f32 v59, v59, v104
    v_sub_f32 v60, v60, v105
    v_sub_f32 v61, v61, v105
    v_sub_f32 v62, v62, v105
    v_sub_f32 v63, v63, v105
    v_mul_f32 v116, v116, v106
    v_mul_f32 v117, v117, v107
    v_mul_f32 v128, v128, v106
    v_mul_f32 v129, v129, v106
    v_mul_f32 v130, v130, v106
    v_mul_f32 v131, v131, v106
    v_mul_f32 v132, v132, v107
    v_mul_f32 v133, v133, v107
    v_mul_f32 v134, v134, v107
    v_mul_f32 v135, v135, v107
    v_mul_f32 v136, v136, v106
    v_mul_f32 v137, v137, v106
    v_mul_f32 v138, v138, v106
    v_mul_f32 v139, v139, v106
    v_mul_f32 v140, v140, v107
    v_mul_f32 v141, v141, v107
    v_mul_f32 v142, v142, v107
    v_mul_f32 v143, v143, v107
    v_mul_f32 v144, v144, v106
    v_mul_f32 v145, v145, v106
    v_mul_f32 v146, v146, v106
    v_mul_f32 v147, v147, v106
    v_mul_f32 v148, v148, v107
    v_mul_f32 v149, v149, v107
    v_mul_f32 v150, v150, v107
    v_mul_f32 v151, v151, v107
    v_mul_f32 v152, v152, v106
    v_mul_f32 v153, v153, v106
    v_mul_f32 v154, v154, v106
    v_mul_f32 v155, v155, v106
    v_mul_f32 v156, v156, v107
    v_mul_f32 v157, v157, v107
    v_mul_f32 v158, v158, v107
    v_mul_f32 v159, v159, v107
    v_mul_f32 v160, v160, v106
    v_mul_f32 v161, v161, v106
    v_mul_f32 v162, v162, v106
    v_mul_f32 v163, v163, v106
    v_mul_f32 v164, v164, v107
    v_mul_f32 v165, v165, v107
    v_mul_f32 v166, v166, v107
    v_mul_f32 v167, v167, v107
    v_mul_f32 v168, v168, v106
    v_mul_f32 v169, v169, v106
    v_mul_f32 v170, v170, v106
    v_mul_f32 v171, v171, v106
    v_mul_f32 v172, v172, v107
    v_mul_f32 v173, v173, v107
    v_mul_f32 v174, v174, v107
    v_mul_f32 v175, v175, v107
    v_mul_f32 v176, v176, v106
    v_mul_f32 v177, v177, v106
    v_mul_f32 v178, v178, v106
    v_mul_f32 v179, v179, v106
    v_mul_f32 v180, v180, v107
    v_mul_f32 v181, v181, v107
    v_mul_f32 v182, v182, v107
    v_mul_f32 v183, v183, v107
    v_mul_f32 v184, v184, v106
    v_mul_f32 v185, v185, v106
    v_mul_f32 v186, v186, v106
    v_mul_f32 v187, v187, v106
    v_mul_f32 v188, v188, v107
    v_mul_f32 v189, v189, v107
    v_mul_f32 v190, v190, v107
    v_mul_f32 v191, v191, v107
    v_mul_f32 v192, v192, v106
    v_mul_f32 v193, v193, v106
    v_mul_f32 v194, v194, v106
    v_mul_f32 v195, v195, v106
    v_mul_f32 v196, v196, v107
    v_mul_f32 v197, v197, v107
    v_mul_f32 v198, v198, v107
    v_mul_f32 v199, v199, v107
    v_mul_f32 v200, v200, v106
    v_mul_f32 v201, v201, v106
    v_mul_f32 v202, v202, v106
    v_mul_f32 v203, v203, v106
    v_mul_f32 v204, v204, v107
    v_mul_f32 v205, v205, v107
    v_mul_f32 v206, v206, v107
    v_mul_f32 v207, v207, v107
    v_mul_f32 v208, v208, v106
    v_mul_f32 v209, v209, v106
    v_mul_f32 v210, v210, v106
    v_mul_f32 v211, v211, v106
    v_mul_f32 v212, v212, v107
    v_mul_f32 v213, v213, v107
    v_mul_f32 v214, v214, v107
    v_mul_f32 v215, v215, v107
    v_mul_f32 v216, v216, v106
    v_mul_f32 v217, v217, v106
    v_mul_f32 v218, v218, v106
    v_mul_f32 v219, v219, v106
    v_mul_f32 v220, v220, v107
    v_mul_f32 v221, v221, v107
    v_mul_f32 v222, v222, v107
    v_mul_f32 v223, v223, v107
    v_mul_f32 v224, v224, v106
    v_mul_f32 v225, v225, v106
    v_mul_f32 v226, v226, v106
    v_mul_f32 v227, v227, v106
    v_mul_f32 v228, v228, v107
    v_mul_f32 v229, v229, v107
    v_mul_f32 v230, v230, v107
    v_mul_f32 v231, v231, v107
    v_mul_f32 v232, v232, v106
    v_mul_f32 v233, v233, v106
    v_mul_f32 v234, v234, v106
    v_mul_f32 v235, v235, v106
    v_mul_f32 v236, v236, v107
    v_mul_f32 v237, v237, v107
    v_mul_f32 v238, v238, v107
    v_mul_f32 v239, v239, v107
    v_mul_f32 v240, v240, v106
    v_mul_f32 v241, v241, v106
    v_mul_f32 v242, v242, v106
    v_mul_f32 v243, v243, v106
    v_mul_f32 v244, v244, v107
    v_mul_f32 v245, v245, v107
    v_mul_f32 v246, v246, v107
    v_mul_f32 v247, v247, v107
    v_mul_f32 v248, v248, v106
    v_mul_f32 v249, v249, v106
    v_mul_f32 v250, v250, v106
    v_mul_f32 v251, v251, v106
    v_mul_f32 v252, v252, v107
    v_mul_f32 v253, v253, v107
    v_mul_f32 v254, v254, v107
    v_mul_f32 v255, v255, v107
    v_exp_f32 v64, v80
    v_exp_f32 v65, v81
    v_exp_f32 v66, v82
    v_exp_f32 v67, v83
    v_exp_f32 v68, v84
    v_exp_f32 v69, v85
    v_exp_f32 v70, v86
    v_exp_f32 v71, v87
    v_exp_f32 v72, v88
    v_exp_f32 v73, v89
    v_exp_f32 v74, v90
    v_exp_f32 v75, v91
    v_exp_f32 v76, v92
    v_exp_f32 v77, v93
    v_exp_f32 v78, v94
    v_exp_f32 v79, v95
    v_add_f32 v118, v64, v65
    v_add_f32 v118, v118, v66
    v_add_f32 v118, v118, v67
    v_add_f32 v119, v68, v69
    v_add_f32 v119, v119, v70
    v_add_f32 v119, v119, v71
    v_add_f32 v118, v118, v72
    v_add_f32 v118, v118, v73
    v_add_f32 v118, v118, v74
    v_add_f32 v118, v118, v75
    v_add_f32 v119, v119, v76
    v_add_f32 v119, v119, v77
    v_add_f32 v119, v119, v78
    v_add_f32 v119, v119, v79
    v_cvt_pk_bf16_f32 v32, v64, v65
    v_cvt_pk_bf16_f32 v33, v66, v67
    v_cvt_pk_bf16_f32 v36, v68, v69
    v_cvt_pk_bf16_f32 v37, v70, v71
    v_cvt_pk_bf16_f32 v34, v72, v73
    v_cvt_pk_bf16_f32 v35, v74, v75
    v_cvt_pk_bf16_f32 v38, v76, v77
    v_cvt_pk_bf16_f32 v39, v78, v79
    v_exp_f32 v64, v48
    v_exp_f32 v65, v49
    v_exp_f32 v66, v50
    v_exp_f32 v67, v51
    v_exp_f32 v68, v52
    v_exp_f32 v69, v53
    v_exp_f32 v70, v54
    v_exp_f32 v71, v55
    v_exp_f32 v72, v56
    v_exp_f32 v73, v57
    v_exp_f32 v74, v58
    v_exp_f32 v75, v59
    v_exp_f32 v76, v60
    v_exp_f32 v77, v61
    v_exp_f32 v78, v62
    v_exp_f32 v79, v63
    v_add_f32 v118, v118, v64
    v_add_f32 v118, v118, v65
    v_add_f32 v118, v118, v66
    v_add_f32 v118, v118, v67
    v_add_f32 v119, v119, v68
    v_add_f32 v119, v119, v69
    v_add_f32 v119, v119, v70
    v_add_f32 v119, v119, v71
    v_add_f32 v118, v118, v72
    v_add_f32 v118, v118, v73
    v_add_f32 v118, v118, v74
    v_add_f32 v118, v118, v75
    v_add_f32 v119, v119, v76
    v_add_f32 v119, v119, v77
    v_add_f32 v119, v119, v78
    v_add_f32 v119, v119, v79
    s_nop 1
    s_branch back_t3
slow_t5:
    s_nop 15
    v_max_f32 v104, v80, v81
    v_max_f32 v105, v84, v85
    v_max3_f32 v104, v104, v82, v83
    v_max3_f32 v105, v105, v86, v87
    v_max3_f32 v104, v104, v88, v89
    v_max3_f32 v105, v105, v92, v93
    v_max3_f32 v104, v104, v90, v91
    v_max3_f32 v105, v105, v94, v95
    v_max3_f32 v104, v104, v48, v49
    v_max3_f32 v105, v105, v52, v53
    v_max3_f32 v104, v104, v50, v51
    v_max3_f32 v105, v105, v54, v55
    v_max3_f32 v104, v104, v56, v57
    v_max3_f32 v105, v105, v60, v61
    v_max3_f32 v104, v104, v58, v59
    v_max3_f32 v105, v105, v62, v63
    v_mov_b32 v106, v104
    v_mov_b32 v107, v105
    s_nop 0
    v_permlane32_swap_b32 v104, v106
    v_permlane32_swap_b32 v105, v107
    v_max_f32 v104, v104, v106
    v_max_f32 v105, v105, v107
    v_mov_b32 v106, v104
    v_mov_b32 v107, v105
    s_nop 0
    v_permlane16_swap_b32 v104, v106
    v_permlane16_swap_b32 v105, v107
    v_max3_f32 v104, v104, v106, 0
    v_max3_f32 v105, v105, v107, 0
    v_ceil_f32 v104, v104
    v_ceil_f32 v105, v105
    v_sub_f32 v106, 0, v104
    v_sub_f32 v107, 0, v105
    v_exp_f32 v106, v106
    v_exp_f32 v107, v107
    v_sub_f32 v96, v96, v104
    v_sub_f32 v97, v97, v104
    v_sub_f32 v98, v98, v104
    v_sub_f32 v99, v99, v104
    v_sub_f32 v100, v100, v105
    v_sub_f32 v101, v101, v105
    v_sub_f32 v102, v102, v105
    v_sub_f32 v103, v103, v105
    v_sub_f32 v80, v80, v104
    v_sub_f32 v81, v81, v104
    v_sub_f32 v82, v82, v104
    v_sub_f32 v83, v83, v104
    v_sub_f32 v84, v84, v105
    v_sub_f32 v85, v85, v105
    v_sub_f32 v86, v86, v105
    v_sub_f32 v87, v87, v105
    v_sub_f32 v88, v88, v104
    v_sub_f32 v89, v89, v104
    v_sub_f32 v90, v90, v104
    v_sub_f32 v91, v91, v104
    v_sub_f32 v92, v92, v105
    v_sub_f32 v93, v93, v105
    v_sub_f32 v94, v94, v105
    v_sub_f32 v95, v95, v105
    v_sub_f32 v48, v48, v104
    v_sub_f32 v49, v49, v104
    v_sub_f32 v50, v50, v104
    v_sub_f32 v51, v51, v104
    v_sub_f32 v52, v52, v105
    v_sub_f32 v53, v53, v105
    v_sub_f32 v54, v54, v105
    v_sub_f32 v55, v55, v105
    v_sub_f32 v56, v56, v104
    v_sub_f32 v57, v57, v104
    v_sub_f32 v58, v58, v104
    v_sub_f32 v59, v59, v104
    v_sub_f32 v60, v60, v105
    v_sub_f32 v61, v61, v105
    v_sub_f32 v62, v62, v105
    v_sub_f32 v63, v63, v105
    v_mul_f32 v116, v116, v106
    v_mul_f32 v117, v117, v107
    v_mul_f32 v128, v128, v106
    v_mul_f32 v129, v129, v106
    v_mul_f32 v130, v130, v106
    v_mul_f32 v131, v131, v106
    v_mul_f32 v132, v132, v107
    v_mul_f32 v133, v133, v107
    v_mul_f32 v134, v134, v107
    v_mul_f32 v135, v135, v107
    v_mul_f32 v136, v136, v106
    v_mul_f32 v137, v137, v106
    v_mul_f32 v138, v138, v106
    v_mul_f32 v139, v139, v106
    v_mul_f32 v140, v140, v107
    v_mul_f32 v141, v141, v107
    v_mul_f32 v142, v142, v107
    v_mul_f32 v143, v143, v107
    v_mul_f32 v144, v144, v106
    v_mul_f32 v145, v145, v106
    v_mul_f32 v146, v146, v106
    v_mul_f32 v147, v147, v106
    v_mul_f32 v148, v148, v107
    v_mul_f32 v149, v149, v107
    v_mul_f32 v150, v150, v107
    v_mul_f32 v151, v151, v107
    v_mul_f32 v152, v152, v106
    v_mul_f32 v153, v153, v106
    v_mul_f32 v154, v154, v106
    v_mul_f32 v155, v155, v106
    v_mul_f32 v156, v156, v107
    v_mul_f32 v157, v157, v107
    v_mul_f32 v158, v158, v107
    v_mul_f32 v159, v159, v107
    v_mul_f32 v160, v160, v106
    v_mul_f32 v161, v161, v106
    v_mul_f32 v162, v162, v106
    v_mul_f32 v163, v163, v106
    v_mul_f32 v164, v164, v107
    v_mul_f32 v165, v165, v107
    v_mul_f32 v166, v166, v107
    v_mul_f32 v167, v167, v107
    v_mul_f32 v168, v168, v106
    v_mul_f32 v169, v169, v106
    v_mul_f32 v170, v170, v106
    v_mul_f32 v171, v171, v106
    v_mul_f32 v172, v172, v107
    v_mul_f32 v173, v173, v107
    v_mul_f32 v174, v174, v107
    v_mul_f32 v175, v175, v107
    v_mul_f32 v176, v176, v106
    v_mul_f32 v177, v177, v106
    v_mul_f32 v178, v178, v106
    v_mul_f32 v179, v179, v106
    v_mul_f32 v180, v180, v107
    v_mul_f32 v181, v181, v107
    v_mul_f32 v182, v182, v107
    v_mul_f32 v183, v183, v107
    v_mul_f32 v184, v184, v106
    v_mul_f32 v185, v185, v106
    v_mul_f32 v186, v186, v106
    v_mul_f32 v187, v187, v106
    v_mul_f32 v188, v188, v107
    v_mul_f32 v189, v189, v107
    v_mul_f32 v190, v190, v107
    v_mul_f32 v191, v191, v107
    v_mul_f32 v192, v192, v106
    v_mul_f32 v193, v193, v106
    v_mul_f32 v194, v194, v106
    v_mul_f32 v195, v195, v106
    v_mul_f32 v196, v196, v107
    v_mul_f32 v197, v197, v107
    v_mul_f32 v198, v198, v107
    v_mul_f32 v199, v199, v107
    v_mul_f32 v200, v200, v106
    v_mul_f32 v201, v201, v106
    v_mul_f32 v202, v202, v106
    v_mul_f32 v203, v203, v106
    v_mul_f32 v204, v204, v107
    v_mul_f32 v205, v205, v107
    v_mul_f32 v206, v206, v107
    v_mul_f32 v207, v207, v107
    v_mul_f32 v208, v208, v106
    v_mul_f32 v209, v209, v106
    v_mul_f32 v210, v210, v106
    v_mul_f32 v211, v211, v106
    v_mul_f32 v212, v212, v107
    v_mul_f32 v213, v213, v107
    v_mul_f32 v214, v214, v107
    v_mul_f32 v215, v215, v107
    v_mul_f32 v216, v216, v106
    v_mul_f32 v217, v217, v106
    v_mul_f32 v218, v218, v106
    v_mul_f32 v219, v219, v106
    v_mul_f32 v220, v220, v107
    v_mul_f32 v221, v221, v107
    v_mul_f32 v222, v222, v107
    v_mul_f32 v223, v223, v107
    v_mul_f32 v224, v224, v106
    v_mul_f32 v225, v225, v106
    v_mul_f32 v226, v226, v106
    v_mul_f32 v227, v227, v106
    v_mul_f32 v228, v228, v107
    v_mul_f32 v229, v229, v107
    v_mul_f32 v230, v230, v107
    v_mul_f32 v231, v231, v107
    v_mul_f32 v232, v232, v106
    v_mul_f32 v233, v233, v106
    v_mul_f32 v234, v234, v106
    v_mul_f32 v235, v235, v106
    v_mul_f32 v236, v236, v107
    v_mul_f32 v237, v237, v107
    v_mul_f32 v238, v238, v107
    v_mul_f32 v239, v239, v107
    v_mul_f32 v240, v240, v106
    v_mul_f32 v241, v241, v106
    v_mul_f32 v242, v242, v106
    v_mul_f32 v243, v243, v106
    v_mul_f32 v244, v244, v107
    v_mul_f32 v245, v245, v107
    v_mul_f32 v246, v246, v107
    v_mul_f32 v247, v247, v107
    v_mul_f32 v248, v248, v106
    v_mul_f32 v249, v249, v106
    v_mul_f32 v250, v250, v106
    v_mul_f32 v251, v251, v106
    v_mul_f32 v252, v252, v107
    v_mul_f32 v253, v253, v107
    v_mul_f32 v254, v254, v107
    v_mul_f32 v255, v255, v107
    v_exp_f32 v64, v80
    v_exp_f32 v65, v81
    v_exp_f32 v66, v82
    v_exp_f32 v67, v83
    v_exp_f32 v68, v84
    v_exp_f32 v69, v85
    v_exp_f32 v70, v86
    v_exp_f32 v71, v87
    v_exp_f32 v72, v88
    v_exp_f32 v73, v89
    v_exp_f32 v74, v90
    v_exp_f32 v75, v91
    v_exp_f32 v76, v92
    v_exp_f32 v77, v93
    v_exp_f32 v78, v94
    v_exp_f32 v79, v95
    v_add_f32 v118, v64, v65
    v_add_f32 v118, v118, v66
    v_add_f32 v118, v118, v67
    v_add_f32 v119, v68, v69
    v_add_f32 v119, v119, v70
    v_add_f32 v119, v119, v71
    v_add_f32 v118, v118, v72
    v_add_f32 v118, v118, v73
    v_add_f32 v118, v118, v74
    v_add_f32 v118, v118, v75
    v_add_f32 v119, v119, v76
    v_add_f32 v119, v119, v77
    v_add_f32 v119, v119, v78
    v_add_f32 v119, v119, v79
    v_cvt_pk_bf16_f32 v16, v64, v65
    v_cvt_pk_bf16_f32 v17, v66, v67
    v_cvt_pk_bf16_f32 v20, v68, v69
    v_cvt_pk_bf16_f32 v21, v70, v71
    v_cvt_pk_bf16_f32 v18, v72, v73
    v_cvt_pk_bf16_f32 v19, v74, v75
    v_cvt_pk_bf16_f32 v22, v76, v77
    v_cvt_pk_bf16_f32 v23, v78, v79
    v_exp_f32 v64, v48
    v_exp_f32 v65, v49
    v_exp_f32 v66, v50
    v_exp_f32 v67, v51
    v_exp_f32 v68, v52
    v_exp_f32 v69, v53
    v_exp_f32 v70, v54
    v_exp_f32 v71, v55
    v_exp_f32 v72, v56
    v_exp_f32 v73, v57
    v_exp_f32 v74, v58
    v_exp_f32 v75, v59
    v_exp_f32 v76, v60
    v_exp_f32 v77, v61
    v_exp_f32 v78, v62
    v_exp_f32 v79, v63
    v_add_f32 v118, v118, v64
    v_add_f32 v118, v118, v65
    v_add_f32 v118, v118, v66
    v_add_f32 v118, v118, v67
    v_add_f32 v119, v119, v68
    v_add_f32 v119, v119, v69
    v_add_f32 v119, v119, v70
    v_add_f32 v119, v119, v71
    v_add_f32 v118, v118, v72
    v_add_f32 v118, v118, v73
    v_add_f32 v118, v118, v74
    v_add_f32 v118, v118, v75
    v_add_f32 v119, v119, v76
    v_add_f32 v119, v119, v77
    v_add_f32 v119, v119, v78
    v_add_f32 v119, v119, v79
    s_nop 1
    s_branch back_t5
slow_t7:
    s_nop 15
    v_max_f32 v104, v80, v81
    v_max_f32 v105, v84, v85
    v_max3_f32 v104, v104, v82, v83
    v_max3_f32 v105, v105, v86, v87
    v_max3_f32 v104, v104, v88, v89
    v_max3_f32 v105, v105, v92, v93
    v_max3_f32 v104, v104, v90, v91
    v_max3_f32 v105, v105, v94, v95
    v_max3_f32 v104, v104, v48, v49
    v_max3_f32 v105, v105, v52, v53
    v_max3_f32 v104, v104, v50, v51
    v_max3_f32 v105, v105, v54, v55
    v_max3_f32 v104, v104, v56, v57
    v_max3_f32 v105, v105, v60, v61
    v_max3_f32 v104, v104, v58, v59
    v_max3_f32 v105, v105, v62, v63
    v_mov_b32 v106, v104
    v_mov_b32 v107, v105
    s_nop 0
    v_permlane32_swap_b32 v104, v106
    v_permlane32_swap_b32 v105, v107
    v_max_f32 v104, v104, v106
    v_max_f32 v105, v105, v107
    v_mov_b32 v106, v104
    v_mov_b32 v107, v105
    s_nop 0
    v_permlane16_swap_b32 v104, v106
    v_permlane16_swap_b32 v105, v107
    v_max3_f32 v104, v104, v106, 0
    v_max3_f32 v105, v105, v107, 0
    v_ceil_f32 v104, v104
    v_ceil_f32 v105, v105
    v_sub_f32 v106, 0, v104
    v_sub_f32 v107, 0, v105
    v_exp_f32 v106, v106
    v_exp_f32 v107, v107
    v_sub_f32 v96, v96, v104
    v_sub_f32 v97, v97, v104
    v_sub_f32 v98, v98, v104
    v_sub_f32 v99, v99, v104
    v_sub_f32 v100, v100, v105
    v_sub_f32 v101, v101, v105
    v_sub_f32 v102, v102, v105
    v_sub_f32 v103, v103, v105
    v_sub_f32 v80, v80, v104
    v_sub_f32 v81, v81, v104
    v_sub_f32 v82, v82, v104
    v_sub_f32 v83, v83, v104
    v_sub_f32 v84, v84, v105
    v_sub_f32 v85, v85, v105
    v_sub_f32 v86, v86, v105
    v_sub_f32 v87, v87, v105
    v_sub_f32 v88, v88, v104
    v_sub_f32 v89, v89, v104
    v_sub_f32 v90, v90, v104
    v_sub_f32 v91, v91, v104
    v_sub_f32 v92, v92, v105
    v_sub_f32 v93, v93, v105
    v_sub_f32 v94, v94, v105
    v_sub_f32 v95, v95, v105
    v_sub_f32 v48, v48, v104
    v_sub_f32 v49, v49, v104
    v_sub_f32 v50, v50, v104
    v_sub_f32 v51, v51, v104
    v_sub_f32 v52, v52, v105
    v_sub_f32 v53, v53, v105
    v_sub_f32 v54, v54, v105
    v_sub_f32 v55, v55, v105
    v_sub_f32 v56, v56, v104
    v_sub_f32 v57, v57, v104
    v_sub_f32 v58, v58, v104
    v_sub_f32 v59, v59, v104
    v_sub_f32 v60, v60, v105
    v_sub_f32 v61, v61, v105
    v_sub_f32 v62, v62, v105
    v_sub_f32 v63, v63, v105
    v_mul_f32 v116, v116, v106
    v_mul_f32 v117, v117, v107
    v_mul_f32 v128, v128, v106
    v_mul_f32 v129, v129, v106
    v_mul_f32 v130, v130, v106
    v_mul_f32 v131, v131, v106
    v_mul_f32 v132, v132, v107
    v_mul_f32 v133, v133, v107
    v_mul_f32 v134, v134, v107
    v_mul_f32 v135, v135, v107
    v_mul_f32 v136, v136, v106
    v_mul_f32 v137, v137, v106
    v_mul_f32 v138, v138, v106
    v_mul_f32 v139, v139, v106
    v_mul_f32 v140, v140, v107
    v_mul_f32 v141, v141, v107
    v_mul_f32 v142, v142, v107
    v_mul_f32 v143, v143, v107
    v_mul_f32 v144, v144, v106
    v_mul_f32 v145, v145, v106
    v_mul_f32 v146, v146, v106
    v_mul_f32 v147, v147, v106
    v_mul_f32 v148, v148, v107
    v_mul_f32 v149, v149, v107
    v_mul_f32 v150, v150, v107
    v_mul_f32 v151, v151, v107
    v_mul_f32 v152, v152, v106
    v_mul_f32 v153, v153, v106
    v_mul_f32 v154, v154, v106
    v_mul_f32 v155, v155, v106
    v_mul_f32 v156, v156, v107
    v_mul_f32 v157, v157, v107
    v_mul_f32 v158, v158, v107
    v_mul_f32 v159, v159, v107
    v_mul_f32 v160, v160, v106
    v_mul_f32 v161, v161, v106
    v_mul_f32 v162, v162, v106
    v_mul_f32 v163, v163, v106
    v_mul_f32 v164, v164, v107
    v_mul_f32 v165, v165, v107
    v_mul_f32 v166, v166, v107
    v_mul_f32 v167, v167, v107
    v_mul_f32 v168, v168, v106
    v_mul_f32 v169, v169, v106
    v_mul_f32 v170, v170, v106
    v_mul_f32 v171, v171, v106
    v_mul_f32 v172, v172, v107
    v_mul_f32 v173, v173, v107
    v_mul_f32 v174, v174, v107
    v_mul_f32 v175, v175, v107
    v_mul_f32 v176, v176, v106
    v_mul_f32 v177, v177, v106
    v_mul_f32 v178, v178, v106
    v_mul_f32 v179, v179, v106
    v_mul_f32 v180, v180, v107
    v_mul_f32 v181, v181, v107
    v_mul_f32 v182, v182, v107
    v_mul_f32 v183, v183, v107
    v_mul_f32 v184, v184, v106
    v_mul_f32 v185, v185, v106
    v_mul_f32 v186, v186, v106
    v_mul_f32 v187, v187, v106
    v_mul_f32 v188, v188, v107
    v_mul_f32 v189, v189, v107
    v_mul_f32 v190, v190, v107
    v_mul_f32 v191, v191, v107
    v_mul_f32 v192, v192, v106
    v_mul_f32 v193, v193, v106
    v_mul_f32 v194, v194, v106
    v_mul_f32 v195, v195, v106
    v_mul_f32 v196, v196, v107
    v_mul_f32 v197, v197, v107
    v_mul_f32 v198, v198, v107
    v_mul_f32 v199, v199, v107
    v_mul_f32 v200, v200, v106
    v_mul_f32 v201, v201, v106
    v_mul_f32 v202, v202, v106
    v_mul_f32 v203, v203, v106
    v_mul_f32 v204, v204, v107
    v_mul_f32 v205, v205, v107
    v_mul_f32 v206, v206, v107
    v_mul_f32 v207, v207, v107
    v_mul_f32 v208, v208, v106
    v_mul_f32 v209, v209, v106
    v_mul_f32 v210, v210, v106
    v_mul_f32 v211, v211, v106
    v_mul_f32 v212, v212, v107
    v_mul_f32 v213, v213, v107
    v_mul_f32 v214, v214, v107
    v_mul_f32 v215, v215, v107
    v_mul_f32 v216, v216, v106
    v_mul_f32 v217, v217, v106
    v_mul_f32 v218, v218, v106
    v_mul_f32 v219, v219, v106
    v_mul_f32 v220, v220, v107
    v_mul_f32 v221, v221, v107
    v_mul_f32 v222, v222, v107
    v_mul_f32 v223, v223, v107
    v_mul_f32 v224, v224, v106
    v_mul_f32 v225, v225, v106
    v_mul_f32 v226, v226, v106
    v_mul_f32 v227, v227, v106
    v_mul_f32 v228, v228, v107
    v_mul_f32 v229, v229, v107
    v_mul_f32 v230, v230, v107
    v_mul_f32 v231, v231, v107
    v_mul_f32 v232, v232, v106
    v_mul_f32 v233, v233, v106
    v_mul_f32 v234, v234, v106
    v_mul_f32 v235, v235, v106
    v_mul_f32 v236, v236, v107
    v_mul_f32 v237, v237, v107
    v_mul_f32 v238, v238, v107
    v_mul_f32 v239, v239, v107
    v_mul_f32 v240, v240, v106
    v_mul_f32 v241, v241, v106
    v_mul_f32 v242, v242, v106
    v_mul_f32 v243, v243, v106
    v_mul_f32 v244, v244, v107
    v_mul_f32 v245, v245, v107
    v_mul_f32 v246, v246, v107
    v_mul_f32 v247, v247, v107
    v_mul_f32 v248, v248, v106
    v_mul_f32 v249, v249, v106
    v_mul_f32 v250, v250, v106
    v_mul_f32 v251, v251, v106
    v_mul_f32 v252, v252, v107
    v_mul_f32 v253, v253, v107
    v_mul_f32 v254, v254, v107
    v_mul_f32 v255, v255, v107
    v_exp_f32 v64, v80
    v_exp_f32 v65, v81
    v_exp_f32 v66, v82
    v_exp_f32 v67, v83
    v_exp_f32 v68, v84
    v_exp_f32 v69, v85
    v_exp_f32 v70, v86
    v_exp_f32 v71, v87
    v_exp_f32 v72, v88
    v_exp_f32 v73, v89
    v_exp_f32 v74, v90
    v_exp_f32 v75, v91
    v_exp_f32 v76, v92
    v_exp_f32 v77, v93
    v_exp_f32 v78, v94
    v_exp_f32 v79, v95
    v_add_f32 v118, v64, v65
    v_add_f32 v118, v118, v66
    v_add_f32 v118, v118, v67
    v_add_f32 v119, v68, v69
    v_add_f32 v119, v119, v70
    v_add_f32 v119, v119, v71
    v_add_f32 v118, v118, v72
    v_add_f32 v118, v118, v73
    v_add_f32 v118, v118, v74
    v_add_f32 v118, v118, v75
    v_add_f32 v119, v119, v76
    v_add_f32 v119, v119, v77
    v_add_f32 v119, v119, v78
    v_add_f32 v119, v119, v79
    v_cvt_pk_bf16_f32 v32, v64, v65
    v_cvt_pk_bf16_f32 v33, v66, v67
    v_cvt_pk_bf16_f32 v36, v68, v69
    v_cvt_pk_bf16_f32 v37, v70, v71
    v_cvt_pk_bf16_f32 v34, v72, v73
    v_cvt_pk_bf16_f32 v35, v74, v75
    v_cvt_pk_bf16_f32 v38, v76, v77
    v_cvt_pk_bf16_f32 v39, v78, v79
    v_exp_f32 v64, v48
    v_exp_f32 v65, v49
    v_exp_f32 v66, v50
    v_exp_f32 v67, v51
    v_exp_f32 v68, v52
    v_exp_f32 v69, v53
    v_exp_f32 v70, v54
    v_exp_f32 v71, v55
    v_exp_f32 v72, v56
    v_exp_f32 v73, v57
    v_exp_f32 v74, v58
    v_exp_f32 v75, v59
    v_exp_f32 v76, v60
    v_exp_f32 v77, v61
    v_exp_f32 v78, v62
    v_exp_f32 v79, v63
    v_add_f32 v118, v118, v64
    v_add_f32 v118, v118, v65
    v_add_f32 v118, v118, v66
    v_add_f32 v118, v118, v67
    v_add_f32 v119, v119, v68
    v_add_f32 v119, v119, v69
    v_add_f32 v119, v119, v70
    v_add_f32 v119, v119, v71
    v_add_f32 v118, v118, v72
    v_add_f32 v118, v118, v73
    v_add_f32 v118, v118, v74
    v_add_f32 v118, v118, v75
    v_add_f32 v119, v119, v76
    v_add_f32 v119, v119, v77
    v_add_f32 v119, v119, v78
    v_add_f32 v119, v119, v79
    s_nop 1
    s_branch back_t7
slow_l01:
    s_nop 15
    v_max_f32 v104, v80, v81
    v_max_f32 v105, v84, v85
    v_max3_f32 v104, v104, v82, v83
    v_max3_f32 v105, v105, v86, v87
    v_max3_f32 v104, v104, v88, v89
    v_max3_f32 v105, v105, v92, v93
    v_max3_f32 v104, v104, v90, v91
    v_max3_f32 v105, v105, v94, v95
    v_max3_f32 v104, v104, v48, v49
    v_max3_f32 v105, v105, v52, v53
    v_max3_f32 v104, v104, v50, v51
    v_max3_f32 v105, v105, v54, v55
    v_max3_f32 v104, v104, v56, v57
    v_max3_f32 v105, v105, v60, v61
    v_max3_f32 v104, v104, v58, v59
    v_max3_f32 v105, v105, v62, v63
    v_mov_b32 v106, v104
    v_mov_b32 v107, v105
    s_nop 0
    v_permlane32_swap_b32 v104, v106
    v_permlane32_swap_b32 v105, v107
    v_max_f32 v104, v104, v106
    v_max_f32 v105, v105, v107
    v_mov_b32 v106, v104
    v_mov_b32 v107, v105
    s_nop 0
    v_permlane16_swap_b32 v104, v106
    v_permlane16_swap_b32 v105, v107
    v_max3_f32 v104, v104, v106, 0
    v_max3_f32 v105, v105, v107, 0
    v_ceil_f32 v104, v104
    v_ceil_f32 v105, v105
    v_sub_f32 v106, 0, v104
    v_sub_f32 v107, 0, v105
    v_exp_f32 v106, v106
    v_exp_f32 v107, v107
    v_sub_f32 v96, v96, v104
    v_sub_f32 v97, v97, v104
    v_sub_f32 v98, v98, v104
    v_sub_f32 v99, v99, v104
    v_sub_f32 v100, v100, v105
    v_sub_f32 v101, v101, v105
    v_sub_f32 v102, v102, v105
    v_sub_f32 v103, v103, v105
    v_sub_f32 v80, v80, v104
    v_sub_f32 v81, v81, v104
    v_sub_f32 v82, v82, v104
    v_sub_f32 v83, v83, v104
    v_sub_f32 v84, v84, v105
    v_sub_f32 v85, v85, v105
    v_sub_f32 v86, v86, v105
    v_sub_f32 v87, v87, v105
    v_sub_f32 v88, v88, v104
    v_sub_f32 v89, v89, v104
    v_sub_f32 v90, v90, v104
    v_sub_f32 v91, v91, v104
    v_sub_f32 v92, v92, v105
    v_sub_f32 v93, v93, v105
    v_sub_f32 v94, v94, v105
    v_sub_f32 v95, v95, v105
    v_sub_f32 v48, v48, v104
    v_sub_f32 v49, v49, v104
    v_sub_f32 v50, v50, v104
    v_sub_f32 v51, v51, v104
    v_sub_f32 v52, v52, v105
    v_sub_f32 v53, v53, v105
    v_sub_f32 v54, v54, v105
    v_sub_f32 v55, v55, v105
    v_sub_f32 v56, v56, v104
    v_sub_f32 v57, v57, v104
    v_sub_f32 v58, v58, v104
    v_sub_f32 v59, v59, v104
    v_sub_f32 v60, v60, v105
    v_sub_f32 v61, v61, v105
    v_sub_f32 v62, v62, v105
    v_sub_f32 v63, v63, v105
    v_mul_f32 v116, v116, v106
    v_mul_f32 v117, v117, v107
    v_mul_f32 v128, v128, v106
    v_mul_f32 v129, v129, v106
    v_mul_f32 v130, v130, v106
    v_mul_f32 v131, v131, v106
    v_mul_f32 v132, v132, v107
    v_mul_f32 v133, v133, v107
    v_mul_f32 v134, v134, v107
    v_mul_f32 v135, v135, v107
    v_mul_f32 v136, v136, v106
    v_mul_f32 v137, v137, v106
    v_mul_f32 v138, v138, v106
    v_mul_f32 v139, v139, v106
    v_mul_f32 v140, v140, v107
    v_mul_f32 v141, v141, v107
    v_mul_f32 v142, v142, v107
    v_mul_f32 v143, v143, v107
    v_mul_f32 v144, v144, v106
    v_mul_f32 v145, v145, v106
    v_mul_f32 v146, v146, v106
    v_mul_f32 v147, v147, v106
    v_mul_f32 v148, v148, v107
    v_mul_f32 v149, v149, v107
    v_mul_f32 v150, v150, v107
    v_mul_f32 v151, v151, v107
    v_mul_f32 v152, v152, v106
    v_mul_f32 v153, v153, v106
    v_mul_f32 v154, v154, v106
    v_mul_f32 v155, v155, v106
    v_mul_f32 v156, v156, v107
    v_mul_f32 v157, v157, v107
    v_mul_f32 v158, v158, v107
    v_mul_f32 v159, v159, v107
    v_mul_f32 v160, v160, v106
    v_mul_f32 v161, v161, v106
    v_mul_f32 v162, v162, v106
    v_mul_f32 v163, v163, v106
    v_mul_f32 v164, v164, v107
    v_mul_f32 v165, v165, v107
    v_mul_f32 v166, v166, v107
    v_mul_f32 v167, v167, v107
    v_mul_f32 v168, v168, v106
    v_mul_f32 v169, v169, v106
    v_mul_f32 v170, v170, v106
    v_mul_f32 v171, v171, v106
    v_mul_f32 v172, v172, v107
    v_mul_f32 v173, v173, v107
    v_mul_f32 v174, v174, v107
    v_mul_f32 v175, v175, v107
    v_mul_f32 v176, v176, v106
    v_mul_f32 v177, v177, v106
    v_mul_f32 v178, v178, v106
    v_mul_f32 v179, v179, v106
    v_mul_f32 v180, v180, v107
    v_mul_f32 v181, v181, v107
    v_mul_f32 v182, v182, v107
    v_mul_f32 v183, v183, v107
    v_mul_f32 v184, v184, v106
    v_mul_f32 v185, v185, v106
    v_mul_f32 v186, v186, v106
    v_mul_f32 v187, v187, v106
    v_mul_f32 v188, v188, v107
    v_mul_f32 v189, v189, v107
    v_mul_f32 v190, v190, v107
    v_mul_f32 v191, v191, v107
    v_mul_f32 v192, v192, v106
    v_mul_f32 v193, v193, v106
    v_mul_f32 v194, v194, v106
    v_mul_f32 v195, v195, v106
    v_mul_f32 v196, v196, v107
    v_mul_f32 v197, v197, v107
    v_mul_f32 v198, v198, v107
    v_mul_f32 v199, v199, v107
    v_mul_f32 v200, v200, v106
    v_mul_f32 v201, v201, v106
    v_mul_f32 v202, v202, v106
    v_mul_f32 v203, v203, v106
    v_mul_f32 v204, v204, v107
    v_mul_f32 v205, v205, v107
    v_mul_f32 v206, v206, v107
    v_mul_f32 v207, v207, v107
    v_mul_f32 v208, v208, v106
    v_mul_f32 v209, v209, v106
    v_mul_f32 v210, v210, v106
    v_mul_f32 v211, v211, v106
    v_mul_f32 v212, v212, v107
    v_mul_f32 v213, v213, v107
    v_mul_f32 v214, v214, v107
    v_mul_f32 v215, v215, v107
    v_mul_f32 v216, v216, v106
    v_mul_f32 v217, v217, v106
    v_mul_f32 v218, v218, v106
    v_mul_f32 v219, v219, v106
    v_mul_f32 v220, v220, v107
    v_mul_f32 v221, v221, v107
    v_mul_f32 v222, v222, v107
    v_mul_f32 v223, v223, v107
    v_mul_f32 v224, v224, v106
    v_mul_f32 v225, v225, v106
    v_mul_f32 v226, v226, v106
    v_mul_f32 v227, v227, v106
    v_mul_f32 v228, v228, v107
    v_mul_f32 v229, v229, v107
    v_mul_f32 v230, v230, v107
    v_mul_f32 v231, v231, v107
    v_mul_f32 v232, v232, v106
    v_mul_f32 v233, v233, v106
    v_mul_f32 v234, v234, v106
    v_mul_f32 v235, v235, v106
    v_mul_f32 v236, v236, v107
    v_mul_f32 v237, v237, v107
    v_mul_f32 v238, v238, v107
    v_mul_f32 v239, v239, v107
    v_mul_f32 v240, v240, v106
    v_mul_f32 v241, v241, v106
    v_mul_f32 v242, v242, v106
    v_mul_f32 v243, v243, v106
    v_mul_f32 v244, v244, v107
    v_mul_f32 v245, v245, v107
    v_mul_f32 v246, v246, v107
    v_mul_f32 v247, v247, v107
    v_mul_f32 v248, v248, v106
    v_mul_f32 v249, v249, v106
    v_mul_f32 v250, v250, v106
    v_mul_f32 v251, v251, v106
    v_mul_f32 v252, v252, v107
    v_mul_f32 v253, v253, v107
    v_mul_f32 v254, v254, v107
    v_mul_f32 v255, v255, v107
    v_exp_f32 v64, v80
    v_exp_f32 v65, v81
    v_exp_f32 v66, v82
    v_exp_f32 v67, v83
    v_exp_f32 v68, v84
    v_exp_f32 v69, v85
    v_exp_f32 v70, v86
    v_exp_f32 v71, v87
    v_exp_f32 v72, v88
    v_exp_f32 v73, v89
    v_exp_f32 v74, v90
    v_exp_f32 v75, v91
    v_exp_f32 v76, v92
    v_exp_f32 v77, v93
    v_exp_f32 v78, v94
    v_exp_f32 v79, v95
    v_add_f32 v118, v64, v65
    v_add_f32 v118, v118, v66
    v_add_f32 v118, v118, v67
    v_add_f32 v119, v68, v69
    v_add_f32 v119, v119, v70
    v_add_f32 v119, v119, v71
    v_add_f32 v118, v118, v72
    v_add_f32 v118, v118, v73
    v_add_f32 v118, v118, v74
    v_add_f32 v118, v118, v75
    v_add_f32 v119, v119, v76
    v_add_f32 v119, v119, v77
    v_add_f32 v119, v119, v78
    v_add_f32 v119, v119, v79
    v_cvt_pk_bf16_f32 v16, v64, v65
    v_cvt_pk_bf16_f32 v17, v66, v67
    v_cvt_pk_bf16_f32 v20, v68, v69
    v_cvt_pk_bf16_f32 v21, v70, v71
    v_cvt_pk_bf16_f32 v18, v72, v73
    v_cvt_pk_bf16_f32 v19, v74, v75
    v_cvt_pk_bf16_f32 v22, v76, v77
    v_cvt_pk_bf16_f32 v23, v78, v79
    v_exp_f32 v64, v48
    v_exp_f32 v65, v49
    v_exp_f32 v66, v50
    v_exp_f32 v67, v51
    v_exp_f32 v68, v52
    v_exp_f32 v69, v53
    v_exp_f32 v70, v54
    v_exp_f32 v71, v55
    v_exp_f32 v72, v56
    v_exp_f32 v73, v57
    v_exp_f32 v74, v58
    v_exp_f32 v75, v59
    v_exp_f32 v76, v60
    v_exp_f32 v77, v61
    v_exp_f32 v78, v62
    v_exp_f32 v79, v63
    v_add_f32 v118, v118, v64
    v_add_f32 v118, v118, v65
    v_add_f32 v118, v118, v66
    v_add_f32 v118, v118, v67
    v_add_f32 v119, v119, v68
    v_add_f32 v119, v119, v69
    v_add_f32 v119, v119, v70
    v_add_f32 v119, v119, v71
    v_add_f32 v118, v118, v72
    v_add_f32 v118, v118, v73
    v_add_f32 v118, v118, v74
    v_add_f32 v118, v118, v75
    v_add_f32 v119, v119, v76
    v_add_f32 v119, v119, v77
    v_add_f32 v119, v119, v78
    v_add_f32 v119, v119, v79
    s_nop 1
    s_branch back_l01
slow_l03:
    s_nop 15
    v_max_f32 v104, v80, v81
    v_max_f32 v105, v84, v85
    v_max3_f32 v104, v104, v82, v83
    v_max3_f32 v105, v105, v86, v87
    v_max3_f32 v104, v104, v88, v89
    v_max3_f32 v105, v105, v92, v93
    v_max3_f32 v104, v104, v90, v91
    v_max3_f32 v105, v105, v94, v95
    v_max3_f32 v104, v104, v48, v49
    v_max3_f32 v105, v105, v52, v53
    v_max3_f32 v104, v104, v50, v51
    v_max3_f32 v105, v105, v54, v55
    v_max3_f32 v104, v104, v56, v57
    v_max3_f32 v105, v105, v60, v61
    v_max3_f32 v104, v104, v58, v59
    v_max3_f32 v105, v105, v62, v63
    v_mov_b32 v106, v104
    v_mov_b32 v107, v105
    s_nop 0
    v_permlane32_swap_b32 v104, v106
    v_permlane32_swap_b32 v105, v107
    v_max_f32 v104, v104, v106
    v_max_f32 v105, v105, v107
    v_mov_b32 v106, v104
    v_mov_b32 v107, v105
    s_nop 0
    v_permlane16_swap_b32 v104, v106
    v_permlane16_swap_b32 v105, v107
    v_max3_f32 v104, v104, v106, 0
    v_max3_f32 v105, v105, v107, 0
    v_ceil_f32 v104, v104
    v_ceil_f32 v105, v105
    v_sub_f32 v106, 0, v104
    v_sub_f32 v107, 0, v105
    v_exp_f32 v106, v106
    v_exp_f32 v107, v107
    v_sub_f32 v96, v96, v104
    v_sub_f32 v97, v97, v104
    v_sub_f32 v98, v98, v104
    v_sub_f32 v99, v99, v104
    v_sub_f32 v100, v100, v105
    v_sub_f32 v101, v101, v105
    v_sub_f32 v102, v102, v105
    v_sub_f32 v103, v103, v105
    v_sub_f32 v80, v80, v104
    v_sub_f32 v81, v81, v104
    v_sub_f32 v82, v82, v104
    v_sub_f32 v83, v83, v104
    v_sub_f32 v84, v84, v105
    v_sub_f32 v85, v85, v105
    v_sub_f32 v86, v86, v105
    v_sub_f32 v87, v87, v105
    v_sub_f32 v88, v88, v104
    v_sub_f32 v89, v89, v104
    v_sub_f32 v90, v90, v104
    v_sub_f32 v91, v91, v104
    v_sub_f32 v92, v92, v105
    v_sub_f32 v93, v93, v105
    v_sub_f32 v94, v94, v105
    v_sub_f32 v95, v95, v105
    v_sub_f32 v48, v48, v104
    v_sub_f32 v49, v49, v104
    v_sub_f32 v50, v50, v104
    v_sub_f32 v51, v51, v104
    v_sub_f32 v52, v52, v105
    v_sub_f32 v53, v53, v105
    v_sub_f32 v54, v54, v105
    v_sub_f32 v55, v55, v105
    v_sub_f32 v56, v56, v104
    v_sub_f32 v57, v57, v104
    v_sub_f32 v58, v58, v104
    v_sub_f32 v59, v59, v104
    v_sub_f32 v60, v60, v105
    v_sub_f32 v61, v61, v105
    v_sub_f32 v62, v62, v105
    v_sub_f32 v63, v63, v105
    v_mul_f32 v116, v116, v106
    v_mul_f32 v117, v117, v107
    v_mul_f32 v128, v128, v106
    v_mul_f32 v129, v129, v106
    v_mul_f32 v130, v130, v106
    v_mul_f32 v131, v131, v106
    v_mul_f32 v132, v132, v107
    v_mul_f32 v133, v133, v107
    v_mul_f32 v134, v134, v107
    v_mul_f32 v135, v135, v107
    v_mul_f32 v136, v136, v106
    v_mul_f32 v137, v137, v106
    v_mul_f32 v138, v138, v106
    v_mul_f32 v139, v139, v106
    v_mul_f32 v140, v140, v107
    v_mul_f32 v141, v141, v107
    v_mul_f32 v142, v142, v107
    v_mul_f32 v143, v143, v107
    v_mul_f32 v144, v144, v106
    v_mul_f32 v145, v145, v106
    v_mul_f32 v146, v146, v106
    v_mul_f32 v147, v147, v106
    v_mul_f32 v148, v148, v107
    v_mul_f32 v149, v149, v107
    v_mul_f32 v150, v150, v107
    v_mul_f32 v151, v151, v107
    v_mul_f32 v152, v152, v106
    v_mul_f32 v153, v153, v106
    v_mul_f32 v154, v154, v106
    v_mul_f32 v155, v155, v106
    v_mul_f32 v156, v156, v107
    v_mul_f32 v157, v157, v107
    v_mul_f32 v158, v158, v107
    v_mul_f32 v159, v159, v107
    v_mul_f32 v160, v160, v106
    v_mul_f32 v161, v161, v106
    v_mul_f32 v162, v162, v106
    v_mul_f32 v163, v163, v106
    v_mul_f32 v164, v164, v107
    v_mul_f32 v165, v165, v107
    v_mul_f32 v166, v166, v107
    v_mul_f32 v167, v167, v107
    v_mul_f32 v168, v168, v106
    v_mul_f32 v169, v169, v106
    v_mul_f32 v170, v170, v106
    v_mul_f32 v171, v171, v106
    v_mul_f32 v172, v172, v107
    v_mul_f32 v173, v173, v107
    v_mul_f32 v174, v174, v107
    v_mul_f32 v175, v175, v107
    v_mul_f32 v176, v176, v106
    v_mul_f32 v177, v177, v106
    v_mul_f32 v178, v178, v106
    v_mul_f32 v179, v179, v106
    v_mul_f32 v180, v180, v107
    v_mul_f32 v181, v181, v107
    v_mul_f32 v182, v182, v107
    v_mul_f32 v183, v183, v107
    v_mul_f32 v184, v184, v106
    v_mul_f32 v185, v185, v106
    v_mul_f32 v186, v186, v106
    v_mul_f32 v187, v187, v106
    v_mul_f32 v188, v188, v107
    v_mul_f32 v189, v189, v107
    v_mul_f32 v190, v190, v107
    v_mul_f32 v191, v191, v107
    v_mul_f32 v192, v192, v106
    v_mul_f32 v193, v193, v106
    v_mul_f32 v194, v194, v106
    v_mul_f32 v195, v195, v106
    v_mul_f32 v196, v196, v107
    v_mul_f32 v197, v197, v107
    v_mul_f32 v198, v198, v107
    v_mul_f32 v199, v199, v107
    v_mul_f32 v200, v200, v106
    v_mul_f32 v201, v201, v106
    v_mul_f32 v202, v202, v106
    v_mul_f32 v203, v203, v106
    v_mul_f32 v204, v204, v107
    v_mul_f32 v205, v205, v107
    v_mul_f32 v206, v206, v107
    v_mul_f32 v207, v207, v107
    v_mul_f32 v208, v208, v106
    v_mul_f32 v209, v209, v106
    v_mul_f32 v210, v210, v106
    v_mul_f32 v211, v211, v106
    v_mul_f32 v212, v212, v107
    v_mul_f32 v213, v213, v107
    v_mul_f32 v214, v214, v107
    v_mul_f32 v215, v215, v107
    v_mul_f32 v216, v216, v106
    v_mul_f32 v217, v217, v106
    v_mul_f32 v218, v218, v106
    v_mul_f32 v219, v219, v106
    v_mul_f32 v220, v220, v107
    v_mul_f32 v221, v221, v107
    v_mul_f32 v222, v222, v107
    v_mul_f32 v223, v223, v107
    v_mul_f32 v224, v224, v106
    v_mul_f32 v225, v225, v106
    v_mul_f32 v226, v226, v106
    v_mul_f32 v227, v227, v106
    v_mul_f32 v228, v228, v107
    v_mul_f32 v229, v229, v107
    v_mul_f32 v230, v230, v107
    v_mul_f32 v231, v231, v107
    v_mul_f32 v232, v232, v106
    v_mul_f32 v233, v233, v106
    v_mul_f32 v234, v234, v106
    v_mul_f32 v235, v235, v106
    v_mul_f32 v236, v236, v107
    v_mul_f32 v237, v237, v107
    v_mul_f32 v238, v238, v107
    v_mul_f32 v239, v239, v107
    v_mul_f32 v240, v240, v106
    v_mul_f32 v241, v241, v106
    v_mul_f32 v242, v242, v106
    v_mul_f32 v243, v243, v106
    v_mul_f32 v244, v244, v107
    v_mul_f32 v245, v245, v107
    v_mul_f32 v246, v246, v107
    v_mul_f32 v247, v247, v107
    v_mul_f32 v248, v248, v106
    v_mul_f32 v249, v249, v106
    v_mul_f32 v250, v250, v106
    v_mul_f32 v251, v251, v106
    v_mul_f32 v252, v252, v107
    v_mul_f32 v253, v253, v107
    v_mul_f32 v254, v254, v107
    v_mul_f32 v255, v255, v107
    v_exp_f32 v64, v80
    v_exp_f32 v65, v81
    v_exp_f32 v66, v82
    v_exp_f32 v67, v83
    v_exp_f32 v68, v84
    v_exp_f32 v69, v85
    v_exp_f32 v70, v86
    v_exp_f32 v71, v87
    v_exp_f32 v72, v88
    v_exp_f32 v73, v89
    v_exp_f32 v74, v90
    v_exp_f32 v75, v91
    v_exp_f32 v76, v92
    v_exp_f32 v77, v93
    v_exp_f32 v78, v94
    v_exp_f32 v79, v95
    v_add_f32 v118, v64, v65
    v_add_f32 v118, v118, v66
    v_add_f32 v118, v118, v67
    v_add_f32 v119, v68, v69
    v_add_f32 v119, v119, v70
    v_add_f32 v119, v119, v71
    v_add_f32 v118, v118, v72
    v_add_f32 v118, v118, v73
    v_add_f32 v118, v118, v74
    v_add_f32 v118, v118, v75
    v_add_f32 v119, v119, v76
    v_add_f32 v119, v119, v77
    v_add_f32 v119, v119, v78
    v_add_f32 v119, v119, v79
    v_cvt_pk_bf16_f32 v32, v64, v65
    v_cvt_pk_bf16_f32 v33, v66, v67
    v_cvt_pk_bf16_f32 v36, v68, v69
    v_cvt_pk_bf16_f32 v37, v70, v71
    v_cvt_pk_bf16_f32 v34, v72, v73
    v_cvt_pk_bf16_f32 v35, v74, v75
    v_cvt_pk_bf16_f32 v38, v76, v77
    v_cvt_pk_bf16_f32 v39, v78, v79
    v_exp_f32 v64, v48
    v_exp_f32 v65, v49
    v_exp_f32 v66, v50
    v_exp_f32 v67, v51
    v_exp_f32 v68, v52
    v_exp_f32 v69, v53
    v_exp_f32 v70, v54
    v_exp_f32 v71, v55
    v_exp_f32 v72, v56
    v_exp_f32 v73, v57
    v_exp_f32 v74, v58
    v_exp_f32 v75, v59
    v_exp_f32 v76, v60
    v_exp_f32 v77, v61
    v_exp_f32 v78, v62
    v_exp_f32 v79, v63
    v_add_f32 v118, v118, v64
    v_add_f32 v118, v118, v65
    v_add_f32 v118, v118, v66
    v_add_f32 v118, v118, v67
    v_add_f32 v119, v119, v68
    v_add_f32 v119, v119, v69
    v_add_f32 v119, v119, v70
    v_add_f32 v119, v119, v71
    v_add_f32 v118, v118, v72
    v_add_f32 v118, v118, v73
    v_add_f32 v118, v118, v74
    v_add_f32 v118, v118, v75
    v_add_f32 v119, v119, v76
    v_add_f32 v119, v119, v77
    v_add_f32 v119, v119, v78
    v_add_f32 v119, v119, v79
    s_nop 1
    s_branch back_l03
slow_l11:
    s_nop 15
    v_max_f32 v104, v80, v81
    v_max_f32 v105, v84, v85
    v_max3_f32 v104, v104, v82, v83
    v_max3_f32 v105, v105, v86, v87
    v_max3_f32 v104, v104, v88, v89
    v_max3_f32 v105, v105, v92, v93
    v_max3_f32 v104, v104, v90, v91
    v_max3_f32 v105, v105, v94, v95
    v_max3_f32 v104, v104, v48, v49
    v_max3_f32 v105, v105, v52, v53
    v_max3_f32 v104, v104, v50, v51
    v_max3_f32 v105, v105, v54, v55
    v_max3_f32 v104, v104, v56, v57
    v_max3_f32 v105, v105, v60, v61
    v_max3_f32 v104, v104, v58, v59
    v_max3_f32 v105, v105, v62, v63
    v_mov_b32 v106, v104
    v_mov_b32 v107, v105
    s_nop 0
    v_permlane32_swap_b32 v104, v106
    v_permlane32_swap_b32 v105, v107
    v_max_f32 v104, v104, v106
    v_max_f32 v105, v105, v107
    v_mov_b32 v106, v104
    v_mov_b32 v107, v105
    s_nop 0
    v_permlane16_swap_b32 v104, v106
    v_permlane16_swap_b32 v105, v107
    v_max3_f32 v104, v104, v106, 0
    v_max3_f32 v105, v105, v107, 0
    v_ceil_f32 v104, v104
    v_ceil_f32 v105, v105
    v_sub_f32 v106, 0, v104
    v_sub_f32 v107, 0, v105
    v_exp_f32 v106, v106
    v_exp_f32 v107, v107
    v_sub_f32 v96, v96, v104
    v_sub_f32 v97, v97, v104
    v_sub_f32 v98, v98, v104
    v_sub_f32 v99, v99, v104
    v_sub_f32 v100, v100, v105
    v_sub_f32 v101, v101, v105
    v_sub_f32 v102, v102, v105
    v_sub_f32 v103, v103, v105
    v_sub_f32 v80, v80, v104
    v_sub_f32 v81, v81, v104
    v_sub_f32 v82, v82, v104
    v_sub_f32 v83, v83, v104
    v_sub_f32 v84, v84, v105
    v_sub_f32 v85, v85, v105
    v_sub_f32 v86, v86, v105
    v_sub_f32 v87, v87, v105
    v_sub_f32 v88, v88, v104
    v_sub_f32 v89, v89, v104
    v_sub_f32 v90, v90, v104
    v_sub_f32 v91, v91, v104
    v_sub_f32 v92, v92, v105
    v_sub_f32 v93, v93, v105
    v_sub_f32 v94, v94, v105
    v_sub_f32 v95, v95, v105
    v_sub_f32 v48, v48, v104
    v_sub_f32 v49, v49, v104
    v_sub_f32 v50, v50, v104
    v_sub_f32 v51, v51, v104
    v_sub_f32 v52, v52, v105
    v_sub_f32 v53, v53, v105
    v_sub_f32 v54, v54, v105
    v_sub_f32 v55, v55, v105
    v_sub_f32 v56, v56, v104
    v_sub_f32 v57, v57, v104
    v_sub_f32 v58, v58, v104
    v_sub_f32 v59, v59, v104
    v_sub_f32 v60, v60, v105
    v_sub_f32 v61, v61, v105
    v_sub_f32 v62, v62, v105
    v_sub_f32 v63, v63, v105
    v_mul_f32 v116, v116, v106
    v_mul_f32 v117, v117, v107
    v_mul_f32 v128, v128, v106
    v_mul_f32 v129, v129, v106
    v_mul_f32 v130, v130, v106
    v_mul_f32 v131, v131, v106
    v_mul_f32 v132, v132, v107
    v_mul_f32 v133, v133, v107
    v_mul_f32 v134, v134, v107
    v_mul_f32 v135, v135, v107
    v_mul_f32 v136, v136, v106
    v_mul_f32 v137, v137, v106
    v_mul_f32 v138, v138, v106
    v_mul_f32 v139, v139, v106
    v_mul_f32 v140, v140, v107
    v_mul_f32 v141, v141, v107
    v_mul_f32 v142, v142, v107
    v_mul_f32 v143, v143, v107
    v_mul_f32 v144, v144, v106
    v_mul_f32 v145, v145, v106
    v_mul_f32 v146, v146, v106
    v_mul_f32 v147, v147, v106
    v_mul_f32 v148, v148, v107
    v_mul_f32 v149, v149, v107
    v_mul_f32 v150, v150, v107
    v_mul_f32 v151, v151, v107
    v_mul_f32 v152, v152, v106
    v_mul_f32 v153, v153, v106
    v_mul_f32 v154, v154, v106
    v_mul_f32 v155, v155, v106
    v_mul_f32 v156, v156, v107
    v_mul_f32 v157, v157, v107
    v_mul_f32 v158, v158, v107
    v_mul_f32 v159, v159, v107
    v_mul_f32 v160, v160, v106
    v_mul_f32 v161, v161, v106
    v_mul_f32 v162, v162, v106
    v_mul_f32 v163, v163, v106
    v_mul_f32 v164, v164, v107
    v_mul_f32 v165, v165, v107
    v_mul_f32 v166, v166, v107
    v_mul_f32 v167, v167, v107
    v_mul_f32 v168, v168, v106
    v_mul_f32 v169, v169, v106
    v_mul_f32 v170, v170, v106
    v_mul_f32 v171, v171, v106
    v_mul_f32 v172, v172, v107
    v_mul_f32 v173, v173, v107
    v_mul_f32 v174, v174, v107
    v_mul_f32 v175, v175, v107
    v_mul_f32 v176, v176, v106
    v_mul_f32 v177, v177, v106
    v_mul_f32 v178, v178, v106
    v_mul_f32 v179, v179, v106
    v_mul_f32 v180, v180, v107
    v_mul_f32 v181, v181, v107
    v_mul_f32 v182, v182, v107
    v_mul_f32 v183, v183, v107
    v_mul_f32 v184, v184, v106
    v_mul_f32 v185, v185, v106
    v_mul_f32 v186, v186, v106
    v_mul_f32 v187, v187, v106
    v_mul_f32 v188, v188, v107
    v_mul_f32 v189, v189, v107
    v_mul_f32 v190, v190, v107
    v_mul_f32 v191, v191, v107
    v_mul_f32 v192, v192, v106
    v_mul_f32 v193, v193, v106
    v_mul_f32 v194, v194, v106
    v_mul_f32 v195, v195, v106
    v_mul_f32 v196, v196, v107
    v_mul_f32 v197, v197, v107
    v_mul_f32 v198, v198, v107
    v_mul_f32 v199, v199, v107
    v_mul_f32 v200, v200, v106
    v_mul_f32 v201, v201, v106
    v_mul_f32 v202, v202, v106
    v_mul_f32 v203, v203, v106
    v_mul_f32 v204, v204, v107
    v_mul_f32 v205, v205, v107
    v_mul_f32 v206, v206, v107
    v_mul_f32 v207, v207, v107
    v_mul_f32 v208, v208, v106
    v_mul_f32 v209, v209, v106
    v_mul_f32 v210, v210, v106
    v_mul_f32 v211, v211, v106
    v_mul_f32 v212, v212, v107
    v_mul_f32 v213, v213, v107
    v_mul_f32 v214, v214, v107
    v_mul_f32 v215, v215, v107
    v_mul_f32 v216, v216, v106
    v_mul_f32 v217, v217, v106
    v_mul_f32 v218, v218, v106
    v_mul_f32 v219, v219, v106
    v_mul_f32 v220, v220, v107
    v_mul_f32 v221, v221, v107
    v_mul_f32 v222, v222, v107
    v_mul_f32 v223, v223, v107
    v_mul_f32 v224, v224, v106
    v_mul_f32 v225, v225, v106
    v_mul_f32 v226, v226, v106
    v_mul_f32 v227, v227, v106
    v_mul_f32 v228, v228, v107
    v_mul_f32 v229, v229, v107
    v_mul_f32 v230, v230, v107
    v_mul_f32 v231, v231, v107
    v_mul_f32 v232, v232, v106
    v_mul_f32 v233, v233, v106
    v_mul_f32 v234, v234, v106
    v_mul_f32 v235, v235, v106
    v_mul_f32 v236, v236, v107
    v_mul_f32 v237, v237, v107
    v_mul_f32 v238, v238, v107
    v_mul_f32 v239, v239, v107
    v_mul_f32 v240, v240, v106
    v_mul_f32 v241, v241, v106
    v_mul_f32 v242, v242, v106
    v_mul_f32 v243, v243, v106
    v_mul_f32 v244, v244, v107
    v_mul_f32 v245, v245, v107
    v_mul_f32 v246, v246, v107
    v_mul_f32 v247, v247, v107
    v_mul_f32 v248, v248, v106
    v_mul_f32 v249, v249, v106
    v_mul_f32 v250, v250, v106
    v_mul_f32 v251, v251, v106
    v_mul_f32 v252, v252, v107
    v_mul_f32 v253, v253, v107
    v_mul_f32 v254, v254, v107
    v_mul_f32 v255, v255, v107
    v_exp_f32 v64, v80
    v_exp_f32 v65, v81
    v_exp_f32 v66, v82
    v_exp_f32 v67, v83
    v_exp_f32 v68, v84
    v_exp_f32 v69, v85
    v_exp_f32 v70, v86
    v_exp_f32 v71, v87
    v_exp_f32 v72, v88
    v_exp_f32 v73, v89
    v_exp_f32 v74, v90
    v_exp_f32 v75, v91
    v_exp_f32 v76, v92
    v_exp_f32 v77, v93
    v_exp_f32 v78, v94
    v_exp_f32 v79, v95
    v_add_f32 v118, v64, v65
    v_add_f32 v118, v118, v66
    v_add_f32 v118, v118, v67
    v_add_f32 v119, v68, v69
    v_add_f32 v119, v119, v70
    v_add_f32 v119, v119, v71
    v_add_f32 v118, v118, v72
    v_add_f32 v118, v118, v73
    v_add_f32 v118, v118, v74
    v_add_f32 v118, v118, v75
    v_add_f32 v119, v119, v76
    v_add_f32 v119, v119, v77
    v_add_f32 v119, v119, v78
    v_add_f32 v119, v119, v79
    v_cvt_pk_bf16_f32 v16, v64, v65
    v_cvt_pk_bf16_f32 v17, v66, v67
    v_cvt_pk_bf16_f32 v20, v68, v69
    v_cvt_pk_bf16_f32 v21, v70, v71
    v_cvt_pk_bf16_f32 v18, v72, v73
    v_cvt_pk_bf16_f32 v19, v74, v75
    v_cvt_pk_bf16_f32 v22, v76, v77
    v_cvt_pk_bf16_f32 v23, v78, v79
    v_exp_f32 v64, v48
    v_exp_f32 v65, v49
    v_exp_f32 v66, v50
    v_exp_f32 v67, v51
    v_exp_f32 v68, v52
    v_exp_f32 v69, v53
    v_exp_f32 v70, v54
    v_exp_f32 v71, v55
    v_exp_f32 v72, v56
    v_exp_f32 v73, v57
    v_exp_f32 v74, v58
    v_exp_f32 v75, v59
    v_exp_f32 v76, v60
    v_exp_f32 v77, v61
    v_exp_f32 v78, v62
    v_exp_f32 v79, v63
    v_add_f32 v118, v118, v64
    v_add_f32 v118, v118, v65
    v_add_f32 v118, v118, v66
    v_add_f32 v118, v118, v67
    v_add_f32 v119, v119, v68
    v_add_f32 v119, v119, v69
    v_add_f32 v119, v119, v70
    v_add_f32 v119, v119, v71
    v_add_f32 v118, v118, v72
    v_add_f32 v118, v118, v73
    v_add_f32 v118, v118, v74
    v_add_f32 v118, v118, v75
    v_add_f32 v119, v119, v76
    v_add_f32 v119, v119, v77
    v_add_f32 v119, v119, v78
    v_add_f32 v119, v119, v79
    s_nop 1
    s_branch back_l11
slow_l13:
    s_nop 15
    v_max_f32 v104, v80, v81
    v_max_f32 v105, v84, v85
    v_max3_f32 v104, v104, v82, v83
    v_max3_f32 v105, v105, v86, v87
    v_max3_f32 v104, v104, v88, v89
    v_max3_f32 v105, v105, v92, v93
    v_max3_f32 v104, v104, v90, v91
    v_max3_f32 v105, v105, v94, v95
    v_max3_f32 v104, v104, v48, v49
    v_max3_f32 v105, v105, v52, v53
    v_max3_f32 v104, v104, v50, v51
    v_max3_f32 v105, v105, v54, v55
    v_max3_f32 v104, v104, v56, v57
    v_max3_f32 v105, v105, v60, v61
    v_max3_f32 v104, v104, v58, v59
    v_max3_f32 v105, v105, v62, v63
    v_mov_b32 v106, v104
    v_mov_b32 v107, v105
    s_nop 0
    v_permlane32_swap_b32 v104, v106
    v_permlane32_swap_b32 v105, v107
    v_max_f32 v104, v104, v106
    v_max_f32 v105, v105, v107
    v_mov_b32 v106, v104
    v_mov_b32 v107, v105
    s_nop 0
    v_permlane16_swap_b32 v104, v106
    v_permlane16_swap_b32 v105, v107
    v_max3_f32 v104, v104, v106, 0
    v_max3_f32 v105, v105, v107, 0
    v_ceil_f32 v104, v104
    v_ceil_f32 v105, v105
    v_sub_f32 v106, 0, v104
    v_sub_f32 v107, 0, v105
    v_exp_f32 v106, v106
    v_exp_f32 v107, v107
    v_sub_f32 v96, v96, v104
    v_sub_f32 v97, v97, v104
    v_sub_f32 v98, v98, v104
    v_sub_f32 v99, v99, v104
    v_sub_f32 v100, v100, v105
    v_sub_f32 v101, v101, v105
    v_sub_f32 v102, v102, v105
    v_sub_f32 v103, v103, v105
    v_sub_f32 v80, v80, v104
    v_sub_f32 v81, v81, v104
    v_sub_f32 v82, v82, v104
    v_sub_f32 v83, v83, v104
    v_sub_f32 v84, v84, v105
    v_sub_f32 v85, v85, v105
    v_sub_f32 v86, v86, v105
    v_sub_f32 v87, v87, v105
    v_sub_f32 v88, v88, v104
    v_sub_f32 v89, v89, v104
    v_sub_f32 v90, v90, v104
    v_sub_f32 v91, v91, v104
    v_sub_f32 v92, v92, v105
    v_sub_f32 v93, v93, v105
    v_sub_f32 v94, v94, v105
    v_sub_f32 v95, v95, v105
    v_sub_f32 v48, v48, v104
    v_sub_f32 v49, v49, v104
    v_sub_f32 v50, v50, v104
    v_sub_f32 v51, v51, v104
    v_sub_f32 v52, v52, v105
    v_sub_f32 v53, v53, v105
    v_sub_f32 v54, v54, v105
    v_sub_f32 v55, v55, v105
    v_sub_f32 v56, v56, v104
    v_sub_f32 v57, v57, v104
    v_sub_f32 v58, v58, v104
    v_sub_f32 v59, v59, v104
    v_sub_f32 v60, v60, v105
    v_sub_f32 v61, v61, v105
    v_sub_f32 v62, v62, v105
    v_sub_f32 v63, v63, v105
    v_mul_f32 v116, v116, v106
    v_mul_f32 v117, v117, v107
    v_mul_f32 v128, v128, v106
    v_mul_f32 v129, v129, v106
    v_mul_f32 v130, v130, v106
    v_mul_f32 v131, v131, v106
    v_mul_f32 v132, v132, v107
    v_mul_f32 v133, v133, v107
    v_mul_f32 v134, v134, v107
    v_mul_f32 v135, v135, v107
    v_mul_f32 v136, v136, v106
    v_mul_f32 v137, v137, v106
    v_mul_f32 v138, v138, v106
    v_mul_f32 v139, v139, v106
    v_mul_f32 v140, v140, v107
    v_mul_f32 v141, v141, v107
    v_mul_f32 v142, v142, v107
    v_mul_f32 v143, v143, v107
    v_mul_f32 v144, v144, v106
    v_mul_f32 v145, v145, v106
    v_mul_f32 v146, v146, v106
    v_mul_f32 v147, v147, v106
    v_mul_f32 v148, v148, v107
    v_mul_f32 v149, v149, v107
    v_mul_f32 v150, v150, v107
    v_mul_f32 v151, v151, v107
    v_mul_f32 v152, v152, v106
    v_mul_f32 v153, v153, v106
    v_mul_f32 v154, v154, v106
    v_mul_f32 v155, v155, v106
    v_mul_f32 v156, v156, v107
    v_mul_f32 v157, v157, v107
    v_mul_f32 v158, v158, v107
    v_mul_f32 v159, v159, v107
    v_mul_f32 v160, v160, v106
    v_mul_f32 v161, v161, v106
    v_mul_f32 v162, v162, v106
    v_mul_f32 v163, v163, v106
    v_mul_f32 v164, v164, v107
    v_mul_f32 v165, v165, v107
    v_mul_f32 v166, v166, v107
    v_mul_f32 v167, v167, v107
    v_mul_f32 v168, v168, v106
    v_mul_f32 v169, v169, v106
    v_mul_f32 v170, v170, v106
    v_mul_f32 v171, v171, v106
    v_mul_f32 v172, v172, v107
    v_mul_f32 v173, v173, v107
    v_mul_f32 v174, v174, v107
    v_mul_f32 v175, v175, v107
    v_mul_f32 v176, v176, v106
    v_mul_f32 v177, v177, v106
    v_mul_f32 v178, v178, v106
    v_mul_f32 v179, v179, v106
    v_mul_f32 v180, v180, v107
    v_mul_f32 v181, v181, v107
    v_mul_f32 v182, v182, v107
    v_mul_f32 v183, v183, v107
    v_mul_f32 v184, v184, v106
    v_mul_f32 v185, v185, v106
    v_mul_f32 v186, v186, v106
    v_mul_f32 v187, v187, v106
    v_mul_f32 v188, v188, v107
    v_mul_f32 v189, v189, v107
    v_mul_f32 v190, v190, v107
    v_mul_f32 v191, v191, v107
    v_mul_f32 v192, v192, v106
    v_mul_f32 v193, v193, v106
    v_mul_f32 v194, v194, v106
    v_mul_f32 v195, v195, v106
    v_mul_f32 v196, v196, v107
    v_mul_f32 v197, v197, v107
    v_mul_f32 v198, v198, v107
    v_mul_f32 v199, v199, v107
    v_mul_f32 v200, v200, v106
    v_mul_f32 v201, v201, v106
    v_mul_f32 v202, v202, v106
    v_mul_f32 v203, v203, v106
    v_mul_f32 v204, v204, v107
    v_mul_f32 v205, v205, v107
    v_mul_f32 v206, v206, v107
    v_mul_f32 v207, v207, v107
    v_mul_f32 v208, v208, v106
    v_mul_f32 v209, v209, v106
    v_mul_f32 v210, v210, v106
    v_mul_f32 v211, v211, v106
    v_mul_f32 v212, v212, v107
    v_mul_f32 v213, v213, v107
    v_mul_f32 v214, v214, v107
    v_mul_f32 v215, v215, v107
    v_mul_f32 v216, v216, v106
    v_mul_f32 v217, v217, v106
    v_mul_f32 v218, v218, v106
    v_mul_f32 v219, v219, v106
    v_mul_f32 v220, v220, v107
    v_mul_f32 v221, v221, v107
    v_mul_f32 v222, v222, v107
    v_mul_f32 v223, v223, v107
    v_mul_f32 v224, v224, v106
    v_mul_f32 v225, v225, v106
    v_mul_f32 v226, v226, v106
    v_mul_f32 v227, v227, v106
    v_mul_f32 v228, v228, v107
    v_mul_f32 v229, v229, v107
    v_mul_f32 v230, v230, v107
    v_mul_f32 v231, v231, v107
    v_mul_f32 v232, v232, v106
    v_mul_f32 v233, v233, v106
    v_mul_f32 v234, v234, v106
    v_mul_f32 v235, v235, v106
    v_mul_f32 v236, v236, v107
    v_mul_f32 v237, v237, v107
    v_mul_f32 v238, v238, v107
    v_mul_f32 v239, v239, v107
    v_mul_f32 v240, v240, v106
    v_mul_f32 v241, v241, v106
    v_mul_f32 v242, v242, v106
    v_mul_f32 v243, v243, v106
    v_mul_f32 v244, v244, v107
    v_mul_f32 v245, v245, v107
    v_mul_f32 v246, v246, v107
    v_mul_f32 v247, v247, v107
    v_mul_f32 v248, v248, v106
    v_mul_f32 v249, v249, v106
    v_mul_f32 v250, v250, v106
    v_mul_f32 v251, v251, v106
    v_mul_f32 v252, v252, v107
    v_mul_f32 v253, v253, v107
    v_mul_f32 v254, v254, v107
    v_mul_f32 v255, v255, v107
    v_exp_f32 v64, v80
    v_exp_f32 v65, v81
    v_exp_f32 v66, v82
    v_exp_f32 v67, v83
    v_exp_f32 v68, v84
    v_exp_f32 v69, v85
    v_exp_f32 v70, v86
    v_exp_f32 v71, v87
    v_exp_f32 v72, v88
    v_exp_f32 v73, v89
    v_exp_f32 v74, v90
    v_exp_f32 v75, v91
    v_exp_f32 v76, v92
    v_exp_f32 v77, v93
    v_exp_f32 v78, v94
    v_exp_f32 v79, v95
    v_add_f32 v118, v64, v65
    v_add_f32 v118, v118, v66
    v_add_f32 v118, v118, v67
    v_add_f32 v119, v68, v69
    v_add_f32 v119, v119, v70
    v_add_f32 v119, v119, v71
    v_add_f32 v118, v118, v72
    v_add_f32 v118, v118, v73
    v_add_f32 v118, v118, v74
    v_add_f32 v118, v118, v75
    v_add_f32 v119, v119, v76
    v_add_f32 v119, v119, v77
    v_add_f32 v119, v119, v78
    v_add_f32 v119, v119, v79
    v_cvt_pk_bf16_f32 v32, v64, v65
    v_cvt_pk_bf16_f32 v33, v66, v67
    v_cvt_pk_bf16_f32 v36, v68, v69
    v_cvt_pk_bf16_f32 v37, v70, v71
    v_cvt_pk_bf16_f32 v34, v72, v73
    v_cvt_pk_bf16_f32 v35, v74, v75
    v_cvt_pk_bf16_f32 v38, v76, v77
    v_cvt_pk_bf16_f32 v39, v78, v79
    v_exp_f32 v64, v48
    v_exp_f32 v65, v49
    v_exp_f32 v66, v50
    v_exp_f32 v67, v51
    v_exp_f32 v68, v52
    v_exp_f32 v69, v53
    v_exp_f32 v70, v54
    v_exp_f32 v71, v55
    v_exp_f32 v72, v56
    v_exp_f32 v73, v57
    v_exp_f32 v74, v58
    v_exp_f32 v75, v59
    v_exp_f32 v76, v60
    v_exp_f32 v77, v61
    v_exp_f32 v78, v62
    v_exp_f32 v79, v63
    v_add_f32 v118, v118, v64
    v_add_f32 v118, v118, v65
    v_add_f32 v118, v118, v66
    v_add_f32 v118, v118, v67
    v_add_f32 v119, v119, v68
    v_add_f32 v119, v119, v69
    v_add_f32 v119, v119, v70
    v_add_f32 v119, v119, v71
    v_add_f32 v118, v118, v72
    v_add_f32 v118, v118, v73
    v_add_f32 v118, v118, v74
    v_add_f32 v118, v118, v75
    v_add_f32 v119, v119, v76
    v_add_f32 v119, v119, v77
    v_add_f32 v119, v119, v78
    v_add_f32 v119, v119, v79
    s_nop 1
    s_branch back_l13
slow_t61:
    s_nop 15
    v_max_f32 v104, v80, v81
    v_max_f32 v105, v84, v85
    v_max3_f32 v104, v104, v82, v83
    v_max3_f32 v105, v105, v86, v87
    v_max3_f32 v104, v104, v88, v89
    v_max3_f32 v105, v105, v92, v93
    v_max3_f32 v104, v104, v90, v91
    v_max3_f32 v105, v105, v94, v95
    v_max3_f32 v104, v104, v48, v49
    v_max3_f32 v105, v105, v52, v53
    v_max3_f32 v104, v104, v50, v51
    v_max3_f32 v105, v105, v54, v55
    v_max3_f32 v104, v104, v56, v57
    v_max3_f32 v105, v105, v60, v61
    v_max3_f32 v104, v104, v58, v59
    v_max3_f32 v105, v105, v62, v63
    v_mov_b32 v106, v104
    v_mov_b32 v107, v105
    s_nop 0
    v_permlane32_swap_b32 v104, v106
    v_permlane32_swap_b32 v105, v107
    v_max_f32 v104, v104, v106
    v_max_f32 v105, v105, v107
    v_mov_b32 v106, v104
    v_mov_b32 v107, v105
    s_nop 0
    v_permlane16_swap_b32 v104, v106
    v_permlane16_swap_b32 v105, v107
    v_max3_f32 v104, v104, v106, 0
    v_max3_f32 v105, v105, v107, 0
    v_ceil_f32 v104, v104
    v_ceil_f32 v105, v105
    v_sub_f32 v106, 0, v104
    v_sub_f32 v107, 0, v105
    v_exp_f32 v106, v106
    v_exp_f32 v107, v107
    v_sub_f32 v96, v96, v104
    v_sub_f32 v97, v97, v104
    v_sub_f32 v98, v98, v104
    v_sub_f32 v99, v99, v104
    v_sub_f32 v100, v100, v105
    v_sub_f32 v101, v101, v105
    v_sub_f32 v102, v102, v105
    v_sub_f32 v103, v103, v105
    v_sub_f32 v80, v80, v104
    v_sub_f32 v81, v81, v104
    v_sub_f32 v82, v82, v104
    v_sub_f32 v83, v83, v104
    v_sub_f32 v84, v84, v105
    v_sub_f32 v85, v85, v105
    v_sub_f32 v86, v86, v105
    v_sub_f32 v87, v87, v105
    v_sub_f32 v88, v88, v104
    v_sub_f32 v89, v89, v104
    v_sub_f32 v90, v90, v104
    v_sub_f32 v91, v91, v104
    v_sub_f32 v92, v92, v105
    v_sub_f32 v93, v93, v105
    v_sub_f32 v94, v94, v105
    v_sub_f32 v95, v95, v105
    v_sub_f32 v48, v48, v104
    v_sub_f32 v49, v49, v104
    v_sub_f32 v50, v50, v104
    v_sub_f32 v51, v51, v104
    v_sub_f32 v52, v52, v105
    v_sub_f32 v53, v53, v105
    v_sub_f32 v54, v54, v105
    v_sub_f32 v55, v55, v105
    v_sub_f32 v56, v56, v104
    v_sub_f32 v57, v57, v104
    v_sub_f32 v58, v58, v104
    v_sub_f32 v59, v59, v104
    v_sub_f32 v60, v60, v105
    v_sub_f32 v61, v61, v105
    v_sub_f32 v62, v62, v105
    v_sub_f32 v63, v63, v105
    v_mul_f32 v116, v116, v106
    v_mul_f32 v117, v117, v107
    v_mul_f32 v128, v128, v106
    v_mul_f32 v129, v129, v106
    v_mul_f32 v130, v130, v106
    v_mul_f32 v131, v131, v106
    v_mul_f32 v132, v132, v107
    v_mul_f32 v133, v133, v107
    v_mul_f32 v134, v134, v107
    v_mul_f32 v135, v135, v107
    v_mul_f32 v136, v136, v106
    v_mul_f32 v137, v137, v106
    v_mul_f32 v138, v138, v106
    v_mul_f32 v139, v139, v106
    v_mul_f32 v140, v140, v107
    v_mul_f32 v141, v141, v107
    v_mul_f32 v142, v142, v107
    v_mul_f32 v143, v143, v107
    v_mul_f32 v144, v144, v106
    v_mul_f32 v145, v145, v106
    v_mul_f32 v146, v146, v106
    v_mul_f32 v147, v147, v106
    v_mul_f32 v148, v148, v107
    v_mul_f32 v149, v149, v107
    v_mul_f32 v150, v150, v107
    v_mul_f32 v151, v151, v107
    v_mul_f32 v152, v152, v106
    v_mul_f32 v153, v153, v106
    v_mul_f32 v154, v154, v106
    v_mul_f32 v155, v155, v106
    v_mul_f32 v156, v156, v107
    v_mul_f32 v157, v157, v107
    v_mul_f32 v158, v158, v107
    v_mul_f32 v159, v159, v107
    v_mul_f32 v160, v160, v106
    v_mul_f32 v161, v161, v106
    v_mul_f32 v162, v162, v106
    v_mul_f32 v163, v163, v106
    v_mul_f32 v164, v164, v107
    v_mul_f32 v165, v165, v107
    v_mul_f32 v166, v166, v107
    v_mul_f32 v167, v167, v107
    v_mul_f32 v168, v168, v106
    v_mul_f32 v169, v169, v106
    v_mul_f32 v170, v170, v106
    v_mul_f32 v171, v171, v106
    v_mul_f32 v172, v172, v107
    v_mul_f32 v173, v173, v107
    v_mul_f32 v174, v174, v107
    v_mul_f32 v175, v175, v107
    v_mul_f32 v176, v176, v106
    v_mul_f32 v177, v177, v106
    v_mul_f32 v178, v178, v106
    v_mul_f32 v179, v179, v106
    v_mul_f32 v180, v180, v107
    v_mul_f32 v181, v181, v107
    v_mul_f32 v182, v182, v107
    v_mul_f32 v183, v183, v107
    v_mul_f32 v184, v184, v106
    v_mul_f32 v185, v185, v106
    v_mul_f32 v186, v186, v106
    v_mul_f32 v187, v187, v106
    v_mul_f32 v188, v188, v107
    v_mul_f32 v189, v189, v107
    v_mul_f32 v190, v190, v107
    v_mul_f32 v191, v191, v107
    v_mul_f32 v192, v192, v106
    v_mul_f32 v193, v193, v106
    v_mul_f32 v194, v194, v106
    v_mul_f32 v195, v195, v106
    v_mul_f32 v196, v196, v107
    v_mul_f32 v197, v197, v107
    v_mul_f32 v198, v198, v107
    v_mul_f32 v199, v199, v107
    v_mul_f32 v200, v200, v106
    v_mul_f32 v201, v201, v106
    v_mul_f32 v202, v202, v106
    v_mul_f32 v203, v203, v106
    v_mul_f32 v204, v204, v107
    v_mul_f32 v205, v205, v107
    v_mul_f32 v206, v206, v107
    v_mul_f32 v207, v207, v107
    v_mul_f32 v208, v208, v106
    v_mul_f32 v209, v209, v106
    v_mul_f32 v210, v210, v106
    v_mul_f32 v211, v211, v106
    v_mul_f32 v212, v212, v107
    v_mul_f32 v213, v213, v107
    v_mul_f32 v214, v214, v107
    v_mul_f32 v215, v215, v107
    v_mul_f32 v216, v216, v106
    v_mul_f32 v217, v217, v106
    v_mul_f32 v218, v218, v106
    v_mul_f32 v219, v219, v106
    v_mul_f32 v220, v220, v107
    v_mul_f32 v221, v221, v107
    v_mul_f32 v222, v222, v107
    v_mul_f32 v223, v223, v107
    v_mul_f32 v224, v224, v106
    v_mul_f32 v225, v225, v106
    v_mul_f32 v226, v226, v106
    v_mul_f32 v227, v227, v106
    v_mul_f32 v228, v228, v107
    v_mul_f32 v229, v229, v107
    v_mul_f32 v230, v230, v107
    v_mul_f32 v231, v231, v107
    v_mul_f32 v232, v232, v106
    v_mul_f32 v233, v233, v106
    v_mul_f32 v234, v234, v106
    v_mul_f32 v235, v235, v106
    v_mul_f32 v236, v236, v107
    v_mul_f32 v237, v237, v107
    v_mul_f32 v238, v238, v107
    v_mul_f32 v239, v239, v107
    v_mul_f32 v240, v240, v106
    v_mul_f32 v241, v241, v106
    v_mul_f32 v242, v242, v106
    v_mul_f32 v243, v243, v106
    v_mul_f32 v244, v244, v107
    v_mul_f32 v245, v245, v107
    v_mul_f32 v246, v246, v107
    v_mul_f32 v247, v247, v107
    v_mul_f32 v248, v248, v106
    v_mul_f32 v249, v249, v106
    v_mul_f32 v250, v250, v106
    v_mul_f32 v251, v251, v106
    v_mul_f32 v252, v252, v107
    v_mul_f32 v253, v253, v107
    v_mul_f32 v254, v254, v107
    v_mul_f32 v255, v255, v107
    v_exp_f32 v64, v80
    v_exp_f32 v65, v81
    v_exp_f32 v66, v82
    v_exp_f32 v67, v83
    v_exp_f32 v68, v84
    v_exp_f32 v69, v85
    v_exp_f32 v70, v86
    v_exp_f32 v71, v87
    v_exp_f32 v72, v88
    v_exp_f32 v73, v89
    v_exp_f32 v74, v90
    v_exp_f32 v75, v91
    v_exp_f32 v76, v92
    v_exp_f32 v77, v93
    v_exp_f32 v78, v94
    v_exp_f32 v79, v95
    v_add_f32 v118, v64, v65
    v_add_f32 v118, v118, v66
    v_add_f32 v118, v118, v67
    v_add_f32 v119, v68, v69
    v_add_f32 v119, v119, v70
    v_add_f32 v119, v119, v71
    v_add_f32 v118, v118, v72
    v_add_f32 v118, v118, v73
    v_add_f32 v118, v118, v74
    v_add_f32 v118, v118, v75
    v_add_f32 v119, v119, v76
    v_add_f32 v119, v119, v77
    v_add_f32 v119, v119, v78
    v_add_f32 v119, v119, v79
    v_cvt_pk_bf16_f32 v16, v64, v65
    v_cvt_pk_bf16_f32 v17, v66, v67
    v_cvt_pk_bf16_f32 v20, v68, v69
    v_cvt_pk_bf16_f32 v21, v70, v71
    v_cvt_pk_bf16_f32 v18, v72, v73
    v_cvt_pk_bf16_f32 v19, v74, v75
    v_cvt_pk_bf16_f32 v22, v76, v77
    v_cvt_pk_bf16_f32 v23, v78, v79
    v_exp_f32 v64, v48
    v_exp_f32 v65, v49
    v_exp_f32 v66, v50
    v_exp_f32 v67, v51
    v_exp_f32 v68, v52
    v_exp_f32 v69, v53
    v_exp_f32 v70, v54
    v_exp_f32 v71, v55
    v_exp_f32 v72, v56
    v_exp_f32 v73, v57
    v_exp_f32 v74, v58
    v_exp_f32 v75, v59
    v_exp_f32 v76, v60
    v_exp_f32 v77, v61
    v_exp_f32 v78, v62
    v_exp_f32 v79, v63
    v_add_f32 v118, v118, v64
    v_add_f32 v118, v118, v65
    v_add_f32 v118, v118, v66
    v_add_f32 v118, v118, v67
    v_add_f32 v119, v119, v68
    v_add_f32 v119, v119, v69
    v_add_f32 v119, v119, v70
    v_add_f32 v119, v119, v71
    v_add_f32 v118, v118, v72
    v_add_f32 v118, v118, v73
    v_add_f32 v118, v118, v74
    v_add_f32 v118, v118, v75
    v_add_f32 v119, v119, v76
    v_add_f32 v119, v119, v77
    v_add_f32 v119, v119, v78
    v_add_f32 v119, v119, v79
    s_nop 1
    s_branch back_t61
slow_t63:
    s_nop 15
    v_max_f32 v104, v80, v81
    v_max_f32 v105, v84, v85
    v_max3_f32 v104, v104, v82, v83
    v_max3_f32 v105, v105, v86, v87
    v_max3_f32 v104, v104, v88, v89
    v_max3_f32 v105, v105, v92, v93
    v_max3_f32 v104, v104, v90, v91
    v_max3_f32 v105, v105, v94, v95
    v_max3_f32 v104, v104, v48, v49
    v_max3_f32 v105, v105, v52, v53
    v_max3_f32 v104, v104, v50, v51
    v_max3_f32 v105, v105, v54, v55
    v_max3_f32 v104, v104, v56, v57
    v_max3_f32 v105, v105, v60, v61
    v_max3_f32 v104, v104, v58, v59
    v_max3_f32 v105, v105, v62, v63
    v_mov_b32 v106, v104
    v_mov_b32 v107, v105
    s_nop 0
    v_permlane32_swap_b32 v104, v106
    v_permlane32_swap_b32 v105, v107
    v_max_f32 v104, v104, v106
    v_max_f32 v105, v105, v107
    v_mov_b32 v106, v104
    v_mov_b32 v107, v105
    s_nop 0
    v_permlane16_swap_b32 v104, v106
    v_permlane16_swap_b32 v105, v107
    v_max3_f32 v104, v104, v106, 0
    v_max3_f32 v105, v105, v107, 0
    v_ceil_f32 v104, v104
    v_ceil_f32 v105, v105
    v_sub_f32 v106, 0, v104
    v_sub_f32 v107, 0, v105
    v_exp_f32 v106, v106
    v_exp_f32 v107, v107
    v_sub_f32 v96, v96, v104
    v_sub_f32 v97, v97, v104
    v_sub_f32 v98, v98, v104
    v_sub_f32 v99, v99, v104
    v_sub_f32 v100, v100, v105
    v_sub_f32 v101, v101, v105
    v_sub_f32 v102, v102, v105
    v_sub_f32 v103, v103, v105
    v_sub_f32 v80, v80, v104
    v_sub_f32 v81, v81, v104
    v_sub_f32 v82, v82, v104
    v_sub_f32 v83, v83, v104
    v_sub_f32 v84, v84, v105
    v_sub_f32 v85, v85, v105
    v_sub_f32 v86, v86, v105
    v_sub_f32 v87, v87, v105
    v_sub_f32 v88, v88, v104
    v_sub_f32 v89, v89, v104
    v_sub_f32 v90, v90, v104
    v_sub_f32 v91, v91, v104
    v_sub_f32 v92, v92, v105
    v_sub_f32 v93, v93, v105
    v_sub_f32 v94, v94, v105
    v_sub_f32 v95, v95, v105
    v_sub_f32 v48, v48, v104
    v_sub_f32 v49, v49, v104
    v_sub_f32 v50, v50, v104
    v_sub_f32 v51, v51, v104
    v_sub_f32 v52, v52, v105
    v_sub_f32 v53, v53, v105
    v_sub_f32 v54, v54, v105
    v_sub_f32 v55, v55, v105
    v_sub_f32 v56, v56, v104
    v_sub_f32 v57, v57, v104
    v_sub_f32 v58, v58, v104
    v_sub_f32 v59, v59, v104
    v_sub_f32 v60, v60, v105
    v_sub_f32 v61, v61, v105
    v_sub_f32 v62, v62, v105
    v_sub_f32 v63, v63, v105
    v_mul_f32 v116, v116, v106
    v_mul_f32 v117, v117, v107
    v_mul_f32 v128, v128, v106
    v_mul_f32 v129, v129, v106
    v_mul_f32 v130, v130, v106
    v_mul_f32 v131, v131, v106
    v_mul_f32 v132, v132, v107
    v_mul_f32 v133, v133, v107
    v_mul_f32 v134, v134, v107
    v_mul_f32 v135, v135, v107
    v_mul_f32 v136, v136, v106
    v_mul_f32 v137, v137, v106
    v_mul_f32 v138, v138, v106
    v_mul_f32 v139, v139, v106
    v_mul_f32 v140, v140, v107
    v_mul_f32 v141, v141, v107
    v_mul_f32 v142, v142, v107
    v_mul_f32 v143, v143, v107
    v_mul_f32 v144, v144, v106
    v_mul_f32 v145, v145, v106
    v_mul_f32 v146, v146, v106
    v_mul_f32 v147, v147, v106
    v_mul_f32 v148, v148, v107
    v_mul_f32 v149, v149, v107
    v_mul_f32 v150, v150, v107
    v_mul_f32 v151, v151, v107
    v_mul_f32 v152, v152, v106
    v_mul_f32 v153, v153, v106
    v_mul_f32 v154, v154, v106
    v_mul_f32 v155, v155, v106
    v_mul_f32 v156, v156, v107
    v_mul_f32 v157, v157, v107
    v_mul_f32 v158, v158, v107
    v_mul_f32 v159, v159, v107
    v_mul_f32 v160, v160, v106
    v_mul_f32 v161, v161, v106
    v_mul_f32 v162, v162, v106
    v_mul_f32 v163, v163, v106
    v_mul_f32 v164, v164, v107
    v_mul_f32 v165, v165, v107
    v_mul_f32 v166, v166, v107
    v_mul_f32 v167, v167, v107
    v_mul_f32 v168, v168, v106
    v_mul_f32 v169, v169, v106
    v_mul_f32 v170, v170, v106
    v_mul_f32 v171, v171, v106
    v_mul_f32 v172, v172, v107
    v_mul_f32 v173, v173, v107
    v_mul_f32 v174, v174, v107
    v_mul_f32 v175, v175, v107
    v_mul_f32 v176, v176, v106
    v_mul_f32 v177, v177, v106
    v_mul_f32 v178, v178, v106
    v_mul_f32 v179, v179, v106
    v_mul_f32 v180, v180, v107
    v_mul_f32 v181, v181, v107
    v_mul_f32 v182, v182, v107
    v_mul_f32 v183, v183, v107
    v_mul_f32 v184, v184, v106
    v_mul_f32 v185, v185, v106
    v_mul_f32 v186, v186, v106
    v_mul_f32 v187, v187, v106
    v_mul_f32 v188, v188, v107
    v_mul_f32 v189, v189, v107
    v_mul_f32 v190, v190, v107
    v_mul_f32 v191, v191, v107
    v_mul_f32 v192, v192, v106
    v_mul_f32 v193, v193, v106
    v_mul_f32 v194, v194, v106
    v_mul_f32 v195, v195, v106
    v_mul_f32 v196, v196, v107
    v_mul_f32 v197, v197, v107
    v_mul_f32 v198, v198, v107
    v_mul_f32 v199, v199, v107
    v_mul_f32 v200, v200, v106
    v_mul_f32 v201, v201, v106
    v_mul_f32 v202, v202, v106
    v_mul_f32 v203, v203, v106
    v_mul_f32 v204, v204, v107
    v_mul_f32 v205, v205, v107
    v_mul_f32 v206, v206, v107
    v_mul_f32 v207, v207, v107
    v_mul_f32 v208, v208, v106
    v_mul_f32 v209, v209, v106
    v_mul_f32 v210, v210, v106
    v_mul_f32 v211, v211, v106
    v_mul_f32 v212, v212, v107
    v_mul_f32 v213, v213, v107
    v_mul_f32 v214, v214, v107
    v_mul_f32 v215, v215, v107
    v_mul_f32 v216, v216, v106
    v_mul_f32 v217, v217, v106
    v_mul_f32 v218, v218, v106
    v_mul_f32 v219, v219, v106
    v_mul_f32 v220, v220, v107
    v_mul_f32 v221, v221, v107
    v_mul_f32 v222, v222, v107
    v_mul_f32 v223, v223, v107
    v_mul_f32 v224, v224, v106
    v_mul_f32 v225, v225, v106
    v_mul_f32 v226, v226, v106
    v_mul_f32 v227, v227, v106
    v_mul_f32 v228, v228, v107
    v_mul_f32 v229, v229, v107
    v_mul_f32 v230, v230, v107
    v_mul_f32 v231, v231, v107
    v_mul_f32 v232, v232, v106
    v_mul_f32 v233, v233, v106
    v_mul_f32 v234, v234, v106
    v_mul_f32 v235, v235, v106
    v_mul_f32 v236, v236, v107
    v_mul_f32 v237, v237, v107
    v_mul_f32 v238, v238, v107
    v_mul_f32 v239, v239, v107
    v_mul_f32 v240, v240, v106
    v_mul_f32 v241, v241, v106
    v_mul_f32 v242, v242, v106
    v_mul_f32 v243, v243, v106
    v_mul_f32 v244, v244, v107
    v_mul_f32 v245, v245, v107
    v_mul_f32 v246, v246, v107
    v_mul_f32 v247, v247, v107
    v_mul_f32 v248, v248, v106
    v_mul_f32 v249, v249, v106
    v_mul_f32 v250, v250, v106
    v_mul_f32 v251, v251, v106
    v_mul_f32 v252, v252, v107
    v_mul_f32 v253, v253, v107
    v_mul_f32 v254, v254, v107
    v_mul_f32 v255, v255, v107
    v_exp_f32 v64, v80
    v_exp_f32 v65, v81
    v_exp_f32 v66, v82
    v_exp_f32 v67, v83
    v_exp_f32 v68, v84
    v_exp_f32 v69, v85
    v_exp_f32 v70, v86
    v_exp_f32 v71, v87
    v_exp_f32 v72, v88
    v_exp_f32 v73, v89
    v_exp_f32 v74, v90
    v_exp_f32 v75, v91
    v_exp_f32 v76, v92
    v_exp_f32 v77, v93
    v_exp_f32 v78, v94
    v_exp_f32 v79, v95
    v_add_f32 v118, v64, v65
    v_add_f32 v118, v118, v66
    v_add_f32 v118, v118, v67
    v_add_f32 v119, v68, v69
    v_add_f32 v119, v119, v70
    v_add_f32 v119, v119, v71
    v_add_f32 v118, v118, v72
    v_add_f32 v118, v118, v73
    v_add_f32 v118, v118, v74
    v_add_f32 v118, v118, v75
    v_add_f32 v119, v119, v76
    v_add_f32 v119, v119, v77
    v_add_f32 v119, v119, v78
    v_add_f32 v119, v119, v79
    v_cvt_pk_bf16_f32 v32, v64, v65
    v_cvt_pk_bf16_f32 v33, v66, v67
    v_cvt_pk_bf16_f32 v36, v68, v69
    v_cvt_pk_bf16_f32 v37, v70, v71
    v_cvt_pk_bf16_f32 v34, v72, v73
    v_cvt_pk_bf16_f32 v35, v74, v75
    v_cvt_pk_bf16_f32 v38, v76, v77
    v_cvt_pk_bf16_f32 v39, v78, v79
    v_exp_f32 v64, v48
    v_exp_f32 v65, v49
    v_exp_f32 v66, v50
    v_exp_f32 v67, v51
    v_exp_f32 v68, v52
    v_exp_f32 v69, v53
    v_exp_f32 v70, v54
    v_exp_f32 v71, v55
    v_exp_f32 v72, v56
    v_exp_f32 v73, v57
    v_exp_f32 v74, v58
    v_exp_f32 v75, v59
    v_exp_f32 v76, v60
    v_exp_f32 v77, v61
    v_exp_f32 v78, v62
    v_exp_f32 v79, v63
    v_add_f32 v118, v118, v64
    v_add_f32 v118, v118, v65
    v_add_f32 v118, v118, v66
    v_add_f32 v118, v118, v67
    v_add_f32 v119, v119, v68
    v_add_f32 v119, v119, v69
    v_add_f32 v119, v119, v70
    v_add_f32 v119, v119, v71
    v_add_f32 v118, v118, v72
    v_add_f32 v118, v118, v73
    v_add_f32 v118, v118, v74
    v_add_f32 v118, v118, v75
    v_add_f32 v119, v119, v76
    v_add_f32 v119, v119, v77
    v_add_f32 v119, v119, v78
    v_add_f32 v119, v119, v79
    v_cvt_pk_bf16_f32 v40, v64, v65
    v_cvt_pk_bf16_f32 v41, v66, v67
    v_cvt_pk_bf16_f32 v44, v68, v69
    v_cvt_pk_bf16_f32 v45, v70, v71
    v_cvt_pk_bf16_f32 v42, v72, v73
    v_cvt_pk_bf16_f32 v43, v74, v75
    v_cvt_pk_bf16_f32 v46, v76, v77
    v_cvt_pk_bf16_f32 v47, v78, v79
    s_nop 1
    s_branch back_t63
spin_c:
    s_cmp_eq_u32 s62, 0
    s_cbranch_scc1 ok_c
    s_sub_u32 s62, s62, 1
    buffer_load_dword v15, v5, s[96:99], 0 offen sc1
    s_waitcnt vmcnt(0)
    v_cmp_gt_u32 vcc, 16, v15
    s_cbranch_vccnz spin_c
    s_branch ok_c
spin_f:
    s_cmp_eq_u32 s62, 0
    s_cbranch_scc1 ok_f
    s_sub_u32 s62, s62, 1
    buffer_load_dword v15, v7, s[32:35], 0 offen sc1
    s_waitcnt vmcnt(0)
    v_cmp_gt_u32 vcc, 1, v15
    s_cbranch_vccnz spin_f
    s_branch ok_f
spin_a:
    s_cmp_eq_u32 s62, 0
    s_cbranch_scc1 ok_a
    s_sub_u32 s62, s62, 1
    buffer_load_dword v15, v7, s[32:35], 0 offen sc1
    s_waitcnt vmcnt(0)
    v_cmp_gt_u32 vcc, s51, v15
    s_cbranch_vccnz spin_a
    s_branch ok_a
.section .rodata,"a"
.p2align 6
.amdhsa_kernel recurrent_scan__gqa_block_cached__glu_gated_bilinear__prompt_kernel
  .amdhsa_next_free_vgpr 512
  .amdhsa_next_free_sgpr 102
  .amdhsa_accum_offset 256
  .amdhsa_group_segment_fixed_size 0
  .amdhsa_kernarg_size 96
  .amdhsa_user_sgpr_count 2
  .amdhsa_user_sgpr_kernarg_segment_ptr 1
  .amdhsa_system_sgpr_workgroup_id_x 1
.end_amdhsa_kernel
```
